```python
import torch

def _softmax(x, axis=-1):
    return torch.softmax(x, dim=axis)
def _gelu(x):
    return torch.nn.functional.gelu(x, approximate="tanh")
def _silu(x):
    return torch.nn.functional.silu(x)
def _sigmoid(x):
    return torch.sigmoid(x)
def _layernorm(x, axis=-1, eps=1e-5):
    m = x.mean(dim=axis, keepdim=True)
    v = x.var(dim=axis, keepdim=True, unbiased=False)
    return (x - m) / torch.sqrt(v + eps)
def _scatter_add(tgt, idx, src, axis=0):
    return tgt.clone().index_add_(axis, idx, src)
def _segment_sum(src, seg, n):
    out = torch.zeros((n,) + src.shape[1:], dtype=src.dtype)
    return out.index_add_(0, seg, src)
def _pad(x, pw):
    flat = tuple(v for pair in reversed(pw) for v in pair)
    return torch.nn.functional.pad(x, flat)

kernel_name = 'gated_mix__softmax_full_mha__sliding_local_dilated__prompt'

def setup_inputs():

    _w = (lambda a: (lambda t: t.to(torch.bfloat16) if t.is_floating_point() else t)(torch.as_tensor(a)))
    def _A_setup():
        B, S, D = 1, 2048, 1024
        return {
            "x": _w((lambda *s: torch.randn(*s, dtype=torch.bfloat16) * 0.05)(B, S, D)),
            "wqkv": _w((lambda *s: torch.randn(*s, dtype=torch.bfloat16) * 0.8)(D, 3 * D)),
            "wo": _w((lambda *s: torch.randn(*s, dtype=torch.bfloat16) * 0.1)(D, D)),
        }
    _A_in = _A_setup()

    def _B_setup():
        B, S, D = 1, 2048, 1024
        return {
            "x": _w((lambda *s: torch.randn(*s, dtype=torch.bfloat16) * 0.05)(B, S, D)),
            "wqkv": _w((lambda *s: torch.randn(*s, dtype=torch.bfloat16) * 0.8)(D, 3 * D)),
            "wo": _w((lambda *s: torch.randn(*s, dtype=torch.bfloat16) * 0.05)(D, D)),
        }
    _B_in = _B_setup()

    return {
        "A_x": _A_in["x"],
        "A_wqkv": _A_in["wqkv"],
        "A_wo": _A_in["wo"],
        "B_x": _B_in["x"],
        "B_wqkv": _B_in["wqkv"],
        "B_wo": _B_in["wo"],
        "gate_w": _w((lambda *s: torch.randn(*s, dtype=torch.bfloat16) * 0.05)(1024) * 16.0),
    }

def reference(A_x, A_wqkv, A_wo, B_x, B_wqkv, B_wo, gate_w):
    def _A_ref(x, wqkv, wo):
        B, S, D = x.shape
        H = 32; Dh = D // H
        qkv = (lambda x, *d: x.permute(*d))((x @ wqkv).reshape(B, S, 3, H, Dh), 2, 0, 3, 1, 4)
        q, k, v = qkv[0], qkv[1], qkv[2]
        scale = Dh ** -0.5
        scores = torch.einsum("bhqd,bhkd->bhqk", q, k) * scale
        p = _softmax(scores, axis=-1)
        o = torch.einsum("bhqk,bhkd->bhqd", p, v)
        return (lambda x, *d: x.permute(*d))(o, 0, 2, 1, 3).reshape(B, S, D) @ wo

    def _B_ref(x, wqkv, wo):
        B, S, D = x.shape
        H = 32; Dh = D // H
        W, dil = 8, 2
        qkv = (lambda x, *d: x.permute(*d))((x @ wqkv).reshape(B, S, 3, H, Dh), 2, 0, 3, 1, 4)
        q, k, v = qkv[0], qkv[1], qkv[2]
        scale = Dh ** -0.5
        pos = torch.arange(S)
        off = torch.arange(W) * dil
        idx = pos[:, None] - off[None, :]
        mask = idx >= 0
        idx_c = torch.where(mask, idx, 0).reshape(-1)
        kg = k[:, :, idx_c, :].reshape(B, H, S, W, Dh)
        vg = v[:, :, idx_c, :].reshape(B, H, S, W, Dh)
        logits = torch.einsum("bhsd,bhswd->bhsw", q, kg) * scale
        logits = torch.where(mask[None, None, :, :], logits, -1e9)
        attn = _softmax(logits, axis=-1)
        o = torch.einsum("bhsw,bhswd->bhsd", attn, vg)
        return (lambda x, *d: x.permute(*d))(o, 0, 2, 1, 3).reshape(B, S, D) @ wo

    x = A_x
    g = _sigmoid((x * gate_w).sum(-1, keepdims=True))
    a = _A_ref(x, A_wqkv, A_wo)
    b = _B_ref(x, B_wqkv, B_wo)
    return g * a + (1 - g) * b
```

```asm
; @launch grid=(256,1,1) block=(256,1,1) lds=163840
.amdgcn_target "amdgcn-amd-amdhsa--gfx950"
.text
.globl gated_mix__softmax_full_mha__sliding_local_dilated__prompt_kernel
.p2align 8
.type gated_mix__softmax_full_mha__sliding_local_dilated__prompt_kernel,@function
gated_mix__softmax_full_mha__sliding_local_dilated__prompt_kernel:
L_START:
    s_cmp_ge_u32 s2, 256
    s_cbranch_scc1 L_END
    s_load_dwordx4 s[48:51], s[0:1], 0
    s_load_dwordx2 s[52:53], s[0:1], 32
    s_load_dwordx2 s[54:55], s[0:1], 72
    s_load_dwordx2 s[70:71], s[0:1], 16
    s_load_dwordx4 s[72:75], s[0:1], 40
    s_load_dwordx4 s[76:79], s[0:1], 56
    s_getpc_b64 s[56:57]
L_PC0:
    s_lshr_b32 s35, s2, 3
    s_mul_i32 s35, s35, 20
    v_min_u32 v2, 19, v0
    v_add_u32 v2, s35, v2
    v_lshlrev_b32 v2, 7, v2
    v_min_u32 v2, L_END - L_PC0, v2
    global_load_dword v28, v2, s[56:57]
    v_lshrrev_b32 v19, 6, v0
    v_and_b32 v1, 63, v0
    s_and_b32 s37, s2, 3
    v_readfirstlane_b32 s20, v19
    s_bfe_u32 s39, s2, 0x10002
    s_lshr_b32 s35, s2, 3
    s_and_b32 s38, s35, 3
    s_lshl2_add_u32 s21, s37, s38
    s_lshr_b32 s38, s35, 2
    s_lshl3_add_u32 s22, s39, s38
    s_and_b32 s23, s20, 1
    s_lshl_b32 s38, s37, 5
    s_add_u32 s38, s38, s35
    s_lshl_b32 s38, s38, 14
    s_lshl_b32 s47, s39, 21
    s_add_u32 s38, s38, s47
    s_lshl_b32 s39, s39, 5
    s_add_u32 s39, s39, s35
    s_mul_i32 s39, s39, 6144
    s_lshl_b32 s47, s37, 9
    s_add_u32 s39, s39, s47
    s_mov_b32 s46, 393216
    s_cmp_eq_u32 s20, 0
    s_cselect_b32 s39, s38, s39
    s_cselect_b32 s46, 128, s46
    s_cselect_b32 s38, 7, 11
    s_cselect_b32 s47, 0, 2
    s_cselect_b32 s36, 0, 3
    s_cmp_eq_u32 s20, 3
    s_cselect_b32 s46, 0, s46
    s_cselect_b32 s38, 0, s38
    v_min_u32 v21, s38, v1
    v_and_b32 v22, s36, v21
    v_lshrrev_b32 v21, s47, v21
    v_lshlrev_b32 v22, 7, v22
    v_lshl_add_u32 v21, v21, 11, v22
    v_add_u32 v27, s39, v21
    v_lshrrev_b32 v19, 3, v1
    v_and_b32 v20, 7, v1
    v_lshrrev_b32 v21, 1, v19
    v_xor_b32 v21, v21, v20
    v_lshlrev_b32 v22, 11, v19
    v_lshl_add_u32 v21, v21, 4, v22
    s_lshl2_add_u32 s36, s22, s20
    s_lshl_b32 s36, s36, 16
    v_add_u32 v15, s36, v21
    v_xor_b32 v16, 64, v15
    v_add_u32 v16, 16384, v16
    v_add_u32 v17, 32768, v15
    v_add_u32 v18, 32768, v16
    s_lshl_b32 s30, s20, 12
    s_waitcnt lgkmcnt(0)
    s_cmp_eq_u32 s20, 0
    s_cselect_b64 s[44:45], s[48:49], s[50:51]
    s_cmp_eq_u32 s20, 2
    s_cselect_b64 s[44:45], s[52:53], s[44:45]
    global_load_dword v28, v27, s[44:45]
    v_add_u32 v27, s46, v27
    global_load_dword v28, v27, s[44:45]
    v_add_u32 v27, s46, v27
    s_add_u32 m0, s30, 0
    v_and_b32 v21, 2, v19
    global_load_lds_dwordx4 v15, s[48:49]
    v_add_u32 v15, 128, v15
    s_lshl_b32 s36, s23, 2
    v_xor_b32 v21, v21, v20
    v_xor_b32 v21, s36, v21
    s_add_u32 m0, s30, 1024
    v_mul_u32_u24 v22, 6144, v19
    global_load_lds_dwordx4 v16, s[48:49]
    v_add_u32 v16, 128, v16
    v_lshl_add_u32 v21, v21, 4, v22
    s_mul_i32 s36, s20, 49152
    s_lshl_b32 s37, s21, 7
    s_add_u32 m0, s30, 2048
    s_add_u32 s36, s36, s37
    global_load_lds_dwordx4 v17, s[48:49]
    v_add_u32 v17, 128, v17
    v_add_u32 v12, s36, v21
    v_add_u32 v13, 2048, v12
    s_add_u32 m0, s30, 3072
    v_add_u32 v14, 4096, v12
    global_load_lds_dwordx4 v18, s[48:49]
    v_add_u32 v18, 128, v18
    s_lshl_b32 s34, s20, 10
    s_lshr_b32 s24, s20, 1
    s_add_u32 m0, s34, 49152
    s_mov_b32 s16, s54
    global_load_lds_dwordx4 v12, s[50:51]
    s_and_b32 s17, s55, 0xffff
    s_mov_b32 s18, 0x10000000
    s_mov_b32 s19, 0x20000
    s_mov_b32 s40, s56
    s_and_b32 s41, s57, 0xffff
    s_mov_b32 s42, L_END - L_PC0
    s_mov_b32 s43, 0x20000
    s_mov_b32 s4, s48
    s_and_b32 s5, s49, 0xffff
    s_mov_b32 s6, 4194304
    s_mov_b32 s7, 0x20000
    s_mul_i32 s47, s35, 20
    v_min_u32 v26, 19, v1
    v_add_u32 v26, s47, v26
    v_lshlrev_b32 v26, 7, v26
    v_and_b32 v19, 15, v1
    v_lshrrev_b32 v20, 4, v1
    v_lshrrev_b32 v21, 1, v19
    s_add_u32 m0, s34, 53248
    v_xor_b32 v21, v21, v20
    global_load_lds_dwordx4 v13, s[50:51]
    v_lshlrev_b32 v21, 4, v21
    v_lshl_add_u32 v21, v19, 7, v21
    s_lshl_b32 s36, s23, 13
    v_add_u32 v2, s36, v21
    v_xor_b32 v3, 64, v2
    v_lshrrev_b32 v21, 2, v19
    v_lshl_add_u32 v23, v20, 3, v21
    v_lshrrev_b32 v21, 3, v19
    v_and_b32 v22, 1, v20
    v_lshl_or_b32 v21, v22, 1, v21
    s_lshl_b32 s36, s24, 1
    v_xor_b32 v21, s36, v21
    v_lshlrev_b32 v21, 5, v21
    v_lshl_add_u32 v21, v23, 7, v21
    v_and_b32 v22, 3, v19
    v_lshl_add_u32 v21, v22, 3, v21
    v_add_u32 v4, 49152, v21
    v_xor_b32 v5, 32, v4
    s_add_u32 m0, s34, 57344
    v_add_u32 v10, 49152, v4
    global_load_lds_dwordx4 v14, s[50:51]
    v_add_u32 v11, 49152, v5
    v_lshlrev_b32 v29, 4, v1
    v_and_b32 v19, 15, v1
    v_add_u32 v19, 2, v19
    v_mov_b32 v21, 0x5555
    v_lshlrev_b32 v19, v19, v21
    v_lshrrev_b32 v20, 4, v1
    v_lshlrev_b32 v20, 2, v20
    v_lshrrev_b32 v19, v20, v19
    v_not_b32 v19, v19
    s_mov_b32 s36, 4048155338
    v_bfe_i32 v32, v19, 0, 1
    v_and_b32 v32, s36, v32
    v_bfe_i32 v33, v19, 1, 1
    v_and_b32 v33, s36, v33
    v_bfe_i32 v34, v19, 2, 1
    v_and_b32 v34, s36, v34
    v_bfe_i32 v35, v19, 3, 1
    s_add_u32 m0, s34, 61440
    v_and_b32 v35, s36, v35
    global_load_lds_dwordx4 v12, s[52:53]
    v_add_u32 v12, 196608, v12
    v_bfe_i32 v36, v19, 16, 1
    v_and_b32 v36, s36, v36
    v_bfe_i32 v37, v19, 17, 1
    v_and_b32 v37, s36, v37
    v_bfe_i32 v38, v19, 18, 1
    v_and_b32 v38, s36, v38
    v_bfe_i32 v39, v19, 19, 1
    v_and_b32 v39, s36, v39
    v_mov_b32 v19, 0x3f803f80
    v_accvgpr_write_b32 a112, v19
    v_accvgpr_write_b32 a113, v19
    v_accvgpr_write_b32 a114, v19
    v_accvgpr_write_b32 a115, v19
    v_lshrrev_b32 v19, 1, v1
    v_xor_b32 v19, v19, v1
    v_and_b32 v19, 4, v19
    v_lshl_or_b32 v19, v19, 1, v19
    v_xor_b32 v19, v19, v1
    s_add_u32 m0, s34, 65536
    v_lshlrev_b32 v56, 4, v19
    global_load_lds_dwordx4 v13, s[52:53]
    v_add_u32 v13, 196608, v13
    v_min_u32 v31, 1, v1
    v_lshlrev_b32 v31, 31, v31
    s_mov_b32 s61, 1048744942
    s_mov_b32 s62, 1048744942
    s_mov_b32 s63, 1048744942
    s_lshl_b32 s36, s21, 19
    s_lshl_b32 s37, s20, 13
    s_lshl_b32 s38, s24, 14
    s_lshl_b32 s39, s23, 13
    s_add_u32 s27, s38, s39
    s_add_u32 s81, s36, s27
    s_lshl_b32 s82, s22, 15
    s_add_u32 s80, s81, s82
    s_and_b32 s82, s22, 7
    s_and_b32 s3, s22, 8
    s_add_u32 s36, s38, 98304
    v_add_u32 v6, s36, v29
    v_add_u32 v7, 32768, v6
    s_add_u32 m0, s34, 69632
    s_lshl_b32 s97, s21, 1
    global_load_lds_dwordx4 v14, s[52:53]
    v_add_u32 v14, 196608, v14
    s_add_u32 s97, s97, s24
    s_lshl_b32 s94, s22, 1
    s_add_u32 s94, s94, s23
    s_lshl_b32 s37, s94, 6
    s_add_u32 s37, s37, s97
    s_lshl_b32 s86, s37, 11
    s_lshl_b32 s38, s97, 5
    s_add_u32 s38, s38, s94
    s_lshl_b32 s28, s38, 2
    s_lshl_b32 s38, s38, 12
    s_add_u32 s93, s38, 16777216
    s_mov_b32 s83, 0
    s_add_u32 s84, s54, s81
    s_addc_u32 s85, s55, 0
    s_lshl_b32 s36, s2, 2
    s_add_u32 s36, s36, s20
    s_lshl_b32 s36, s36, 11
    v_and_b32 v24, 15, v1
    v_lshlrev_b32 v24, 7, v24
    s_add_u32 m0, s34, 73728
    v_add_u32 v60, s36, v24
    global_load_lds_dwordx4 v12, s[50:51]
    s_lshr_b32 s36, s2, 3
    s_lshl_b32 s36, s36, 2
    s_add_u32 s36, s36, s20
    s_lshl_b32 s36, s36, 14
    v_add_u32 v0, s36, v24
    s_lshl_b32 s36, s94, 6
    s_lshl_b32 s37, s97, 1
    s_add_u32 s36, s36, s37
    v_lshrrev_b32 v9, 5, v1
    v_add_u32 v8, s36, v9
    v_and_b32 v25, 31, v1
    v_lshlrev_b32 v25, 4, v25
    v_lshl_add_u32 v9, v8, 11, v25
    s_mov_b32 s56, s74
    s_and_b32 s57, s75, 0xffff
    s_mov_b32 s58, 2048
    s_mov_b32 s59, 0x20000
    s_lshl_b32 s38, s21, 2
    s_add_u32 m0, s34, 77824
    s_add_u32 s38, s38, s20
    global_load_lds_dwordx4 v13, s[50:51]
    s_lshl_b32 s38, s38, 6
    s_add_u32 s31, s38, 22020096
    s_lshl_b32 s38, s22, 2
    s_add_u32 s32, s31, s38
    s_add_u32 s33, s28, 22024188
    s_cmp_eq_u32 s94, 0
    s_cselect_b32 s38, 4, 0
    s_add_u32 s33, s33, s38
    s_mov_b32 s8, s72
    s_and_b32 s9, s73, 0xffff
    s_mov_b32 s10, 2097152
    s_mov_b32 s11, 0x20000
    s_mov_b32 s12, s76
    s_and_b32 s13, s77, 0xffff
    s_mov_b32 s14, 4194304
    s_mov_b32 s15, 0x20000
    s_and_b32 s36, s2, 7
    s_lshr_b32 s37, s2, 3
    s_and_b32 s89, s37, 15
    s_add_u32 m0, s34, 81920
    s_lshr_b32 s37, s37, 4
    global_load_lds_dwordx4 v14, s[50:51]
    s_lshl_b32 s36, s36, 1
    s_add_u32 s88, s36, s37
    v_lshrrev_b32 v80, 3, v1
    v_and_b32 v81, 7, v1
    s_lshl_b32 s36, s20, 14
    s_lshl_b32 s37, s89, 7
    s_add_u32 s37, s36, s37
    v_lshlrev_b32 v83, 11, v80
    v_add_u32 v83, s37, v83
    v_and_b32 v82, 6, v80
    v_xor_b32 v82, v82, v81
    v_lshl_add_u32 v64, v82, 4, v83
    v_and_b32 v82, 2, v80
    s_lshl_b32 s36, s24, 2
    v_xor_b32 v82, v82, v81
    v_xor_b32 v82, s36, v82
    v_lshl_add_u32 v65, v82, 4, v83
    v_lshrrev_b32 v81, 2, v1
    s_add_u32 m0, s34, 86016
    v_and_b32 v82, 6, v81
    global_load_lds_dwordx4 v12, s[52:53]
    v_add_u32 v12, 196608, v12
    v_lshlrev_b32 v82, 4, v82
    v_lshl_add_u32 v82, v81, 7, v82
    v_and_b32 v83, 3, v1
    v_lshl_add_u32 v66, v83, 3, v82
    v_xor_b32 v67, 32, v66
    v_xor_b32 v68, 64, v66
    v_xor_b32 v69, 96, v66
    s_lshl_b32 s36, s88, 2
    s_add_u32 s36, s36, s20
    s_lshl_b32 s96, s36, 16
    s_lshr_b32 s36, s36, 1
    s_lshl_b32 s29, s36, 7
    s_lshr_b32 s36, s89, 1
    s_lshl_b32 s90, s36, 13
    s_lshl_b32 s91, s36, 18
    v_and_b32 v70, 31, v1
    v_lshlrev_b32 v70, 2, v70
    v_and_b32 v71, 15, v1
    s_add_u32 m0, s34, 90112
    v_cmp_le_u32 vcc, s82, v71
    v_add_u32 v71, s3, v71
    s_nop 0
    v_addc_co_u32 v71, vcc, 0, v71, vcc
    global_load_lds_dwordx4 v13, s[52:53]
    v_add_u32 v13, 196608, v13
    v_and_b32 v71, 15, v71
    v_lshlrev_b32 v71, 2, v71
    s_lshl_b32 s36, s2, 2
    s_add_u32 s36, s36, s20
    s_lshl_b32 s36, s36, 11
    v_and_b32 v72, 7, v1
    v_lshlrev_b32 v72, 7, v72
    v_add_u32 v72, s36, v72
    s_add_u32 s36, s96, 12582912
    s_add_u32 s100, s54, s36
    s_addc_u32 s101, s55, 0
    v_accvgpr_write_b32 a116, v64
    v_accvgpr_write_b32 a117, v65
    v_accvgpr_write_b32 a118, v66
    v_accvgpr_write_b32 a119, v67
    v_accvgpr_write_b32 a120, v68
    v_accvgpr_write_b32 a121, v69
    v_accvgpr_write_b32 a122, v70
    v_accvgpr_write_b32 a123, v71
    s_add_u32 m0, s34, 94208
    v_accvgpr_write_b32 a124, v72
    global_load_lds_dwordx4 v14, s[52:53]
    v_add_u32 v14, 196608, v14
    v_lshrrev_b32 v64, 1, v1
    v_and_b32 v64, 3, v64
    v_min_u32 v65, 1, v64
    v_add_u32 v65, -1, v65
    v_and_b32 v65, 0x3f803f80, v65
    v_accvgpr_write_b32 a125, v65
    v_xor_b32 v64, 2, v64
    v_min_u32 v65, 1, v64
    v_add_u32 v65, -1, v65
    v_and_b32 v65, 0x3f803f80, v65
    v_accvgpr_write_b32 a126, v65
    v_and_b32 v65, 1, v1
    v_mul_u32_u24 v65, 0xaaaa, v65
    v_add_u32 v65, 0x4444, v65
    v_accvgpr_write_b32 a127, v65
    s_or_b32 s36, s2, s20
    s_cmp_lg_u32 s36, 0
    s_cbranch_scc1 L_NONONCE
    s_memrealtime s[36:37]
    v_mov_b32 v20, 0
    s_waitcnt lgkmcnt(0)
    s_or_b32 s36, s36, 1
    v_mov_b32 v19, s36
    global_store_dword v20, v19, s[78:79] sc1
L_NONONCE:
    s_waitcnt vmcnt(6)
    s_barrier
    ds_read_b128 a[0:3], v2 offset:0
    ds_read_b128 a[4:7], v2 offset:2048
    ds_read_b128 a[8:11], v2 offset:4096
    ds_read_b128 a[12:15], v2 offset:6144
    ds_read_b64_tr_b16 a[32:33], v4 offset:0
    ds_read_b64_tr_b16 a[34:35], v4 offset:512
    ds_read_b64_tr_b16 a[36:37], v5 offset:0
    ds_read_b64_tr_b16 a[38:39], v5 offset:512
    ds_read_b64_tr_b16 a[40:41], v4 offset:4096
    ds_read_b64_tr_b16 a[42:43], v4 offset:4608
    ds_read_b64_tr_b16 a[44:45], v5 offset:4096
    ds_read_b64_tr_b16 a[46:47], v5 offset:4608
    ds_read_b64_tr_b16 a[48:49], v4 offset:8192
    ds_read_b64_tr_b16 a[50:51], v4 offset:8704
    ds_read_b64_tr_b16 a[52:53], v5 offset:8192
    ds_read_b64_tr_b16 a[54:55], v5 offset:8704
    s_waitcnt lgkmcnt(0)
    v_mfma_f32_16x16x32_bf16 v[64:67], a[32:35], a[0:3], 0
    ds_read_b64_tr_b16 a[56:57], v4 offset:12288
    v_mfma_f32_16x16x32_bf16 v[68:71], a[32:35], a[4:7], 0
    ds_read_b64_tr_b16 a[58:59], v4 offset:12800
    v_mfma_f32_16x16x32_bf16 v[80:83], a[32:35], a[8:11], 0
    ds_read_b64_tr_b16 a[60:61], v5 offset:12288
    v_mfma_f32_16x16x32_bf16 v[84:87], a[32:35], a[12:15], 0
    ds_read_b64_tr_b16 a[62:63], v5 offset:12800
    v_mfma_f32_16x16x32_bf16 v[72:75], a[36:39], a[0:3], 0
    ds_read_b64_tr_b16 a[64:65], v4 offset:16384
    v_mfma_f32_16x16x32_bf16 v[76:79], a[36:39], a[4:7], 0
    ds_read_b64_tr_b16 a[66:67], v4 offset:16896
    v_mfma_f32_16x16x32_bf16 v[88:91], a[36:39], a[8:11], 0
    ds_read_b64_tr_b16 a[68:69], v5 offset:16384
    v_mfma_f32_16x16x32_bf16 v[92:95], a[36:39], a[12:15], 0
    ds_read_b64_tr_b16 a[70:71], v5 offset:16896
    v_mfma_f32_16x16x32_bf16 v[96:99], a[40:43], a[0:3], 0
    ds_read_b64_tr_b16 a[72:73], v4 offset:20480
    v_mfma_f32_16x16x32_bf16 v[100:103], a[40:43], a[4:7], 0
    ds_read_b64_tr_b16 a[74:75], v4 offset:20992
    v_mfma_f32_16x16x32_bf16 v[112:115], a[40:43], a[8:11], 0
    ds_read_b64_tr_b16 a[76:77], v5 offset:20480
    v_mfma_f32_16x16x32_bf16 v[116:119], a[40:43], a[12:15], 0
    ds_read_b64_tr_b16 a[78:79], v5 offset:20992
    s_add_u32 m0, s30, 16384
    v_mfma_f32_16x16x32_bf16 v[104:107], a[44:47], a[0:3], 0
    global_load_lds_dwordx4 v15, s[48:49]
    v_add_u32 v15, 128, v15
    v_mfma_f32_16x16x32_bf16 v[108:111], a[44:47], a[4:7], 0
    s_add_u32 m0, s30, 17408
    v_mfma_f32_16x16x32_bf16 v[120:123], a[44:47], a[8:11], 0
    global_load_lds_dwordx4 v16, s[48:49]
    v_add_u32 v16, 128, v16
    v_mfma_f32_16x16x32_bf16 v[124:127], a[44:47], a[12:15], 0
    s_add_u32 m0, s30, 18432
    v_mfma_f32_16x16x32_bf16 v[128:131], a[0:3], a[48:51], 0
    global_load_lds_dwordx4 v17, s[48:49]
    v_add_u32 v17, 128, v17
    v_mfma_f32_16x16x32_bf16 v[136:139], a[4:7], a[48:51], 0
    s_add_u32 m0, s30, 19456
    v_mfma_f32_16x16x32_bf16 v[144:147], a[8:11], a[48:51], 0
    global_load_lds_dwordx4 v18, s[48:49]
    v_add_u32 v18, 128, v18
    v_mfma_f32_16x16x32_bf16 v[152:155], a[12:15], a[48:51], 0
    s_add_u32 m0, s34, 98304
    v_mfma_f32_16x16x32_bf16 v[132:135], a[0:3], a[52:55], 0
    global_load_lds_dwordx4 v12, s[50:51]
    v_mfma_f32_16x16x32_bf16 v[140:143], a[4:7], a[52:55], 0
    s_add_u32 m0, s34, 102400
    v_mfma_f32_16x16x32_bf16 v[148:151], a[8:11], a[52:55], 0
    global_load_lds_dwordx4 v13, s[50:51]
    v_mfma_f32_16x16x32_bf16 v[156:159], a[12:15], a[52:55], 0
    global_load_dword v28, v27, s[44:45]
    v_add_u32 v27, s46, v27
    s_waitcnt vmcnt(7) lgkmcnt(0)
    s_barrier
    v_mfma_f32_16x16x32_bf16 v[160:163], a[56:59], a[0:3], 0
    ds_read_b128 a[16:19], v3 offset:0
    v_mfma_f32_16x16x32_bf16 v[168:171], a[56:59], a[4:7], 0
    ds_read_b128 a[20:23], v3 offset:2048
    v_mfma_f32_16x16x32_bf16 v[176:179], a[56:59], a[8:11], 0
    ds_read_b128 a[24:27], v3 offset:4096
    v_mfma_f32_16x16x32_bf16 v[184:187], a[56:59], a[12:15], 0
    ds_read_b128 a[28:31], v3 offset:6144
    v_mfma_f32_16x16x32_bf16 v[164:167], a[60:63], a[0:3], 0
    ds_read_b64_tr_b16 a[32:33], v4 offset:24576
    v_mfma_f32_16x16x32_bf16 v[172:175], a[60:63], a[4:7], 0
    ds_read_b64_tr_b16 a[34:35], v4 offset:25088
    v_mfma_f32_16x16x32_bf16 v[180:183], a[60:63], a[8:11], 0
    ds_read_b64_tr_b16 a[36:37], v5 offset:24576
    v_mfma_f32_16x16x32_bf16 v[188:191], a[60:63], a[12:15], 0
    ds_read_b64_tr_b16 a[38:39], v5 offset:25088
    v_mfma_f32_16x16x32_bf16 v[192:195], a[64:67], a[0:3], 0
    ds_read_b64_tr_b16 a[40:41], v4 offset:28672
    v_mfma_f32_16x16x32_bf16 v[200:203], a[64:67], a[4:7], 0
    ds_read_b64_tr_b16 a[42:43], v4 offset:29184
    v_mfma_f32_16x16x32_bf16 v[208:211], a[64:67], a[8:11], 0
    ds_read_b64_tr_b16 a[44:45], v5 offset:28672
    v_mfma_f32_16x16x32_bf16 v[216:219], a[64:67], a[12:15], 0
    ds_read_b64_tr_b16 a[46:47], v5 offset:29184
    v_mfma_f32_16x16x32_bf16 v[196:199], a[68:71], a[0:3], 0
    ds_read_b64_tr_b16 a[48:49], v4 offset:32768
    s_add_u32 m0, s34, 106496
    v_mfma_f32_16x16x32_bf16 v[204:207], a[68:71], a[4:7], 0
    global_load_lds_dwordx4 v14, s[50:51]
    ds_read_b64_tr_b16 a[50:51], v4 offset:33280
    v_mfma_f32_16x16x32_bf16 v[212:215], a[68:71], a[8:11], 0
    ds_read_b64_tr_b16 a[52:53], v5 offset:32768
    s_add_u32 m0, s34, 110592
    v_mfma_f32_16x16x32_bf16 v[220:223], a[68:71], a[12:15], 0
    global_load_lds_dwordx4 v12, s[52:53]
    ds_read_b64_tr_b16 a[54:55], v5 offset:33280
    v_add_u32 v12, 196608, v12
    v_mfma_f32_16x16x32_bf16 v[224:227], a[0:3], a[72:75], 0
    s_add_u32 m0, s34, 114688
    v_mfma_f32_16x16x32_bf16 v[228:231], a[4:7], a[72:75], 0
    global_load_lds_dwordx4 v13, s[52:53]
    v_add_u32 v13, 196608, v13
    v_mfma_f32_16x16x32_bf16 v[240:243], a[8:11], a[72:75], 0
    s_add_u32 m0, s34, 118784
    v_mfma_f32_16x16x32_bf16 v[244:247], a[12:15], a[72:75], 0
    global_load_lds_dwordx4 v14, s[52:53]
    v_add_u32 v14, 196608, v14
    v_mfma_f32_16x16x32_bf16 v[232:235], a[0:3], a[76:79], 0
    s_add_u32 m0, s34, 122880
    v_mfma_f32_16x16x32_bf16 v[236:239], a[4:7], a[76:79], 0
    global_load_lds_dwordx4 v12, s[50:51]
    v_mfma_f32_16x16x32_bf16 v[248:251], a[8:11], a[76:79], 0
    s_add_u32 m0, s34, 126976
    v_mfma_f32_16x16x32_bf16 v[252:255], a[12:15], a[76:79], 0
    global_load_lds_dwordx4 v13, s[50:51]
    s_waitcnt lgkmcnt(8)
    v_mfma_f32_16x16x32_bf16 v[64:67], a[32:35], a[16:19], v[64:67]
    ds_read_b64_tr_b16 a[56:57], v4 offset:36864
    v_mfma_f32_16x16x32_bf16 v[68:71], a[32:35], a[20:23], v[68:71]
    ds_read_b64_tr_b16 a[58:59], v4 offset:37376
    v_mfma_f32_16x16x32_bf16 v[80:83], a[32:35], a[24:27], v[80:83]
    ds_read_b64_tr_b16 a[60:61], v5 offset:36864
    v_mfma_f32_16x16x32_bf16 v[84:87], a[32:35], a[28:31], v[84:87]
    ds_read_b64_tr_b16 a[62:63], v5 offset:37376
    v_mfma_f32_16x16x32_bf16 v[72:75], a[36:39], a[16:19], v[72:75]
    ds_read_b64_tr_b16 a[64:65], v4 offset:40960
    v_mfma_f32_16x16x32_bf16 v[76:79], a[36:39], a[20:23], v[76:79]
    ds_read_b64_tr_b16 a[66:67], v4 offset:41472
    v_mfma_f32_16x16x32_bf16 v[88:91], a[36:39], a[24:27], v[88:91]
    ds_read_b64_tr_b16 a[68:69], v5 offset:40960
    v_mfma_f32_16x16x32_bf16 v[92:95], a[36:39], a[28:31], v[92:95]
    ds_read_b64_tr_b16 a[70:71], v5 offset:41472
    s_waitcnt lgkmcnt(8)
    v_mfma_f32_16x16x32_bf16 v[96:99], a[40:43], a[16:19], v[96:99]
    ds_read_b64_tr_b16 a[72:73], v4 offset:45056
    v_mfma_f32_16x16x32_bf16 v[100:103], a[40:43], a[20:23], v[100:103]
    ds_read_b64_tr_b16 a[74:75], v4 offset:45568
    v_mfma_f32_16x16x32_bf16 v[112:115], a[40:43], a[24:27], v[112:115]
    ds_read_b64_tr_b16 a[76:77], v5 offset:45056
    v_mfma_f32_16x16x32_bf16 v[116:119], a[40:43], a[28:31], v[116:119]
    ds_read_b64_tr_b16 a[78:79], v5 offset:45568
    s_add_u32 m0, s34, 131072
    v_mfma_f32_16x16x32_bf16 v[104:107], a[44:47], a[16:19], v[104:107]
    global_load_lds_dwordx4 v14, s[50:51]
    v_mfma_f32_16x16x32_bf16 v[108:111], a[44:47], a[20:23], v[108:111]
    s_add_u32 m0, s34, 135168
    v_mfma_f32_16x16x32_bf16 v[120:123], a[44:47], a[24:27], v[120:123]
    global_load_lds_dwordx4 v12, s[52:53]
    v_add_u32 v12, 196608, v12
    v_mfma_f32_16x16x32_bf16 v[124:127], a[44:47], a[28:31], v[124:127]
    s_add_u32 m0, s34, 139264
    v_mfma_f32_16x16x32_bf16 v[128:131], a[16:19], a[48:51], v[128:131]
    global_load_lds_dwordx4 v13, s[52:53]
    v_add_u32 v13, 196608, v13
    v_mfma_f32_16x16x32_bf16 v[136:139], a[20:23], a[48:51], v[136:139]
    s_add_u32 m0, s34, 143360
    v_mfma_f32_16x16x32_bf16 v[144:147], a[24:27], a[48:51], v[144:147]
    global_load_lds_dwordx4 v14, s[52:53]
    v_add_u32 v14, 196608, v14
    v_mfma_f32_16x16x32_bf16 v[152:155], a[28:31], a[48:51], v[152:155]
    s_add_u32 m0, s34, 49152
    v_mfma_f32_16x16x32_bf16 v[132:135], a[16:19], a[52:55], v[132:135]
    global_load_lds_dwordx4 v12, s[50:51]
    v_mfma_f32_16x16x32_bf16 v[140:143], a[20:23], a[52:55], v[140:143]
    s_add_u32 m0, s34, 53248
    v_mfma_f32_16x16x32_bf16 v[148:151], a[24:27], a[52:55], v[148:151]
    global_load_lds_dwordx4 v13, s[50:51]
    v_mfma_f32_16x16x32_bf16 v[156:159], a[28:31], a[52:55], v[156:159]
    global_load_dword v28, v27, s[44:45]
    v_add_u32 v27, s46, v27
    s_waitcnt vmcnt(9) lgkmcnt(0)
    s_barrier
    v_mfma_f32_16x16x32_bf16 v[160:163], a[56:59], a[16:19], v[160:163]
    ds_read_b128 a[0:3], v2 offset:16384
    v_mfma_f32_16x16x32_bf16 v[168:171], a[56:59], a[20:23], v[168:171]
    ds_read_b128 a[4:7], v2 offset:18432
    v_mfma_f32_16x16x32_bf16 v[176:179], a[56:59], a[24:27], v[176:179]
    ds_read_b128 a[8:11], v2 offset:20480
    v_mfma_f32_16x16x32_bf16 v[184:187], a[56:59], a[28:31], v[184:187]
    ds_read_b128 a[12:15], v2 offset:22528
    v_mfma_f32_16x16x32_bf16 v[164:167], a[60:63], a[16:19], v[164:167]
    ds_read_b64_tr_b16 a[32:33], v10 offset:0
    v_mfma_f32_16x16x32_bf16 v[172:175], a[60:63], a[20:23], v[172:175]
    ds_read_b64_tr_b16 a[34:35], v10 offset:512
    v_mfma_f32_16x16x32_bf16 v[180:183], a[60:63], a[24:27], v[180:183]
    ds_read_b64_tr_b16 a[36:37], v11 offset:0
    v_mfma_f32_16x16x32_bf16 v[188:191], a[60:63], a[28:31], v[188:191]
    ds_read_b64_tr_b16 a[38:39], v11 offset:512
    v_mfma_f32_16x16x32_bf16 v[192:195], a[64:67], a[16:19], v[192:195]
    ds_read_b64_tr_b16 a[40:41], v10 offset:4096
    v_mfma_f32_16x16x32_bf16 v[200:203], a[64:67], a[20:23], v[200:203]
    ds_read_b64_tr_b16 a[42:43], v10 offset:4608
    v_mfma_f32_16x16x32_bf16 v[208:211], a[64:67], a[24:27], v[208:211]
    ds_read_b64_tr_b16 a[44:45], v11 offset:4096
    v_mfma_f32_16x16x32_bf16 v[216:219], a[64:67], a[28:31], v[216:219]
    ds_read_b64_tr_b16 a[46:47], v11 offset:4608
    v_mfma_f32_16x16x32_bf16 v[196:199], a[68:71], a[16:19], v[196:199]
    ds_read_b64_tr_b16 a[48:49], v10 offset:8192
    s_add_u32 m0, s30, 32768
    v_mfma_f32_16x16x32_bf16 v[204:207], a[68:71], a[20:23], v[204:207]
    global_load_lds_dwordx4 v15, s[48:49]
    ds_read_b64_tr_b16 a[50:51], v10 offset:8704
    v_add_u32 v15, 128, v15
    v_mfma_f32_16x16x32_bf16 v[212:215], a[68:71], a[24:27], v[212:215]
    ds_read_b64_tr_b16 a[52:53], v11 offset:8192
    s_add_u32 m0, s30, 33792
    v_mfma_f32_16x16x32_bf16 v[220:223], a[68:71], a[28:31], v[220:223]
    global_load_lds_dwordx4 v16, s[48:49]
    ds_read_b64_tr_b16 a[54:55], v11 offset:8704
    v_add_u32 v16, 128, v16
    v_mfma_f32_16x16x32_bf16 v[224:227], a[16:19], a[72:75], v[224:227]
    s_add_u32 m0, s30, 34816
    v_mfma_f32_16x16x32_bf16 v[228:231], a[20:23], a[72:75], v[228:231]
    global_load_lds_dwordx4 v17, s[48:49]
    v_add_u32 v17, 128, v17
    v_mfma_f32_16x16x32_bf16 v[240:243], a[24:27], a[72:75], v[240:243]
    s_add_u32 m0, s30, 35840
    v_mfma_f32_16x16x32_bf16 v[244:247], a[28:31], a[72:75], v[244:247]
    global_load_lds_dwordx4 v18, s[48:49]
    v_add_u32 v18, 128, v18
    v_mfma_f32_16x16x32_bf16 v[232:235], a[16:19], a[76:79], v[232:235]
    s_add_u32 m0, s34, 57344
    v_mfma_f32_16x16x32_bf16 v[236:239], a[20:23], a[76:79], v[236:239]
    global_load_lds_dwordx4 v14, s[50:51]
    v_mfma_f32_16x16x32_bf16 v[248:251], a[24:27], a[76:79], v[248:251]
    s_add_u32 m0, s34, 61440
    v_mfma_f32_16x16x32_bf16 v[252:255], a[28:31], a[76:79], v[252:255]
    global_load_lds_dwordx4 v12, s[52:53]
    v_add_u32 v12, 196608, v12
    s_waitcnt lgkmcnt(8)
    v_mfma_f32_16x16x32_bf16 v[64:67], a[32:35], a[0:3], v[64:67]
    ds_read_b64_tr_b16 a[56:57], v10 offset:12288
    v_mfma_f32_16x16x32_bf16 v[68:71], a[32:35], a[4:7], v[68:71]
    ds_read_b64_tr_b16 a[58:59], v10 offset:12800
    v_mfma_f32_16x16x32_bf16 v[80:83], a[32:35], a[8:11], v[80:83]
    ds_read_b64_tr_b16 a[60:61], v11 offset:12288
    v_mfma_f32_16x16x32_bf16 v[84:87], a[32:35], a[12:15], v[84:87]
    ds_read_b64_tr_b16 a[62:63], v11 offset:12800
    v_mfma_f32_16x16x32_bf16 v[72:75], a[36:39], a[0:3], v[72:75]
    ds_read_b64_tr_b16 a[64:65], v10 offset:16384
    v_mfma_f32_16x16x32_bf16 v[76:79], a[36:39], a[4:7], v[76:79]
    ds_read_b64_tr_b16 a[66:67], v10 offset:16896
    v_mfma_f32_16x16x32_bf16 v[88:91], a[36:39], a[8:11], v[88:91]
    ds_read_b64_tr_b16 a[68:69], v11 offset:16384
    v_mfma_f32_16x16x32_bf16 v[92:95], a[36:39], a[12:15], v[92:95]
    ds_read_b64_tr_b16 a[70:71], v11 offset:16896
    s_waitcnt lgkmcnt(8)
    v_mfma_f32_16x16x32_bf16 v[96:99], a[40:43], a[0:3], v[96:99]
    ds_read_b64_tr_b16 a[72:73], v10 offset:20480
    v_mfma_f32_16x16x32_bf16 v[100:103], a[40:43], a[4:7], v[100:103]
    ds_read_b64_tr_b16 a[74:75], v10 offset:20992
    v_mfma_f32_16x16x32_bf16 v[112:115], a[40:43], a[8:11], v[112:115]
    ds_read_b64_tr_b16 a[76:77], v11 offset:20480
    v_mfma_f32_16x16x32_bf16 v[116:119], a[40:43], a[12:15], v[116:119]
    ds_read_b64_tr_b16 a[78:79], v11 offset:20992
    s_add_u32 m0, s34, 65536
    v_mfma_f32_16x16x32_bf16 v[104:107], a[44:47], a[0:3], v[104:107]
    global_load_lds_dwordx4 v13, s[52:53]
    v_add_u32 v13, 196608, v13
    v_mfma_f32_16x16x32_bf16 v[108:111], a[44:47], a[4:7], v[108:111]
    s_add_u32 m0, s34, 69632
    v_mfma_f32_16x16x32_bf16 v[120:123], a[44:47], a[8:11], v[120:123]
    global_load_lds_dwordx4 v14, s[52:53]
    v_add_u32 v14, 196608, v14
    v_mfma_f32_16x16x32_bf16 v[124:127], a[44:47], a[12:15], v[124:127]
    s_add_u32 m0, s34, 73728
    v_mfma_f32_16x16x32_bf16 v[128:131], a[0:3], a[48:51], v[128:131]
    global_load_lds_dwordx4 v12, s[50:51]
    v_mfma_f32_16x16x32_bf16 v[136:139], a[4:7], a[48:51], v[136:139]
    s_add_u32 m0, s34, 77824
    v_mfma_f32_16x16x32_bf16 v[144:147], a[8:11], a[48:51], v[144:147]
    global_load_lds_dwordx4 v13, s[50:51]
    v_mfma_f32_16x16x32_bf16 v[152:155], a[12:15], a[48:51], v[152:155]
    s_add_u32 m0, s34, 81920
    v_mfma_f32_16x16x32_bf16 v[132:135], a[0:3], a[52:55], v[132:135]
    global_load_lds_dwordx4 v14, s[50:51]
    v_mfma_f32_16x16x32_bf16 v[140:143], a[4:7], a[52:55], v[140:143]
    s_add_u32 m0, s34, 86016
    v_mfma_f32_16x16x32_bf16 v[148:151], a[8:11], a[52:55], v[148:151]
    global_load_lds_dwordx4 v12, s[52:53]
    v_add_u32 v12, 196608, v12
    v_mfma_f32_16x16x32_bf16 v[156:159], a[12:15], a[52:55], v[156:159]
    s_waitcnt vmcnt(15) lgkmcnt(0)
    s_barrier
    v_mfma_f32_16x16x32_bf16 v[160:163], a[56:59], a[0:3], v[160:163]
    ds_read_b128 a[16:19], v3 offset:16384
    v_mfma_f32_16x16x32_bf16 v[168:171], a[56:59], a[4:7], v[168:171]
    ds_read_b128 a[20:23], v3 offset:18432
    v_mfma_f32_16x16x32_bf16 v[176:179], a[56:59], a[8:11], v[176:179]
    ds_read_b128 a[24:27], v3 offset:20480
    v_mfma_f32_16x16x32_bf16 v[184:187], a[56:59], a[12:15], v[184:187]
    ds_read_b128 a[28:31], v3 offset:22528
    v_mfma_f32_16x16x32_bf16 v[164:167], a[60:63], a[0:3], v[164:167]
    ds_read_b64_tr_b16 a[32:33], v10 offset:24576
    v_mfma_f32_16x16x32_bf16 v[172:175], a[60:63], a[4:7], v[172:175]
    ds_read_b64_tr_b16 a[34:35], v10 offset:25088
    v_mfma_f32_16x16x32_bf16 v[180:183], a[60:63], a[8:11], v[180:183]
    ds_read_b64_tr_b16 a[36:37], v11 offset:24576
    v_mfma_f32_16x16x32_bf16 v[188:191], a[60:63], a[12:15], v[188:191]
    ds_read_b64_tr_b16 a[38:39], v11 offset:25088
    v_mfma_f32_16x16x32_bf16 v[192:195], a[64:67], a[0:3], v[192:195]
    ds_read_b64_tr_b16 a[40:41], v10 offset:28672
    v_mfma_f32_16x16x32_bf16 v[200:203], a[64:67], a[4:7], v[200:203]
    ds_read_b64_tr_b16 a[42:43], v10 offset:29184
    v_mfma_f32_16x16x32_bf16 v[208:211], a[64:67], a[8:11], v[208:211]
    ds_read_b64_tr_b16 a[44:45], v11 offset:28672
    v_mfma_f32_16x16x32_bf16 v[216:219], a[64:67], a[12:15], v[216:219]
    ds_read_b64_tr_b16 a[46:47], v11 offset:29184
    v_mfma_f32_16x16x32_bf16 v[196:199], a[68:71], a[0:3], v[196:199]
    ds_read_b64_tr_b16 a[48:49], v10 offset:32768
    s_add_u32 m0, s34, 90112
    v_mfma_f32_16x16x32_bf16 v[204:207], a[68:71], a[4:7], v[204:207]
    global_load_lds_dwordx4 v13, s[52:53]
    ds_read_b64_tr_b16 a[50:51], v10 offset:33280
    v_add_u32 v13, 196608, v13
    v_mfma_f32_16x16x32_bf16 v[212:215], a[68:71], a[8:11], v[212:215]
    ds_read_b64_tr_b16 a[52:53], v11 offset:32768
    s_add_u32 m0, s34, 94208
    v_mfma_f32_16x16x32_bf16 v[220:223], a[68:71], a[12:15], v[220:223]
    global_load_lds_dwordx4 v14, s[52:53]
    ds_read_b64_tr_b16 a[54:55], v11 offset:33280
    v_add_u32 v14, 196608, v14
    v_mfma_f32_16x16x32_bf16 v[224:227], a[0:3], a[72:75], v[224:227]
    s_add_u32 m0, s30, 0
    v_mfma_f32_16x16x32_bf16 v[228:231], a[4:7], a[72:75], v[228:231]
    global_load_lds_dwordx4 v15, s[48:49]
    v_add_u32 v15, 128, v15
    v_mfma_f32_16x16x32_bf16 v[240:243], a[8:11], a[72:75], v[240:243]
    s_add_u32 m0, s30, 1024
    v_mfma_f32_16x16x32_bf16 v[244:247], a[12:15], a[72:75], v[244:247]
    global_load_lds_dwordx4 v16, s[48:49]
    v_add_u32 v16, 128, v16
    v_mfma_f32_16x16x32_bf16 v[232:235], a[0:3], a[76:79], v[232:235]
    s_add_u32 m0, s30, 2048
    v_mfma_f32_16x16x32_bf16 v[236:239], a[4:7], a[76:79], v[236:239]
    global_load_lds_dwordx4 v17, s[48:49]
    v_add_u32 v17, 128, v17
    v_mfma_f32_16x16x32_bf16 v[248:251], a[8:11], a[76:79], v[248:251]
    s_add_u32 m0, s30, 3072
    v_mfma_f32_16x16x32_bf16 v[252:255], a[12:15], a[76:79], v[252:255]
    global_load_lds_dwordx4 v18, s[48:49]
    v_add_u32 v18, 128, v18
    s_waitcnt lgkmcnt(8)
    v_mfma_f32_16x16x32_bf16 v[64:67], a[32:35], a[16:19], v[64:67]
    ds_read_b64_tr_b16 a[56:57], v10 offset:36864
    v_mfma_f32_16x16x32_bf16 v[68:71], a[32:35], a[20:23], v[68:71]
    ds_read_b64_tr_b16 a[58:59], v10 offset:37376
    v_mfma_f32_16x16x32_bf16 v[80:83], a[32:35], a[24:27], v[80:83]
    ds_read_b64_tr_b16 a[60:61], v11 offset:36864
    v_mfma_f32_16x16x32_bf16 v[84:87], a[32:35], a[28:31], v[84:87]
    ds_read_b64_tr_b16 a[62:63], v11 offset:37376
    v_mfma_f32_16x16x32_bf16 v[72:75], a[36:39], a[16:19], v[72:75]
    ds_read_b64_tr_b16 a[64:65], v10 offset:40960
    v_mfma_f32_16x16x32_bf16 v[76:79], a[36:39], a[20:23], v[76:79]
    ds_read_b64_tr_b16 a[66:67], v10 offset:41472
    v_mfma_f32_16x16x32_bf16 v[88:91], a[36:39], a[24:27], v[88:91]
    ds_read_b64_tr_b16 a[68:69], v11 offset:40960
    v_mfma_f32_16x16x32_bf16 v[92:95], a[36:39], a[28:31], v[92:95]
    ds_read_b64_tr_b16 a[70:71], v11 offset:41472
    s_waitcnt lgkmcnt(8)
    v_mfma_f32_16x16x32_bf16 v[96:99], a[40:43], a[16:19], v[96:99]
    ds_read_b64_tr_b16 a[72:73], v10 offset:45056
    v_mfma_f32_16x16x32_bf16 v[100:103], a[40:43], a[20:23], v[100:103]
    ds_read_b64_tr_b16 a[74:75], v10 offset:45568
    v_mfma_f32_16x16x32_bf16 v[112:115], a[40:43], a[24:27], v[112:115]
    ds_read_b64_tr_b16 a[76:77], v11 offset:45056
    v_mfma_f32_16x16x32_bf16 v[116:119], a[40:43], a[28:31], v[116:119]
    ds_read_b64_tr_b16 a[78:79], v11 offset:45568
    s_add_u32 m0, s34, 98304
    v_mfma_f32_16x16x32_bf16 v[104:107], a[44:47], a[16:19], v[104:107]
    global_load_lds_dwordx4 v12, s[50:51]
    v_mfma_f32_16x16x32_bf16 v[108:111], a[44:47], a[20:23], v[108:111]
    s_add_u32 m0, s34, 102400
    v_mfma_f32_16x16x32_bf16 v[120:123], a[44:47], a[24:27], v[120:123]
    global_load_lds_dwordx4 v13, s[50:51]
    v_mfma_f32_16x16x32_bf16 v[124:127], a[44:47], a[28:31], v[124:127]
    s_add_u32 m0, s34, 106496
    v_mfma_f32_16x16x32_bf16 v[128:131], a[16:19], a[48:51], v[128:131]
    global_load_lds_dwordx4 v14, s[50:51]
    v_mfma_f32_16x16x32_bf16 v[136:139], a[20:23], a[48:51], v[136:139]
    s_add_u32 m0, s34, 110592
    v_mfma_f32_16x16x32_bf16 v[144:147], a[24:27], a[48:51], v[144:147]
    global_load_lds_dwordx4 v12, s[52:53]
    v_add_u32 v12, 196608, v12
    v_mfma_f32_16x16x32_bf16 v[152:155], a[28:31], a[48:51], v[152:155]
    s_add_u32 m0, s34, 114688
    v_mfma_f32_16x16x32_bf16 v[132:135], a[16:19], a[52:55], v[132:135]
    global_load_lds_dwordx4 v13, s[52:53]
    v_add_u32 v13, 196608, v13
    v_mfma_f32_16x16x32_bf16 v[140:143], a[20:23], a[52:55], v[140:143]
    s_add_u32 m0, s34, 118784
    v_mfma_f32_16x16x32_bf16 v[148:151], a[24:27], a[52:55], v[148:151]
    global_load_lds_dwordx4 v14, s[52:53]
    v_add_u32 v14, 196608, v14
    v_mfma_f32_16x16x32_bf16 v[156:159], a[28:31], a[52:55], v[156:159]
    global_load_dword v28, v27, s[44:45]
    v_add_u32 v27, s46, v27
    s_waitcnt vmcnt(17) lgkmcnt(0)
    s_barrier
    v_mfma_f32_16x16x32_bf16 v[160:163], a[56:59], a[16:19], v[160:163]
    ds_read_b128 a[0:3], v2 offset:32768
    v_mfma_f32_16x16x32_bf16 v[168:171], a[56:59], a[20:23], v[168:171]
    ds_read_b128 a[4:7], v2 offset:34816
    s_add_u32 m0, s34, 122880
    v_mfma_f32_16x16x32_bf16 v[176:179], a[56:59], a[24:27], v[176:179]
    global_load_lds_dwordx4 v12, s[50:51]
    v_mfma_f32_16x16x32_bf16 v[184:187], a[56:59], a[28:31], v[184:187]
    ds_read_b128 a[8:11], v2 offset:36864
    v_mfma_f32_16x16x32_bf16 v[164:167], a[60:63], a[16:19], v[164:167]
    ds_read_b128 a[12:15], v2 offset:38912
    v_mfma_f32_16x16x32_bf16 v[172:175], a[60:63], a[20:23], v[172:175]
    ds_read_b64_tr_b16 a[32:33], v4 offset:0
    v_mfma_f32_16x16x32_bf16 v[180:183], a[60:63], a[24:27], v[180:183]
    ds_read_b64_tr_b16 a[34:35], v4 offset:512
    v_mfma_f32_16x16x32_bf16 v[188:191], a[60:63], a[28:31], v[188:191]
    ds_read_b64_tr_b16 a[36:37], v5 offset:0
    s_add_u32 m0, s34, 126976
    v_mfma_f32_16x16x32_bf16 v[192:195], a[64:67], a[16:19], v[192:195]
    global_load_lds_dwordx4 v13, s[50:51]
    v_mfma_f32_16x16x32_bf16 v[200:203], a[64:67], a[20:23], v[200:203]
    ds_read_b64_tr_b16 a[38:39], v5 offset:512
    v_mfma_f32_16x16x32_bf16 v[208:211], a[64:67], a[24:27], v[208:211]
    ds_read_b64_tr_b16 a[40:41], v4 offset:4096
    v_mfma_f32_16x16x32_bf16 v[216:219], a[64:67], a[28:31], v[216:219]
    ds_read_b64_tr_b16 a[42:43], v4 offset:4608
    v_mfma_f32_16x16x32_bf16 v[196:199], a[68:71], a[16:19], v[196:199]
    ds_read_b64_tr_b16 a[44:45], v5 offset:4096
    v_mfma_f32_16x16x32_bf16 v[204:207], a[68:71], a[20:23], v[204:207]
    ds_read_b64_tr_b16 a[46:47], v5 offset:4608
    s_add_u32 m0, s34, 131072
    v_mfma_f32_16x16x32_bf16 v[212:215], a[68:71], a[24:27], v[212:215]
    global_load_lds_dwordx4 v14, s[50:51]
    v_mfma_f32_16x16x32_bf16 v[220:223], a[68:71], a[28:31], v[220:223]
    ds_read_b64_tr_b16 a[48:49], v4 offset:8192
    v_mfma_f32_16x16x32_bf16 v[224:227], a[16:19], a[72:75], v[224:227]
    ds_read_b64_tr_b16 a[50:51], v4 offset:8704
    v_mfma_f32_16x16x32_bf16 v[228:231], a[20:23], a[72:75], v[228:231]
    ds_read_b64_tr_b16 a[52:53], v5 offset:8192
    v_mfma_f32_16x16x32_bf16 v[240:243], a[24:27], a[72:75], v[240:243]
    ds_read_b64_tr_b16 a[54:55], v5 offset:8704
    v_mfma_f32_16x16x32_bf16 v[244:247], a[28:31], a[72:75], v[244:247]
    s_add_u32 m0, s30, 16384
    v_mfma_f32_16x16x32_bf16 v[232:235], a[16:19], a[76:79], v[232:235]
    global_load_lds_dwordx4 v15, s[48:49]
    v_mfma_f32_16x16x32_bf16 v[236:239], a[20:23], a[76:79], v[236:239]
    v_add_u32 v15, 128, v15
    v_mfma_f32_16x16x32_bf16 v[248:251], a[24:27], a[76:79], v[248:251]
    v_mfma_f32_16x16x32_bf16 v[252:255], a[28:31], a[76:79], v[252:255]
    s_waitcnt lgkmcnt(8)
    v_mfma_f32_16x16x32_bf16 v[64:67], a[32:35], a[0:3], v[64:67]
    ds_read_b64_tr_b16 a[56:57], v4 offset:12288
    v_mfma_f32_16x16x32_bf16 v[68:71], a[32:35], a[4:7], v[68:71]
    ds_read_b64_tr_b16 a[58:59], v4 offset:12800
    s_add_u32 m0, s34, 135168
    v_mfma_f32_16x16x32_bf16 v[80:83], a[32:35], a[8:11], v[80:83]
    global_load_lds_dwordx4 v12, s[52:53]
    v_mfma_f32_16x16x32_bf16 v[84:87], a[32:35], a[12:15], v[84:87]
    ds_read_b64_tr_b16 a[60:61], v5 offset:12288
    v_add_u32 v12, 196608, v12
    v_mfma_f32_16x16x32_bf16 v[72:75], a[36:39], a[0:3], v[72:75]
    ds_read_b64_tr_b16 a[62:63], v5 offset:12800
    v_mfma_f32_16x16x32_bf16 v[76:79], a[36:39], a[4:7], v[76:79]
    ds_read_b64_tr_b16 a[64:65], v4 offset:16384
    v_mfma_f32_16x16x32_bf16 v[88:91], a[36:39], a[8:11], v[88:91]
    ds_read_b64_tr_b16 a[66:67], v4 offset:16896
    v_mfma_f32_16x16x32_bf16 v[92:95], a[36:39], a[12:15], v[92:95]
    ds_read_b64_tr_b16 a[68:69], v5 offset:16384
    s_add_u32 m0, s34, 139264
    s_waitcnt lgkmcnt(7)
    v_mfma_f32_16x16x32_bf16 v[96:99], a[40:43], a[0:3], v[96:99]
    global_load_lds_dwordx4 v13, s[52:53]
    v_mfma_f32_16x16x32_bf16 v[100:103], a[40:43], a[4:7], v[100:103]
    ds_read_b64_tr_b16 a[70:71], v5 offset:16896
    v_add_u32 v13, 196608, v13
    v_mfma_f32_16x16x32_bf16 v[112:115], a[40:43], a[8:11], v[112:115]
    ds_read_b64_tr_b16 a[72:73], v4 offset:20480
    v_mfma_f32_16x16x32_bf16 v[116:119], a[40:43], a[12:15], v[116:119]
    ds_read_b64_tr_b16 a[74:75], v4 offset:20992
    v_mfma_f32_16x16x32_bf16 v[104:107], a[44:47], a[0:3], v[104:107]
    ds_read_b64_tr_b16 a[76:77], v5 offset:20480
    v_mfma_f32_16x16x32_bf16 v[108:111], a[44:47], a[4:7], v[108:111]
    ds_read_b64_tr_b16 a[78:79], v5 offset:20992
    s_add_u32 m0, s34, 143360
    v_mfma_f32_16x16x32_bf16 v[120:123], a[44:47], a[8:11], v[120:123]
    global_load_lds_dwordx4 v14, s[52:53]
    v_mfma_f32_16x16x32_bf16 v[124:127], a[44:47], a[12:15], v[124:127]
    v_add_u32 v14, 196608, v14
    v_mfma_f32_16x16x32_bf16 v[128:131], a[0:3], a[48:51], v[128:131]
    v_mfma_f32_16x16x32_bf16 v[136:139], a[4:7], a[48:51], v[136:139]
    v_mfma_f32_16x16x32_bf16 v[144:147], a[8:11], a[48:51], v[144:147]
    v_mfma_f32_16x16x32_bf16 v[152:155], a[12:15], a[48:51], v[152:155]
    s_add_u32 m0, s30, 17408
    v_mfma_f32_16x16x32_bf16 v[132:135], a[0:3], a[52:55], v[132:135]
    global_load_lds_dwordx4 v16, s[48:49]
    v_mfma_f32_16x16x32_bf16 v[140:143], a[4:7], a[52:55], v[140:143]
    v_add_u32 v16, 128, v16
    v_mfma_f32_16x16x32_bf16 v[148:151], a[8:11], a[52:55], v[148:151]
    v_mfma_f32_16x16x32_bf16 v[156:159], a[12:15], a[52:55], v[156:159]
    s_waitcnt vmcnt(19) lgkmcnt(0)
    s_barrier
    v_mfma_f32_16x16x32_bf16 v[160:163], a[56:59], a[0:3], v[160:163]
    ds_read_b128 a[16:19], v3 offset:32768
    v_mfma_f32_16x16x32_bf16 v[168:171], a[56:59], a[4:7], v[168:171]
    ds_read_b128 a[20:23], v3 offset:34816
    s_add_u32 m0, s34, 49152
    v_mfma_f32_16x16x32_bf16 v[176:179], a[56:59], a[8:11], v[176:179]
    global_load_lds_dwordx4 v12, s[50:51]
    v_mfma_f32_16x16x32_bf16 v[184:187], a[56:59], a[12:15], v[184:187]
    ds_read_b128 a[24:27], v3 offset:36864
    v_mfma_f32_16x16x32_bf16 v[164:167], a[60:63], a[0:3], v[164:167]
    ds_read_b128 a[28:31], v3 offset:38912
    v_mfma_f32_16x16x32_bf16 v[172:175], a[60:63], a[4:7], v[172:175]
    ds_read_b64_tr_b16 a[32:33], v4 offset:24576
    v_mfma_f32_16x16x32_bf16 v[180:183], a[60:63], a[8:11], v[180:183]
    ds_read_b64_tr_b16 a[34:35], v4 offset:25088
    v_mfma_f32_16x16x32_bf16 v[188:191], a[60:63], a[12:15], v[188:191]
    ds_read_b64_tr_b16 a[36:37], v5 offset:24576
    s_add_u32 m0, s34, 53248
    v_mfma_f32_16x16x32_bf16 v[192:195], a[64:67], a[0:3], v[192:195]
    global_load_lds_dwordx4 v13, s[50:51]
    v_mfma_f32_16x16x32_bf16 v[200:203], a[64:67], a[4:7], v[200:203]
    ds_read_b64_tr_b16 a[38:39], v5 offset:25088
    v_mfma_f32_16x16x32_bf16 v[208:211], a[64:67], a[8:11], v[208:211]
    ds_read_b64_tr_b16 a[40:41], v4 offset:28672
    v_mfma_f32_16x16x32_bf16 v[216:219], a[64:67], a[12:15], v[216:219]
    ds_read_b64_tr_b16 a[42:43], v4 offset:29184
    v_mfma_f32_16x16x32_bf16 v[196:199], a[68:71], a[0:3], v[196:199]
    ds_read_b64_tr_b16 a[44:45], v5 offset:28672
    v_mfma_f32_16x16x32_bf16 v[204:207], a[68:71], a[4:7], v[204:207]
    ds_read_b64_tr_b16 a[46:47], v5 offset:29184
    s_add_u32 m0, s34, 57344
    v_mfma_f32_16x16x32_bf16 v[212:215], a[68:71], a[8:11], v[212:215]
    global_load_lds_dwordx4 v14, s[50:51]
    v_mfma_f32_16x16x32_bf16 v[220:223], a[68:71], a[12:15], v[220:223]
    ds_read_b64_tr_b16 a[48:49], v4 offset:32768
    v_mfma_f32_16x16x32_bf16 v[224:227], a[0:3], a[72:75], v[224:227]
    ds_read_b64_tr_b16 a[50:51], v4 offset:33280
    v_mfma_f32_16x16x32_bf16 v[228:231], a[4:7], a[72:75], v[228:231]
    ds_read_b64_tr_b16 a[52:53], v5 offset:32768
    v_mfma_f32_16x16x32_bf16 v[240:243], a[8:11], a[72:75], v[240:243]
    ds_read_b64_tr_b16 a[54:55], v5 offset:33280
    v_mfma_f32_16x16x32_bf16 v[244:247], a[12:15], a[72:75], v[244:247]
    s_add_u32 m0, s30, 18432
    v_mfma_f32_16x16x32_bf16 v[232:235], a[0:3], a[76:79], v[232:235]
    global_load_lds_dwordx4 v17, s[48:49]
    v_mfma_f32_16x16x32_bf16 v[236:239], a[4:7], a[76:79], v[236:239]
    v_add_u32 v17, 128, v17
    v_mfma_f32_16x16x32_bf16 v[248:251], a[8:11], a[76:79], v[248:251]
    v_mfma_f32_16x16x32_bf16 v[252:255], a[12:15], a[76:79], v[252:255]
    s_waitcnt lgkmcnt(8)
    v_mfma_f32_16x16x32_bf16 v[64:67], a[32:35], a[16:19], v[64:67]
    ds_read_b64_tr_b16 a[56:57], v4 offset:36864
    v_mfma_f32_16x16x32_bf16 v[68:71], a[32:35], a[20:23], v[68:71]
    ds_read_b64_tr_b16 a[58:59], v4 offset:37376
    s_add_u32 m0, s34, 61440
    v_mfma_f32_16x16x32_bf16 v[80:83], a[32:35], a[24:27], v[80:83]
    global_load_lds_dwordx4 v12, s[52:53]
    v_mfma_f32_16x16x32_bf16 v[84:87], a[32:35], a[28:31], v[84:87]
    ds_read_b64_tr_b16 a[60:61], v5 offset:36864
    v_add_u32 v12, 196608, v12
    v_mfma_f32_16x16x32_bf16 v[72:75], a[36:39], a[16:19], v[72:75]
    ds_read_b64_tr_b16 a[62:63], v5 offset:37376
    v_mfma_f32_16x16x32_bf16 v[76:79], a[36:39], a[20:23], v[76:79]
    ds_read_b64_tr_b16 a[64:65], v4 offset:40960
    v_mfma_f32_16x16x32_bf16 v[88:91], a[36:39], a[24:27], v[88:91]
    ds_read_b64_tr_b16 a[66:67], v4 offset:41472
    v_mfma_f32_16x16x32_bf16 v[92:95], a[36:39], a[28:31], v[92:95]
    ds_read_b64_tr_b16 a[68:69], v5 offset:40960
    s_add_u32 m0, s34, 65536
    s_waitcnt lgkmcnt(7)
    v_mfma_f32_16x16x32_bf16 v[96:99], a[40:43], a[16:19], v[96:99]
    global_load_lds_dwordx4 v13, s[52:53]
    v_mfma_f32_16x16x32_bf16 v[100:103], a[40:43], a[20:23], v[100:103]
    ds_read_b64_tr_b16 a[70:71], v5 offset:41472
    v_add_u32 v13, 196608, v13
    v_mfma_f32_16x16x32_bf16 v[112:115], a[40:43], a[24:27], v[112:115]
    ds_read_b64_tr_b16 a[72:73], v4 offset:45056
    v_mfma_f32_16x16x32_bf16 v[116:119], a[40:43], a[28:31], v[116:119]
    ds_read_b64_tr_b16 a[74:75], v4 offset:45568
    v_mfma_f32_16x16x32_bf16 v[104:107], a[44:47], a[16:19], v[104:107]
    ds_read_b64_tr_b16 a[76:77], v5 offset:45056
    v_mfma_f32_16x16x32_bf16 v[108:111], a[44:47], a[20:23], v[108:111]
    ds_read_b64_tr_b16 a[78:79], v5 offset:45568
    s_add_u32 m0, s34, 69632
    v_mfma_f32_16x16x32_bf16 v[120:123], a[44:47], a[24:27], v[120:123]
    global_load_lds_dwordx4 v14, s[52:53]
    v_mfma_f32_16x16x32_bf16 v[124:127], a[44:47], a[28:31], v[124:127]
    v_add_u32 v14, 196608, v14
    v_mfma_f32_16x16x32_bf16 v[128:131], a[16:19], a[48:51], v[128:131]
    v_mfma_f32_16x16x32_bf16 v[136:139], a[20:23], a[48:51], v[136:139]
    v_mfma_f32_16x16x32_bf16 v[144:147], a[24:27], a[48:51], v[144:147]
    v_mfma_f32_16x16x32_bf16 v[152:155], a[28:31], a[48:51], v[152:155]
    s_add_u32 m0, s30, 19456
    v_mfma_f32_16x16x32_bf16 v[132:135], a[16:19], a[52:55], v[132:135]
    global_load_lds_dwordx4 v18, s[48:49]
    v_mfma_f32_16x16x32_bf16 v[140:143], a[20:23], a[52:55], v[140:143]
    v_add_u32 v18, 128, v18
    v_mfma_f32_16x16x32_bf16 v[148:151], a[24:27], a[52:55], v[148:151]
    v_mfma_f32_16x16x32_bf16 v[156:159], a[28:31], a[52:55], v[156:159]
    global_load_dword v28, v27, s[44:45]
    v_add_u32 v27, s46, v27
    s_waitcnt vmcnt(18) lgkmcnt(0)
    s_barrier
    v_mfma_f32_16x16x32_bf16 v[160:163], a[56:59], a[16:19], v[160:163]
    ds_read_b128 a[0:3], v2 offset:0
    v_mfma_f32_16x16x32_bf16 v[168:171], a[56:59], a[20:23], v[168:171]
    ds_read_b128 a[4:7], v2 offset:2048
    s_add_u32 m0, s34, 73728
    v_mfma_f32_16x16x32_bf16 v[176:179], a[56:59], a[24:27], v[176:179]
    global_load_lds_dwordx4 v12, s[50:51]
    v_mfma_f32_16x16x32_bf16 v[184:187], a[56:59], a[28:31], v[184:187]
    ds_read_b128 a[8:11], v2 offset:4096
    v_mfma_f32_16x16x32_bf16 v[164:167], a[60:63], a[16:19], v[164:167]
    ds_read_b128 a[12:15], v2 offset:6144
    v_mfma_f32_16x16x32_bf16 v[172:175], a[60:63], a[20:23], v[172:175]
    ds_read_b64_tr_b16 a[32:33], v10 offset:0
    v_mfma_f32_16x16x32_bf16 v[180:183], a[60:63], a[24:27], v[180:183]
    ds_read_b64_tr_b16 a[34:35], v10 offset:512
    v_mfma_f32_16x16x32_bf16 v[188:191], a[60:63], a[28:31], v[188:191]
    ds_read_b64_tr_b16 a[36:37], v11 offset:0
    s_add_u32 m0, s34, 77824
    v_mfma_f32_16x16x32_bf16 v[192:195], a[64:67], a[16:19], v[192:195]
    global_load_lds_dwordx4 v13, s[50:51]
    v_mfma_f32_16x16x32_bf16 v[200:203], a[64:67], a[20:23], v[200:203]
    ds_read_b64_tr_b16 a[38:39], v11 offset:512
    v_mfma_f32_16x16x32_bf16 v[208:211], a[64:67], a[24:27], v[208:211]
    ds_read_b64_tr_b16 a[40:41], v10 offset:4096
    v_mfma_f32_16x16x32_bf16 v[216:219], a[64:67], a[28:31], v[216:219]
    ds_read_b64_tr_b16 a[42:43], v10 offset:4608
    v_mfma_f32_16x16x32_bf16 v[196:199], a[68:71], a[16:19], v[196:199]
    ds_read_b64_tr_b16 a[44:45], v11 offset:4096
    v_mfma_f32_16x16x32_bf16 v[204:207], a[68:71], a[20:23], v[204:207]
    ds_read_b64_tr_b16 a[46:47], v11 offset:4608
    s_add_u32 m0, s34, 81920
    v_mfma_f32_16x16x32_bf16 v[212:215], a[68:71], a[24:27], v[212:215]
    global_load_lds_dwordx4 v14, s[50:51]
    v_mfma_f32_16x16x32_bf16 v[220:223], a[68:71], a[28:31], v[220:223]
    ds_read_b64_tr_b16 a[48:49], v10 offset:8192
    v_mfma_f32_16x16x32_bf16 v[224:227], a[16:19], a[72:75], v[224:227]
    ds_read_b64_tr_b16 a[50:51], v10 offset:8704
    v_mfma_f32_16x16x32_bf16 v[228:231], a[20:23], a[72:75], v[228:231]
    ds_read_b64_tr_b16 a[52:53], v11 offset:8192
    v_mfma_f32_16x16x32_bf16 v[240:243], a[24:27], a[72:75], v[240:243]
    ds_read_b64_tr_b16 a[54:55], v11 offset:8704
    v_mfma_f32_16x16x32_bf16 v[244:247], a[28:31], a[72:75], v[244:247]
    s_add_u32 m0, s30, 32768
    v_mfma_f32_16x16x32_bf16 v[232:235], a[16:19], a[76:79], v[232:235]
    global_load_lds_dwordx4 v15, s[48:49]
    v_mfma_f32_16x16x32_bf16 v[236:239], a[20:23], a[76:79], v[236:239]
    v_add_u32 v15, 128, v15
    v_mfma_f32_16x16x32_bf16 v[248:251], a[24:27], a[76:79], v[248:251]
    v_mfma_f32_16x16x32_bf16 v[252:255], a[28:31], a[76:79], v[252:255]
    s_waitcnt lgkmcnt(8)
    v_mfma_f32_16x16x32_bf16 v[64:67], a[32:35], a[0:3], v[64:67]
    ds_read_b64_tr_b16 a[56:57], v10 offset:12288
    v_mfma_f32_16x16x32_bf16 v[68:71], a[32:35], a[4:7], v[68:71]
    ds_read_b64_tr_b16 a[58:59], v10 offset:12800
    s_add_u32 m0, s34, 86016
    v_mfma_f32_16x16x32_bf16 v[80:83], a[32:35], a[8:11], v[80:83]
    global_load_lds_dwordx4 v12, s[52:53]
    v_mfma_f32_16x16x32_bf16 v[84:87], a[32:35], a[12:15], v[84:87]
    ds_read_b64_tr_b16 a[60:61], v11 offset:12288
    v_add_u32 v12, 196608, v12
    v_mfma_f32_16x16x32_bf16 v[72:75], a[36:39], a[0:3], v[72:75]
    ds_read_b64_tr_b16 a[62:63], v11 offset:12800
    v_mfma_f32_16x16x32_bf16 v[76:79], a[36:39], a[4:7], v[76:79]
    ds_read_b64_tr_b16 a[64:65], v10 offset:16384
    v_mfma_f32_16x16x32_bf16 v[88:91], a[36:39], a[8:11], v[88:91]
    ds_read_b64_tr_b16 a[66:67], v10 offset:16896
    v_mfma_f32_16x16x32_bf16 v[92:95], a[36:39], a[12:15], v[92:95]
    ds_read_b64_tr_b16 a[68:69], v11 offset:16384
    s_add_u32 m0, s34, 90112
    s_waitcnt lgkmcnt(7)
    v_mfma_f32_16x16x32_bf16 v[96:99], a[40:43], a[0:3], v[96:99]
    global_load_lds_dwordx4 v13, s[52:53]
    v_mfma_f32_16x16x32_bf16 v[100:103], a[40:43], a[4:7], v[100:103]
    ds_read_b64_tr_b16 a[70:71], v11 offset:16896
    v_add_u32 v13, 196608, v13
    v_mfma_f32_16x16x32_bf16 v[112:115], a[40:43], a[8:11], v[112:115]
    ds_read_b64_tr_b16 a[72:73], v10 offset:20480
    v_mfma_f32_16x16x32_bf16 v[116:119], a[40:43], a[12:15], v[116:119]
    ds_read_b64_tr_b16 a[74:75], v10 offset:20992
    v_mfma_f32_16x16x32_bf16 v[104:107], a[44:47], a[0:3], v[104:107]
    ds_read_b64_tr_b16 a[76:77], v11 offset:20480
    v_mfma_f32_16x16x32_bf16 v[108:111], a[44:47], a[4:7], v[108:111]
    ds_read_b64_tr_b16 a[78:79], v11 offset:20992
    s_add_u32 m0, s34, 94208
    v_mfma_f32_16x16x32_bf16 v[120:123], a[44:47], a[8:11], v[120:123]
    global_load_lds_dwordx4 v14, s[52:53]
    v_mfma_f32_16x16x32_bf16 v[124:127], a[44:47], a[12:15], v[124:127]
    v_add_u32 v14, 196608, v14
    v_mfma_f32_16x16x32_bf16 v[128:131], a[0:3], a[48:51], v[128:131]
    v_mfma_f32_16x16x32_bf16 v[136:139], a[4:7], a[48:51], v[136:139]
    v_mfma_f32_16x16x32_bf16 v[144:147], a[8:11], a[48:51], v[144:147]
    v_mfma_f32_16x16x32_bf16 v[152:155], a[12:15], a[48:51], v[152:155]
    s_add_u32 m0, s30, 33792
    v_mfma_f32_16x16x32_bf16 v[132:135], a[0:3], a[52:55], v[132:135]
    global_load_lds_dwordx4 v16, s[48:49]
    v_mfma_f32_16x16x32_bf16 v[140:143], a[4:7], a[52:55], v[140:143]
    v_add_u32 v16, 128, v16
    v_mfma_f32_16x16x32_bf16 v[148:151], a[8:11], a[52:55], v[148:151]
    v_mfma_f32_16x16x32_bf16 v[156:159], a[12:15], a[52:55], v[156:159]
    s_waitcnt vmcnt(18) lgkmcnt(0)
    s_barrier
    v_mfma_f32_16x16x32_bf16 v[160:163], a[56:59], a[0:3], v[160:163]
    ds_read_b128 a[16:19], v3 offset:0
    v_mfma_f32_16x16x32_bf16 v[168:171], a[56:59], a[4:7], v[168:171]
    ds_read_b128 a[20:23], v3 offset:2048
    s_add_u32 m0, s34, 98304
    v_mfma_f32_16x16x32_bf16 v[176:179], a[56:59], a[8:11], v[176:179]
    global_load_lds_dwordx4 v12, s[50:51]
    v_mfma_f32_16x16x32_bf16 v[184:187], a[56:59], a[12:15], v[184:187]
    ds_read_b128 a[24:27], v3 offset:4096
    v_mfma_f32_16x16x32_bf16 v[164:167], a[60:63], a[0:3], v[164:167]
    ds_read_b128 a[28:31], v3 offset:6144
    v_mfma_f32_16x16x32_bf16 v[172:175], a[60:63], a[4:7], v[172:175]
    ds_read_b64_tr_b16 a[32:33], v10 offset:24576
    v_mfma_f32_16x16x32_bf16 v[180:183], a[60:63], a[8:11], v[180:183]
    ds_read_b64_tr_b16 a[34:35], v10 offset:25088
    v_mfma_f32_16x16x32_bf16 v[188:191], a[60:63], a[12:15], v[188:191]
    ds_read_b64_tr_b16 a[36:37], v11 offset:24576
    s_add_u32 m0, s34, 102400
    v_mfma_f32_16x16x32_bf16 v[192:195], a[64:67], a[0:3], v[192:195]
    global_load_lds_dwordx4 v13, s[50:51]
    v_mfma_f32_16x16x32_bf16 v[200:203], a[64:67], a[4:7], v[200:203]
    ds_read_b64_tr_b16 a[38:39], v11 offset:25088
    v_mfma_f32_16x16x32_bf16 v[208:211], a[64:67], a[8:11], v[208:211]
    ds_read_b64_tr_b16 a[40:41], v10 offset:28672
    v_mfma_f32_16x16x32_bf16 v[216:219], a[64:67], a[12:15], v[216:219]
    ds_read_b64_tr_b16 a[42:43], v10 offset:29184
    v_mfma_f32_16x16x32_bf16 v[196:199], a[68:71], a[0:3], v[196:199]
    ds_read_b64_tr_b16 a[44:45], v11 offset:28672
    v_mfma_f32_16x16x32_bf16 v[204:207], a[68:71], a[4:7], v[204:207]
    ds_read_b64_tr_b16 a[46:47], v11 offset:29184
    s_add_u32 m0, s34, 106496
    v_mfma_f32_16x16x32_bf16 v[212:215], a[68:71], a[8:11], v[212:215]
    global_load_lds_dwordx4 v14, s[50:51]
    v_mfma_f32_16x16x32_bf16 v[220:223], a[68:71], a[12:15], v[220:223]
    ds_read_b64_tr_b16 a[48:49], v10 offset:32768
    v_mfma_f32_16x16x32_bf16 v[224:227], a[0:3], a[72:75], v[224:227]
    ds_read_b64_tr_b16 a[50:51], v10 offset:33280
    v_mfma_f32_16x16x32_bf16 v[228:231], a[4:7], a[72:75], v[228:231]
    ds_read_b64_tr_b16 a[52:53], v11 offset:32768
    v_mfma_f32_16x16x32_bf16 v[240:243], a[8:11], a[72:75], v[240:243]
    ds_read_b64_tr_b16 a[54:55], v11 offset:33280
    v_mfma_f32_16x16x32_bf16 v[244:247], a[12:15], a[72:75], v[244:247]
    s_add_u32 m0, s30, 34816
    v_mfma_f32_16x16x32_bf16 v[232:235], a[0:3], a[76:79], v[232:235]
    global_load_lds_dwordx4 v17, s[48:49]
    v_mfma_f32_16x16x32_bf16 v[236:239], a[4:7], a[76:79], v[236:239]
    v_add_u32 v17, 128, v17
    v_mfma_f32_16x16x32_bf16 v[248:251], a[8:11], a[76:79], v[248:251]
    v_mfma_f32_16x16x32_bf16 v[252:255], a[12:15], a[76:79], v[252:255]
    s_waitcnt lgkmcnt(8)
    v_mfma_f32_16x16x32_bf16 v[64:67], a[32:35], a[16:19], v[64:67]
    ds_read_b64_tr_b16 a[56:57], v10 offset:36864
    v_mfma_f32_16x16x32_bf16 v[68:71], a[32:35], a[20:23], v[68:71]
    ds_read_b64_tr_b16 a[58:59], v10 offset:37376
    s_add_u32 m0, s34, 110592
    v_mfma_f32_16x16x32_bf16 v[80:83], a[32:35], a[24:27], v[80:83]
    global_load_lds_dwordx4 v12, s[52:53]
    v_mfma_f32_16x16x32_bf16 v[84:87], a[32:35], a[28:31], v[84:87]
    ds_read_b64_tr_b16 a[60:61], v11 offset:36864
    v_add_u32 v12, 196608, v12
    v_mfma_f32_16x16x32_bf16 v[72:75], a[36:39], a[16:19], v[72:75]
    ds_read_b64_tr_b16 a[62:63], v11 offset:37376
    v_mfma_f32_16x16x32_bf16 v[76:79], a[36:39], a[20:23], v[76:79]
    ds_read_b64_tr_b16 a[64:65], v10 offset:40960
    v_mfma_f32_16x16x32_bf16 v[88:91], a[36:39], a[24:27], v[88:91]
    ds_read_b64_tr_b16 a[66:67], v10 offset:41472
    v_mfma_f32_16x16x32_bf16 v[92:95], a[36:39], a[28:31], v[92:95]
    ds_read_b64_tr_b16 a[68:69], v11 offset:40960
    s_add_u32 m0, s34, 114688
    s_waitcnt lgkmcnt(7)
    v_mfma_f32_16x16x32_bf16 v[96:99], a[40:43], a[16:19], v[96:99]
    global_load_lds_dwordx4 v13, s[52:53]
    v_mfma_f32_16x16x32_bf16 v[100:103], a[40:43], a[20:23], v[100:103]
    ds_read_b64_tr_b16 a[70:71], v11 offset:41472
    v_add_u32 v13, 196608, v13
    v_mfma_f32_16x16x32_bf16 v[112:115], a[40:43], a[24:27], v[112:115]
    ds_read_b64_tr_b16 a[72:73], v10 offset:45056
    v_mfma_f32_16x16x32_bf16 v[116:119], a[40:43], a[28:31], v[116:119]
    ds_read_b64_tr_b16 a[74:75], v10 offset:45568
    v_mfma_f32_16x16x32_bf16 v[104:107], a[44:47], a[16:19], v[104:107]
    ds_read_b64_tr_b16 a[76:77], v11 offset:45056
    v_mfma_f32_16x16x32_bf16 v[108:111], a[44:47], a[20:23], v[108:111]
    ds_read_b64_tr_b16 a[78:79], v11 offset:45568
    s_add_u32 m0, s34, 118784
    v_mfma_f32_16x16x32_bf16 v[120:123], a[44:47], a[24:27], v[120:123]
    global_load_lds_dwordx4 v14, s[52:53]
    v_mfma_f32_16x16x32_bf16 v[124:127], a[44:47], a[28:31], v[124:127]
    v_add_u32 v14, 196608, v14
    v_mfma_f32_16x16x32_bf16 v[128:131], a[16:19], a[48:51], v[128:131]
    v_mfma_f32_16x16x32_bf16 v[136:139], a[20:23], a[48:51], v[136:139]
    v_mfma_f32_16x16x32_bf16 v[144:147], a[24:27], a[48:51], v[144:147]
    v_mfma_f32_16x16x32_bf16 v[152:155], a[28:31], a[48:51], v[152:155]
    s_add_u32 m0, s30, 35840
    v_mfma_f32_16x16x32_bf16 v[132:135], a[16:19], a[52:55], v[132:135]
    global_load_lds_dwordx4 v18, s[48:49]
    v_mfma_f32_16x16x32_bf16 v[140:143], a[20:23], a[52:55], v[140:143]
    v_add_u32 v18, 128, v18
    v_mfma_f32_16x16x32_bf16 v[148:151], a[24:27], a[52:55], v[148:151]
    v_mfma_f32_16x16x32_bf16 v[156:159], a[28:31], a[52:55], v[156:159]
    global_load_dword v28, v27, s[44:45]
    v_add_u32 v27, s46, v27
    s_waitcnt vmcnt(18) lgkmcnt(0)
    s_barrier
    v_mfma_f32_16x16x32_bf16 v[160:163], a[56:59], a[16:19], v[160:163]
    ds_read_b128 a[0:3], v2 offset:16384
    v_mfma_f32_16x16x32_bf16 v[168:171], a[56:59], a[20:23], v[168:171]
    ds_read_b128 a[4:7], v2 offset:18432
    s_add_u32 m0, s34, 122880
    v_mfma_f32_16x16x32_bf16 v[176:179], a[56:59], a[24:27], v[176:179]
    global_load_lds_dwordx4 v12, s[50:51]
    v_mfma_f32_16x16x32_bf16 v[184:187], a[56:59], a[28:31], v[184:187]
    ds_read_b128 a[8:11], v2 offset:20480
    v_mfma_f32_16x16x32_bf16 v[164:167], a[60:63], a[16:19], v[164:167]
    ds_read_b128 a[12:15], v2 offset:22528
    v_mfma_f32_16x16x32_bf16 v[172:175], a[60:63], a[20:23], v[172:175]
    ds_read_b64_tr_b16 a[32:33], v4 offset:0
    v_mfma_f32_16x16x32_bf16 v[180:183], a[60:63], a[24:27], v[180:183]
    ds_read_b64_tr_b16 a[34:35], v4 offset:512
    v_mfma_f32_16x16x32_bf16 v[188:191], a[60:63], a[28:31], v[188:191]
    ds_read_b64_tr_b16 a[36:37], v5 offset:0
    s_add_u32 m0, s34, 126976
    v_mfma_f32_16x16x32_bf16 v[192:195], a[64:67], a[16:19], v[192:195]
    global_load_lds_dwordx4 v13, s[50:51]
    v_mfma_f32_16x16x32_bf16 v[200:203], a[64:67], a[20:23], v[200:203]
    ds_read_b64_tr_b16 a[38:39], v5 offset:512
    v_mfma_f32_16x16x32_bf16 v[208:211], a[64:67], a[24:27], v[208:211]
    ds_read_b64_tr_b16 a[40:41], v4 offset:4096
    v_mfma_f32_16x16x32_bf16 v[216:219], a[64:67], a[28:31], v[216:219]
    ds_read_b64_tr_b16 a[42:43], v4 offset:4608
    v_mfma_f32_16x16x32_bf16 v[196:199], a[68:71], a[16:19], v[196:199]
    ds_read_b64_tr_b16 a[44:45], v5 offset:4096
    v_mfma_f32_16x16x32_bf16 v[204:207], a[68:71], a[20:23], v[204:207]
    ds_read_b64_tr_b16 a[46:47], v5 offset:4608
    s_add_u32 m0, s34, 131072
    v_mfma_f32_16x16x32_bf16 v[212:215], a[68:71], a[24:27], v[212:215]
    global_load_lds_dwordx4 v14, s[50:51]
    v_mfma_f32_16x16x32_bf16 v[220:223], a[68:71], a[28:31], v[220:223]
    ds_read_b64_tr_b16 a[48:49], v4 offset:8192
    v_mfma_f32_16x16x32_bf16 v[224:227], a[16:19], a[72:75], v[224:227]
    ds_read_b64_tr_b16 a[50:51], v4 offset:8704
    v_mfma_f32_16x16x32_bf16 v[228:231], a[20:23], a[72:75], v[228:231]
    ds_read_b64_tr_b16 a[52:53], v5 offset:8192
    v_mfma_f32_16x16x32_bf16 v[240:243], a[24:27], a[72:75], v[240:243]
    ds_read_b64_tr_b16 a[54:55], v5 offset:8704
    v_mfma_f32_16x16x32_bf16 v[244:247], a[28:31], a[72:75], v[244:247]
    s_add_u32 m0, s30, 0
    v_mfma_f32_16x16x32_bf16 v[232:235], a[16:19], a[76:79], v[232:235]
    global_load_lds_dwordx4 v15, s[48:49]
    v_mfma_f32_16x16x32_bf16 v[236:239], a[20:23], a[76:79], v[236:239]
    v_add_u32 v15, 128, v15
    v_mfma_f32_16x16x32_bf16 v[248:251], a[24:27], a[76:79], v[248:251]
    v_mfma_f32_16x16x32_bf16 v[252:255], a[28:31], a[76:79], v[252:255]
    s_waitcnt lgkmcnt(8)
    v_mfma_f32_16x16x32_bf16 v[64:67], a[32:35], a[0:3], v[64:67]
    ds_read_b64_tr_b16 a[56:57], v4 offset:12288
    v_mfma_f32_16x16x32_bf16 v[68:71], a[32:35], a[4:7], v[68:71]
    ds_read_b64_tr_b16 a[58:59], v4 offset:12800
    s_add_u32 m0, s34, 135168
    v_mfma_f32_16x16x32_bf16 v[80:83], a[32:35], a[8:11], v[80:83]
    global_load_lds_dwordx4 v12, s[52:53]
    v_mfma_f32_16x16x32_bf16 v[84:87], a[32:35], a[12:15], v[84:87]
    ds_read_b64_tr_b16 a[60:61], v5 offset:12288
    v_add_u32 v12, 196608, v12
    v_mfma_f32_16x16x32_bf16 v[72:75], a[36:39], a[0:3], v[72:75]
    ds_read_b64_tr_b16 a[62:63], v5 offset:12800
    v_mfma_f32_16x16x32_bf16 v[76:79], a[36:39], a[4:7], v[76:79]
    ds_read_b64_tr_b16 a[64:65], v4 offset:16384
    v_mfma_f32_16x16x32_bf16 v[88:91], a[36:39], a[8:11], v[88:91]
    ds_read_b64_tr_b16 a[66:67], v4 offset:16896
    v_mfma_f32_16x16x32_bf16 v[92:95], a[36:39], a[12:15], v[92:95]
    ds_read_b64_tr_b16 a[68:69], v5 offset:16384
    s_add_u32 m0, s34, 139264
    s_waitcnt lgkmcnt(7)
    v_mfma_f32_16x16x32_bf16 v[96:99], a[40:43], a[0:3], v[96:99]
    global_load_lds_dwordx4 v13, s[52:53]
    v_mfma_f32_16x16x32_bf16 v[100:103], a[40:43], a[4:7], v[100:103]
    ds_read_b64_tr_b16 a[70:71], v5 offset:16896
    v_add_u32 v13, 196608, v13
    v_mfma_f32_16x16x32_bf16 v[112:115], a[40:43], a[8:11], v[112:115]
    ds_read_b64_tr_b16 a[72:73], v4 offset:20480
    v_mfma_f32_16x16x32_bf16 v[116:119], a[40:43], a[12:15], v[116:119]
    ds_read_b64_tr_b16 a[74:75], v4 offset:20992
    v_mfma_f32_16x16x32_bf16 v[104:107], a[44:47], a[0:3], v[104:107]
    ds_read_b64_tr_b16 a[76:77], v5 offset:20480
    v_mfma_f32_16x16x32_bf16 v[108:111], a[44:47], a[4:7], v[108:111]
    ds_read_b64_tr_b16 a[78:79], v5 offset:20992
    s_add_u32 m0, s34, 143360
    v_mfma_f32_16x16x32_bf16 v[120:123], a[44:47], a[8:11], v[120:123]
    global_load_lds_dwordx4 v14, s[52:53]
    v_mfma_f32_16x16x32_bf16 v[124:127], a[44:47], a[12:15], v[124:127]
    v_add_u32 v14, 196608, v14
    v_mfma_f32_16x16x32_bf16 v[128:131], a[0:3], a[48:51], v[128:131]
    v_mfma_f32_16x16x32_bf16 v[136:139], a[4:7], a[48:51], v[136:139]
    v_mfma_f32_16x16x32_bf16 v[144:147], a[8:11], a[48:51], v[144:147]
    v_mfma_f32_16x16x32_bf16 v[152:155], a[12:15], a[48:51], v[152:155]
    s_add_u32 m0, s30, 1024
    v_mfma_f32_16x16x32_bf16 v[132:135], a[0:3], a[52:55], v[132:135]
    global_load_lds_dwordx4 v16, s[48:49]
    v_mfma_f32_16x16x32_bf16 v[140:143], a[4:7], a[52:55], v[140:143]
    v_add_u32 v16, 128, v16
    v_mfma_f32_16x16x32_bf16 v[148:151], a[8:11], a[52:55], v[148:151]
    v_mfma_f32_16x16x32_bf16 v[156:159], a[12:15], a[52:55], v[156:159]
    s_waitcnt vmcnt(18) lgkmcnt(0)
    s_barrier
    v_mfma_f32_16x16x32_bf16 v[160:163], a[56:59], a[0:3], v[160:163]
    ds_read_b128 a[16:19], v3 offset:16384
    v_mfma_f32_16x16x32_bf16 v[168:171], a[56:59], a[4:7], v[168:171]
    ds_read_b128 a[20:23], v3 offset:18432
    s_add_u32 m0, s34, 49152
    v_mfma_f32_16x16x32_bf16 v[176:179], a[56:59], a[8:11], v[176:179]
    global_load_lds_dwordx4 v12, s[50:51]
    v_mfma_f32_16x16x32_bf16 v[184:187], a[56:59], a[12:15], v[184:187]
    ds_read_b128 a[24:27], v3 offset:20480
    v_mfma_f32_16x16x32_bf16 v[164:167], a[60:63], a[0:3], v[164:167]
    ds_read_b128 a[28:31], v3 offset:22528
    v_mfma_f32_16x16x32_bf16 v[172:175], a[60:63], a[4:7], v[172:175]
    ds_read_b64_tr_b16 a[32:33], v4 offset:24576
    v_mfma_f32_16x16x32_bf16 v[180:183], a[60:63], a[8:11], v[180:183]
    ds_read_b64_tr_b16 a[34:35], v4 offset:25088
    v_mfma_f32_16x16x32_bf16 v[188:191], a[60:63], a[12:15], v[188:191]
    ds_read_b64_tr_b16 a[36:37], v5 offset:24576
    s_add_u32 m0, s34, 53248
    v_mfma_f32_16x16x32_bf16 v[192:195], a[64:67], a[0:3], v[192:195]
    global_load_lds_dwordx4 v13, s[50:51]
    v_mfma_f32_16x16x32_bf16 v[200:203], a[64:67], a[4:7], v[200:203]
    ds_read_b64_tr_b16 a[38:39], v5 offset:25088
    v_mfma_f32_16x16x32_bf16 v[208:211], a[64:67], a[8:11], v[208:211]
    ds_read_b64_tr_b16 a[40:41], v4 offset:28672
    v_mfma_f32_16x16x32_bf16 v[216:219], a[64:67], a[12:15], v[216:219]
    ds_read_b64_tr_b16 a[42:43], v4 offset:29184
    v_mfma_f32_16x16x32_bf16 v[196:199], a[68:71], a[0:3], v[196:199]
    ds_read_b64_tr_b16 a[44:45], v5 offset:28672
    v_mfma_f32_16x16x32_bf16 v[204:207], a[68:71], a[4:7], v[204:207]
    ds_read_b64_tr_b16 a[46:47], v5 offset:29184
    s_add_u32 m0, s34, 57344
    v_mfma_f32_16x16x32_bf16 v[212:215], a[68:71], a[8:11], v[212:215]
    global_load_lds_dwordx4 v14, s[50:51]
    v_mfma_f32_16x16x32_bf16 v[220:223], a[68:71], a[12:15], v[220:223]
    ds_read_b64_tr_b16 a[48:49], v4 offset:32768
    v_mfma_f32_16x16x32_bf16 v[224:227], a[0:3], a[72:75], v[224:227]
    ds_read_b64_tr_b16 a[50:51], v4 offset:33280
    v_mfma_f32_16x16x32_bf16 v[228:231], a[4:7], a[72:75], v[228:231]
    ds_read_b64_tr_b16 a[52:53], v5 offset:32768
    v_mfma_f32_16x16x32_bf16 v[240:243], a[8:11], a[72:75], v[240:243]
    ds_read_b64_tr_b16 a[54:55], v5 offset:33280
    v_mfma_f32_16x16x32_bf16 v[244:247], a[12:15], a[72:75], v[244:247]
    s_add_u32 m0, s30, 2048
    v_mfma_f32_16x16x32_bf16 v[232:235], a[0:3], a[76:79], v[232:235]
    global_load_lds_dwordx4 v17, s[48:49]
    v_mfma_f32_16x16x32_bf16 v[236:239], a[4:7], a[76:79], v[236:239]
    v_add_u32 v17, 128, v17
    v_mfma_f32_16x16x32_bf16 v[248:251], a[8:11], a[76:79], v[248:251]
    v_mfma_f32_16x16x32_bf16 v[252:255], a[12:15], a[76:79], v[252:255]
    s_waitcnt lgkmcnt(8)
    v_mfma_f32_16x16x32_bf16 v[64:67], a[32:35], a[16:19], v[64:67]
    ds_read_b64_tr_b16 a[56:57], v4 offset:36864
    v_mfma_f32_16x16x32_bf16 v[68:71], a[32:35], a[20:23], v[68:71]
    ds_read_b64_tr_b16 a[58:59], v4 offset:37376
    s_add_u32 m0, s34, 61440
    v_mfma_f32_16x16x32_bf16 v[80:83], a[32:35], a[24:27], v[80:83]
    global_load_lds_dwordx4 v12, s[52:53]
    v_mfma_f32_16x16x32_bf16 v[84:87], a[32:35], a[28:31], v[84:87]
    ds_read_b64_tr_b16 a[60:61], v5 offset:36864
    v_add_u32 v12, 196608, v12
    v_mfma_f32_16x16x32_bf16 v[72:75], a[36:39], a[16:19], v[72:75]
    ds_read_b64_tr_b16 a[62:63], v5 offset:37376
    v_mfma_f32_16x16x32_bf16 v[76:79], a[36:39], a[20:23], v[76:79]
    ds_read_b64_tr_b16 a[64:65], v4 offset:40960
    v_mfma_f32_16x16x32_bf16 v[88:91], a[36:39], a[24:27], v[88:91]
    ds_read_b64_tr_b16 a[66:67], v4 offset:41472
    v_mfma_f32_16x16x32_bf16 v[92:95], a[36:39], a[28:31], v[92:95]
    ds_read_b64_tr_b16 a[68:69], v5 offset:40960
    s_add_u32 m0, s34, 65536
    s_waitcnt lgkmcnt(7)
    v_mfma_f32_16x16x32_bf16 v[96:99], a[40:43], a[16:19], v[96:99]
    global_load_lds_dwordx4 v13, s[52:53]
    v_mfma_f32_16x16x32_bf16 v[100:103], a[40:43], a[20:23], v[100:103]
    ds_read_b64_tr_b16 a[70:71], v5 offset:41472
    v_add_u32 v13, 196608, v13
    v_mfma_f32_16x16x32_bf16 v[112:115], a[40:43], a[24:27], v[112:115]
    ds_read_b64_tr_b16 a[72:73], v4 offset:45056
    v_mfma_f32_16x16x32_bf16 v[116:119], a[40:43], a[28:31], v[116:119]
    ds_read_b64_tr_b16 a[74:75], v4 offset:45568
    v_mfma_f32_16x16x32_bf16 v[104:107], a[44:47], a[16:19], v[104:107]
    ds_read_b64_tr_b16 a[76:77], v5 offset:45056
    v_mfma_f32_16x16x32_bf16 v[108:111], a[44:47], a[20:23], v[108:111]
    ds_read_b64_tr_b16 a[78:79], v5 offset:45568
    s_add_u32 m0, s34, 69632
    v_mfma_f32_16x16x32_bf16 v[120:123], a[44:47], a[24:27], v[120:123]
    global_load_lds_dwordx4 v14, s[52:53]
    v_mfma_f32_16x16x32_bf16 v[124:127], a[44:47], a[28:31], v[124:127]
    v_add_u32 v14, 196608, v14
    v_mfma_f32_16x16x32_bf16 v[128:131], a[16:19], a[48:51], v[128:131]
    v_mfma_f32_16x16x32_bf16 v[136:139], a[20:23], a[48:51], v[136:139]
    v_mfma_f32_16x16x32_bf16 v[144:147], a[24:27], a[48:51], v[144:147]
    v_mfma_f32_16x16x32_bf16 v[152:155], a[28:31], a[48:51], v[152:155]
    s_add_u32 m0, s30, 3072
    v_mfma_f32_16x16x32_bf16 v[132:135], a[16:19], a[52:55], v[132:135]
    global_load_lds_dwordx4 v18, s[48:49]
    v_mfma_f32_16x16x32_bf16 v[140:143], a[20:23], a[52:55], v[140:143]
    v_add_u32 v18, 128, v18
    v_mfma_f32_16x16x32_bf16 v[148:151], a[24:27], a[52:55], v[148:151]
    v_mfma_f32_16x16x32_bf16 v[156:159], a[28:31], a[52:55], v[156:159]
    global_load_dword v28, v27, s[44:45]
    v_add_u32 v27, s46, v27
    s_waitcnt vmcnt(18) lgkmcnt(0)
    s_barrier
    v_mfma_f32_16x16x32_bf16 v[160:163], a[56:59], a[16:19], v[160:163]
    ds_read_b128 a[0:3], v2 offset:32768
    v_mfma_f32_16x16x32_bf16 v[168:171], a[56:59], a[20:23], v[168:171]
    ds_read_b128 a[4:7], v2 offset:34816
    s_add_u32 m0, s34, 73728
    v_mfma_f32_16x16x32_bf16 v[176:179], a[56:59], a[24:27], v[176:179]
    global_load_lds_dwordx4 v12, s[50:51]
    v_mfma_f32_16x16x32_bf16 v[184:187], a[56:59], a[28:31], v[184:187]
    ds_read_b128 a[8:11], v2 offset:36864
    v_mfma_f32_16x16x32_bf16 v[164:167], a[60:63], a[16:19], v[164:167]
    ds_read_b128 a[12:15], v2 offset:38912
    v_mfma_f32_16x16x32_bf16 v[172:175], a[60:63], a[20:23], v[172:175]
    ds_read_b64_tr_b16 a[32:33], v10 offset:0
    v_mfma_f32_16x16x32_bf16 v[180:183], a[60:63], a[24:27], v[180:183]
    ds_read_b64_tr_b16 a[34:35], v10 offset:512
    v_mfma_f32_16x16x32_bf16 v[188:191], a[60:63], a[28:31], v[188:191]
    ds_read_b64_tr_b16 a[36:37], v11 offset:0
    s_add_u32 m0, s34, 77824
    v_mfma_f32_16x16x32_bf16 v[192:195], a[64:67], a[16:19], v[192:195]
    global_load_lds_dwordx4 v13, s[50:51]
    v_mfma_f32_16x16x32_bf16 v[200:203], a[64:67], a[20:23], v[200:203]
    ds_read_b64_tr_b16 a[38:39], v11 offset:512
    v_mfma_f32_16x16x32_bf16 v[208:211], a[64:67], a[24:27], v[208:211]
    ds_read_b64_tr_b16 a[40:41], v10 offset:4096
    v_mfma_f32_16x16x32_bf16 v[216:219], a[64:67], a[28:31], v[216:219]
    ds_read_b64_tr_b16 a[42:43], v10 offset:4608
    v_mfma_f32_16x16x32_bf16 v[196:199], a[68:71], a[16:19], v[196:199]
    ds_read_b64_tr_b16 a[44:45], v11 offset:4096
    v_mfma_f32_16x16x32_bf16 v[204:207], a[68:71], a[20:23], v[204:207]
    ds_read_b64_tr_b16 a[46:47], v11 offset:4608
    s_add_u32 m0, s34, 81920
    v_mfma_f32_16x16x32_bf16 v[212:215], a[68:71], a[24:27], v[212:215]
    global_load_lds_dwordx4 v14, s[50:51]
    v_mfma_f32_16x16x32_bf16 v[220:223], a[68:71], a[28:31], v[220:223]
    ds_read_b64_tr_b16 a[48:49], v10 offset:8192
    v_mfma_f32_16x16x32_bf16 v[224:227], a[16:19], a[72:75], v[224:227]
    ds_read_b64_tr_b16 a[50:51], v10 offset:8704
    v_mfma_f32_16x16x32_bf16 v[228:231], a[20:23], a[72:75], v[228:231]
    ds_read_b64_tr_b16 a[52:53], v11 offset:8192
    v_mfma_f32_16x16x32_bf16 v[240:243], a[24:27], a[72:75], v[240:243]
    ds_read_b64_tr_b16 a[54:55], v11 offset:8704
    v_mfma_f32_16x16x32_bf16 v[244:247], a[28:31], a[72:75], v[244:247]
    s_add_u32 m0, s30, 16384
    v_mfma_f32_16x16x32_bf16 v[232:235], a[16:19], a[76:79], v[232:235]
    global_load_lds_dwordx4 v15, s[48:49]
    v_mfma_f32_16x16x32_bf16 v[236:239], a[20:23], a[76:79], v[236:239]
    v_add_u32 v15, 128, v15
    v_mfma_f32_16x16x32_bf16 v[248:251], a[24:27], a[76:79], v[248:251]
    v_mfma_f32_16x16x32_bf16 v[252:255], a[28:31], a[76:79], v[252:255]
    s_waitcnt lgkmcnt(8)
    v_mfma_f32_16x16x32_bf16 v[64:67], a[32:35], a[0:3], v[64:67]
    ds_read_b64_tr_b16 a[56:57], v10 offset:12288
    v_mfma_f32_16x16x32_bf16 v[68:71], a[32:35], a[4:7], v[68:71]
    ds_read_b64_tr_b16 a[58:59], v10 offset:12800
    s_add_u32 m0, s34, 86016
    v_mfma_f32_16x16x32_bf16 v[80:83], a[32:35], a[8:11], v[80:83]
    global_load_lds_dwordx4 v12, s[52:53]
    v_mfma_f32_16x16x32_bf16 v[84:87], a[32:35], a[12:15], v[84:87]
    ds_read_b64_tr_b16 a[60:61], v11 offset:12288
    v_add_u32 v12, 196608, v12
    v_mfma_f32_16x16x32_bf16 v[72:75], a[36:39], a[0:3], v[72:75]
    ds_read_b64_tr_b16 a[62:63], v11 offset:12800
    v_mfma_f32_16x16x32_bf16 v[76:79], a[36:39], a[4:7], v[76:79]
    ds_read_b64_tr_b16 a[64:65], v10 offset:16384
    v_mfma_f32_16x16x32_bf16 v[88:91], a[36:39], a[8:11], v[88:91]
    ds_read_b64_tr_b16 a[66:67], v10 offset:16896
    v_mfma_f32_16x16x32_bf16 v[92:95], a[36:39], a[12:15], v[92:95]
    ds_read_b64_tr_b16 a[68:69], v11 offset:16384
    s_add_u32 m0, s34, 90112
    s_waitcnt lgkmcnt(7)
    v_mfma_f32_16x16x32_bf16 v[96:99], a[40:43], a[0:3], v[96:99]
    global_load_lds_dwordx4 v13, s[52:53]
    v_mfma_f32_16x16x32_bf16 v[100:103], a[40:43], a[4:7], v[100:103]
    ds_read_b64_tr_b16 a[70:71], v11 offset:16896
    v_add_u32 v13, 196608, v13
    v_mfma_f32_16x16x32_bf16 v[112:115], a[40:43], a[8:11], v[112:115]
    ds_read_b64_tr_b16 a[72:73], v10 offset:20480
    v_mfma_f32_16x16x32_bf16 v[116:119], a[40:43], a[12:15], v[116:119]
    ds_read_b64_tr_b16 a[74:75], v10 offset:20992
    v_mfma_f32_16x16x32_bf16 v[104:107], a[44:47], a[0:3], v[104:107]
    ds_read_b64_tr_b16 a[76:77], v11 offset:20480
    v_mfma_f32_16x16x32_bf16 v[108:111], a[44:47], a[4:7], v[108:111]
    ds_read_b64_tr_b16 a[78:79], v11 offset:20992
    s_add_u32 m0, s34, 94208
    v_mfma_f32_16x16x32_bf16 v[120:123], a[44:47], a[8:11], v[120:123]
    global_load_lds_dwordx4 v14, s[52:53]
    v_mfma_f32_16x16x32_bf16 v[124:127], a[44:47], a[12:15], v[124:127]
    v_add_u32 v14, 196608, v14
    v_mfma_f32_16x16x32_bf16 v[128:131], a[0:3], a[48:51], v[128:131]
    v_mfma_f32_16x16x32_bf16 v[136:139], a[4:7], a[48:51], v[136:139]
    v_mfma_f32_16x16x32_bf16 v[144:147], a[8:11], a[48:51], v[144:147]
    v_mfma_f32_16x16x32_bf16 v[152:155], a[12:15], a[48:51], v[152:155]
    s_add_u32 m0, s30, 17408
    v_mfma_f32_16x16x32_bf16 v[132:135], a[0:3], a[52:55], v[132:135]
    global_load_lds_dwordx4 v16, s[48:49]
    v_mfma_f32_16x16x32_bf16 v[140:143], a[4:7], a[52:55], v[140:143]
    v_add_u32 v16, 128, v16
    v_mfma_f32_16x16x32_bf16 v[148:151], a[8:11], a[52:55], v[148:151]
    v_mfma_f32_16x16x32_bf16 v[156:159], a[12:15], a[52:55], v[156:159]
    s_waitcnt vmcnt(18) lgkmcnt(0)
    s_barrier
    v_mfma_f32_16x16x32_bf16 v[160:163], a[56:59], a[0:3], v[160:163]
    ds_read_b128 a[16:19], v3 offset:32768
    v_mfma_f32_16x16x32_bf16 v[168:171], a[56:59], a[4:7], v[168:171]
    ds_read_b128 a[20:23], v3 offset:34816
    s_add_u32 m0, s34, 98304
    v_mfma_f32_16x16x32_bf16 v[176:179], a[56:59], a[8:11], v[176:179]
    global_load_lds_dwordx4 v12, s[50:51]
    v_mfma_f32_16x16x32_bf16 v[184:187], a[56:59], a[12:15], v[184:187]
    ds_read_b128 a[24:27], v3 offset:36864
    v_mfma_f32_16x16x32_bf16 v[164:167], a[60:63], a[0:3], v[164:167]
    ds_read_b128 a[28:31], v3 offset:38912
    v_mfma_f32_16x16x32_bf16 v[172:175], a[60:63], a[4:7], v[172:175]
    ds_read_b64_tr_b16 a[32:33], v10 offset:24576
    v_mfma_f32_16x16x32_bf16 v[180:183], a[60:63], a[8:11], v[180:183]
    ds_read_b64_tr_b16 a[34:35], v10 offset:25088
    v_mfma_f32_16x16x32_bf16 v[188:191], a[60:63], a[12:15], v[188:191]
    ds_read_b64_tr_b16 a[36:37], v11 offset:24576
    s_add_u32 m0, s34, 102400
    v_mfma_f32_16x16x32_bf16 v[192:195], a[64:67], a[0:3], v[192:195]
    global_load_lds_dwordx4 v13, s[50:51]
    v_mfma_f32_16x16x32_bf16 v[200:203], a[64:67], a[4:7], v[200:203]
    ds_read_b64_tr_b16 a[38:39], v11 offset:25088
    v_mfma_f32_16x16x32_bf16 v[208:211], a[64:67], a[8:11], v[208:211]
    ds_read_b64_tr_b16 a[40:41], v10 offset:28672
    v_mfma_f32_16x16x32_bf16 v[216:219], a[64:67], a[12:15], v[216:219]
    ds_read_b64_tr_b16 a[42:43], v10 offset:29184
    v_mfma_f32_16x16x32_bf16 v[196:199], a[68:71], a[0:3], v[196:199]
    ds_read_b64_tr_b16 a[44:45], v11 offset:28672
    v_mfma_f32_16x16x32_bf16 v[204:207], a[68:71], a[4:7], v[204:207]
    ds_read_b64_tr_b16 a[46:47], v11 offset:29184
    s_add_u32 m0, s34, 106496
    v_mfma_f32_16x16x32_bf16 v[212:215], a[68:71], a[8:11], v[212:215]
    global_load_lds_dwordx4 v14, s[50:51]
    v_mfma_f32_16x16x32_bf16 v[220:223], a[68:71], a[12:15], v[220:223]
    ds_read_b64_tr_b16 a[48:49], v10 offset:32768
    v_mfma_f32_16x16x32_bf16 v[224:227], a[0:3], a[72:75], v[224:227]
    ds_read_b64_tr_b16 a[50:51], v10 offset:33280
    v_mfma_f32_16x16x32_bf16 v[228:231], a[4:7], a[72:75], v[228:231]
    ds_read_b64_tr_b16 a[52:53], v11 offset:32768
    v_mfma_f32_16x16x32_bf16 v[240:243], a[8:11], a[72:75], v[240:243]
    ds_read_b64_tr_b16 a[54:55], v11 offset:33280
    v_mfma_f32_16x16x32_bf16 v[244:247], a[12:15], a[72:75], v[244:247]
    s_add_u32 m0, s30, 18432
    v_mfma_f32_16x16x32_bf16 v[232:235], a[0:3], a[76:79], v[232:235]
    global_load_lds_dwordx4 v17, s[48:49]
    v_mfma_f32_16x16x32_bf16 v[236:239], a[4:7], a[76:79], v[236:239]
    v_add_u32 v17, 128, v17
    v_mfma_f32_16x16x32_bf16 v[248:251], a[8:11], a[76:79], v[248:251]
    v_mfma_f32_16x16x32_bf16 v[252:255], a[12:15], a[76:79], v[252:255]
    s_waitcnt lgkmcnt(8)
    v_mfma_f32_16x16x32_bf16 v[64:67], a[32:35], a[16:19], v[64:67]
    ds_read_b64_tr_b16 a[56:57], v10 offset:36864
    v_mfma_f32_16x16x32_bf16 v[68:71], a[32:35], a[20:23], v[68:71]
    ds_read_b64_tr_b16 a[58:59], v10 offset:37376
    s_add_u32 m0, s34, 110592
    v_mfma_f32_16x16x32_bf16 v[80:83], a[32:35], a[24:27], v[80:83]
    global_load_lds_dwordx4 v12, s[52:53]
    v_mfma_f32_16x16x32_bf16 v[84:87], a[32:35], a[28:31], v[84:87]
    ds_read_b64_tr_b16 a[60:61], v11 offset:36864
    v_add_u32 v12, 196608, v12
    v_mfma_f32_16x16x32_bf16 v[72:75], a[36:39], a[16:19], v[72:75]
    ds_read_b64_tr_b16 a[62:63], v11 offset:37376
    v_mfma_f32_16x16x32_bf16 v[76:79], a[36:39], a[20:23], v[76:79]
    ds_read_b64_tr_b16 a[64:65], v10 offset:40960
    v_mfma_f32_16x16x32_bf16 v[88:91], a[36:39], a[24:27], v[88:91]
    ds_read_b64_tr_b16 a[66:67], v10 offset:41472
    v_mfma_f32_16x16x32_bf16 v[92:95], a[36:39], a[28:31], v[92:95]
    ds_read_b64_tr_b16 a[68:69], v11 offset:40960
    s_add_u32 m0, s34, 114688
    s_waitcnt lgkmcnt(7)
    v_mfma_f32_16x16x32_bf16 v[96:99], a[40:43], a[16:19], v[96:99]
    global_load_lds_dwordx4 v13, s[52:53]
    v_mfma_f32_16x16x32_bf16 v[100:103], a[40:43], a[20:23], v[100:103]
    ds_read_b64_tr_b16 a[70:71], v11 offset:41472
    v_add_u32 v13, 196608, v13
    v_mfma_f32_16x16x32_bf16 v[112:115], a[40:43], a[24:27], v[112:115]
    ds_read_b64_tr_b16 a[72:73], v10 offset:45056
    v_mfma_f32_16x16x32_bf16 v[116:119], a[40:43], a[28:31], v[116:119]
    ds_read_b64_tr_b16 a[74:75], v10 offset:45568
    v_mfma_f32_16x16x32_bf16 v[104:107], a[44:47], a[16:19], v[104:107]
    ds_read_b64_tr_b16 a[76:77], v11 offset:45056
    v_mfma_f32_16x16x32_bf16 v[108:111], a[44:47], a[20:23], v[108:111]
    ds_read_b64_tr_b16 a[78:79], v11 offset:45568
    s_add_u32 m0, s34, 118784
    v_mfma_f32_16x16x32_bf16 v[120:123], a[44:47], a[24:27], v[120:123]
    global_load_lds_dwordx4 v14, s[52:53]
    v_mfma_f32_16x16x32_bf16 v[124:127], a[44:47], a[28:31], v[124:127]
    v_add_u32 v14, 196608, v14
    v_mfma_f32_16x16x32_bf16 v[128:131], a[16:19], a[48:51], v[128:131]
    v_mfma_f32_16x16x32_bf16 v[136:139], a[20:23], a[48:51], v[136:139]
    v_mfma_f32_16x16x32_bf16 v[144:147], a[24:27], a[48:51], v[144:147]
    v_mfma_f32_16x16x32_bf16 v[152:155], a[28:31], a[48:51], v[152:155]
    s_add_u32 m0, s30, 19456
    v_mfma_f32_16x16x32_bf16 v[132:135], a[16:19], a[52:55], v[132:135]
    global_load_lds_dwordx4 v18, s[48:49]
    v_mfma_f32_16x16x32_bf16 v[140:143], a[20:23], a[52:55], v[140:143]
    v_add_u32 v18, 128, v18
    v_mfma_f32_16x16x32_bf16 v[148:151], a[24:27], a[52:55], v[148:151]
    v_mfma_f32_16x16x32_bf16 v[156:159], a[28:31], a[52:55], v[156:159]
    global_load_dword v28, v27, s[44:45]
    v_add_u32 v27, s46, v27
    s_waitcnt vmcnt(18) lgkmcnt(0)
    s_barrier
    v_mfma_f32_16x16x32_bf16 v[160:163], a[56:59], a[16:19], v[160:163]
    ds_read_b128 a[0:3], v2 offset:0
    v_mfma_f32_16x16x32_bf16 v[168:171], a[56:59], a[20:23], v[168:171]
    ds_read_b128 a[4:7], v2 offset:2048
    s_add_u32 m0, s34, 122880
    v_mfma_f32_16x16x32_bf16 v[176:179], a[56:59], a[24:27], v[176:179]
    global_load_lds_dwordx4 v12, s[50:51]
    v_mfma_f32_16x16x32_bf16 v[184:187], a[56:59], a[28:31], v[184:187]
    ds_read_b128 a[8:11], v2 offset:4096
    v_mfma_f32_16x16x32_bf16 v[164:167], a[60:63], a[16:19], v[164:167]
    ds_read_b128 a[12:15], v2 offset:6144
    v_mfma_f32_16x16x32_bf16 v[172:175], a[60:63], a[20:23], v[172:175]
    ds_read_b64_tr_b16 a[32:33], v4 offset:0
    v_mfma_f32_16x16x32_bf16 v[180:183], a[60:63], a[24:27], v[180:183]
    ds_read_b64_tr_b16 a[34:35], v4 offset:512
    v_mfma_f32_16x16x32_bf16 v[188:191], a[60:63], a[28:31], v[188:191]
    ds_read_b64_tr_b16 a[36:37], v5 offset:0
    s_add_u32 m0, s34, 126976
    v_mfma_f32_16x16x32_bf16 v[192:195], a[64:67], a[16:19], v[192:195]
    global_load_lds_dwordx4 v13, s[50:51]
    v_mfma_f32_16x16x32_bf16 v[200:203], a[64:67], a[20:23], v[200:203]
    ds_read_b64_tr_b16 a[38:39], v5 offset:512
    v_mfma_f32_16x16x32_bf16 v[208:211], a[64:67], a[24:27], v[208:211]
    ds_read_b64_tr_b16 a[40:41], v4 offset:4096
    v_mfma_f32_16x16x32_bf16 v[216:219], a[64:67], a[28:31], v[216:219]
    ds_read_b64_tr_b16 a[42:43], v4 offset:4608
    v_mfma_f32_16x16x32_bf16 v[196:199], a[68:71], a[16:19], v[196:199]
    ds_read_b64_tr_b16 a[44:45], v5 offset:4096
    v_mfma_f32_16x16x32_bf16 v[204:207], a[68:71], a[20:23], v[204:207]
    ds_read_b64_tr_b16 a[46:47], v5 offset:4608
    s_add_u32 m0, s34, 131072
    v_mfma_f32_16x16x32_bf16 v[212:215], a[68:71], a[24:27], v[212:215]
    global_load_lds_dwordx4 v14, s[50:51]
    v_mfma_f32_16x16x32_bf16 v[220:223], a[68:71], a[28:31], v[220:223]
    ds_read_b64_tr_b16 a[48:49], v4 offset:8192
    v_mfma_f32_16x16x32_bf16 v[224:227], a[16:19], a[72:75], v[224:227]
    ds_read_b64_tr_b16 a[50:51], v4 offset:8704
    v_mfma_f32_16x16x32_bf16 v[228:231], a[20:23], a[72:75], v[228:231]
    ds_read_b64_tr_b16 a[52:53], v5 offset:8192
    v_mfma_f32_16x16x32_bf16 v[240:243], a[24:27], a[72:75], v[240:243]
    ds_read_b64_tr_b16 a[54:55], v5 offset:8704
    v_mfma_f32_16x16x32_bf16 v[244:247], a[28:31], a[72:75], v[244:247]
    s_add_u32 m0, s30, 32768
    v_mfma_f32_16x16x32_bf16 v[232:235], a[16:19], a[76:79], v[232:235]
    global_load_lds_dwordx4 v15, s[48:49]
    v_mfma_f32_16x16x32_bf16 v[236:239], a[20:23], a[76:79], v[236:239]
    v_add_u32 v15, 128, v15
    v_mfma_f32_16x16x32_bf16 v[248:251], a[24:27], a[76:79], v[248:251]
    v_mfma_f32_16x16x32_bf16 v[252:255], a[28:31], a[76:79], v[252:255]
    s_waitcnt lgkmcnt(8)
    v_mfma_f32_16x16x32_bf16 v[64:67], a[32:35], a[0:3], v[64:67]
    ds_read_b64_tr_b16 a[56:57], v4 offset:12288
    v_mfma_f32_16x16x32_bf16 v[68:71], a[32:35], a[4:7], v[68:71]
    ds_read_b64_tr_b16 a[58:59], v4 offset:12800
    s_add_u32 m0, s34, 135168
    v_mfma_f32_16x16x32_bf16 v[80:83], a[32:35], a[8:11], v[80:83]
    global_load_lds_dwordx4 v12, s[52:53]
    v_mfma_f32_16x16x32_bf16 v[84:87], a[32:35], a[12:15], v[84:87]
    ds_read_b64_tr_b16 a[60:61], v5 offset:12288
    v_add_u32 v12, 196608, v12
    v_mfma_f32_16x16x32_bf16 v[72:75], a[36:39], a[0:3], v[72:75]
    ds_read_b64_tr_b16 a[62:63], v5 offset:12800
    v_mfma_f32_16x16x32_bf16 v[76:79], a[36:39], a[4:7], v[76:79]
    ds_read_b64_tr_b16 a[64:65], v4 offset:16384
    v_mfma_f32_16x16x32_bf16 v[88:91], a[36:39], a[8:11], v[88:91]
    ds_read_b64_tr_b16 a[66:67], v4 offset:16896
    v_mfma_f32_16x16x32_bf16 v[92:95], a[36:39], a[12:15], v[92:95]
    ds_read_b64_tr_b16 a[68:69], v5 offset:16384
    s_add_u32 m0, s34, 139264
    s_waitcnt lgkmcnt(7)
    v_mfma_f32_16x16x32_bf16 v[96:99], a[40:43], a[0:3], v[96:99]
    global_load_lds_dwordx4 v13, s[52:53]
    v_mfma_f32_16x16x32_bf16 v[100:103], a[40:43], a[4:7], v[100:103]
    ds_read_b64_tr_b16 a[70:71], v5 offset:16896
    v_add_u32 v13, 196608, v13
    v_mfma_f32_16x16x32_bf16 v[112:115], a[40:43], a[8:11], v[112:115]
    ds_read_b64_tr_b16 a[72:73], v4 offset:20480
    v_mfma_f32_16x16x32_bf16 v[116:119], a[40:43], a[12:15], v[116:119]
    ds_read_b64_tr_b16 a[74:75], v4 offset:20992
    v_mfma_f32_16x16x32_bf16 v[104:107], a[44:47], a[0:3], v[104:107]
    ds_read_b64_tr_b16 a[76:77], v5 offset:20480
    v_mfma_f32_16x16x32_bf16 v[108:111], a[44:47], a[4:7], v[108:111]
    ds_read_b64_tr_b16 a[78:79], v5 offset:20992
    s_add_u32 m0, s34, 143360
    v_mfma_f32_16x16x32_bf16 v[120:123], a[44:47], a[8:11], v[120:123]
    global_load_lds_dwordx4 v14, s[52:53]
    v_mfma_f32_16x16x32_bf16 v[124:127], a[44:47], a[12:15], v[124:127]
    v_add_u32 v14, 196608, v14
    v_mfma_f32_16x16x32_bf16 v[128:131], a[0:3], a[48:51], v[128:131]
    v_mfma_f32_16x16x32_bf16 v[136:139], a[4:7], a[48:51], v[136:139]
    v_mfma_f32_16x16x32_bf16 v[144:147], a[8:11], a[48:51], v[144:147]
    v_mfma_f32_16x16x32_bf16 v[152:155], a[12:15], a[48:51], v[152:155]
    s_add_u32 m0, s30, 33792
    v_mfma_f32_16x16x32_bf16 v[132:135], a[0:3], a[52:55], v[132:135]
    global_load_lds_dwordx4 v16, s[48:49]
    v_mfma_f32_16x16x32_bf16 v[140:143], a[4:7], a[52:55], v[140:143]
    v_add_u32 v16, 128, v16
    v_mfma_f32_16x16x32_bf16 v[148:151], a[8:11], a[52:55], v[148:151]
    v_mfma_f32_16x16x32_bf16 v[156:159], a[12:15], a[52:55], v[156:159]
    s_waitcnt vmcnt(18) lgkmcnt(0)
    s_barrier
    v_mfma_f32_16x16x32_bf16 v[160:163], a[56:59], a[0:3], v[160:163]
    ds_read_b128 a[16:19], v3 offset:0
    v_mfma_f32_16x16x32_bf16 v[168:171], a[56:59], a[4:7], v[168:171]
    ds_read_b128 a[20:23], v3 offset:2048
    s_add_u32 m0, s34, 49152
    v_mfma_f32_16x16x32_bf16 v[176:179], a[56:59], a[8:11], v[176:179]
    global_load_lds_dwordx4 v12, s[50:51]
    v_mfma_f32_16x16x32_bf16 v[184:187], a[56:59], a[12:15], v[184:187]
    ds_read_b128 a[24:27], v3 offset:4096
    v_mfma_f32_16x16x32_bf16 v[164:167], a[60:63], a[0:3], v[164:167]
    ds_read_b128 a[28:31], v3 offset:6144
    v_mfma_f32_16x16x32_bf16 v[172:175], a[60:63], a[4:7], v[172:175]
    ds_read_b64_tr_b16 a[32:33], v4 offset:24576
    v_mfma_f32_16x16x32_bf16 v[180:183], a[60:63], a[8:11], v[180:183]
    ds_read_b64_tr_b16 a[34:35], v4 offset:25088
    v_mfma_f32_16x16x32_bf16 v[188:191], a[60:63], a[12:15], v[188:191]
    ds_read_b64_tr_b16 a[36:37], v5 offset:24576
    s_add_u32 m0, s34, 53248
    v_mfma_f32_16x16x32_bf16 v[192:195], a[64:67], a[0:3], v[192:195]
    global_load_lds_dwordx4 v13, s[50:51]
    v_mfma_f32_16x16x32_bf16 v[200:203], a[64:67], a[4:7], v[200:203]
    ds_read_b64_tr_b16 a[38:39], v5 offset:25088
    v_mfma_f32_16x16x32_bf16 v[208:211], a[64:67], a[8:11], v[208:211]
    ds_read_b64_tr_b16 a[40:41], v4 offset:28672
    v_mfma_f32_16x16x32_bf16 v[216:219], a[64:67], a[12:15], v[216:219]
    ds_read_b64_tr_b16 a[42:43], v4 offset:29184
    v_mfma_f32_16x16x32_bf16 v[196:199], a[68:71], a[0:3], v[196:199]
    ds_read_b64_tr_b16 a[44:45], v5 offset:28672
    v_mfma_f32_16x16x32_bf16 v[204:207], a[68:71], a[4:7], v[204:207]
    ds_read_b64_tr_b16 a[46:47], v5 offset:29184
    s_add_u32 m0, s34, 57344
    v_mfma_f32_16x16x32_bf16 v[212:215], a[68:71], a[8:11], v[212:215]
    global_load_lds_dwordx4 v14, s[50:51]
    v_mfma_f32_16x16x32_bf16 v[220:223], a[68:71], a[12:15], v[220:223]
    ds_read_b64_tr_b16 a[48:49], v4 offset:32768
    v_mfma_f32_16x16x32_bf16 v[224:227], a[0:3], a[72:75], v[224:227]
    ds_read_b64_tr_b16 a[50:51], v4 offset:33280
    v_mfma_f32_16x16x32_bf16 v[228:231], a[4:7], a[72:75], v[228:231]
    ds_read_b64_tr_b16 a[52:53], v5 offset:32768
    v_mfma_f32_16x16x32_bf16 v[240:243], a[8:11], a[72:75], v[240:243]
    ds_read_b64_tr_b16 a[54:55], v5 offset:33280
    v_mfma_f32_16x16x32_bf16 v[244:247], a[12:15], a[72:75], v[244:247]
    s_add_u32 m0, s30, 34816
    v_mfma_f32_16x16x32_bf16 v[232:235], a[0:3], a[76:79], v[232:235]
    global_load_lds_dwordx4 v17, s[48:49]
    v_mfma_f32_16x16x32_bf16 v[236:239], a[4:7], a[76:79], v[236:239]
    v_add_u32 v17, 128, v17
    v_mfma_f32_16x16x32_bf16 v[248:251], a[8:11], a[76:79], v[248:251]
    v_mfma_f32_16x16x32_bf16 v[252:255], a[12:15], a[76:79], v[252:255]
    s_waitcnt lgkmcnt(8)
    v_mfma_f32_16x16x32_bf16 v[64:67], a[32:35], a[16:19], v[64:67]
    ds_read_b64_tr_b16 a[56:57], v4 offset:36864
    v_mfma_f32_16x16x32_bf16 v[68:71], a[32:35], a[20:23], v[68:71]
    ds_read_b64_tr_b16 a[58:59], v4 offset:37376
    s_add_u32 m0, s34, 61440
    v_mfma_f32_16x16x32_bf16 v[80:83], a[32:35], a[24:27], v[80:83]
    global_load_lds_dwordx4 v12, s[52:53]
    v_mfma_f32_16x16x32_bf16 v[84:87], a[32:35], a[28:31], v[84:87]
    ds_read_b64_tr_b16 a[60:61], v5 offset:36864
    v_add_u32 v12, 196608, v12
    v_mfma_f32_16x16x32_bf16 v[72:75], a[36:39], a[16:19], v[72:75]
    ds_read_b64_tr_b16 a[62:63], v5 offset:37376
    v_mfma_f32_16x16x32_bf16 v[76:79], a[36:39], a[20:23], v[76:79]
    ds_read_b64_tr_b16 a[64:65], v4 offset:40960
    v_mfma_f32_16x16x32_bf16 v[88:91], a[36:39], a[24:27], v[88:91]
    ds_read_b64_tr_b16 a[66:67], v4 offset:41472
    v_mfma_f32_16x16x32_bf16 v[92:95], a[36:39], a[28:31], v[92:95]
    ds_read_b64_tr_b16 a[68:69], v5 offset:40960
    s_add_u32 m0, s34, 65536
    s_waitcnt lgkmcnt(7)
    v_mfma_f32_16x16x32_bf16 v[96:99], a[40:43], a[16:19], v[96:99]
    global_load_lds_dwordx4 v13, s[52:53]
    v_mfma_f32_16x16x32_bf16 v[100:103], a[40:43], a[20:23], v[100:103]
    ds_read_b64_tr_b16 a[70:71], v5 offset:41472
    v_add_u32 v13, 196608, v13
    v_mfma_f32_16x16x32_bf16 v[112:115], a[40:43], a[24:27], v[112:115]
    ds_read_b64_tr_b16 a[72:73], v4 offset:45056
    v_mfma_f32_16x16x32_bf16 v[116:119], a[40:43], a[28:31], v[116:119]
    ds_read_b64_tr_b16 a[74:75], v4 offset:45568
    v_mfma_f32_16x16x32_bf16 v[104:107], a[44:47], a[16:19], v[104:107]
    ds_read_b64_tr_b16 a[76:77], v5 offset:45056
    v_mfma_f32_16x16x32_bf16 v[108:111], a[44:47], a[20:23], v[108:111]
    ds_read_b64_tr_b16 a[78:79], v5 offset:45568
    s_add_u32 m0, s34, 69632
    v_mfma_f32_16x16x32_bf16 v[120:123], a[44:47], a[24:27], v[120:123]
    global_load_lds_dwordx4 v14, s[52:53]
    v_mfma_f32_16x16x32_bf16 v[124:127], a[44:47], a[28:31], v[124:127]
    v_add_u32 v14, 196608, v14
    v_mfma_f32_16x16x32_bf16 v[128:131], a[16:19], a[48:51], v[128:131]
    v_mfma_f32_16x16x32_bf16 v[136:139], a[20:23], a[48:51], v[136:139]
    v_mfma_f32_16x16x32_bf16 v[144:147], a[24:27], a[48:51], v[144:147]
    v_mfma_f32_16x16x32_bf16 v[152:155], a[28:31], a[48:51], v[152:155]
    s_add_u32 m0, s30, 35840
    v_mfma_f32_16x16x32_bf16 v[132:135], a[16:19], a[52:55], v[132:135]
    global_load_lds_dwordx4 v18, s[48:49]
    v_mfma_f32_16x16x32_bf16 v[140:143], a[20:23], a[52:55], v[140:143]
    v_add_u32 v18, 128, v18
    v_mfma_f32_16x16x32_bf16 v[148:151], a[24:27], a[52:55], v[148:151]
    v_mfma_f32_16x16x32_bf16 v[156:159], a[28:31], a[52:55], v[156:159]
    global_load_dword v28, v27, s[44:45]
    v_add_u32 v27, s46, v27
    s_waitcnt vmcnt(18) lgkmcnt(0)
    s_barrier
    v_mfma_f32_16x16x32_bf16 v[160:163], a[56:59], a[16:19], v[160:163]
    ds_read_b128 a[0:3], v2 offset:16384
    v_mfma_f32_16x16x32_bf16 v[168:171], a[56:59], a[20:23], v[168:171]
    ds_read_b128 a[4:7], v2 offset:18432
    s_add_u32 m0, s34, 73728
    v_mfma_f32_16x16x32_bf16 v[176:179], a[56:59], a[24:27], v[176:179]
    global_load_lds_dwordx4 v12, s[50:51]
    v_mfma_f32_16x16x32_bf16 v[184:187], a[56:59], a[28:31], v[184:187]
    ds_read_b128 a[8:11], v2 offset:20480
    v_mfma_f32_16x16x32_bf16 v[164:167], a[60:63], a[16:19], v[164:167]
    ds_read_b128 a[12:15], v2 offset:22528
    v_mfma_f32_16x16x32_bf16 v[172:175], a[60:63], a[20:23], v[172:175]
    ds_read_b64_tr_b16 a[32:33], v10 offset:0
    v_mfma_f32_16x16x32_bf16 v[180:183], a[60:63], a[24:27], v[180:183]
    ds_read_b64_tr_b16 a[34:35], v10 offset:512
    v_mfma_f32_16x16x32_bf16 v[188:191], a[60:63], a[28:31], v[188:191]
    ds_read_b64_tr_b16 a[36:37], v11 offset:0
    s_add_u32 m0, s34, 77824
    v_mfma_f32_16x16x32_bf16 v[192:195], a[64:67], a[16:19], v[192:195]
    global_load_lds_dwordx4 v13, s[50:51]
    v_mfma_f32_16x16x32_bf16 v[200:203], a[64:67], a[20:23], v[200:203]
    ds_read_b64_tr_b16 a[38:39], v11 offset:512
    v_mfma_f32_16x16x32_bf16 v[208:211], a[64:67], a[24:27], v[208:211]
    ds_read_b64_tr_b16 a[40:41], v10 offset:4096
    v_mfma_f32_16x16x32_bf16 v[216:219], a[64:67], a[28:31], v[216:219]
    ds_read_b64_tr_b16 a[42:43], v10 offset:4608
    v_mfma_f32_16x16x32_bf16 v[196:199], a[68:71], a[16:19], v[196:199]
    ds_read_b64_tr_b16 a[44:45], v11 offset:4096
    v_mfma_f32_16x16x32_bf16 v[204:207], a[68:71], a[20:23], v[204:207]
    ds_read_b64_tr_b16 a[46:47], v11 offset:4608
    s_add_u32 m0, s34, 81920
    v_mfma_f32_16x16x32_bf16 v[212:215], a[68:71], a[24:27], v[212:215]
    global_load_lds_dwordx4 v14, s[50:51]
    v_mfma_f32_16x16x32_bf16 v[220:223], a[68:71], a[28:31], v[220:223]
    ds_read_b64_tr_b16 a[48:49], v10 offset:8192
    v_mfma_f32_16x16x32_bf16 v[224:227], a[16:19], a[72:75], v[224:227]
    ds_read_b64_tr_b16 a[50:51], v10 offset:8704
    v_mfma_f32_16x16x32_bf16 v[228:231], a[20:23], a[72:75], v[228:231]
    ds_read_b64_tr_b16 a[52:53], v11 offset:8192
    v_mfma_f32_16x16x32_bf16 v[240:243], a[24:27], a[72:75], v[240:243]
    ds_read_b64_tr_b16 a[54:55], v11 offset:8704
    v_mfma_f32_16x16x32_bf16 v[244:247], a[28:31], a[72:75], v[244:247]
    s_add_u32 m0, s30, 0
    v_mfma_f32_16x16x32_bf16 v[232:235], a[16:19], a[76:79], v[232:235]
    global_load_lds_dwordx4 v15, s[48:49]
    v_mfma_f32_16x16x32_bf16 v[236:239], a[20:23], a[76:79], v[236:239]
    v_add_u32 v15, 128, v15
    v_mfma_f32_16x16x32_bf16 v[248:251], a[24:27], a[76:79], v[248:251]
    v_mfma_f32_16x16x32_bf16 v[252:255], a[28:31], a[76:79], v[252:255]
    s_waitcnt lgkmcnt(8)
    v_mfma_f32_16x16x32_bf16 v[64:67], a[32:35], a[0:3], v[64:67]
    ds_read_b64_tr_b16 a[56:57], v10 offset:12288
    v_mfma_f32_16x16x32_bf16 v[68:71], a[32:35], a[4:7], v[68:71]
    ds_read_b64_tr_b16 a[58:59], v10 offset:12800
    s_add_u32 m0, s34, 86016
    v_mfma_f32_16x16x32_bf16 v[80:83], a[32:35], a[8:11], v[80:83]
    global_load_lds_dwordx4 v12, s[52:53]
    v_mfma_f32_16x16x32_bf16 v[84:87], a[32:35], a[12:15], v[84:87]
    ds_read_b64_tr_b16 a[60:61], v11 offset:12288
    v_add_u32 v12, 196608, v12
    v_mfma_f32_16x16x32_bf16 v[72:75], a[36:39], a[0:3], v[72:75]
    ds_read_b64_tr_b16 a[62:63], v11 offset:12800
    v_mfma_f32_16x16x32_bf16 v[76:79], a[36:39], a[4:7], v[76:79]
    ds_read_b64_tr_b16 a[64:65], v10 offset:16384
    v_mfma_f32_16x16x32_bf16 v[88:91], a[36:39], a[8:11], v[88:91]
    ds_read_b64_tr_b16 a[66:67], v10 offset:16896
    v_mfma_f32_16x16x32_bf16 v[92:95], a[36:39], a[12:15], v[92:95]
    ds_read_b64_tr_b16 a[68:69], v11 offset:16384
    s_add_u32 m0, s34, 90112
    s_waitcnt lgkmcnt(7)
    v_mfma_f32_16x16x32_bf16 v[96:99], a[40:43], a[0:3], v[96:99]
    global_load_lds_dwordx4 v13, s[52:53]
    v_mfma_f32_16x16x32_bf16 v[100:103], a[40:43], a[4:7], v[100:103]
    ds_read_b64_tr_b16 a[70:71], v11 offset:16896
    v_add_u32 v13, 196608, v13
    v_mfma_f32_16x16x32_bf16 v[112:115], a[40:43], a[8:11], v[112:115]
    ds_read_b64_tr_b16 a[72:73], v10 offset:20480
    v_mfma_f32_16x16x32_bf16 v[116:119], a[40:43], a[12:15], v[116:119]
    ds_read_b64_tr_b16 a[74:75], v10 offset:20992
    v_mfma_f32_16x16x32_bf16 v[104:107], a[44:47], a[0:3], v[104:107]
    ds_read_b64_tr_b16 a[76:77], v11 offset:20480
    v_mfma_f32_16x16x32_bf16 v[108:111], a[44:47], a[4:7], v[108:111]
    ds_read_b64_tr_b16 a[78:79], v11 offset:20992
    s_add_u32 m0, s34, 94208
    v_mfma_f32_16x16x32_bf16 v[120:123], a[44:47], a[8:11], v[120:123]
    global_load_lds_dwordx4 v14, s[52:53]
    v_mfma_f32_16x16x32_bf16 v[124:127], a[44:47], a[12:15], v[124:127]
    v_add_u32 v14, 196608, v14
    v_mfma_f32_16x16x32_bf16 v[128:131], a[0:3], a[48:51], v[128:131]
    v_mfma_f32_16x16x32_bf16 v[136:139], a[4:7], a[48:51], v[136:139]
    v_mfma_f32_16x16x32_bf16 v[144:147], a[8:11], a[48:51], v[144:147]
    v_mfma_f32_16x16x32_bf16 v[152:155], a[12:15], a[48:51], v[152:155]
    s_add_u32 m0, s30, 1024
    v_mfma_f32_16x16x32_bf16 v[132:135], a[0:3], a[52:55], v[132:135]
    global_load_lds_dwordx4 v16, s[48:49]
    v_mfma_f32_16x16x32_bf16 v[140:143], a[4:7], a[52:55], v[140:143]
    v_add_u32 v16, 128, v16
    v_mfma_f32_16x16x32_bf16 v[148:151], a[8:11], a[52:55], v[148:151]
    v_mfma_f32_16x16x32_bf16 v[156:159], a[12:15], a[52:55], v[156:159]
    s_waitcnt vmcnt(18) lgkmcnt(0)
    s_barrier
    v_mfma_f32_16x16x32_bf16 v[160:163], a[56:59], a[0:3], v[160:163]
    ds_read_b128 a[16:19], v3 offset:16384
    v_mfma_f32_16x16x32_bf16 v[168:171], a[56:59], a[4:7], v[168:171]
    ds_read_b128 a[20:23], v3 offset:18432
    s_add_u32 m0, s34, 98304
    v_mfma_f32_16x16x32_bf16 v[176:179], a[56:59], a[8:11], v[176:179]
    global_load_lds_dwordx4 v12, s[50:51]
    v_mfma_f32_16x16x32_bf16 v[184:187], a[56:59], a[12:15], v[184:187]
    ds_read_b128 a[24:27], v3 offset:20480
    v_mfma_f32_16x16x32_bf16 v[164:167], a[60:63], a[0:3], v[164:167]
    ds_read_b128 a[28:31], v3 offset:22528
    v_mfma_f32_16x16x32_bf16 v[172:175], a[60:63], a[4:7], v[172:175]
    ds_read_b64_tr_b16 a[32:33], v10 offset:24576
    v_mfma_f32_16x16x32_bf16 v[180:183], a[60:63], a[8:11], v[180:183]
    ds_read_b64_tr_b16 a[34:35], v10 offset:25088
    v_mfma_f32_16x16x32_bf16 v[188:191], a[60:63], a[12:15], v[188:191]
    ds_read_b64_tr_b16 a[36:37], v11 offset:24576
    s_add_u32 m0, s34, 102400
    v_mfma_f32_16x16x32_bf16 v[192:195], a[64:67], a[0:3], v[192:195]
    global_load_lds_dwordx4 v13, s[50:51]
    v_mfma_f32_16x16x32_bf16 v[200:203], a[64:67], a[4:7], v[200:203]
    ds_read_b64_tr_b16 a[38:39], v11 offset:25088
    v_mfma_f32_16x16x32_bf16 v[208:211], a[64:67], a[8:11], v[208:211]
    ds_read_b64_tr_b16 a[40:41], v10 offset:28672
    v_mfma_f32_16x16x32_bf16 v[216:219], a[64:67], a[12:15], v[216:219]
    ds_read_b64_tr_b16 a[42:43], v10 offset:29184
    v_mfma_f32_16x16x32_bf16 v[196:199], a[68:71], a[0:3], v[196:199]
    ds_read_b64_tr_b16 a[44:45], v11 offset:28672
    v_mfma_f32_16x16x32_bf16 v[204:207], a[68:71], a[4:7], v[204:207]
    ds_read_b64_tr_b16 a[46:47], v11 offset:29184
    s_add_u32 m0, s34, 106496
    v_mfma_f32_16x16x32_bf16 v[212:215], a[68:71], a[8:11], v[212:215]
    global_load_lds_dwordx4 v14, s[50:51]
    v_mfma_f32_16x16x32_bf16 v[220:223], a[68:71], a[12:15], v[220:223]
    ds_read_b64_tr_b16 a[48:49], v10 offset:32768
    v_mfma_f32_16x16x32_bf16 v[224:227], a[0:3], a[72:75], v[224:227]
    ds_read_b64_tr_b16 a[50:51], v10 offset:33280
    v_mfma_f32_16x16x32_bf16 v[228:231], a[4:7], a[72:75], v[228:231]
    ds_read_b64_tr_b16 a[52:53], v11 offset:32768
    v_mfma_f32_16x16x32_bf16 v[240:243], a[8:11], a[72:75], v[240:243]
    ds_read_b64_tr_b16 a[54:55], v11 offset:33280
    v_mfma_f32_16x16x32_bf16 v[244:247], a[12:15], a[72:75], v[244:247]
    s_add_u32 m0, s30, 2048
    v_mfma_f32_16x16x32_bf16 v[232:235], a[0:3], a[76:79], v[232:235]
    global_load_lds_dwordx4 v17, s[48:49]
    v_mfma_f32_16x16x32_bf16 v[236:239], a[4:7], a[76:79], v[236:239]
    v_add_u32 v17, 128, v17
    v_mfma_f32_16x16x32_bf16 v[248:251], a[8:11], a[76:79], v[248:251]
    v_mfma_f32_16x16x32_bf16 v[252:255], a[12:15], a[76:79], v[252:255]
    s_waitcnt lgkmcnt(8)
    v_mfma_f32_16x16x32_bf16 v[64:67], a[32:35], a[16:19], v[64:67]
    ds_read_b64_tr_b16 a[56:57], v10 offset:36864
    v_mfma_f32_16x16x32_bf16 v[68:71], a[32:35], a[20:23], v[68:71]
    ds_read_b64_tr_b16 a[58:59], v10 offset:37376
    s_add_u32 m0, s34, 110592
    v_mfma_f32_16x16x32_bf16 v[80:83], a[32:35], a[24:27], v[80:83]
    global_load_lds_dwordx4 v12, s[52:53]
    v_mfma_f32_16x16x32_bf16 v[84:87], a[32:35], a[28:31], v[84:87]
    ds_read_b64_tr_b16 a[60:61], v11 offset:36864
    v_add_u32 v12, 196608, v12
    v_mfma_f32_16x16x32_bf16 v[72:75], a[36:39], a[16:19], v[72:75]
    ds_read_b64_tr_b16 a[62:63], v11 offset:37376
    v_mfma_f32_16x16x32_bf16 v[76:79], a[36:39], a[20:23], v[76:79]
    ds_read_b64_tr_b16 a[64:65], v10 offset:40960
    v_mfma_f32_16x16x32_bf16 v[88:91], a[36:39], a[24:27], v[88:91]
    ds_read_b64_tr_b16 a[66:67], v10 offset:41472
    v_mfma_f32_16x16x32_bf16 v[92:95], a[36:39], a[28:31], v[92:95]
    ds_read_b64_tr_b16 a[68:69], v11 offset:40960
    s_add_u32 m0, s34, 114688
    s_waitcnt lgkmcnt(7)
    v_mfma_f32_16x16x32_bf16 v[96:99], a[40:43], a[16:19], v[96:99]
    global_load_lds_dwordx4 v13, s[52:53]
    v_mfma_f32_16x16x32_bf16 v[100:103], a[40:43], a[20:23], v[100:103]
    ds_read_b64_tr_b16 a[70:71], v11 offset:41472
    v_add_u32 v13, 196608, v13
    v_mfma_f32_16x16x32_bf16 v[112:115], a[40:43], a[24:27], v[112:115]
    ds_read_b64_tr_b16 a[72:73], v10 offset:45056
    v_mfma_f32_16x16x32_bf16 v[116:119], a[40:43], a[28:31], v[116:119]
    ds_read_b64_tr_b16 a[74:75], v10 offset:45568
    v_mfma_f32_16x16x32_bf16 v[104:107], a[44:47], a[16:19], v[104:107]
    ds_read_b64_tr_b16 a[76:77], v11 offset:45056
    v_mfma_f32_16x16x32_bf16 v[108:111], a[44:47], a[20:23], v[108:111]
    ds_read_b64_tr_b16 a[78:79], v11 offset:45568
    s_add_u32 m0, s34, 118784
    v_mfma_f32_16x16x32_bf16 v[120:123], a[44:47], a[24:27], v[120:123]
    global_load_lds_dwordx4 v14, s[52:53]
    v_mfma_f32_16x16x32_bf16 v[124:127], a[44:47], a[28:31], v[124:127]
    v_add_u32 v14, 196608, v14
    v_mfma_f32_16x16x32_bf16 v[128:131], a[16:19], a[48:51], v[128:131]
    v_mfma_f32_16x16x32_bf16 v[136:139], a[20:23], a[48:51], v[136:139]
    v_mfma_f32_16x16x32_bf16 v[144:147], a[24:27], a[48:51], v[144:147]
    v_mfma_f32_16x16x32_bf16 v[152:155], a[28:31], a[48:51], v[152:155]
    s_add_u32 m0, s30, 3072
    v_mfma_f32_16x16x32_bf16 v[132:135], a[16:19], a[52:55], v[132:135]
    global_load_lds_dwordx4 v18, s[48:49]
    v_mfma_f32_16x16x32_bf16 v[140:143], a[20:23], a[52:55], v[140:143]
    v_add_u32 v18, 128, v18
    v_mfma_f32_16x16x32_bf16 v[148:151], a[24:27], a[52:55], v[148:151]
    v_mfma_f32_16x16x32_bf16 v[156:159], a[28:31], a[52:55], v[156:159]
    global_load_dword v28, v27, s[44:45]
    v_add_u32 v27, s46, v27
    s_waitcnt vmcnt(18) lgkmcnt(0)
    s_barrier
    v_mfma_f32_16x16x32_bf16 v[160:163], a[56:59], a[16:19], v[160:163]
    ds_read_b128 a[0:3], v2 offset:32768
    v_mfma_f32_16x16x32_bf16 v[168:171], a[56:59], a[20:23], v[168:171]
    ds_read_b128 a[4:7], v2 offset:34816
    s_add_u32 m0, s34, 122880
    v_mfma_f32_16x16x32_bf16 v[176:179], a[56:59], a[24:27], v[176:179]
    global_load_lds_dwordx4 v12, s[50:51]
    v_mfma_f32_16x16x32_bf16 v[184:187], a[56:59], a[28:31], v[184:187]
    ds_read_b128 a[8:11], v2 offset:36864
    v_mfma_f32_16x16x32_bf16 v[164:167], a[60:63], a[16:19], v[164:167]
    ds_read_b128 a[12:15], v2 offset:38912
    v_mfma_f32_16x16x32_bf16 v[172:175], a[60:63], a[20:23], v[172:175]
    ds_read_b64_tr_b16 a[32:33], v4 offset:0
    v_mfma_f32_16x16x32_bf16 v[180:183], a[60:63], a[24:27], v[180:183]
    ds_read_b64_tr_b16 a[34:35], v4 offset:512
    v_mfma_f32_16x16x32_bf16 v[188:191], a[60:63], a[28:31], v[188:191]
    ds_read_b64_tr_b16 a[36:37], v5 offset:0
    s_add_u32 m0, s34, 126976
    v_mfma_f32_16x16x32_bf16 v[192:195], a[64:67], a[16:19], v[192:195]
    global_load_lds_dwordx4 v13, s[50:51]
    v_mfma_f32_16x16x32_bf16 v[200:203], a[64:67], a[20:23], v[200:203]
    ds_read_b64_tr_b16 a[38:39], v5 offset:512
    v_mfma_f32_16x16x32_bf16 v[208:211], a[64:67], a[24:27], v[208:211]
    ds_read_b64_tr_b16 a[40:41], v4 offset:4096
    v_mfma_f32_16x16x32_bf16 v[216:219], a[64:67], a[28:31], v[216:219]
    ds_read_b64_tr_b16 a[42:43], v4 offset:4608
    v_mfma_f32_16x16x32_bf16 v[196:199], a[68:71], a[16:19], v[196:199]
    ds_read_b64_tr_b16 a[44:45], v5 offset:4096
    v_mfma_f32_16x16x32_bf16 v[204:207], a[68:71], a[20:23], v[204:207]
    ds_read_b64_tr_b16 a[46:47], v5 offset:4608
    s_add_u32 m0, s34, 131072
    v_mfma_f32_16x16x32_bf16 v[212:215], a[68:71], a[24:27], v[212:215]
    global_load_lds_dwordx4 v14, s[50:51]
    v_mfma_f32_16x16x32_bf16 v[220:223], a[68:71], a[28:31], v[220:223]
    ds_read_b64_tr_b16 a[48:49], v4 offset:8192
    v_mfma_f32_16x16x32_bf16 v[224:227], a[16:19], a[72:75], v[224:227]
    ds_read_b64_tr_b16 a[50:51], v4 offset:8704
    v_mfma_f32_16x16x32_bf16 v[228:231], a[20:23], a[72:75], v[228:231]
    ds_read_b64_tr_b16 a[52:53], v5 offset:8192
    v_mfma_f32_16x16x32_bf16 v[240:243], a[24:27], a[72:75], v[240:243]
    ds_read_b64_tr_b16 a[54:55], v5 offset:8704
    v_mfma_f32_16x16x32_bf16 v[244:247], a[28:31], a[72:75], v[244:247]
    s_add_u32 m0, s30, 16384
    v_mfma_f32_16x16x32_bf16 v[232:235], a[16:19], a[76:79], v[232:235]
    global_load_lds_dwordx4 v15, s[48:49]
    v_mfma_f32_16x16x32_bf16 v[236:239], a[20:23], a[76:79], v[236:239]
    v_add_u32 v15, 128, v15
    v_mfma_f32_16x16x32_bf16 v[248:251], a[24:27], a[76:79], v[248:251]
    v_mfma_f32_16x16x32_bf16 v[252:255], a[28:31], a[76:79], v[252:255]
    s_waitcnt lgkmcnt(8)
    v_mfma_f32_16x16x32_bf16 v[64:67], a[32:35], a[0:3], v[64:67]
    ds_read_b64_tr_b16 a[56:57], v4 offset:12288
    v_mfma_f32_16x16x32_bf16 v[68:71], a[32:35], a[4:7], v[68:71]
    ds_read_b64_tr_b16 a[58:59], v4 offset:12800
    s_add_u32 m0, s34, 135168
    v_mfma_f32_16x16x32_bf16 v[80:83], a[32:35], a[8:11], v[80:83]
    global_load_lds_dwordx4 v12, s[52:53]
    v_mfma_f32_16x16x32_bf16 v[84:87], a[32:35], a[12:15], v[84:87]
    ds_read_b64_tr_b16 a[60:61], v5 offset:12288
    v_add_u32 v12, 196608, v12
    v_mfma_f32_16x16x32_bf16 v[72:75], a[36:39], a[0:3], v[72:75]
    ds_read_b64_tr_b16 a[62:63], v5 offset:12800
    v_mfma_f32_16x16x32_bf16 v[76:79], a[36:39], a[4:7], v[76:79]
    ds_read_b64_tr_b16 a[64:65], v4 offset:16384
    v_mfma_f32_16x16x32_bf16 v[88:91], a[36:39], a[8:11], v[88:91]
    ds_read_b64_tr_b16 a[66:67], v4 offset:16896
    v_mfma_f32_16x16x32_bf16 v[92:95], a[36:39], a[12:15], v[92:95]
    ds_read_b64_tr_b16 a[68:69], v5 offset:16384
    s_add_u32 m0, s34, 139264
    s_waitcnt lgkmcnt(7)
    v_mfma_f32_16x16x32_bf16 v[96:99], a[40:43], a[0:3], v[96:99]
    global_load_lds_dwordx4 v13, s[52:53]
    v_mfma_f32_16x16x32_bf16 v[100:103], a[40:43], a[4:7], v[100:103]
    ds_read_b64_tr_b16 a[70:71], v5 offset:16896
    v_add_u32 v13, 196608, v13
    v_mfma_f32_16x16x32_bf16 v[112:115], a[40:43], a[8:11], v[112:115]
    ds_read_b64_tr_b16 a[72:73], v4 offset:20480
    v_mfma_f32_16x16x32_bf16 v[116:119], a[40:43], a[12:15], v[116:119]
    ds_read_b64_tr_b16 a[74:75], v4 offset:20992
    v_mfma_f32_16x16x32_bf16 v[104:107], a[44:47], a[0:3], v[104:107]
    ds_read_b64_tr_b16 a[76:77], v5 offset:20480
    v_mfma_f32_16x16x32_bf16 v[108:111], a[44:47], a[4:7], v[108:111]
    ds_read_b64_tr_b16 a[78:79], v5 offset:20992
    s_add_u32 m0, s34, 143360
    v_mfma_f32_16x16x32_bf16 v[120:123], a[44:47], a[8:11], v[120:123]
    global_load_lds_dwordx4 v14, s[52:53]
    v_mfma_f32_16x16x32_bf16 v[124:127], a[44:47], a[12:15], v[124:127]
    v_add_u32 v14, 196608, v14
    v_mfma_f32_16x16x32_bf16 v[128:131], a[0:3], a[48:51], v[128:131]
    v_mfma_f32_16x16x32_bf16 v[136:139], a[4:7], a[48:51], v[136:139]
    v_mfma_f32_16x16x32_bf16 v[144:147], a[8:11], a[48:51], v[144:147]
    v_mfma_f32_16x16x32_bf16 v[152:155], a[12:15], a[48:51], v[152:155]
    s_add_u32 m0, s30, 17408
    v_mfma_f32_16x16x32_bf16 v[132:135], a[0:3], a[52:55], v[132:135]
    global_load_lds_dwordx4 v16, s[48:49]
    v_mfma_f32_16x16x32_bf16 v[140:143], a[4:7], a[52:55], v[140:143]
    v_add_u32 v16, 128, v16
    v_mfma_f32_16x16x32_bf16 v[148:151], a[8:11], a[52:55], v[148:151]
    v_mfma_f32_16x16x32_bf16 v[156:159], a[12:15], a[52:55], v[156:159]
    s_waitcnt vmcnt(18) lgkmcnt(0)
    s_barrier
    v_mfma_f32_16x16x32_bf16 v[160:163], a[56:59], a[0:3], v[160:163]
    ds_read_b128 a[16:19], v3 offset:32768
    v_mfma_f32_16x16x32_bf16 v[168:171], a[56:59], a[4:7], v[168:171]
    ds_read_b128 a[20:23], v3 offset:34816
    s_add_u32 m0, s34, 49152
    v_mfma_f32_16x16x32_bf16 v[176:179], a[56:59], a[8:11], v[176:179]
    global_load_lds_dwordx4 v12, s[50:51]
    v_mfma_f32_16x16x32_bf16 v[184:187], a[56:59], a[12:15], v[184:187]
    ds_read_b128 a[24:27], v3 offset:36864
    v_mfma_f32_16x16x32_bf16 v[164:167], a[60:63], a[0:3], v[164:167]
    ds_read_b128 a[28:31], v3 offset:38912
    v_mfma_f32_16x16x32_bf16 v[172:175], a[60:63], a[4:7], v[172:175]
    ds_read_b64_tr_b16 a[32:33], v4 offset:24576
    v_mfma_f32_16x16x32_bf16 v[180:183], a[60:63], a[8:11], v[180:183]
    ds_read_b64_tr_b16 a[34:35], v4 offset:25088
    v_mfma_f32_16x16x32_bf16 v[188:191], a[60:63], a[12:15], v[188:191]
    ds_read_b64_tr_b16 a[36:37], v5 offset:24576
    s_add_u32 m0, s34, 53248
    v_mfma_f32_16x16x32_bf16 v[192:195], a[64:67], a[0:3], v[192:195]
    global_load_lds_dwordx4 v13, s[50:51]
    v_mfma_f32_16x16x32_bf16 v[200:203], a[64:67], a[4:7], v[200:203]
    ds_read_b64_tr_b16 a[38:39], v5 offset:25088
    v_mfma_f32_16x16x32_bf16 v[208:211], a[64:67], a[8:11], v[208:211]
    ds_read_b64_tr_b16 a[40:41], v4 offset:28672
    v_mfma_f32_16x16x32_bf16 v[216:219], a[64:67], a[12:15], v[216:219]
    ds_read_b64_tr_b16 a[42:43], v4 offset:29184
    v_mfma_f32_16x16x32_bf16 v[196:199], a[68:71], a[0:3], v[196:199]
    ds_read_b64_tr_b16 a[44:45], v5 offset:28672
    v_mfma_f32_16x16x32_bf16 v[204:207], a[68:71], a[4:7], v[204:207]
    ds_read_b64_tr_b16 a[46:47], v5 offset:29184
    s_add_u32 m0, s34, 57344
    v_mfma_f32_16x16x32_bf16 v[212:215], a[68:71], a[8:11], v[212:215]
    global_load_lds_dwordx4 v14, s[50:51]
    v_mfma_f32_16x16x32_bf16 v[220:223], a[68:71], a[12:15], v[220:223]
    ds_read_b64_tr_b16 a[48:49], v4 offset:32768
    v_mfma_f32_16x16x32_bf16 v[224:227], a[0:3], a[72:75], v[224:227]
    ds_read_b64_tr_b16 a[50:51], v4 offset:33280
    v_mfma_f32_16x16x32_bf16 v[228:231], a[4:7], a[72:75], v[228:231]
    ds_read_b64_tr_b16 a[52:53], v5 offset:32768
    v_mfma_f32_16x16x32_bf16 v[240:243], a[8:11], a[72:75], v[240:243]
    ds_read_b64_tr_b16 a[54:55], v5 offset:33280
    v_mfma_f32_16x16x32_bf16 v[244:247], a[12:15], a[72:75], v[244:247]
    s_add_u32 m0, s30, 18432
    v_mfma_f32_16x16x32_bf16 v[232:235], a[0:3], a[76:79], v[232:235]
    global_load_lds_dwordx4 v17, s[48:49]
    v_mfma_f32_16x16x32_bf16 v[236:239], a[4:7], a[76:79], v[236:239]
    v_add_u32 v17, 128, v17
    v_mfma_f32_16x16x32_bf16 v[248:251], a[8:11], a[76:79], v[248:251]
    v_mfma_f32_16x16x32_bf16 v[252:255], a[12:15], a[76:79], v[252:255]
    s_waitcnt lgkmcnt(8)
    v_mfma_f32_16x16x32_bf16 v[64:67], a[32:35], a[16:19], v[64:67]
    ds_read_b64_tr_b16 a[56:57], v4 offset:36864
    v_mfma_f32_16x16x32_bf16 v[68:71], a[32:35], a[20:23], v[68:71]
    ds_read_b64_tr_b16 a[58:59], v4 offset:37376
    s_add_u32 m0, s34, 61440
    v_mfma_f32_16x16x32_bf16 v[80:83], a[32:35], a[24:27], v[80:83]
    global_load_lds_dwordx4 v12, s[52:53]
    v_mfma_f32_16x16x32_bf16 v[84:87], a[32:35], a[28:31], v[84:87]
    ds_read_b64_tr_b16 a[60:61], v5 offset:36864
    v_add_u32 v12, 196608, v12
    v_mfma_f32_16x16x32_bf16 v[72:75], a[36:39], a[16:19], v[72:75]
    ds_read_b64_tr_b16 a[62:63], v5 offset:37376
    v_mfma_f32_16x16x32_bf16 v[76:79], a[36:39], a[20:23], v[76:79]
    ds_read_b64_tr_b16 a[64:65], v4 offset:40960
    v_mfma_f32_16x16x32_bf16 v[88:91], a[36:39], a[24:27], v[88:91]
    ds_read_b64_tr_b16 a[66:67], v4 offset:41472
    v_mfma_f32_16x16x32_bf16 v[92:95], a[36:39], a[28:31], v[92:95]
    ds_read_b64_tr_b16 a[68:69], v5 offset:40960
    s_add_u32 m0, s34, 65536
    s_waitcnt lgkmcnt(7)
    v_mfma_f32_16x16x32_bf16 v[96:99], a[40:43], a[16:19], v[96:99]
    global_load_lds_dwordx4 v13, s[52:53]
    v_mfma_f32_16x16x32_bf16 v[100:103], a[40:43], a[20:23], v[100:103]
    ds_read_b64_tr_b16 a[70:71], v5 offset:41472
    v_add_u32 v13, 196608, v13
    v_mfma_f32_16x16x32_bf16 v[112:115], a[40:43], a[24:27], v[112:115]
    ds_read_b64_tr_b16 a[72:73], v4 offset:45056
    v_mfma_f32_16x16x32_bf16 v[116:119], a[40:43], a[28:31], v[116:119]
    ds_read_b64_tr_b16 a[74:75], v4 offset:45568
    v_mfma_f32_16x16x32_bf16 v[104:107], a[44:47], a[16:19], v[104:107]
    ds_read_b64_tr_b16 a[76:77], v5 offset:45056
    v_mfma_f32_16x16x32_bf16 v[108:111], a[44:47], a[20:23], v[108:111]
    ds_read_b64_tr_b16 a[78:79], v5 offset:45568
    s_add_u32 m0, s34, 69632
    v_mfma_f32_16x16x32_bf16 v[120:123], a[44:47], a[24:27], v[120:123]
    global_load_lds_dwordx4 v14, s[52:53]
    v_mfma_f32_16x16x32_bf16 v[124:127], a[44:47], a[28:31], v[124:127]
    v_add_u32 v14, 196608, v14
    v_mfma_f32_16x16x32_bf16 v[128:131], a[16:19], a[48:51], v[128:131]
    v_mfma_f32_16x16x32_bf16 v[136:139], a[20:23], a[48:51], v[136:139]
    v_mfma_f32_16x16x32_bf16 v[144:147], a[24:27], a[48:51], v[144:147]
    v_mfma_f32_16x16x32_bf16 v[152:155], a[28:31], a[48:51], v[152:155]
    s_add_u32 m0, s30, 19456
    v_mfma_f32_16x16x32_bf16 v[132:135], a[16:19], a[52:55], v[132:135]
    global_load_lds_dwordx4 v18, s[48:49]
    v_mfma_f32_16x16x32_bf16 v[140:143], a[20:23], a[52:55], v[140:143]
    v_add_u32 v18, 128, v18
    v_mfma_f32_16x16x32_bf16 v[148:151], a[24:27], a[52:55], v[148:151]
    v_mfma_f32_16x16x32_bf16 v[156:159], a[28:31], a[52:55], v[156:159]
    global_load_dword v28, v27, s[44:45]
    v_add_u32 v27, s46, v27
    s_waitcnt vmcnt(18) lgkmcnt(0)
    s_barrier
    v_mfma_f32_16x16x32_bf16 v[160:163], a[56:59], a[16:19], v[160:163]
    ds_read_b128 a[0:3], v2 offset:0
    v_mfma_f32_16x16x32_bf16 v[168:171], a[56:59], a[20:23], v[168:171]
    ds_read_b128 a[4:7], v2 offset:2048
    s_add_u32 m0, s34, 73728
    v_mfma_f32_16x16x32_bf16 v[176:179], a[56:59], a[24:27], v[176:179]
    global_load_lds_dwordx4 v12, s[50:51]
    v_mfma_f32_16x16x32_bf16 v[184:187], a[56:59], a[28:31], v[184:187]
    ds_read_b128 a[8:11], v2 offset:4096
    v_mfma_f32_16x16x32_bf16 v[164:167], a[60:63], a[16:19], v[164:167]
    ds_read_b128 a[12:15], v2 offset:6144
    v_mfma_f32_16x16x32_bf16 v[172:175], a[60:63], a[20:23], v[172:175]
    ds_read_b64_tr_b16 a[32:33], v10 offset:0
    v_mfma_f32_16x16x32_bf16 v[180:183], a[60:63], a[24:27], v[180:183]
    ds_read_b64_tr_b16 a[34:35], v10 offset:512
    v_mfma_f32_16x16x32_bf16 v[188:191], a[60:63], a[28:31], v[188:191]
    ds_read_b64_tr_b16 a[36:37], v11 offset:0
    s_add_u32 m0, s34, 77824
    v_mfma_f32_16x16x32_bf16 v[192:195], a[64:67], a[16:19], v[192:195]
    global_load_lds_dwordx4 v13, s[50:51]
    v_mfma_f32_16x16x32_bf16 v[200:203], a[64:67], a[20:23], v[200:203]
    ds_read_b64_tr_b16 a[38:39], v11 offset:512
    v_mfma_f32_16x16x32_bf16 v[208:211], a[64:67], a[24:27], v[208:211]
    ds_read_b64_tr_b16 a[40:41], v10 offset:4096
    v_mfma_f32_16x16x32_bf16 v[216:219], a[64:67], a[28:31], v[216:219]
    ds_read_b64_tr_b16 a[42:43], v10 offset:4608
    v_mfma_f32_16x16x32_bf16 v[196:199], a[68:71], a[16:19], v[196:199]
    ds_read_b64_tr_b16 a[44:45], v11 offset:4096
    v_mfma_f32_16x16x32_bf16 v[204:207], a[68:71], a[20:23], v[204:207]
    ds_read_b64_tr_b16 a[46:47], v11 offset:4608
    s_add_u32 m0, s34, 81920
    v_mfma_f32_16x16x32_bf16 v[212:215], a[68:71], a[24:27], v[212:215]
    global_load_lds_dwordx4 v14, s[50:51]
    v_mfma_f32_16x16x32_bf16 v[220:223], a[68:71], a[28:31], v[220:223]
    ds_read_b64_tr_b16 a[48:49], v10 offset:8192
    v_mfma_f32_16x16x32_bf16 v[224:227], a[16:19], a[72:75], v[224:227]
    ds_read_b64_tr_b16 a[50:51], v10 offset:8704
    v_mfma_f32_16x16x32_bf16 v[228:231], a[20:23], a[72:75], v[228:231]
    ds_read_b64_tr_b16 a[52:53], v11 offset:8192
    v_mfma_f32_16x16x32_bf16 v[240:243], a[24:27], a[72:75], v[240:243]
    ds_read_b64_tr_b16 a[54:55], v11 offset:8704
    v_mfma_f32_16x16x32_bf16 v[244:247], a[28:31], a[72:75], v[244:247]
    s_add_u32 m0, s30, 32768
    v_mfma_f32_16x16x32_bf16 v[232:235], a[16:19], a[76:79], v[232:235]
    global_load_lds_dwordx4 v15, s[48:49]
    v_mfma_f32_16x16x32_bf16 v[236:239], a[20:23], a[76:79], v[236:239]
    v_add_u32 v15, 128, v15
    v_mfma_f32_16x16x32_bf16 v[248:251], a[24:27], a[76:79], v[248:251]
    v_mfma_f32_16x16x32_bf16 v[252:255], a[28:31], a[76:79], v[252:255]
    s_waitcnt lgkmcnt(8)
    v_mfma_f32_16x16x32_bf16 v[64:67], a[32:35], a[0:3], v[64:67]
    ds_read_b64_tr_b16 a[56:57], v10 offset:12288
    v_mfma_f32_16x16x32_bf16 v[68:71], a[32:35], a[4:7], v[68:71]
    ds_read_b64_tr_b16 a[58:59], v10 offset:12800
    s_add_u32 m0, s34, 86016
    v_mfma_f32_16x16x32_bf16 v[80:83], a[32:35], a[8:11], v[80:83]
    global_load_lds_dwordx4 v12, s[52:53]
    v_mfma_f32_16x16x32_bf16 v[84:87], a[32:35], a[12:15], v[84:87]
    ds_read_b64_tr_b16 a[60:61], v11 offset:12288
    v_add_u32 v12, 196608, v12
    v_mfma_f32_16x16x32_bf16 v[72:75], a[36:39], a[0:3], v[72:75]
    ds_read_b64_tr_b16 a[62:63], v11 offset:12800
    v_mfma_f32_16x16x32_bf16 v[76:79], a[36:39], a[4:7], v[76:79]
    ds_read_b64_tr_b16 a[64:65], v10 offset:16384
    v_mfma_f32_16x16x32_bf16 v[88:91], a[36:39], a[8:11], v[88:91]
    ds_read_b64_tr_b16 a[66:67], v10 offset:16896
    v_mfma_f32_16x16x32_bf16 v[92:95], a[36:39], a[12:15], v[92:95]
    ds_read_b64_tr_b16 a[68:69], v11 offset:16384
    s_add_u32 m0, s34, 90112
    s_waitcnt lgkmcnt(7)
    v_mfma_f32_16x16x32_bf16 v[96:99], a[40:43], a[0:3], v[96:99]
    global_load_lds_dwordx4 v13, s[52:53]
    v_mfma_f32_16x16x32_bf16 v[100:103], a[40:43], a[4:7], v[100:103]
    ds_read_b64_tr_b16 a[70:71], v11 offset:16896
    v_add_u32 v13, 196608, v13
    v_mfma_f32_16x16x32_bf16 v[112:115], a[40:43], a[8:11], v[112:115]
    ds_read_b64_tr_b16 a[72:73], v10 offset:20480
    v_mfma_f32_16x16x32_bf16 v[116:119], a[40:43], a[12:15], v[116:119]
    ds_read_b64_tr_b16 a[74:75], v10 offset:20992
    v_mfma_f32_16x16x32_bf16 v[104:107], a[44:47], a[0:3], v[104:107]
    ds_read_b64_tr_b16 a[76:77], v11 offset:20480
    v_mfma_f32_16x16x32_bf16 v[108:111], a[44:47], a[4:7], v[108:111]
    ds_read_b64_tr_b16 a[78:79], v11 offset:20992
    s_add_u32 m0, s34, 94208
    v_mfma_f32_16x16x32_bf16 v[120:123], a[44:47], a[8:11], v[120:123]
    global_load_lds_dwordx4 v14, s[52:53]
    v_mfma_f32_16x16x32_bf16 v[124:127], a[44:47], a[12:15], v[124:127]
    v_add_u32 v14, 196608, v14
    v_mfma_f32_16x16x32_bf16 v[128:131], a[0:3], a[48:51], v[128:131]
    v_mfma_f32_16x16x32_bf16 v[136:139], a[4:7], a[48:51], v[136:139]
    v_mfma_f32_16x16x32_bf16 v[144:147], a[8:11], a[48:51], v[144:147]
    v_mfma_f32_16x16x32_bf16 v[152:155], a[12:15], a[48:51], v[152:155]
    s_add_u32 m0, s30, 33792
    v_mfma_f32_16x16x32_bf16 v[132:135], a[0:3], a[52:55], v[132:135]
    global_load_lds_dwordx4 v16, s[48:49]
    v_mfma_f32_16x16x32_bf16 v[140:143], a[4:7], a[52:55], v[140:143]
    v_add_u32 v16, 128, v16
    v_mfma_f32_16x16x32_bf16 v[148:151], a[8:11], a[52:55], v[148:151]
    v_mfma_f32_16x16x32_bf16 v[156:159], a[12:15], a[52:55], v[156:159]
    s_waitcnt vmcnt(18) lgkmcnt(0)
    s_barrier
    v_mfma_f32_16x16x32_bf16 v[160:163], a[56:59], a[0:3], v[160:163]
    ds_read_b128 a[16:19], v3 offset:0
    v_mfma_f32_16x16x32_bf16 v[168:171], a[56:59], a[4:7], v[168:171]
    ds_read_b128 a[20:23], v3 offset:2048
    s_add_u32 m0, s34, 98304
    v_mfma_f32_16x16x32_bf16 v[176:179], a[56:59], a[8:11], v[176:179]
    global_load_lds_dwordx4 v12, s[50:51]
    v_mfma_f32_16x16x32_bf16 v[184:187], a[56:59], a[12:15], v[184:187]
    ds_read_b128 a[24:27], v3 offset:4096
    v_mfma_f32_16x16x32_bf16 v[164:167], a[60:63], a[0:3], v[164:167]
    ds_read_b128 a[28:31], v3 offset:6144
    v_mfma_f32_16x16x32_bf16 v[172:175], a[60:63], a[4:7], v[172:175]
    ds_read_b64_tr_b16 a[32:33], v10 offset:24576
    v_mfma_f32_16x16x32_bf16 v[180:183], a[60:63], a[8:11], v[180:183]
    ds_read_b64_tr_b16 a[34:35], v10 offset:25088
    v_mfma_f32_16x16x32_bf16 v[188:191], a[60:63], a[12:15], v[188:191]
    ds_read_b64_tr_b16 a[36:37], v11 offset:24576
    s_add_u32 m0, s34, 102400
    v_mfma_f32_16x16x32_bf16 v[192:195], a[64:67], a[0:3], v[192:195]
    global_load_lds_dwordx4 v13, s[50:51]
    v_mfma_f32_16x16x32_bf16 v[200:203], a[64:67], a[4:7], v[200:203]
    ds_read_b64_tr_b16 a[38:39], v11 offset:25088
    v_mfma_f32_16x16x32_bf16 v[208:211], a[64:67], a[8:11], v[208:211]
    ds_read_b64_tr_b16 a[40:41], v10 offset:28672
    v_mfma_f32_16x16x32_bf16 v[216:219], a[64:67], a[12:15], v[216:219]
    ds_read_b64_tr_b16 a[42:43], v10 offset:29184
    v_mfma_f32_16x16x32_bf16 v[196:199], a[68:71], a[0:3], v[196:199]
    ds_read_b64_tr_b16 a[44:45], v11 offset:28672
    v_mfma_f32_16x16x32_bf16 v[204:207], a[68:71], a[4:7], v[204:207]
    ds_read_b64_tr_b16 a[46:47], v11 offset:29184
    s_add_u32 m0, s34, 106496
    v_mfma_f32_16x16x32_bf16 v[212:215], a[68:71], a[8:11], v[212:215]
    global_load_lds_dwordx4 v14, s[50:51]
    v_mfma_f32_16x16x32_bf16 v[220:223], a[68:71], a[12:15], v[220:223]
    ds_read_b64_tr_b16 a[48:49], v10 offset:32768
    v_mfma_f32_16x16x32_bf16 v[224:227], a[0:3], a[72:75], v[224:227]
    ds_read_b64_tr_b16 a[50:51], v10 offset:33280
    v_mfma_f32_16x16x32_bf16 v[228:231], a[4:7], a[72:75], v[228:231]
    ds_read_b64_tr_b16 a[52:53], v11 offset:32768
    v_mfma_f32_16x16x32_bf16 v[240:243], a[8:11], a[72:75], v[240:243]
    ds_read_b64_tr_b16 a[54:55], v11 offset:33280
    v_mfma_f32_16x16x32_bf16 v[244:247], a[12:15], a[72:75], v[244:247]
    s_add_u32 m0, s30, 34816
    v_mfma_f32_16x16x32_bf16 v[232:235], a[0:3], a[76:79], v[232:235]
    global_load_lds_dwordx4 v17, s[48:49]
    v_mfma_f32_16x16x32_bf16 v[236:239], a[4:7], a[76:79], v[236:239]
    v_add_u32 v17, 128, v17
    v_mfma_f32_16x16x32_bf16 v[248:251], a[8:11], a[76:79], v[248:251]
    v_mfma_f32_16x16x32_bf16 v[252:255], a[12:15], a[76:79], v[252:255]
    s_waitcnt lgkmcnt(8)
    v_mfma_f32_16x16x32_bf16 v[64:67], a[32:35], a[16:19], v[64:67]
    ds_read_b64_tr_b16 a[56:57], v10 offset:36864
    v_mfma_f32_16x16x32_bf16 v[68:71], a[32:35], a[20:23], v[68:71]
    ds_read_b64_tr_b16 a[58:59], v10 offset:37376
    s_add_u32 m0, s34, 110592
    v_mfma_f32_16x16x32_bf16 v[80:83], a[32:35], a[24:27], v[80:83]
    global_load_lds_dwordx4 v12, s[52:53]
    v_mfma_f32_16x16x32_bf16 v[84:87], a[32:35], a[28:31], v[84:87]
    ds_read_b64_tr_b16 a[60:61], v11 offset:36864
    v_add_u32 v12, 196608, v12
    v_mfma_f32_16x16x32_bf16 v[72:75], a[36:39], a[16:19], v[72:75]
    ds_read_b64_tr_b16 a[62:63], v11 offset:37376
    v_mfma_f32_16x16x32_bf16 v[76:79], a[36:39], a[20:23], v[76:79]
    ds_read_b64_tr_b16 a[64:65], v10 offset:40960
    v_mfma_f32_16x16x32_bf16 v[88:91], a[36:39], a[24:27], v[88:91]
    ds_read_b64_tr_b16 a[66:67], v10 offset:41472
    v_mfma_f32_16x16x32_bf16 v[92:95], a[36:39], a[28:31], v[92:95]
    ds_read_b64_tr_b16 a[68:69], v11 offset:40960
    s_add_u32 m0, s34, 114688
    s_waitcnt lgkmcnt(7)
    v_mfma_f32_16x16x32_bf16 v[96:99], a[40:43], a[16:19], v[96:99]
    global_load_lds_dwordx4 v13, s[52:53]
    v_mfma_f32_16x16x32_bf16 v[100:103], a[40:43], a[20:23], v[100:103]
    ds_read_b64_tr_b16 a[70:71], v11 offset:41472
    v_add_u32 v13, 196608, v13
    v_mfma_f32_16x16x32_bf16 v[112:115], a[40:43], a[24:27], v[112:115]
    ds_read_b64_tr_b16 a[72:73], v10 offset:45056
    v_mfma_f32_16x16x32_bf16 v[116:119], a[40:43], a[28:31], v[116:119]
    ds_read_b64_tr_b16 a[74:75], v10 offset:45568
    v_mfma_f32_16x16x32_bf16 v[104:107], a[44:47], a[16:19], v[104:107]
    ds_read_b64_tr_b16 a[76:77], v11 offset:45056
    v_mfma_f32_16x16x32_bf16 v[108:111], a[44:47], a[20:23], v[108:111]
    ds_read_b64_tr_b16 a[78:79], v11 offset:45568
    s_add_u32 m0, s34, 118784
    v_mfma_f32_16x16x32_bf16 v[120:123], a[44:47], a[24:27], v[120:123]
    global_load_lds_dwordx4 v14, s[52:53]
    v_mfma_f32_16x16x32_bf16 v[124:127], a[44:47], a[28:31], v[124:127]
    v_add_u32 v14, 196608, v14
    v_mfma_f32_16x16x32_bf16 v[128:131], a[16:19], a[48:51], v[128:131]
    v_mfma_f32_16x16x32_bf16 v[136:139], a[20:23], a[48:51], v[136:139]
    v_mfma_f32_16x16x32_bf16 v[144:147], a[24:27], a[48:51], v[144:147]
    v_mfma_f32_16x16x32_bf16 v[152:155], a[28:31], a[48:51], v[152:155]
    s_add_u32 m0, s30, 35840
    v_mfma_f32_16x16x32_bf16 v[132:135], a[16:19], a[52:55], v[132:135]
    global_load_lds_dwordx4 v18, s[48:49]
    v_mfma_f32_16x16x32_bf16 v[140:143], a[20:23], a[52:55], v[140:143]
    v_add_u32 v18, 128, v18
    v_mfma_f32_16x16x32_bf16 v[148:151], a[24:27], a[52:55], v[148:151]
    v_mfma_f32_16x16x32_bf16 v[156:159], a[28:31], a[52:55], v[156:159]
    global_load_dword v28, v27, s[44:45]
    v_add_u32 v27, s46, v27
    s_waitcnt vmcnt(18) lgkmcnt(0)
    s_barrier
    v_mfma_f32_16x16x32_bf16 v[160:163], a[56:59], a[16:19], v[160:163]
    ds_read_b128 a[0:3], v2 offset:16384
    v_mfma_f32_16x16x32_bf16 v[168:171], a[56:59], a[20:23], v[168:171]
    ds_read_b128 a[4:7], v2 offset:18432
    s_add_u32 m0, s34, 122880
    v_mfma_f32_16x16x32_bf16 v[176:179], a[56:59], a[24:27], v[176:179]
    global_load_lds_dwordx4 v12, s[50:51]
    v_mfma_f32_16x16x32_bf16 v[184:187], a[56:59], a[28:31], v[184:187]
    ds_read_b128 a[8:11], v2 offset:20480
    v_mfma_f32_16x16x32_bf16 v[164:167], a[60:63], a[16:19], v[164:167]
    ds_read_b128 a[12:15], v2 offset:22528
    v_mfma_f32_16x16x32_bf16 v[172:175], a[60:63], a[20:23], v[172:175]
    ds_read_b64_tr_b16 a[32:33], v4 offset:0
    v_mfma_f32_16x16x32_bf16 v[180:183], a[60:63], a[24:27], v[180:183]
    ds_read_b64_tr_b16 a[34:35], v4 offset:512
    v_mfma_f32_16x16x32_bf16 v[188:191], a[60:63], a[28:31], v[188:191]
    ds_read_b64_tr_b16 a[36:37], v5 offset:0
    s_add_u32 m0, s34, 126976
    v_mfma_f32_16x16x32_bf16 v[192:195], a[64:67], a[16:19], v[192:195]
    global_load_lds_dwordx4 v13, s[50:51]
    v_mfma_f32_16x16x32_bf16 v[200:203], a[64:67], a[20:23], v[200:203]
    ds_read_b64_tr_b16 a[38:39], v5 offset:512
    v_mfma_f32_16x16x32_bf16 v[208:211], a[64:67], a[24:27], v[208:211]
    ds_read_b64_tr_b16 a[40:41], v4 offset:4096
    v_mfma_f32_16x16x32_bf16 v[216:219], a[64:67], a[28:31], v[216:219]
    ds_read_b64_tr_b16 a[42:43], v4 offset:4608
    v_mfma_f32_16x16x32_bf16 v[196:199], a[68:71], a[16:19], v[196:199]
    ds_read_b64_tr_b16 a[44:45], v5 offset:4096
    v_mfma_f32_16x16x32_bf16 v[204:207], a[68:71], a[20:23], v[204:207]
    ds_read_b64_tr_b16 a[46:47], v5 offset:4608
    s_add_u32 m0, s34, 131072
    v_mfma_f32_16x16x32_bf16 v[212:215], a[68:71], a[24:27], v[212:215]
    global_load_lds_dwordx4 v14, s[50:51]
    v_mfma_f32_16x16x32_bf16 v[220:223], a[68:71], a[28:31], v[220:223]
    ds_read_b64_tr_b16 a[48:49], v4 offset:8192
    v_mfma_f32_16x16x32_bf16 v[224:227], a[16:19], a[72:75], v[224:227]
    ds_read_b64_tr_b16 a[50:51], v4 offset:8704
    v_mfma_f32_16x16x32_bf16 v[228:231], a[20:23], a[72:75], v[228:231]
    ds_read_b64_tr_b16 a[52:53], v5 offset:8192
    v_mfma_f32_16x16x32_bf16 v[240:243], a[24:27], a[72:75], v[240:243]
    ds_read_b64_tr_b16 a[54:55], v5 offset:8704
    v_mfma_f32_16x16x32_bf16 v[244:247], a[28:31], a[72:75], v[244:247]
    s_add_u32 m0, s30, 0
    v_mfma_f32_16x16x32_bf16 v[232:235], a[16:19], a[76:79], v[232:235]
    global_load_lds_dwordx4 v15, s[48:49]
    v_mfma_f32_16x16x32_bf16 v[236:239], a[20:23], a[76:79], v[236:239]
    v_add_u32 v15, 128, v15
    v_mfma_f32_16x16x32_bf16 v[248:251], a[24:27], a[76:79], v[248:251]
    v_mfma_f32_16x16x32_bf16 v[252:255], a[28:31], a[76:79], v[252:255]
    s_waitcnt lgkmcnt(8)
    v_mfma_f32_16x16x32_bf16 v[64:67], a[32:35], a[0:3], v[64:67]
    ds_read_b64_tr_b16 a[56:57], v4 offset:12288
    v_mfma_f32_16x16x32_bf16 v[68:71], a[32:35], a[4:7], v[68:71]
    ds_read_b64_tr_b16 a[58:59], v4 offset:12800
    s_add_u32 m0, s34, 135168
    v_mfma_f32_16x16x32_bf16 v[80:83], a[32:35], a[8:11], v[80:83]
    global_load_lds_dwordx4 v12, s[52:53]
    v_mfma_f32_16x16x32_bf16 v[84:87], a[32:35], a[12:15], v[84:87]
    ds_read_b64_tr_b16 a[60:61], v5 offset:12288
    v_add_u32 v12, 196608, v12
    v_mfma_f32_16x16x32_bf16 v[72:75], a[36:39], a[0:3], v[72:75]
    ds_read_b64_tr_b16 a[62:63], v5 offset:12800
    v_mfma_f32_16x16x32_bf16 v[76:79], a[36:39], a[4:7], v[76:79]
    ds_read_b64_tr_b16 a[64:65], v4 offset:16384
    v_mfma_f32_16x16x32_bf16 v[88:91], a[36:39], a[8:11], v[88:91]
    ds_read_b64_tr_b16 a[66:67], v4 offset:16896
    v_mfma_f32_16x16x32_bf16 v[92:95], a[36:39], a[12:15], v[92:95]
    ds_read_b64_tr_b16 a[68:69], v5 offset:16384
    s_add_u32 m0, s34, 139264
    s_waitcnt lgkmcnt(7)
    v_mfma_f32_16x16x32_bf16 v[96:99], a[40:43], a[0:3], v[96:99]
    global_load_lds_dwordx4 v13, s[52:53]
    v_mfma_f32_16x16x32_bf16 v[100:103], a[40:43], a[4:7], v[100:103]
    ds_read_b64_tr_b16 a[70:71], v5 offset:16896
    v_add_u32 v13, 196608, v13
    v_mfma_f32_16x16x32_bf16 v[112:115], a[40:43], a[8:11], v[112:115]
    ds_read_b64_tr_b16 a[72:73], v4 offset:20480
    v_mfma_f32_16x16x32_bf16 v[116:119], a[40:43], a[12:15], v[116:119]
    ds_read_b64_tr_b16 a[74:75], v4 offset:20992
    v_mfma_f32_16x16x32_bf16 v[104:107], a[44:47], a[0:3], v[104:107]
    ds_read_b64_tr_b16 a[76:77], v5 offset:20480
    v_mfma_f32_16x16x32_bf16 v[108:111], a[44:47], a[4:7], v[108:111]
    ds_read_b64_tr_b16 a[78:79], v5 offset:20992
    s_add_u32 m0, s34, 143360
    v_mfma_f32_16x16x32_bf16 v[120:123], a[44:47], a[8:11], v[120:123]
    global_load_lds_dwordx4 v14, s[52:53]
    v_mfma_f32_16x16x32_bf16 v[124:127], a[44:47], a[12:15], v[124:127]
    v_add_u32 v14, 196608, v14
    v_mfma_f32_16x16x32_bf16 v[128:131], a[0:3], a[48:51], v[128:131]
    v_mfma_f32_16x16x32_bf16 v[136:139], a[4:7], a[48:51], v[136:139]
    v_mfma_f32_16x16x32_bf16 v[144:147], a[8:11], a[48:51], v[144:147]
    v_mfma_f32_16x16x32_bf16 v[152:155], a[12:15], a[48:51], v[152:155]
    s_add_u32 m0, s30, 1024
    v_mfma_f32_16x16x32_bf16 v[132:135], a[0:3], a[52:55], v[132:135]
    global_load_lds_dwordx4 v16, s[48:49]
    v_mfma_f32_16x16x32_bf16 v[140:143], a[4:7], a[52:55], v[140:143]
    v_add_u32 v16, 128, v16
    v_mfma_f32_16x16x32_bf16 v[148:151], a[8:11], a[52:55], v[148:151]
    v_mfma_f32_16x16x32_bf16 v[156:159], a[12:15], a[52:55], v[156:159]
    s_waitcnt vmcnt(18) lgkmcnt(0)
    s_barrier
    v_mfma_f32_16x16x32_bf16 v[160:163], a[56:59], a[0:3], v[160:163]
    ds_read_b128 a[16:19], v3 offset:16384
    v_mfma_f32_16x16x32_bf16 v[168:171], a[56:59], a[4:7], v[168:171]
    ds_read_b128 a[20:23], v3 offset:18432
    s_add_u32 m0, s34, 49152
    v_mfma_f32_16x16x32_bf16 v[176:179], a[56:59], a[8:11], v[176:179]
    global_load_lds_dwordx4 v12, s[50:51]
    v_mfma_f32_16x16x32_bf16 v[184:187], a[56:59], a[12:15], v[184:187]
    ds_read_b128 a[24:27], v3 offset:20480
    v_mfma_f32_16x16x32_bf16 v[164:167], a[60:63], a[0:3], v[164:167]
    ds_read_b128 a[28:31], v3 offset:22528
    v_mfma_f32_16x16x32_bf16 v[172:175], a[60:63], a[4:7], v[172:175]
    ds_read_b64_tr_b16 a[32:33], v4 offset:24576
    v_mfma_f32_16x16x32_bf16 v[180:183], a[60:63], a[8:11], v[180:183]
    ds_read_b64_tr_b16 a[34:35], v4 offset:25088
    v_mfma_f32_16x16x32_bf16 v[188:191], a[60:63], a[12:15], v[188:191]
    ds_read_b64_tr_b16 a[36:37], v5 offset:24576
    s_add_u32 m0, s34, 53248
    v_mfma_f32_16x16x32_bf16 v[192:195], a[64:67], a[0:3], v[192:195]
    global_load_lds_dwordx4 v13, s[50:51]
    v_mfma_f32_16x16x32_bf16 v[200:203], a[64:67], a[4:7], v[200:203]
    ds_read_b64_tr_b16 a[38:39], v5 offset:25088
    v_mfma_f32_16x16x32_bf16 v[208:211], a[64:67], a[8:11], v[208:211]
    ds_read_b64_tr_b16 a[40:41], v4 offset:28672
    v_mfma_f32_16x16x32_bf16 v[216:219], a[64:67], a[12:15], v[216:219]
    ds_read_b64_tr_b16 a[42:43], v4 offset:29184
    v_mfma_f32_16x16x32_bf16 v[196:199], a[68:71], a[0:3], v[196:199]
    ds_read_b64_tr_b16 a[44:45], v5 offset:28672
    v_mfma_f32_16x16x32_bf16 v[204:207], a[68:71], a[4:7], v[204:207]
    ds_read_b64_tr_b16 a[46:47], v5 offset:29184
    s_add_u32 m0, s34, 57344
    v_mfma_f32_16x16x32_bf16 v[212:215], a[68:71], a[8:11], v[212:215]
    global_load_lds_dwordx4 v14, s[50:51]
    v_mfma_f32_16x16x32_bf16 v[220:223], a[68:71], a[12:15], v[220:223]
    ds_read_b64_tr_b16 a[48:49], v4 offset:32768
    v_mfma_f32_16x16x32_bf16 v[224:227], a[0:3], a[72:75], v[224:227]
    ds_read_b64_tr_b16 a[50:51], v4 offset:33280
    v_mfma_f32_16x16x32_bf16 v[228:231], a[4:7], a[72:75], v[228:231]
    ds_read_b64_tr_b16 a[52:53], v5 offset:32768
    v_mfma_f32_16x16x32_bf16 v[240:243], a[8:11], a[72:75], v[240:243]
    ds_read_b64_tr_b16 a[54:55], v5 offset:33280
    v_mfma_f32_16x16x32_bf16 v[244:247], a[12:15], a[72:75], v[244:247]
    s_add_u32 m0, s30, 2048
    v_mfma_f32_16x16x32_bf16 v[232:235], a[0:3], a[76:79], v[232:235]
    global_load_lds_dwordx4 v17, s[48:49]
    v_mfma_f32_16x16x32_bf16 v[236:239], a[4:7], a[76:79], v[236:239]
    v_add_u32 v17, 128, v17
    v_mfma_f32_16x16x32_bf16 v[248:251], a[8:11], a[76:79], v[248:251]
    v_mfma_f32_16x16x32_bf16 v[252:255], a[12:15], a[76:79], v[252:255]
    s_waitcnt lgkmcnt(8)
    v_mfma_f32_16x16x32_bf16 v[64:67], a[32:35], a[16:19], v[64:67]
    ds_read_b64_tr_b16 a[56:57], v4 offset:36864
    v_mfma_f32_16x16x32_bf16 v[68:71], a[32:35], a[20:23], v[68:71]
    ds_read_b64_tr_b16 a[58:59], v4 offset:37376
    s_add_u32 m0, s34, 61440
    v_mfma_f32_16x16x32_bf16 v[80:83], a[32:35], a[24:27], v[80:83]
    global_load_lds_dwordx4 v12, s[52:53]
    v_mfma_f32_16x16x32_bf16 v[84:87], a[32:35], a[28:31], v[84:87]
    ds_read_b64_tr_b16 a[60:61], v5 offset:36864
    v_add_u32 v12, 196608, v12
    v_mfma_f32_16x16x32_bf16 v[72:75], a[36:39], a[16:19], v[72:75]
    ds_read_b64_tr_b16 a[62:63], v5 offset:37376
    v_mfma_f32_16x16x32_bf16 v[76:79], a[36:39], a[20:23], v[76:79]
    ds_read_b64_tr_b16 a[64:65], v4 offset:40960
    v_mfma_f32_16x16x32_bf16 v[88:91], a[36:39], a[24:27], v[88:91]
    ds_read_b64_tr_b16 a[66:67], v4 offset:41472
    v_mfma_f32_16x16x32_bf16 v[92:95], a[36:39], a[28:31], v[92:95]
    ds_read_b64_tr_b16 a[68:69], v5 offset:40960
    s_add_u32 m0, s34, 65536
    s_waitcnt lgkmcnt(7)
    v_mfma_f32_16x16x32_bf16 v[96:99], a[40:43], a[16:19], v[96:99]
    global_load_lds_dwordx4 v13, s[52:53]
    v_mfma_f32_16x16x32_bf16 v[100:103], a[40:43], a[20:23], v[100:103]
    ds_read_b64_tr_b16 a[70:71], v5 offset:41472
    v_add_u32 v13, 196608, v13
    v_mfma_f32_16x16x32_bf16 v[112:115], a[40:43], a[24:27], v[112:115]
    ds_read_b64_tr_b16 a[72:73], v4 offset:45056
    v_mfma_f32_16x16x32_bf16 v[116:119], a[40:43], a[28:31], v[116:119]
    ds_read_b64_tr_b16 a[74:75], v4 offset:45568
    v_mfma_f32_16x16x32_bf16 v[104:107], a[44:47], a[16:19], v[104:107]
    ds_read_b64_tr_b16 a[76:77], v5 offset:45056
    v_mfma_f32_16x16x32_bf16 v[108:111], a[44:47], a[20:23], v[108:111]
    ds_read_b64_tr_b16 a[78:79], v5 offset:45568
    s_add_u32 m0, s34, 69632
    v_mfma_f32_16x16x32_bf16 v[120:123], a[44:47], a[24:27], v[120:123]
    global_load_lds_dwordx4 v14, s[52:53]
    v_mfma_f32_16x16x32_bf16 v[124:127], a[44:47], a[28:31], v[124:127]
    v_add_u32 v14, 196608, v14
    v_mfma_f32_16x16x32_bf16 v[128:131], a[16:19], a[48:51], v[128:131]
    v_mfma_f32_16x16x32_bf16 v[136:139], a[20:23], a[48:51], v[136:139]
    v_mfma_f32_16x16x32_bf16 v[144:147], a[24:27], a[48:51], v[144:147]
    v_mfma_f32_16x16x32_bf16 v[152:155], a[28:31], a[48:51], v[152:155]
    s_add_u32 m0, s30, 3072
    v_mfma_f32_16x16x32_bf16 v[132:135], a[16:19], a[52:55], v[132:135]
    global_load_lds_dwordx4 v18, s[48:49]
    v_mfma_f32_16x16x32_bf16 v[140:143], a[20:23], a[52:55], v[140:143]
    v_add_u32 v18, 128, v18
    v_mfma_f32_16x16x32_bf16 v[148:151], a[24:27], a[52:55], v[148:151]
    v_mfma_f32_16x16x32_bf16 v[156:159], a[28:31], a[52:55], v[156:159]
    global_load_dword v28, v27, s[44:45]
    v_add_u32 v27, s46, v27
    s_waitcnt vmcnt(18) lgkmcnt(0)
    s_barrier
    v_mfma_f32_16x16x32_bf16 v[160:163], a[56:59], a[16:19], v[160:163]
    ds_read_b128 a[0:3], v2 offset:32768
    v_mfma_f32_16x16x32_bf16 v[168:171], a[56:59], a[20:23], v[168:171]
    ds_read_b128 a[4:7], v2 offset:34816
    s_add_u32 m0, s34, 73728
    v_mfma_f32_16x16x32_bf16 v[176:179], a[56:59], a[24:27], v[176:179]
    global_load_lds_dwordx4 v12, s[50:51]
    v_mfma_f32_16x16x32_bf16 v[184:187], a[56:59], a[28:31], v[184:187]
    ds_read_b128 a[8:11], v2 offset:36864
    v_mfma_f32_16x16x32_bf16 v[164:167], a[60:63], a[16:19], v[164:167]
    ds_read_b128 a[12:15], v2 offset:38912
    v_mfma_f32_16x16x32_bf16 v[172:175], a[60:63], a[20:23], v[172:175]
    ds_read_b64_tr_b16 a[32:33], v10 offset:0
    v_mfma_f32_16x16x32_bf16 v[180:183], a[60:63], a[24:27], v[180:183]
    ds_read_b64_tr_b16 a[34:35], v10 offset:512
    v_mfma_f32_16x16x32_bf16 v[188:191], a[60:63], a[28:31], v[188:191]
    ds_read_b64_tr_b16 a[36:37], v11 offset:0
    s_add_u32 m0, s34, 77824
    v_mfma_f32_16x16x32_bf16 v[192:195], a[64:67], a[16:19], v[192:195]
    global_load_lds_dwordx4 v13, s[50:51]
    v_mfma_f32_16x16x32_bf16 v[200:203], a[64:67], a[20:23], v[200:203]
    ds_read_b64_tr_b16 a[38:39], v11 offset:512
    v_mfma_f32_16x16x32_bf16 v[208:211], a[64:67], a[24:27], v[208:211]
    ds_read_b64_tr_b16 a[40:41], v10 offset:4096
    v_mfma_f32_16x16x32_bf16 v[216:219], a[64:67], a[28:31], v[216:219]
    ds_read_b64_tr_b16 a[42:43], v10 offset:4608
    v_mfma_f32_16x16x32_bf16 v[196:199], a[68:71], a[16:19], v[196:199]
    ds_read_b64_tr_b16 a[44:45], v11 offset:4096
    v_mfma_f32_16x16x32_bf16 v[204:207], a[68:71], a[20:23], v[204:207]
    ds_read_b64_tr_b16 a[46:47], v11 offset:4608
    s_add_u32 m0, s34, 81920
    v_mfma_f32_16x16x32_bf16 v[212:215], a[68:71], a[24:27], v[212:215]
    global_load_lds_dwordx4 v14, s[50:51]
    v_mfma_f32_16x16x32_bf16 v[220:223], a[68:71], a[28:31], v[220:223]
    ds_read_b64_tr_b16 a[48:49], v10 offset:8192
    v_mfma_f32_16x16x32_bf16 v[224:227], a[16:19], a[72:75], v[224:227]
    ds_read_b64_tr_b16 a[50:51], v10 offset:8704
    v_mfma_f32_16x16x32_bf16 v[228:231], a[20:23], a[72:75], v[228:231]
    ds_read_b64_tr_b16 a[52:53], v11 offset:8192
    v_mfma_f32_16x16x32_bf16 v[240:243], a[24:27], a[72:75], v[240:243]
    ds_read_b64_tr_b16 a[54:55], v11 offset:8704
    v_mfma_f32_16x16x32_bf16 v[244:247], a[28:31], a[72:75], v[244:247]
    s_add_u32 m0, s30, 16384
    v_mfma_f32_16x16x32_bf16 v[232:235], a[16:19], a[76:79], v[232:235]
    global_load_lds_dwordx4 v15, s[48:49]
    v_mfma_f32_16x16x32_bf16 v[236:239], a[20:23], a[76:79], v[236:239]
    v_add_u32 v15, 128, v15
    v_mfma_f32_16x16x32_bf16 v[248:251], a[24:27], a[76:79], v[248:251]
    v_mfma_f32_16x16x32_bf16 v[252:255], a[28:31], a[76:79], v[252:255]
    s_waitcnt lgkmcnt(8)
    v_mfma_f32_16x16x32_bf16 v[64:67], a[32:35], a[0:3], v[64:67]
    ds_read_b64_tr_b16 a[56:57], v10 offset:12288
    v_mfma_f32_16x16x32_bf16 v[68:71], a[32:35], a[4:7], v[68:71]
    ds_read_b64_tr_b16 a[58:59], v10 offset:12800
    s_add_u32 m0, s34, 86016
    v_mfma_f32_16x16x32_bf16 v[80:83], a[32:35], a[8:11], v[80:83]
    global_load_lds_dwordx4 v12, s[52:53]
    v_mfma_f32_16x16x32_bf16 v[84:87], a[32:35], a[12:15], v[84:87]
    ds_read_b64_tr_b16 a[60:61], v11 offset:12288
    v_add_u32 v12, 196608, v12
    v_mfma_f32_16x16x32_bf16 v[72:75], a[36:39], a[0:3], v[72:75]
    ds_read_b64_tr_b16 a[62:63], v11 offset:12800
    v_mfma_f32_16x16x32_bf16 v[76:79], a[36:39], a[4:7], v[76:79]
    ds_read_b64_tr_b16 a[64:65], v10 offset:16384
    v_mfma_f32_16x16x32_bf16 v[88:91], a[36:39], a[8:11], v[88:91]
    ds_read_b64_tr_b16 a[66:67], v10 offset:16896
    v_mfma_f32_16x16x32_bf16 v[92:95], a[36:39], a[12:15], v[92:95]
    ds_read_b64_tr_b16 a[68:69], v11 offset:16384
    s_add_u32 m0, s34, 90112
    s_waitcnt lgkmcnt(7)
    v_mfma_f32_16x16x32_bf16 v[96:99], a[40:43], a[0:3], v[96:99]
    global_load_lds_dwordx4 v13, s[52:53]
    v_mfma_f32_16x16x32_bf16 v[100:103], a[40:43], a[4:7], v[100:103]
    ds_read_b64_tr_b16 a[70:71], v11 offset:16896
    v_add_u32 v13, 196608, v13
    v_mfma_f32_16x16x32_bf16 v[112:115], a[40:43], a[8:11], v[112:115]
    ds_read_b64_tr_b16 a[72:73], v10 offset:20480
    v_mfma_f32_16x16x32_bf16 v[116:119], a[40:43], a[12:15], v[116:119]
    ds_read_b64_tr_b16 a[74:75], v10 offset:20992
    v_mfma_f32_16x16x32_bf16 v[104:107], a[44:47], a[0:3], v[104:107]
    ds_read_b64_tr_b16 a[76:77], v11 offset:20480
    v_mfma_f32_16x16x32_bf16 v[108:111], a[44:47], a[4:7], v[108:111]
    ds_read_b64_tr_b16 a[78:79], v11 offset:20992
    s_add_u32 m0, s34, 94208
    v_mfma_f32_16x16x32_bf16 v[120:123], a[44:47], a[8:11], v[120:123]
    global_load_lds_dwordx4 v14, s[52:53]
    v_mfma_f32_16x16x32_bf16 v[124:127], a[44:47], a[12:15], v[124:127]
    v_add_u32 v14, 196608, v14
    v_mfma_f32_16x16x32_bf16 v[128:131], a[0:3], a[48:51], v[128:131]
    v_mfma_f32_16x16x32_bf16 v[136:139], a[4:7], a[48:51], v[136:139]
    v_mfma_f32_16x16x32_bf16 v[144:147], a[8:11], a[48:51], v[144:147]
    v_mfma_f32_16x16x32_bf16 v[152:155], a[12:15], a[48:51], v[152:155]
    s_add_u32 m0, s30, 17408
    v_mfma_f32_16x16x32_bf16 v[132:135], a[0:3], a[52:55], v[132:135]
    global_load_lds_dwordx4 v16, s[48:49]
    v_mfma_f32_16x16x32_bf16 v[140:143], a[4:7], a[52:55], v[140:143]
    v_add_u32 v16, 128, v16
    v_mfma_f32_16x16x32_bf16 v[148:151], a[8:11], a[52:55], v[148:151]
    v_mfma_f32_16x16x32_bf16 v[156:159], a[12:15], a[52:55], v[156:159]
    s_waitcnt vmcnt(18) lgkmcnt(0)
    s_barrier
    v_mfma_f32_16x16x32_bf16 v[160:163], a[56:59], a[0:3], v[160:163]
    ds_read_b128 a[16:19], v3 offset:32768
    v_mfma_f32_16x16x32_bf16 v[168:171], a[56:59], a[4:7], v[168:171]
    ds_read_b128 a[20:23], v3 offset:34816
    s_add_u32 m0, s34, 98304
    v_mfma_f32_16x16x32_bf16 v[176:179], a[56:59], a[8:11], v[176:179]
    global_load_lds_dwordx4 v12, s[50:51]
    v_mfma_f32_16x16x32_bf16 v[184:187], a[56:59], a[12:15], v[184:187]
    ds_read_b128 a[24:27], v3 offset:36864
    v_mfma_f32_16x16x32_bf16 v[164:167], a[60:63], a[0:3], v[164:167]
    ds_read_b128 a[28:31], v3 offset:38912
    v_mfma_f32_16x16x32_bf16 v[172:175], a[60:63], a[4:7], v[172:175]
    ds_read_b64_tr_b16 a[32:33], v10 offset:24576
    v_mfma_f32_16x16x32_bf16 v[180:183], a[60:63], a[8:11], v[180:183]
    ds_read_b64_tr_b16 a[34:35], v10 offset:25088
    v_mfma_f32_16x16x32_bf16 v[188:191], a[60:63], a[12:15], v[188:191]
    ds_read_b64_tr_b16 a[36:37], v11 offset:24576
    s_add_u32 m0, s34, 102400
    v_mfma_f32_16x16x32_bf16 v[192:195], a[64:67], a[0:3], v[192:195]
    global_load_lds_dwordx4 v13, s[50:51]
    v_mfma_f32_16x16x32_bf16 v[200:203], a[64:67], a[4:7], v[200:203]
    ds_read_b64_tr_b16 a[38:39], v11 offset:25088
    v_mfma_f32_16x16x32_bf16 v[208:211], a[64:67], a[8:11], v[208:211]
    ds_read_b64_tr_b16 a[40:41], v10 offset:28672
    v_mfma_f32_16x16x32_bf16 v[216:219], a[64:67], a[12:15], v[216:219]
    ds_read_b64_tr_b16 a[42:43], v10 offset:29184
    v_mfma_f32_16x16x32_bf16 v[196:199], a[68:71], a[0:3], v[196:199]
    ds_read_b64_tr_b16 a[44:45], v11 offset:28672
    v_mfma_f32_16x16x32_bf16 v[204:207], a[68:71], a[4:7], v[204:207]
    ds_read_b64_tr_b16 a[46:47], v11 offset:29184
    s_add_u32 m0, s34, 106496
    v_mfma_f32_16x16x32_bf16 v[212:215], a[68:71], a[8:11], v[212:215]
    global_load_lds_dwordx4 v14, s[50:51]
    v_mfma_f32_16x16x32_bf16 v[220:223], a[68:71], a[12:15], v[220:223]
    ds_read_b64_tr_b16 a[48:49], v10 offset:32768
    v_mfma_f32_16x16x32_bf16 v[224:227], a[0:3], a[72:75], v[224:227]
    ds_read_b64_tr_b16 a[50:51], v10 offset:33280
    v_mfma_f32_16x16x32_bf16 v[228:231], a[4:7], a[72:75], v[228:231]
    ds_read_b64_tr_b16 a[52:53], v11 offset:32768
    v_mfma_f32_16x16x32_bf16 v[240:243], a[8:11], a[72:75], v[240:243]
    ds_read_b64_tr_b16 a[54:55], v11 offset:33280
    v_mfma_f32_16x16x32_bf16 v[244:247], a[12:15], a[72:75], v[244:247]
    s_add_u32 m0, s30, 18432
    v_mfma_f32_16x16x32_bf16 v[232:235], a[0:3], a[76:79], v[232:235]
    global_load_lds_dwordx4 v17, s[48:49]
    v_mfma_f32_16x16x32_bf16 v[236:239], a[4:7], a[76:79], v[236:239]
    v_add_u32 v17, 128, v17
    v_mfma_f32_16x16x32_bf16 v[248:251], a[8:11], a[76:79], v[248:251]
    v_mfma_f32_16x16x32_bf16 v[252:255], a[12:15], a[76:79], v[252:255]
    s_waitcnt lgkmcnt(8)
    v_mfma_f32_16x16x32_bf16 v[64:67], a[32:35], a[16:19], v[64:67]
    ds_read_b64_tr_b16 a[56:57], v10 offset:36864
    v_mfma_f32_16x16x32_bf16 v[68:71], a[32:35], a[20:23], v[68:71]
    ds_read_b64_tr_b16 a[58:59], v10 offset:37376
    s_add_u32 m0, s34, 110592
    v_mfma_f32_16x16x32_bf16 v[80:83], a[32:35], a[24:27], v[80:83]
    global_load_lds_dwordx4 v12, s[52:53]
    v_mfma_f32_16x16x32_bf16 v[84:87], a[32:35], a[28:31], v[84:87]
    ds_read_b64_tr_b16 a[60:61], v11 offset:36864
    v_add_u32 v12, 196608, v12
    v_mfma_f32_16x16x32_bf16 v[72:75], a[36:39], a[16:19], v[72:75]
    ds_read_b64_tr_b16 a[62:63], v11 offset:37376
    v_mfma_f32_16x16x32_bf16 v[76:79], a[36:39], a[20:23], v[76:79]
    ds_read_b64_tr_b16 a[64:65], v10 offset:40960
    v_mfma_f32_16x16x32_bf16 v[88:91], a[36:39], a[24:27], v[88:91]
    ds_read_b64_tr_b16 a[66:67], v10 offset:41472
    v_mfma_f32_16x16x32_bf16 v[92:95], a[36:39], a[28:31], v[92:95]
    ds_read_b64_tr_b16 a[68:69], v11 offset:40960
    s_add_u32 m0, s34, 114688
    s_waitcnt lgkmcnt(7)
    v_mfma_f32_16x16x32_bf16 v[96:99], a[40:43], a[16:19], v[96:99]
    global_load_lds_dwordx4 v13, s[52:53]
    v_mfma_f32_16x16x32_bf16 v[100:103], a[40:43], a[20:23], v[100:103]
    ds_read_b64_tr_b16 a[70:71], v11 offset:41472
    v_add_u32 v13, 196608, v13
    v_mfma_f32_16x16x32_bf16 v[112:115], a[40:43], a[24:27], v[112:115]
    ds_read_b64_tr_b16 a[72:73], v10 offset:45056
    v_mfma_f32_16x16x32_bf16 v[116:119], a[40:43], a[28:31], v[116:119]
    ds_read_b64_tr_b16 a[74:75], v10 offset:45568
    v_mfma_f32_16x16x32_bf16 v[104:107], a[44:47], a[16:19], v[104:107]
    ds_read_b64_tr_b16 a[76:77], v11 offset:45056
    v_mfma_f32_16x16x32_bf16 v[108:111], a[44:47], a[20:23], v[108:111]
    ds_read_b64_tr_b16 a[78:79], v11 offset:45568
    s_add_u32 m0, s34, 118784
    v_mfma_f32_16x16x32_bf16 v[120:123], a[44:47], a[24:27], v[120:123]
    global_load_lds_dwordx4 v14, s[52:53]
    v_mfma_f32_16x16x32_bf16 v[124:127], a[44:47], a[28:31], v[124:127]
    v_add_u32 v14, 196608, v14
    v_mfma_f32_16x16x32_bf16 v[128:131], a[16:19], a[48:51], v[128:131]
    v_mfma_f32_16x16x32_bf16 v[136:139], a[20:23], a[48:51], v[136:139]
    v_mfma_f32_16x16x32_bf16 v[144:147], a[24:27], a[48:51], v[144:147]
    v_mfma_f32_16x16x32_bf16 v[152:155], a[28:31], a[48:51], v[152:155]
    s_add_u32 m0, s30, 19456
    v_mfma_f32_16x16x32_bf16 v[132:135], a[16:19], a[52:55], v[132:135]
    global_load_lds_dwordx4 v18, s[48:49]
    v_mfma_f32_16x16x32_bf16 v[140:143], a[20:23], a[52:55], v[140:143]
    v_add_u32 v18, 128, v18
    v_mfma_f32_16x16x32_bf16 v[148:151], a[24:27], a[52:55], v[148:151]
    v_mfma_f32_16x16x32_bf16 v[156:159], a[28:31], a[52:55], v[156:159]
    global_load_dword v28, v27, s[44:45]
    v_add_u32 v27, s46, v27
    s_waitcnt vmcnt(18) lgkmcnt(0)
    s_barrier
    v_mfma_f32_16x16x32_bf16 v[160:163], a[56:59], a[16:19], v[160:163]
    ds_read_b128 a[0:3], v2 offset:0
    v_mfma_f32_16x16x32_bf16 v[168:171], a[56:59], a[20:23], v[168:171]
    ds_read_b128 a[4:7], v2 offset:2048
    s_add_u32 m0, s34, 122880
    v_mfma_f32_16x16x32_bf16 v[176:179], a[56:59], a[24:27], v[176:179]
    global_load_lds_dwordx4 v12, s[50:51]
    v_mfma_f32_16x16x32_bf16 v[184:187], a[56:59], a[28:31], v[184:187]
    ds_read_b128 a[8:11], v2 offset:4096
    v_mfma_f32_16x16x32_bf16 v[164:167], a[60:63], a[16:19], v[164:167]
    ds_read_b128 a[12:15], v2 offset:6144
    v_mfma_f32_16x16x32_bf16 v[172:175], a[60:63], a[20:23], v[172:175]
    ds_read_b64_tr_b16 a[32:33], v4 offset:0
    v_mfma_f32_16x16x32_bf16 v[180:183], a[60:63], a[24:27], v[180:183]
    ds_read_b64_tr_b16 a[34:35], v4 offset:512
    v_mfma_f32_16x16x32_bf16 v[188:191], a[60:63], a[28:31], v[188:191]
    ds_read_b64_tr_b16 a[36:37], v5 offset:0
    s_add_u32 m0, s34, 126976
    v_mfma_f32_16x16x32_bf16 v[192:195], a[64:67], a[16:19], v[192:195]
    global_load_lds_dwordx4 v13, s[50:51]
    v_mfma_f32_16x16x32_bf16 v[200:203], a[64:67], a[20:23], v[200:203]
    ds_read_b64_tr_b16 a[38:39], v5 offset:512
    v_mfma_f32_16x16x32_bf16 v[208:211], a[64:67], a[24:27], v[208:211]
    ds_read_b64_tr_b16 a[40:41], v4 offset:4096
    v_mfma_f32_16x16x32_bf16 v[216:219], a[64:67], a[28:31], v[216:219]
    ds_read_b64_tr_b16 a[42:43], v4 offset:4608
    v_mfma_f32_16x16x32_bf16 v[196:199], a[68:71], a[16:19], v[196:199]
    ds_read_b64_tr_b16 a[44:45], v5 offset:4096
    v_mfma_f32_16x16x32_bf16 v[204:207], a[68:71], a[20:23], v[204:207]
    ds_read_b64_tr_b16 a[46:47], v5 offset:4608
    s_add_u32 m0, s34, 131072
    v_mfma_f32_16x16x32_bf16 v[212:215], a[68:71], a[24:27], v[212:215]
    global_load_lds_dwordx4 v14, s[50:51]
    v_mfma_f32_16x16x32_bf16 v[220:223], a[68:71], a[28:31], v[220:223]
    ds_read_b64_tr_b16 a[48:49], v4 offset:8192
    v_mfma_f32_16x16x32_bf16 v[224:227], a[16:19], a[72:75], v[224:227]
    ds_read_b64_tr_b16 a[50:51], v4 offset:8704
    v_mfma_f32_16x16x32_bf16 v[228:231], a[20:23], a[72:75], v[228:231]
    ds_read_b64_tr_b16 a[52:53], v5 offset:8192
    v_mfma_f32_16x16x32_bf16 v[240:243], a[24:27], a[72:75], v[240:243]
    ds_read_b64_tr_b16 a[54:55], v5 offset:8704
    v_mfma_f32_16x16x32_bf16 v[244:247], a[28:31], a[72:75], v[244:247]
    s_add_u32 m0, s30, 32768
    v_mfma_f32_16x16x32_bf16 v[232:235], a[16:19], a[76:79], v[232:235]
    global_load_lds_dwordx4 v15, s[48:49]
    v_mfma_f32_16x16x32_bf16 v[236:239], a[20:23], a[76:79], v[236:239]
    v_add_u32 v15, 128, v15
    v_mfma_f32_16x16x32_bf16 v[248:251], a[24:27], a[76:79], v[248:251]
    v_mfma_f32_16x16x32_bf16 v[252:255], a[28:31], a[76:79], v[252:255]
    s_waitcnt lgkmcnt(8)
    v_mfma_f32_16x16x32_bf16 v[64:67], a[32:35], a[0:3], v[64:67]
    ds_read_b64_tr_b16 a[56:57], v4 offset:12288
    v_mfma_f32_16x16x32_bf16 v[68:71], a[32:35], a[4:7], v[68:71]
    ds_read_b64_tr_b16 a[58:59], v4 offset:12800
    s_add_u32 m0, s34, 135168
    v_mfma_f32_16x16x32_bf16 v[80:83], a[32:35], a[8:11], v[80:83]
    global_load_lds_dwordx4 v12, s[52:53]
    v_mfma_f32_16x16x32_bf16 v[84:87], a[32:35], a[12:15], v[84:87]
    ds_read_b64_tr_b16 a[60:61], v5 offset:12288
    v_add_u32 v12, 196608, v12
    v_mfma_f32_16x16x32_bf16 v[72:75], a[36:39], a[0:3], v[72:75]
    ds_read_b64_tr_b16 a[62:63], v5 offset:12800
    v_mfma_f32_16x16x32_bf16 v[76:79], a[36:39], a[4:7], v[76:79]
    ds_read_b64_tr_b16 a[64:65], v4 offset:16384
    v_mfma_f32_16x16x32_bf16 v[88:91], a[36:39], a[8:11], v[88:91]
    ds_read_b64_tr_b16 a[66:67], v4 offset:16896
    v_mfma_f32_16x16x32_bf16 v[92:95], a[36:39], a[12:15], v[92:95]
    ds_read_b64_tr_b16 a[68:69], v5 offset:16384
    s_add_u32 m0, s34, 139264
    s_waitcnt lgkmcnt(7)
    v_mfma_f32_16x16x32_bf16 v[96:99], a[40:43], a[0:3], v[96:99]
    global_load_lds_dwordx4 v13, s[52:53]
    v_mfma_f32_16x16x32_bf16 v[100:103], a[40:43], a[4:7], v[100:103]
    ds_read_b64_tr_b16 a[70:71], v5 offset:16896
    v_add_u32 v13, 196608, v13
    v_mfma_f32_16x16x32_bf16 v[112:115], a[40:43], a[8:11], v[112:115]
    ds_read_b64_tr_b16 a[72:73], v4 offset:20480
    v_mfma_f32_16x16x32_bf16 v[116:119], a[40:43], a[12:15], v[116:119]
    ds_read_b64_tr_b16 a[74:75], v4 offset:20992
    v_mfma_f32_16x16x32_bf16 v[104:107], a[44:47], a[0:3], v[104:107]
    ds_read_b64_tr_b16 a[76:77], v5 offset:20480
    v_mfma_f32_16x16x32_bf16 v[108:111], a[44:47], a[4:7], v[108:111]
    ds_read_b64_tr_b16 a[78:79], v5 offset:20992
    s_add_u32 m0, s34, 143360
    v_mfma_f32_16x16x32_bf16 v[120:123], a[44:47], a[8:11], v[120:123]
    global_load_lds_dwordx4 v14, s[52:53]
    v_mfma_f32_16x16x32_bf16 v[124:127], a[44:47], a[12:15], v[124:127]
    v_add_u32 v14, 196608, v14
    v_mfma_f32_16x16x32_bf16 v[128:131], a[0:3], a[48:51], v[128:131]
    v_mfma_f32_16x16x32_bf16 v[136:139], a[4:7], a[48:51], v[136:139]
    v_mfma_f32_16x16x32_bf16 v[144:147], a[8:11], a[48:51], v[144:147]
    v_mfma_f32_16x16x32_bf16 v[152:155], a[12:15], a[48:51], v[152:155]
    s_add_u32 m0, s30, 33792
    v_mfma_f32_16x16x32_bf16 v[132:135], a[0:3], a[52:55], v[132:135]
    global_load_lds_dwordx4 v16, s[48:49]
    v_mfma_f32_16x16x32_bf16 v[140:143], a[4:7], a[52:55], v[140:143]
    v_add_u32 v16, 128, v16
    v_mfma_f32_16x16x32_bf16 v[148:151], a[8:11], a[52:55], v[148:151]
    v_mfma_f32_16x16x32_bf16 v[156:159], a[12:15], a[52:55], v[156:159]
    s_waitcnt vmcnt(18) lgkmcnt(0)
    s_barrier
    v_mfma_f32_16x16x32_bf16 v[160:163], a[56:59], a[0:3], v[160:163]
    ds_read_b128 a[16:19], v3 offset:0
    v_mfma_f32_16x16x32_bf16 v[168:171], a[56:59], a[4:7], v[168:171]
    ds_read_b128 a[20:23], v3 offset:2048
    s_add_u32 m0, s34, 49152
    v_mfma_f32_16x16x32_bf16 v[176:179], a[56:59], a[8:11], v[176:179]
    global_load_lds_dwordx4 v12, s[50:51]
    v_mfma_f32_16x16x32_bf16 v[184:187], a[56:59], a[12:15], v[184:187]
    ds_read_b128 a[24:27], v3 offset:4096
    v_mfma_f32_16x16x32_bf16 v[164:167], a[60:63], a[0:3], v[164:167]
    ds_read_b128 a[28:31], v3 offset:6144
    v_mfma_f32_16x16x32_bf16 v[172:175], a[60:63], a[4:7], v[172:175]
    ds_read_b64_tr_b16 a[32:33], v4 offset:24576
    v_mfma_f32_16x16x32_bf16 v[180:183], a[60:63], a[8:11], v[180:183]
    ds_read_b64_tr_b16 a[34:35], v4 offset:25088
    v_mfma_f32_16x16x32_bf16 v[188:191], a[60:63], a[12:15], v[188:191]
    ds_read_b64_tr_b16 a[36:37], v5 offset:24576
    s_add_u32 m0, s34, 53248
    v_mfma_f32_16x16x32_bf16 v[192:195], a[64:67], a[0:3], v[192:195]
    global_load_lds_dwordx4 v13, s[50:51]
    v_mfma_f32_16x16x32_bf16 v[200:203], a[64:67], a[4:7], v[200:203]
    ds_read_b64_tr_b16 a[38:39], v5 offset:25088
    v_mfma_f32_16x16x32_bf16 v[208:211], a[64:67], a[8:11], v[208:211]
    ds_read_b64_tr_b16 a[40:41], v4 offset:28672
    v_mfma_f32_16x16x32_bf16 v[216:219], a[64:67], a[12:15], v[216:219]
    ds_read_b64_tr_b16 a[42:43], v4 offset:29184
    v_mfma_f32_16x16x32_bf16 v[196:199], a[68:71], a[0:3], v[196:199]
    ds_read_b64_tr_b16 a[44:45], v5 offset:28672
    v_mfma_f32_16x16x32_bf16 v[204:207], a[68:71], a[4:7], v[204:207]
    ds_read_b64_tr_b16 a[46:47], v5 offset:29184
    s_add_u32 m0, s34, 57344
    v_mfma_f32_16x16x32_bf16 v[212:215], a[68:71], a[8:11], v[212:215]
    global_load_lds_dwordx4 v14, s[50:51]
    v_mfma_f32_16x16x32_bf16 v[220:223], a[68:71], a[12:15], v[220:223]
    ds_read_b64_tr_b16 a[48:49], v4 offset:32768
    v_mfma_f32_16x16x32_bf16 v[224:227], a[0:3], a[72:75], v[224:227]
    ds_read_b64_tr_b16 a[50:51], v4 offset:33280
    v_mfma_f32_16x16x32_bf16 v[228:231], a[4:7], a[72:75], v[228:231]
    ds_read_b64_tr_b16 a[52:53], v5 offset:32768
    v_mfma_f32_16x16x32_bf16 v[240:243], a[8:11], a[72:75], v[240:243]
    ds_read_b64_tr_b16 a[54:55], v5 offset:33280
    v_mfma_f32_16x16x32_bf16 v[244:247], a[12:15], a[72:75], v[244:247]
    s_add_u32 m0, s30, 34816
    v_mfma_f32_16x16x32_bf16 v[232:235], a[0:3], a[76:79], v[232:235]
    global_load_lds_dwordx4 v17, s[48:49]
    v_mfma_f32_16x16x32_bf16 v[236:239], a[4:7], a[76:79], v[236:239]
    v_add_u32 v17, 128, v17
    v_mfma_f32_16x16x32_bf16 v[248:251], a[8:11], a[76:79], v[248:251]
    v_mfma_f32_16x16x32_bf16 v[252:255], a[12:15], a[76:79], v[252:255]
    s_waitcnt lgkmcnt(8)
    v_mfma_f32_16x16x32_bf16 v[64:67], a[32:35], a[16:19], v[64:67]
    ds_read_b64_tr_b16 a[56:57], v4 offset:36864
    v_mfma_f32_16x16x32_bf16 v[68:71], a[32:35], a[20:23], v[68:71]
    ds_read_b64_tr_b16 a[58:59], v4 offset:37376
    s_add_u32 m0, s34, 61440
    v_mfma_f32_16x16x32_bf16 v[80:83], a[32:35], a[24:27], v[80:83]
    global_load_lds_dwordx4 v12, s[52:53]
    v_mfma_f32_16x16x32_bf16 v[84:87], a[32:35], a[28:31], v[84:87]
    ds_read_b64_tr_b16 a[60:61], v5 offset:36864
    v_add_u32 v12, 196608, v12
    v_mfma_f32_16x16x32_bf16 v[72:75], a[36:39], a[16:19], v[72:75]
    ds_read_b64_tr_b16 a[62:63], v5 offset:37376
    v_mfma_f32_16x16x32_bf16 v[76:79], a[36:39], a[20:23], v[76:79]
    ds_read_b64_tr_b16 a[64:65], v4 offset:40960
    v_mfma_f32_16x16x32_bf16 v[88:91], a[36:39], a[24:27], v[88:91]
    ds_read_b64_tr_b16 a[66:67], v4 offset:41472
    v_mfma_f32_16x16x32_bf16 v[92:95], a[36:39], a[28:31], v[92:95]
    ds_read_b64_tr_b16 a[68:69], v5 offset:40960
    s_add_u32 m0, s34, 65536
    s_waitcnt lgkmcnt(7)
    v_mfma_f32_16x16x32_bf16 v[96:99], a[40:43], a[16:19], v[96:99]
    global_load_lds_dwordx4 v13, s[52:53]
    v_mfma_f32_16x16x32_bf16 v[100:103], a[40:43], a[20:23], v[100:103]
    ds_read_b64_tr_b16 a[70:71], v5 offset:41472
    v_add_u32 v13, 196608, v13
    v_mfma_f32_16x16x32_bf16 v[112:115], a[40:43], a[24:27], v[112:115]
    ds_read_b64_tr_b16 a[72:73], v4 offset:45056
    v_mfma_f32_16x16x32_bf16 v[116:119], a[40:43], a[28:31], v[116:119]
    ds_read_b64_tr_b16 a[74:75], v4 offset:45568
    v_mfma_f32_16x16x32_bf16 v[104:107], a[44:47], a[16:19], v[104:107]
    ds_read_b64_tr_b16 a[76:77], v5 offset:45056
    v_mfma_f32_16x16x32_bf16 v[108:111], a[44:47], a[20:23], v[108:111]
    ds_read_b64_tr_b16 a[78:79], v5 offset:45568
    s_add_u32 m0, s34, 69632
    v_mfma_f32_16x16x32_bf16 v[120:123], a[44:47], a[24:27], v[120:123]
    global_load_lds_dwordx4 v14, s[52:53]
    v_mfma_f32_16x16x32_bf16 v[124:127], a[44:47], a[28:31], v[124:127]
    v_add_u32 v14, 196608, v14
    v_mfma_f32_16x16x32_bf16 v[128:131], a[16:19], a[48:51], v[128:131]
    v_mfma_f32_16x16x32_bf16 v[136:139], a[20:23], a[48:51], v[136:139]
    v_mfma_f32_16x16x32_bf16 v[144:147], a[24:27], a[48:51], v[144:147]
    v_mfma_f32_16x16x32_bf16 v[152:155], a[28:31], a[48:51], v[152:155]
    s_add_u32 m0, s30, 35840
    v_mfma_f32_16x16x32_bf16 v[132:135], a[16:19], a[52:55], v[132:135]
    global_load_lds_dwordx4 v18, s[48:49]
    v_mfma_f32_16x16x32_bf16 v[140:143], a[20:23], a[52:55], v[140:143]
    v_add_u32 v18, 128, v18
    v_mfma_f32_16x16x32_bf16 v[148:151], a[24:27], a[52:55], v[148:151]
    v_mfma_f32_16x16x32_bf16 v[156:159], a[28:31], a[52:55], v[156:159]
    global_load_dword v28, v27, s[44:45]
    v_add_u32 v27, s46, v27
    s_waitcnt vmcnt(18) lgkmcnt(0)
    s_barrier
    v_mfma_f32_16x16x32_bf16 v[160:163], a[56:59], a[16:19], v[160:163]
    ds_read_b128 a[0:3], v2 offset:16384
    v_mfma_f32_16x16x32_bf16 v[168:171], a[56:59], a[20:23], v[168:171]
    ds_read_b128 a[4:7], v2 offset:18432
    s_add_u32 m0, s34, 73728
    v_mfma_f32_16x16x32_bf16 v[176:179], a[56:59], a[24:27], v[176:179]
    global_load_lds_dwordx4 v12, s[50:51]
    v_mfma_f32_16x16x32_bf16 v[184:187], a[56:59], a[28:31], v[184:187]
    ds_read_b128 a[8:11], v2 offset:20480
    v_mfma_f32_16x16x32_bf16 v[164:167], a[60:63], a[16:19], v[164:167]
    ds_read_b128 a[12:15], v2 offset:22528
    v_mfma_f32_16x16x32_bf16 v[172:175], a[60:63], a[20:23], v[172:175]
    ds_read_b64_tr_b16 a[32:33], v10 offset:0
    v_mfma_f32_16x16x32_bf16 v[180:183], a[60:63], a[24:27], v[180:183]
    ds_read_b64_tr_b16 a[34:35], v10 offset:512
    v_mfma_f32_16x16x32_bf16 v[188:191], a[60:63], a[28:31], v[188:191]
    ds_read_b64_tr_b16 a[36:37], v11 offset:0
    s_add_u32 m0, s34, 77824
    v_mfma_f32_16x16x32_bf16 v[192:195], a[64:67], a[16:19], v[192:195]
    global_load_lds_dwordx4 v13, s[50:51]
    v_mfma_f32_16x16x32_bf16 v[200:203], a[64:67], a[20:23], v[200:203]
    ds_read_b64_tr_b16 a[38:39], v11 offset:512
    v_mfma_f32_16x16x32_bf16 v[208:211], a[64:67], a[24:27], v[208:211]
    ds_read_b64_tr_b16 a[40:41], v10 offset:4096
    v_mfma_f32_16x16x32_bf16 v[216:219], a[64:67], a[28:31], v[216:219]
    ds_read_b64_tr_b16 a[42:43], v10 offset:4608
    v_mfma_f32_16x16x32_bf16 v[196:199], a[68:71], a[16:19], v[196:199]
    ds_read_b64_tr_b16 a[44:45], v11 offset:4096
    v_mfma_f32_16x16x32_bf16 v[204:207], a[68:71], a[20:23], v[204:207]
    ds_read_b64_tr_b16 a[46:47], v11 offset:4608
    s_add_u32 m0, s34, 81920
    v_mfma_f32_16x16x32_bf16 v[212:215], a[68:71], a[24:27], v[212:215]
    global_load_lds_dwordx4 v14, s[50:51]
    v_mfma_f32_16x16x32_bf16 v[220:223], a[68:71], a[28:31], v[220:223]
    ds_read_b64_tr_b16 a[48:49], v10 offset:8192
    v_mfma_f32_16x16x32_bf16 v[224:227], a[16:19], a[72:75], v[224:227]
    ds_read_b64_tr_b16 a[50:51], v10 offset:8704
    v_mfma_f32_16x16x32_bf16 v[228:231], a[20:23], a[72:75], v[228:231]
    ds_read_b64_tr_b16 a[52:53], v11 offset:8192
    v_mfma_f32_16x16x32_bf16 v[240:243], a[24:27], a[72:75], v[240:243]
    ds_read_b64_tr_b16 a[54:55], v11 offset:8704
    v_mfma_f32_16x16x32_bf16 v[244:247], a[28:31], a[72:75], v[244:247]
    s_add_u32 m0, s30, 0
    v_mfma_f32_16x16x32_bf16 v[232:235], a[16:19], a[76:79], v[232:235]
    global_load_lds_dwordx4 v15, s[48:49]
    v_mfma_f32_16x16x32_bf16 v[236:239], a[20:23], a[76:79], v[236:239]
    v_add_u32 v15, 128, v15
    v_mfma_f32_16x16x32_bf16 v[248:251], a[24:27], a[76:79], v[248:251]
    v_mfma_f32_16x16x32_bf16 v[252:255], a[28:31], a[76:79], v[252:255]
    s_waitcnt lgkmcnt(8)
    v_mfma_f32_16x16x32_bf16 v[64:67], a[32:35], a[0:3], v[64:67]
    ds_read_b64_tr_b16 a[56:57], v10 offset:12288
    v_mfma_f32_16x16x32_bf16 v[68:71], a[32:35], a[4:7], v[68:71]
    ds_read_b64_tr_b16 a[58:59], v10 offset:12800
    s_add_u32 m0, s34, 86016
    v_mfma_f32_16x16x32_bf16 v[80:83], a[32:35], a[8:11], v[80:83]
    global_load_lds_dwordx4 v12, s[52:53]
    v_mfma_f32_16x16x32_bf16 v[84:87], a[32:35], a[12:15], v[84:87]
    ds_read_b64_tr_b16 a[60:61], v11 offset:12288
    v_add_u32 v12, 196608, v12
    v_mfma_f32_16x16x32_bf16 v[72:75], a[36:39], a[0:3], v[72:75]
    ds_read_b64_tr_b16 a[62:63], v11 offset:12800
    v_mfma_f32_16x16x32_bf16 v[76:79], a[36:39], a[4:7], v[76:79]
    ds_read_b64_tr_b16 a[64:65], v10 offset:16384
    v_mfma_f32_16x16x32_bf16 v[88:91], a[36:39], a[8:11], v[88:91]
    ds_read_b64_tr_b16 a[66:67], v10 offset:16896
    v_mfma_f32_16x16x32_bf16 v[92:95], a[36:39], a[12:15], v[92:95]
    ds_read_b64_tr_b16 a[68:69], v11 offset:16384
    s_add_u32 m0, s34, 90112
    s_waitcnt lgkmcnt(7)
    v_mfma_f32_16x16x32_bf16 v[96:99], a[40:43], a[0:3], v[96:99]
    global_load_lds_dwordx4 v13, s[52:53]
    v_mfma_f32_16x16x32_bf16 v[100:103], a[40:43], a[4:7], v[100:103]
    ds_read_b64_tr_b16 a[70:71], v11 offset:16896
    v_add_u32 v13, 196608, v13
    v_mfma_f32_16x16x32_bf16 v[112:115], a[40:43], a[8:11], v[112:115]
    ds_read_b64_tr_b16 a[72:73], v10 offset:20480
    v_mfma_f32_16x16x32_bf16 v[116:119], a[40:43], a[12:15], v[116:119]
    ds_read_b64_tr_b16 a[74:75], v10 offset:20992
    v_mfma_f32_16x16x32_bf16 v[104:107], a[44:47], a[0:3], v[104:107]
    ds_read_b64_tr_b16 a[76:77], v11 offset:20480
    v_mfma_f32_16x16x32_bf16 v[108:111], a[44:47], a[4:7], v[108:111]
    ds_read_b64_tr_b16 a[78:79], v11 offset:20992
    s_add_u32 m0, s34, 94208
    v_mfma_f32_16x16x32_bf16 v[120:123], a[44:47], a[8:11], v[120:123]
    global_load_lds_dwordx4 v14, s[52:53]
    v_mfma_f32_16x16x32_bf16 v[124:127], a[44:47], a[12:15], v[124:127]
    v_add_u32 v14, 196608, v14
    v_mfma_f32_16x16x32_bf16 v[128:131], a[0:3], a[48:51], v[128:131]
    v_mfma_f32_16x16x32_bf16 v[136:139], a[4:7], a[48:51], v[136:139]
    v_mfma_f32_16x16x32_bf16 v[144:147], a[8:11], a[48:51], v[144:147]
    v_mfma_f32_16x16x32_bf16 v[152:155], a[12:15], a[48:51], v[152:155]
    s_add_u32 m0, s30, 1024
    v_mfma_f32_16x16x32_bf16 v[132:135], a[0:3], a[52:55], v[132:135]
    global_load_lds_dwordx4 v16, s[48:49]
    v_mfma_f32_16x16x32_bf16 v[140:143], a[4:7], a[52:55], v[140:143]
    v_add_u32 v16, 128, v16
    v_mfma_f32_16x16x32_bf16 v[148:151], a[8:11], a[52:55], v[148:151]
    v_mfma_f32_16x16x32_bf16 v[156:159], a[12:15], a[52:55], v[156:159]
    s_waitcnt vmcnt(18) lgkmcnt(0)
    s_barrier
    v_mfma_f32_16x16x32_bf16 v[160:163], a[56:59], a[0:3], v[160:163]
    ds_read_b128 a[16:19], v3 offset:16384
    v_mfma_f32_16x16x32_bf16 v[168:171], a[56:59], a[4:7], v[168:171]
    ds_read_b128 a[20:23], v3 offset:18432
    s_add_u32 m0, s34, 98304
    v_mfma_f32_16x16x32_bf16 v[176:179], a[56:59], a[8:11], v[176:179]
    global_load_lds_dwordx4 v12, s[50:51]
    v_mfma_f32_16x16x32_bf16 v[184:187], a[56:59], a[12:15], v[184:187]
    ds_read_b128 a[24:27], v3 offset:20480
    v_mfma_f32_16x16x32_bf16 v[164:167], a[60:63], a[0:3], v[164:167]
    ds_read_b128 a[28:31], v3 offset:22528
    v_mfma_f32_16x16x32_bf16 v[172:175], a[60:63], a[4:7], v[172:175]
    ds_read_b64_tr_b16 a[32:33], v10 offset:24576
    v_mfma_f32_16x16x32_bf16 v[180:183], a[60:63], a[8:11], v[180:183]
    ds_read_b64_tr_b16 a[34:35], v10 offset:25088
    v_mfma_f32_16x16x32_bf16 v[188:191], a[60:63], a[12:15], v[188:191]
    ds_read_b64_tr_b16 a[36:37], v11 offset:24576
    s_add_u32 m0, s34, 102400
    v_mfma_f32_16x16x32_bf16 v[192:195], a[64:67], a[0:3], v[192:195]
    global_load_lds_dwordx4 v13, s[50:51]
    v_mfma_f32_16x16x32_bf16 v[200:203], a[64:67], a[4:7], v[200:203]
    ds_read_b64_tr_b16 a[38:39], v11 offset:25088
    v_mfma_f32_16x16x32_bf16 v[208:211], a[64:67], a[8:11], v[208:211]
    ds_read_b64_tr_b16 a[40:41], v10 offset:28672
    v_mfma_f32_16x16x32_bf16 v[216:219], a[64:67], a[12:15], v[216:219]
    ds_read_b64_tr_b16 a[42:43], v10 offset:29184
    v_mfma_f32_16x16x32_bf16 v[196:199], a[68:71], a[0:3], v[196:199]
    ds_read_b64_tr_b16 a[44:45], v11 offset:28672
    v_mfma_f32_16x16x32_bf16 v[204:207], a[68:71], a[4:7], v[204:207]
    ds_read_b64_tr_b16 a[46:47], v11 offset:29184
    s_add_u32 m0, s34, 106496
    v_mfma_f32_16x16x32_bf16 v[212:215], a[68:71], a[8:11], v[212:215]
    global_load_lds_dwordx4 v14, s[50:51]
    v_mfma_f32_16x16x32_bf16 v[220:223], a[68:71], a[12:15], v[220:223]
    ds_read_b64_tr_b16 a[48:49], v10 offset:32768
    v_mfma_f32_16x16x32_bf16 v[224:227], a[0:3], a[72:75], v[224:227]
    ds_read_b64_tr_b16 a[50:51], v10 offset:33280
    v_mfma_f32_16x16x32_bf16 v[228:231], a[4:7], a[72:75], v[228:231]
    ds_read_b64_tr_b16 a[52:53], v11 offset:32768
    v_mfma_f32_16x16x32_bf16 v[240:243], a[8:11], a[72:75], v[240:243]
    ds_read_b64_tr_b16 a[54:55], v11 offset:33280
    v_mfma_f32_16x16x32_bf16 v[244:247], a[12:15], a[72:75], v[244:247]
    s_add_u32 m0, s30, 2048
    v_mfma_f32_16x16x32_bf16 v[232:235], a[0:3], a[76:79], v[232:235]
    global_load_lds_dwordx4 v17, s[48:49]
    v_mfma_f32_16x16x32_bf16 v[236:239], a[4:7], a[76:79], v[236:239]
    v_add_u32 v17, 128, v17
    v_mfma_f32_16x16x32_bf16 v[248:251], a[8:11], a[76:79], v[248:251]
    v_mfma_f32_16x16x32_bf16 v[252:255], a[12:15], a[76:79], v[252:255]
    s_waitcnt lgkmcnt(8)
    v_mfma_f32_16x16x32_bf16 v[64:67], a[32:35], a[16:19], v[64:67]
    ds_read_b64_tr_b16 a[56:57], v10 offset:36864
    v_mfma_f32_16x16x32_bf16 v[68:71], a[32:35], a[20:23], v[68:71]
    ds_read_b64_tr_b16 a[58:59], v10 offset:37376
    s_add_u32 m0, s34, 110592
    v_mfma_f32_16x16x32_bf16 v[80:83], a[32:35], a[24:27], v[80:83]
    global_load_lds_dwordx4 v12, s[52:53]
    v_mfma_f32_16x16x32_bf16 v[84:87], a[32:35], a[28:31], v[84:87]
    ds_read_b64_tr_b16 a[60:61], v11 offset:36864
    v_add_u32 v12, 196608, v12
    v_mfma_f32_16x16x32_bf16 v[72:75], a[36:39], a[16:19], v[72:75]
    ds_read_b64_tr_b16 a[62:63], v11 offset:37376
    v_mfma_f32_16x16x32_bf16 v[76:79], a[36:39], a[20:23], v[76:79]
    ds_read_b64_tr_b16 a[64:65], v10 offset:40960
    v_mfma_f32_16x16x32_bf16 v[88:91], a[36:39], a[24:27], v[88:91]
    ds_read_b64_tr_b16 a[66:67], v10 offset:41472
    v_mfma_f32_16x16x32_bf16 v[92:95], a[36:39], a[28:31], v[92:95]
    ds_read_b64_tr_b16 a[68:69], v11 offset:40960
    s_add_u32 m0, s34, 114688
    s_waitcnt lgkmcnt(7)
    v_mfma_f32_16x16x32_bf16 v[96:99], a[40:43], a[16:19], v[96:99]
    global_load_lds_dwordx4 v13, s[52:53]
    v_mfma_f32_16x16x32_bf16 v[100:103], a[40:43], a[20:23], v[100:103]
    ds_read_b64_tr_b16 a[70:71], v11 offset:41472
    v_add_u32 v13, 196608, v13
    v_mfma_f32_16x16x32_bf16 v[112:115], a[40:43], a[24:27], v[112:115]
    ds_read_b64_tr_b16 a[72:73], v10 offset:45056
    v_mfma_f32_16x16x32_bf16 v[116:119], a[40:43], a[28:31], v[116:119]
    ds_read_b64_tr_b16 a[74:75], v10 offset:45568
    v_mfma_f32_16x16x32_bf16 v[104:107], a[44:47], a[16:19], v[104:107]
    ds_read_b64_tr_b16 a[76:77], v11 offset:45056
    v_mfma_f32_16x16x32_bf16 v[108:111], a[44:47], a[20:23], v[108:111]
    ds_read_b64_tr_b16 a[78:79], v11 offset:45568
    s_add_u32 m0, s34, 118784
    v_mfma_f32_16x16x32_bf16 v[120:123], a[44:47], a[24:27], v[120:123]
    global_load_lds_dwordx4 v14, s[52:53]
    v_mfma_f32_16x16x32_bf16 v[124:127], a[44:47], a[28:31], v[124:127]
    v_add_u32 v14, 196608, v14
    v_mfma_f32_16x16x32_bf16 v[128:131], a[16:19], a[48:51], v[128:131]
    v_mfma_f32_16x16x32_bf16 v[136:139], a[20:23], a[48:51], v[136:139]
    v_mfma_f32_16x16x32_bf16 v[144:147], a[24:27], a[48:51], v[144:147]
    v_mfma_f32_16x16x32_bf16 v[152:155], a[28:31], a[48:51], v[152:155]
    s_add_u32 m0, s30, 3072
    v_mfma_f32_16x16x32_bf16 v[132:135], a[16:19], a[52:55], v[132:135]
    global_load_lds_dwordx4 v18, s[48:49]
    v_mfma_f32_16x16x32_bf16 v[140:143], a[20:23], a[52:55], v[140:143]
    v_add_u32 v18, 128, v18
    v_mfma_f32_16x16x32_bf16 v[148:151], a[24:27], a[52:55], v[148:151]
    v_mfma_f32_16x16x32_bf16 v[156:159], a[28:31], a[52:55], v[156:159]
    s_waitcnt vmcnt(17) lgkmcnt(0)
    s_barrier
    v_mfma_f32_16x16x32_bf16 v[160:163], a[56:59], a[16:19], v[160:163]
    ds_read_b128 a[0:3], v2 offset:32768
    v_mfma_f32_16x16x32_bf16 v[168:171], a[56:59], a[20:23], v[168:171]
    ds_read_b128 a[4:7], v2 offset:34816
    v_mfma_f32_16x16x32_bf16 v[176:179], a[56:59], a[24:27], v[176:179]
    ds_read_b128 a[8:11], v2 offset:36864
    v_mfma_f32_16x16x32_bf16 v[184:187], a[56:59], a[28:31], v[184:187]
    ds_read_b128 a[12:15], v2 offset:38912
    v_mfma_f32_16x16x32_bf16 v[164:167], a[60:63], a[16:19], v[164:167]
    ds_read_b64_tr_b16 a[32:33], v4 offset:4096
    v_mfma_f32_16x16x32_bf16 v[172:175], a[60:63], a[20:23], v[172:175]
    ds_read_b64_tr_b16 a[34:35], v4 offset:4608
    v_mfma_f32_16x16x32_bf16 v[180:183], a[60:63], a[24:27], v[180:183]
    ds_read_b64_tr_b16 a[36:37], v5 offset:4096
    v_mfma_f32_16x16x32_bf16 v[188:191], a[60:63], a[28:31], v[188:191]
    ds_read_b64_tr_b16 a[38:39], v5 offset:4608
    v_mfma_f32_16x16x32_bf16 v[192:195], a[64:67], a[16:19], v[192:195]
    ds_read_b64_tr_b16 a[40:41], v4 offset:8192
    v_mfma_f32_16x16x32_bf16 v[200:203], a[64:67], a[20:23], v[200:203]
    ds_read_b64_tr_b16 a[42:43], v4 offset:8704
    v_mfma_f32_16x16x32_bf16 v[208:211], a[64:67], a[24:27], v[208:211]
    ds_read_b64_tr_b16 a[44:45], v5 offset:8192
    v_mfma_f32_16x16x32_bf16 v[216:219], a[64:67], a[28:31], v[216:219]
    ds_read_b64_tr_b16 a[46:47], v5 offset:8704
    v_mfma_f32_16x16x32_bf16 v[196:199], a[68:71], a[16:19], v[196:199]
    s_add_u32 m0, s34, 122880
    v_mfma_f32_16x16x32_bf16 v[204:207], a[68:71], a[20:23], v[204:207]
    global_load_lds_dwordx4 v12, s[50:51]
    v_mfma_f32_16x16x32_bf16 v[212:215], a[68:71], a[24:27], v[212:215]
    s_add_u32 m0, s34, 126976
    v_mfma_f32_16x16x32_bf16 v[220:223], a[68:71], a[28:31], v[220:223]
    global_load_lds_dwordx4 v13, s[50:51]
    v_mfma_f32_16x16x32_bf16 v[224:227], a[16:19], a[72:75], v[224:227]
    s_add_u32 m0, s34, 131072
    v_mfma_f32_16x16x32_bf16 v[228:231], a[20:23], a[72:75], v[228:231]
    global_load_lds_dwordx4 v14, s[50:51]
    v_mfma_f32_16x16x32_bf16 v[240:243], a[24:27], a[72:75], v[240:243]
    s_add_u32 m0, s34, 135168
    v_mfma_f32_16x16x32_bf16 v[244:247], a[28:31], a[72:75], v[244:247]
    global_load_lds_dwordx4 v12, s[52:53]
    v_add_u32 v12, 196608, v12
    v_mfma_f32_16x16x32_bf16 v[232:235], a[16:19], a[76:79], v[232:235]
    s_add_u32 m0, s34, 139264
    v_mfma_f32_16x16x32_bf16 v[236:239], a[20:23], a[76:79], v[236:239]
    global_load_lds_dwordx4 v13, s[52:53]
    v_add_u32 v13, 196608, v13
    v_mfma_f32_16x16x32_bf16 v[248:251], a[24:27], a[76:79], v[248:251]
    s_add_u32 m0, s34, 143360
    v_mfma_f32_16x16x32_bf16 v[252:255], a[28:31], a[76:79], v[252:255]
    global_load_lds_dwordx4 v14, s[52:53]
    v_add_u32 v14, 196608, v14
    s_waitcnt vmcnt(15) lgkmcnt(0)
    s_barrier
    v_mfma_f32_16x16x32_bf16 v[96:99], a[32:35], a[0:3], v[96:99]
    ds_read_b128 a[16:19], v3 offset:32768
    v_mov_b32 v19, 0
    v_mfma_f32_16x16x32_bf16 v[100:103], a[32:35], a[4:7], v[100:103]
    ds_read_b128 a[20:23], v3 offset:34816
    s_add_u32 s25, s80, 4096
    v_mfma_f32_16x16x32_bf16 v[104:107], a[36:39], a[0:3], v[104:107]
    ds_read_b128 a[24:27], v3 offset:36864
    s_mov_b32 s26, s80
    v_mfma_f32_16x16x32_bf16 v[108:111], a[36:39], a[4:7], v[108:111]
    ds_read_b128 a[28:31], v3 offset:38912
    v_mfma_f32_16x16x32_bf16 v[128:131], a[0:3], a[40:43], v[128:131]
    ds_read_b64_tr_b16 a[56:57], v4 offset:28672
    v_mfma_f32_16x16x32_bf16 v[136:139], a[4:7], a[40:43], v[136:139]
    ds_read_b64_tr_b16 a[58:59], v4 offset:29184
    v_mfma_f32_16x16x32_bf16 v[132:135], a[0:3], a[44:47], v[132:135]
    ds_read_b64_tr_b16 a[60:61], v5 offset:28672
    v_mfma_f32_16x16x32_bf16 v[140:143], a[4:7], a[44:47], v[140:143]
    ds_read_b64_tr_b16 a[62:63], v5 offset:29184
    v_mfma_f32_16x16x32_bf16 v[112:115], a[32:35], a[8:11], v[112:115]
    ds_read_b64_tr_b16 a[64:65], v4 offset:32768
    v_mfma_f32_16x16x32_bf16 v[116:119], a[32:35], a[12:15], v[116:119]
    ds_read_b64_tr_b16 a[66:67], v4 offset:33280
    v_mfma_f32_16x16x32_bf16 v[120:123], a[36:39], a[8:11], v[120:123]
    ds_read_b64_tr_b16 a[68:69], v5 offset:32768
    v_mfma_f32_16x16x32_bf16 v[124:127], a[36:39], a[12:15], v[124:127]
    ds_read_b64_tr_b16 a[70:71], v5 offset:33280
    v_mfma_f32_16x16x32_bf16 v[144:147], a[8:11], a[40:43], v[144:147]
    global_load_dword v21, v19, s[78:79] sc1
    v_mfma_f32_16x16x32_bf16 v[152:155], a[12:15], a[40:43], v[152:155]
    buffer_load_dword v28, v26, s[40:43], 0 offen
    v_mfma_f32_16x16x32_bf16 v[148:151], a[8:11], a[44:47], v[148:151]
    v_mfma_f32_16x16x32_bf16 v[156:159], a[12:15], a[44:47], v[156:159]
    buffer_load_dwordx4 a[80:83], v9, s[4:7], 0 offen offset:0
    s_waitcnt vmcnt(9) lgkmcnt(0)
    s_barrier
    v_mfma_f32_16x16x32_bf16 v[96:99], a[56:59], a[16:19], v[96:99]
    ds_read_b128 a[0:3], v2 offset:0
    v_mfma_f32_16x16x32_bf16 v[100:103], a[56:59], a[20:23], v[100:103]
    ds_read_b128 a[4:7], v2 offset:2048
    v_mfma_f32_16x16x32_bf16 v[104:107], a[60:63], a[16:19], v[104:107]
    ds_read_b128 a[8:11], v2 offset:4096
    v_mfma_f32_16x16x32_bf16 v[108:111], a[60:63], a[20:23], v[108:111]
    ds_read_b128 a[12:15], v2 offset:6144
    v_mfma_f32_16x16x32_bf16 v[128:131], a[16:19], a[64:67], v[128:131]
    ds_read_b64_tr_b16 a[32:33], v10 offset:4096
    v_mfma_f32_16x16x32_bf16 v[136:139], a[20:23], a[64:67], v[136:139]
    ds_read_b64_tr_b16 a[34:35], v10 offset:4608
    v_mfma_f32_16x16x32_bf16 v[132:135], a[16:19], a[68:71], v[132:135]
    ds_read_b64_tr_b16 a[36:37], v11 offset:4096
    v_mfma_f32_16x16x32_bf16 v[140:143], a[20:23], a[68:71], v[140:143]
    ds_read_b64_tr_b16 a[38:39], v11 offset:4608
    v_mfma_f32_16x16x32_bf16 v[112:115], a[56:59], a[24:27], v[112:115]
    ds_read_b64_tr_b16 a[40:41], v10 offset:8192
    v_mfma_f32_16x16x32_bf16 v[116:119], a[56:59], a[28:31], v[116:119]
    ds_read_b64_tr_b16 a[42:43], v10 offset:8704
    v_mfma_f32_16x16x32_bf16 v[120:123], a[60:63], a[24:27], v[120:123]
    ds_read_b64_tr_b16 a[44:45], v11 offset:8192
    v_mfma_f32_16x16x32_bf16 v[124:127], a[60:63], a[28:31], v[124:127]
    ds_read_b64_tr_b16 a[46:47], v11 offset:8704
    v_mfma_f32_16x16x32_bf16 v[144:147], a[24:27], a[64:67], v[144:147]
    buffer_load_dwordx4 a[84:87], v9, s[4:7], 0 offen offset:512
    v_mfma_f32_16x16x32_bf16 v[152:155], a[28:31], a[64:67], v[152:155]
    buffer_load_dwordx4 a[88:91], v9, s[4:7], 0 offen offset:1024
    v_mfma_f32_16x16x32_bf16 v[148:151], a[24:27], a[68:71], v[148:151]
    v_mfma_f32_16x16x32_bf16 v[156:159], a[28:31], a[68:71], v[156:159]
    buffer_load_dwordx4 a[92:95], v9, s[4:7], 0 offen offset:1536
    s_waitcnt vmcnt(6) lgkmcnt(0)
    s_barrier
    v_mfma_f32_16x16x32_bf16 v[96:99], a[32:35], a[0:3], v[96:99]
    ds_read_b128 a[16:19], v3 offset:0
    v_mfma_f32_16x16x32_bf16 v[100:103], a[32:35], a[4:7], v[100:103]
    ds_read_b128 a[20:23], v3 offset:2048
    v_mfma_f32_16x16x32_bf16 v[104:107], a[36:39], a[0:3], v[104:107]
    ds_read_b128 a[24:27], v3 offset:4096
    v_mfma_f32_16x16x32_bf16 v[108:111], a[36:39], a[4:7], v[108:111]
    ds_read_b128 a[28:31], v3 offset:6144
    v_mfma_f32_16x16x32_bf16 v[128:131], a[0:3], a[40:43], v[128:131]
    ds_read_b64_tr_b16 a[56:57], v10 offset:28672
    v_mfma_f32_16x16x32_bf16 v[136:139], a[4:7], a[40:43], v[136:139]
    ds_read_b64_tr_b16 a[58:59], v10 offset:29184
    v_mfma_f32_16x16x32_bf16 v[132:135], a[0:3], a[44:47], v[132:135]
    ds_read_b64_tr_b16 a[60:61], v11 offset:28672
    v_mfma_f32_16x16x32_bf16 v[140:143], a[4:7], a[44:47], v[140:143]
    ds_read_b64_tr_b16 a[62:63], v11 offset:29184
    v_mfma_f32_16x16x32_bf16 v[112:115], a[32:35], a[8:11], v[112:115]
    ds_read_b64_tr_b16 a[64:65], v10 offset:32768
    v_mfma_f32_16x16x32_bf16 v[116:119], a[32:35], a[12:15], v[116:119]
    ds_read_b64_tr_b16 a[66:67], v10 offset:33280
    v_mfma_f32_16x16x32_bf16 v[120:123], a[36:39], a[8:11], v[120:123]
    ds_read_b64_tr_b16 a[68:69], v11 offset:32768
    v_mfma_f32_16x16x32_bf16 v[124:127], a[36:39], a[12:15], v[124:127]
    ds_read_b64_tr_b16 a[70:71], v11 offset:33280
    v_mfma_f32_16x16x32_bf16 v[144:147], a[8:11], a[40:43], v[144:147]
    buffer_load_dwordx4 a[96:99], v25, s[56:59], 0 offen offset:0
    v_mfma_f32_16x16x32_bf16 v[152:155], a[12:15], a[40:43], v[152:155]
    buffer_load_dwordx4 a[100:103], v25, s[56:59], 0 offen offset:512
    v_mfma_f32_16x16x32_bf16 v[148:151], a[8:11], a[44:47], v[148:151]
    v_mfma_f32_16x16x32_bf16 v[156:159], a[12:15], a[44:47], v[156:159]
    buffer_load_dwordx4 a[104:107], v25, s[56:59], 0 offen offset:1024
    s_waitcnt lgkmcnt(0)
    v_mfma_f32_16x16x32_bf16 v[96:99], a[56:59], a[16:19], v[96:99]
    ds_read_b128 a[0:3], v2 offset:32768
    v_mfma_f32_16x16x32_bf16 v[100:103], a[56:59], a[20:23], v[100:103]
    ds_read_b128 a[4:7], v2 offset:34816
    v_mfma_f32_16x16x32_bf16 v[104:107], a[60:63], a[16:19], v[104:107]
    ds_read_b128 a[8:11], v2 offset:36864
    v_mfma_f32_16x16x32_bf16 v[108:111], a[60:63], a[20:23], v[108:111]
    ds_read_b128 a[12:15], v2 offset:38912
    v_mfma_f32_16x16x32_bf16 v[128:131], a[16:19], a[64:67], v[128:131]
    ds_read_b64_tr_b16 a[32:33], v4 offset:16384
    v_mfma_f32_16x16x32_bf16 v[136:139], a[20:23], a[64:67], v[136:139]
    ds_read_b64_tr_b16 a[34:35], v4 offset:16896
    v_mfma_f32_16x16x32_bf16 v[132:135], a[16:19], a[68:71], v[132:135]
    ds_read_b64_tr_b16 a[36:37], v5 offset:16384
    v_mfma_f32_16x16x32_bf16 v[140:143], a[20:23], a[68:71], v[140:143]
    ds_read_b64_tr_b16 a[38:39], v5 offset:16896
    v_mfma_f32_16x16x32_bf16 v[112:115], a[56:59], a[24:27], v[112:115]
    ds_read_b64_tr_b16 a[40:41], v4 offset:20480
    v_mfma_f32_16x16x32_bf16 v[116:119], a[56:59], a[28:31], v[116:119]
    ds_read_b64_tr_b16 a[42:43], v4 offset:20992
    v_mfma_f32_16x16x32_bf16 v[120:123], a[60:63], a[24:27], v[120:123]
    ds_read_b64_tr_b16 a[44:45], v5 offset:20480
    v_mfma_f32_16x16x32_bf16 v[124:127], a[60:63], a[28:31], v[124:127]
    ds_read_b64_tr_b16 a[46:47], v5 offset:20992
    v_mfma_f32_16x16x32_bf16 v[144:147], a[24:27], a[64:67], v[144:147]
    buffer_load_dwordx4 a[108:111], v25, s[56:59], 0 offen offset:1536
    v_mfma_f32_16x16x32_bf16 v[152:155], a[28:31], a[64:67], v[152:155]
    global_load_dword v28, v60, s[72:73]
    v_mfma_f32_16x16x32_bf16 v[148:151], a[24:27], a[68:71], v[148:151]
    v_mfma_f32_16x16x32_bf16 v[156:159], a[28:31], a[68:71], v[156:159]
    s_waitcnt lgkmcnt(4)
    v_mfma_f32_16x16x32_bf16 v[192:195], a[32:35], a[0:3], v[192:195]
    ds_read_b128 a[16:19], v3 offset:32768
    v_mfma_f32_16x16x32_bf16 v[200:203], a[32:35], a[4:7], v[200:203]
    ds_read_b128 a[20:23], v3 offset:34816
    v_mfma_f32_16x16x32_bf16 v[208:211], a[32:35], a[8:11], v[208:211]
    ds_read_b128 a[24:27], v3 offset:36864
    v_mfma_f32_16x16x32_bf16 v[216:219], a[32:35], a[12:15], v[216:219]
    ds_read_b128 a[28:31], v3 offset:38912
    v_mfma_f32_16x16x32_bf16 v[196:199], a[36:39], a[0:3], v[196:199]
    ds_read_b64_tr_b16 a[56:57], v4 offset:40960
    v_cvt_pk_bf16_f32 v96, v96, v97
    v_mfma_f32_16x16x32_bf16 v[204:207], a[36:39], a[4:7], v[204:207]
    ds_read_b64_tr_b16 a[58:59], v4 offset:41472
    v_cvt_pk_bf16_f32 v97, v98, v99
    v_mfma_f32_16x16x32_bf16 v[212:215], a[36:39], a[8:11], v[212:215]
    ds_read_b64_tr_b16 a[60:61], v5 offset:40960
    v_cvt_pk_bf16_f32 v98, v100, v101
    v_mfma_f32_16x16x32_bf16 v[220:223], a[36:39], a[12:15], v[220:223]
    ds_read_b64_tr_b16 a[62:63], v5 offset:41472
    v_cvt_pk_bf16_f32 v99, v102, v103
    s_waitcnt lgkmcnt(8)
    v_mfma_f32_16x16x32_bf16 v[224:227], a[0:3], a[40:43], v[224:227]
    ds_read_b64_tr_b16 a[64:65], v4 offset:45056
    v_cvt_pk_bf16_f32 v100, v104, v105
    v_mfma_f32_16x16x32_bf16 v[228:231], a[4:7], a[40:43], v[228:231]
    ds_read_b64_tr_b16 a[66:67], v4 offset:45568
    v_cvt_pk_bf16_f32 v101, v106, v107
    v_mfma_f32_16x16x32_bf16 v[240:243], a[8:11], a[40:43], v[240:243]
    ds_read_b64_tr_b16 a[68:69], v5 offset:45056
    v_cvt_pk_bf16_f32 v102, v108, v109
    v_mfma_f32_16x16x32_bf16 v[244:247], a[12:15], a[40:43], v[244:247]
    ds_read_b64_tr_b16 a[70:71], v5 offset:45568
    v_cvt_pk_bf16_f32 v103, v110, v111
    v_mfma_f32_16x16x32_bf16 v[232:235], a[0:3], a[44:47], v[232:235]
    v_permlane16_swap_b32 v96, v98
    v_mfma_f32_16x16x32_bf16 v[236:239], a[4:7], a[44:47], v[236:239]
    v_permlane16_swap_b32 v97, v99
    v_mfma_f32_16x16x32_bf16 v[248:251], a[8:11], a[44:47], v[248:251]
    v_permlane16_swap_b32 v100, v102
    v_mfma_f32_16x16x32_bf16 v[252:255], a[12:15], a[44:47], v[252:255]
    v_permlane16_swap_b32 v101, v103
    s_waitcnt lgkmcnt(4)
    v_mfma_f32_16x16x32_bf16 v[192:195], a[56:59], a[16:19], v[192:195]
    ds_read_b128 a[0:3], v2 offset:0
    buffer_store_dwordx4 v[96:99], v56, s[16:19], s26 offen offset:0 sc1
    v_mfma_f32_16x16x32_bf16 v[200:203], a[56:59], a[20:23], v[200:203]
    ds_read_b128 a[4:7], v2 offset:2048
    v_cvt_pk_bf16_f32 v104, v128, v129
    v_mfma_f32_16x16x32_bf16 v[208:211], a[56:59], a[24:27], v[208:211]
    ds_read_b128 a[8:11], v2 offset:4096
    v_cvt_pk_bf16_f32 v105, v130, v131
    v_mfma_f32_16x16x32_bf16 v[216:219], a[56:59], a[28:31], v[216:219]
    ds_read_b128 a[12:15], v2 offset:6144
    v_cvt_pk_bf16_f32 v106, v132, v133
    v_mfma_f32_16x16x32_bf16 v[196:199], a[60:63], a[16:19], v[196:199]
    ds_read_b64_tr_b16 a[32:33], v10 offset:16384
    v_cvt_pk_bf16_f32 v107, v134, v135
    v_mfma_f32_16x16x32_bf16 v[204:207], a[60:63], a[20:23], v[204:207]
    ds_read_b64_tr_b16 a[34:35], v10 offset:16896
    v_cvt_pk_bf16_f32 v108, v136, v137
    v_mfma_f32_16x16x32_bf16 v[212:215], a[60:63], a[24:27], v[212:215]
    ds_read_b64_tr_b16 a[36:37], v11 offset:16384
    buffer_store_dwordx4 v[100:103], v56, s[16:19], s26 offen offset:1024 sc1
    v_mfma_f32_16x16x32_bf16 v[220:223], a[60:63], a[28:31], v[220:223]
    ds_read_b64_tr_b16 a[38:39], v11 offset:16896
    v_cvt_pk_bf16_f32 v109, v138, v139
    s_waitcnt lgkmcnt(8)
    v_mfma_f32_16x16x32_bf16 v[224:227], a[16:19], a[64:67], v[224:227]
    ds_read_b64_tr_b16 a[40:41], v10 offset:20480
    v_cvt_pk_bf16_f32 v110, v140, v141
    v_mfma_f32_16x16x32_bf16 v[228:231], a[20:23], a[64:67], v[228:231]
    ds_read_b64_tr_b16 a[42:43], v10 offset:20992
    v_cvt_pk_bf16_f32 v111, v142, v143
    v_mfma_f32_16x16x32_bf16 v[240:243], a[24:27], a[64:67], v[240:243]
    ds_read_b64_tr_b16 a[44:45], v11 offset:20480
    v_cvt_pk_bf16_f32 v112, v112, v113
    v_mfma_f32_16x16x32_bf16 v[244:247], a[28:31], a[64:67], v[244:247]
    ds_read_b64_tr_b16 a[46:47], v11 offset:20992
    v_cvt_pk_bf16_f32 v113, v114, v115
    v_mfma_f32_16x16x32_bf16 v[232:235], a[16:19], a[68:71], v[232:235]
    v_permlane16_swap_b32 v104, v106
    v_mfma_f32_16x16x32_bf16 v[236:239], a[20:23], a[68:71], v[236:239]
    v_permlane16_swap_b32 v105, v107
    v_mfma_f32_16x16x32_bf16 v[248:251], a[24:27], a[68:71], v[248:251]
    v_permlane16_swap_b32 v108, v110
    v_mfma_f32_16x16x32_bf16 v[252:255], a[28:31], a[68:71], v[252:255]
    v_permlane16_swap_b32 v109, v111
    s_waitcnt lgkmcnt(4)
    v_mfma_f32_16x16x32_bf16 v[192:195], a[32:35], a[0:3], v[192:195]
    ds_read_b128 a[16:19], v3 offset:0
    buffer_store_dwordx4 v[104:107], v29, s[16:19], s26 offen offset:2048 sc1
    v_mfma_f32_16x16x32_bf16 v[200:203], a[32:35], a[4:7], v[200:203]
    ds_read_b128 a[20:23], v3 offset:2048
    v_cvt_pk_bf16_f32 v114, v116, v117
    v_mfma_f32_16x16x32_bf16 v[208:211], a[32:35], a[8:11], v[208:211]
    ds_read_b128 a[24:27], v3 offset:4096
    v_cvt_pk_bf16_f32 v115, v118, v119
    v_mfma_f32_16x16x32_bf16 v[216:219], a[32:35], a[12:15], v[216:219]
    ds_read_b128 a[28:31], v3 offset:6144
    v_cvt_pk_bf16_f32 v116, v120, v121
    v_mfma_f32_16x16x32_bf16 v[196:199], a[36:39], a[0:3], v[196:199]
    ds_read_b64_tr_b16 a[56:57], v10 offset:40960
    v_cvt_pk_bf16_f32 v117, v122, v123
    v_mfma_f32_16x16x32_bf16 v[204:207], a[36:39], a[4:7], v[204:207]
    ds_read_b64_tr_b16 a[58:59], v10 offset:41472
    v_cvt_pk_bf16_f32 v118, v124, v125
    v_mfma_f32_16x16x32_bf16 v[212:215], a[36:39], a[8:11], v[212:215]
    ds_read_b64_tr_b16 a[60:61], v11 offset:40960
    buffer_store_dwordx4 v[108:111], v29, s[16:19], s26 offen offset:3072 sc1
    v_mfma_f32_16x16x32_bf16 v[220:223], a[36:39], a[12:15], v[220:223]
    ds_read_b64_tr_b16 a[62:63], v11 offset:41472
    v_cvt_pk_bf16_f32 v119, v126, v127
    s_waitcnt lgkmcnt(8)
    v_mfma_f32_16x16x32_bf16 v[224:227], a[0:3], a[40:43], v[224:227]
    ds_read_b64_tr_b16 a[64:65], v10 offset:45056
    v_cvt_pk_bf16_f32 v120, v144, v145
    v_mfma_f32_16x16x32_bf16 v[228:231], a[4:7], a[40:43], v[228:231]
    ds_read_b64_tr_b16 a[66:67], v10 offset:45568
    v_cvt_pk_bf16_f32 v121, v146, v147
    v_mfma_f32_16x16x32_bf16 v[240:243], a[8:11], a[40:43], v[240:243]
    ds_read_b64_tr_b16 a[68:69], v11 offset:45056
    v_cvt_pk_bf16_f32 v122, v148, v149
    v_mfma_f32_16x16x32_bf16 v[244:247], a[12:15], a[40:43], v[244:247]
    ds_read_b64_tr_b16 a[70:71], v11 offset:45568
    v_cvt_pk_bf16_f32 v123, v150, v151
    v_mfma_f32_16x16x32_bf16 v[232:235], a[0:3], a[44:47], v[232:235]
    v_permlane16_swap_b32 v112, v114
    v_mfma_f32_16x16x32_bf16 v[236:239], a[4:7], a[44:47], v[236:239]
    v_permlane16_swap_b32 v113, v115
    v_mfma_f32_16x16x32_bf16 v[248:251], a[8:11], a[44:47], v[248:251]
    v_permlane16_swap_b32 v116, v118
    v_mfma_f32_16x16x32_bf16 v[252:255], a[12:15], a[44:47], v[252:255]
    v_permlane16_swap_b32 v117, v119
    s_waitcnt lgkmcnt(0)
    v_mfma_f32_16x16x32_bf16 v[208:211], a[56:59], a[24:27], v[208:211]
    ds_read_b128 a[0:3], v2 offset:32768
    v_cvt_pk_bf16_f32 v124, v152, v153
    v_mfma_f32_16x16x32_bf16 v[216:219], a[56:59], a[28:31], v[216:219]
    ds_read_b128 a[4:7], v2 offset:34816
    v_cvt_pk_bf16_f32 v125, v154, v155
    v_mfma_f32_16x16x32_bf16 v[212:215], a[60:63], a[24:27], v[212:215]
    ds_read_b128 a[8:11], v2 offset:36864
    v_cvt_pk_bf16_f32 v126, v156, v157
    v_mfma_f32_16x16x32_bf16 v[220:223], a[60:63], a[28:31], v[220:223]
    ds_read_b128 a[12:15], v2 offset:38912
    v_cvt_pk_bf16_f32 v127, v158, v159
    v_mfma_f32_16x16x32_bf16 v[240:243], a[24:27], a[64:67], v[240:243]
    ds_read_b64_tr_b16 a[32:33], v4 offset:12288
    v_permlane16_swap_b32 v120, v122
    v_mfma_f32_16x16x32_bf16 v[244:247], a[28:31], a[64:67], v[244:247]
    ds_read_b64_tr_b16 a[34:35], v4 offset:12800
    v_permlane16_swap_b32 v121, v123
    v_mfma_f32_16x16x32_bf16 v[248:251], a[24:27], a[68:71], v[248:251]
    ds_read_b64_tr_b16 a[36:37], v5 offset:12288
    v_permlane16_swap_b32 v124, v126
    v_mfma_f32_16x16x32_bf16 v[252:255], a[28:31], a[68:71], v[252:255]
    ds_read_b64_tr_b16 a[38:39], v5 offset:12800
    v_permlane16_swap_b32 v125, v127
    v_mfma_f32_16x16x32_bf16 v[192:195], a[56:59], a[16:19], v[192:195]
    ds_read_b64_tr_b16 a[40:41], v4 offset:0
    v_mfma_f32_16x16x32_bf16 v[200:203], a[56:59], a[20:23], v[200:203]
    ds_read_b64_tr_b16 a[42:43], v4 offset:512
    v_mfma_f32_16x16x32_bf16 v[196:199], a[60:63], a[16:19], v[196:199]
    ds_read_b64_tr_b16 a[44:45], v5 offset:0
    buffer_store_dwordx4 v[112:115], v56, s[16:19], s25 offen offset:0 sc1
    v_mfma_f32_16x16x32_bf16 v[204:207], a[60:63], a[20:23], v[204:207]
    ds_read_b64_tr_b16 a[46:47], v5 offset:512
    v_mfma_f32_16x16x32_bf16 v[224:227], a[16:19], a[64:67], v[224:227]
    v_mfma_f32_16x16x32_bf16 v[228:231], a[20:23], a[64:67], v[228:231]
    v_mfma_f32_16x16x32_bf16 v[232:235], a[16:19], a[68:71], v[232:235]
    v_mfma_f32_16x16x32_bf16 v[236:239], a[20:23], a[68:71], v[236:239]
    s_waitcnt lgkmcnt(4)
    v_mfma_f32_16x16x32_bf16 v[160:163], a[32:35], a[0:3], v[160:163]
    ds_read_b128 a[16:19], v3 offset:32768
    v_mfma_f32_16x16x32_bf16 v[168:171], a[32:35], a[4:7], v[168:171]
    ds_read_b128 a[20:23], v3 offset:34816
    v_mfma_f32_16x16x32_bf16 v[176:179], a[32:35], a[8:11], v[176:179]
    ds_read_b128 a[24:27], v3 offset:36864
    v_mfma_f32_16x16x32_bf16 v[184:187], a[32:35], a[12:15], v[184:187]
    ds_read_b128 a[28:31], v3 offset:38912
    v_mfma_f32_16x16x32_bf16 v[164:167], a[36:39], a[0:3], v[164:167]
    ds_read_b64_tr_b16 a[56:57], v4 offset:36864
    v_mfma_f32_16x16x32_bf16 v[172:175], a[36:39], a[4:7], v[172:175]
    ds_read_b64_tr_b16 a[58:59], v4 offset:37376
    v_cvt_pk_bf16_f32 v192, v192, v193
    v_mfma_f32_16x16x32_bf16 v[180:183], a[36:39], a[8:11], v[180:183]
    ds_read_b64_tr_b16 a[60:61], v5 offset:36864
    v_cvt_pk_bf16_f32 v193, v194, v195
    v_mfma_f32_16x16x32_bf16 v[188:191], a[36:39], a[12:15], v[188:191]
    ds_read_b64_tr_b16 a[62:63], v5 offset:37376
    v_cvt_pk_bf16_f32 v194, v196, v197
    s_waitcnt lgkmcnt(8)
    v_mfma_f32_16x16x32_bf16 v[64:67], a[40:43], a[0:3], v[64:67]
    ds_read_b64_tr_b16 a[64:65], v4 offset:24576
    v_cvt_pk_bf16_f32 v195, v198, v199
    v_mfma_f32_16x16x32_bf16 v[68:71], a[40:43], a[4:7], v[68:71]
    ds_read_b64_tr_b16 a[66:67], v4 offset:25088
    v_cvt_pk_bf16_f32 v196, v200, v201
    v_mfma_f32_16x16x32_bf16 v[80:83], a[40:43], a[8:11], v[80:83]
    ds_read_b64_tr_b16 a[68:69], v5 offset:24576
    v_cvt_pk_bf16_f32 v197, v202, v203
    v_mfma_f32_16x16x32_bf16 v[84:87], a[40:43], a[12:15], v[84:87]
    ds_read_b64_tr_b16 a[70:71], v5 offset:25088
    v_cvt_pk_bf16_f32 v198, v204, v205
    v_mfma_f32_16x16x32_bf16 v[72:75], a[44:47], a[0:3], v[72:75]
    v_cvt_pk_bf16_f32 v199, v206, v207
    v_cvt_pk_bf16_f32 v200, v208, v209
    v_mfma_f32_16x16x32_bf16 v[76:79], a[44:47], a[4:7], v[76:79]
    v_cvt_pk_bf16_f32 v201, v210, v211
    v_cvt_pk_bf16_f32 v202, v212, v213
    v_mfma_f32_16x16x32_bf16 v[88:91], a[44:47], a[8:11], v[88:91]
    buffer_store_dwordx4 v[116:119], v56, s[16:19], s25 offen offset:1024 sc1
    v_mfma_f32_16x16x32_bf16 v[92:95], a[44:47], a[12:15], v[92:95]
    v_cvt_pk_bf16_f32 v203, v214, v215
    v_cvt_pk_bf16_f32 v204, v216, v217
    s_waitcnt lgkmcnt(4)
    v_mfma_f32_16x16x32_bf16 v[160:163], a[56:59], a[16:19], v[160:163]
    ds_read_b128 a[0:3], v2 offset:0
    v_cvt_pk_bf16_f32 v205, v218, v219
    v_mfma_f32_16x16x32_bf16 v[168:171], a[56:59], a[20:23], v[168:171]
    ds_read_b128 a[4:7], v2 offset:2048
    v_cvt_pk_bf16_f32 v206, v220, v221
    v_mfma_f32_16x16x32_bf16 v[176:179], a[56:59], a[24:27], v[176:179]
    ds_read_b128 a[8:11], v2 offset:4096
    v_cvt_pk_bf16_f32 v207, v222, v223
    v_mfma_f32_16x16x32_bf16 v[184:187], a[56:59], a[28:31], v[184:187]
    ds_read_b128 a[12:15], v2 offset:6144
    v_cvt_pk_bf16_f32 v214, v224, v225
    v_mfma_f32_16x16x32_bf16 v[164:167], a[60:63], a[16:19], v[164:167]
    ds_read_b64_tr_b16 a[32:33], v10 offset:12288
    v_cvt_pk_bf16_f32 v215, v226, v227
    v_mfma_f32_16x16x32_bf16 v[172:175], a[60:63], a[20:23], v[172:175]
    ds_read_b64_tr_b16 a[34:35], v10 offset:12800
    v_cvt_pk_bf16_f32 v216, v228, v229
    v_mfma_f32_16x16x32_bf16 v[180:183], a[60:63], a[24:27], v[180:183]
    ds_read_b64_tr_b16 a[36:37], v11 offset:12288
    v_cvt_pk_bf16_f32 v217, v230, v231
    v_mfma_f32_16x16x32_bf16 v[188:191], a[60:63], a[28:31], v[188:191]
    ds_read_b64_tr_b16 a[38:39], v11 offset:12800
    v_cvt_pk_bf16_f32 v226, v232, v233
    s_waitcnt lgkmcnt(8)
    v_mfma_f32_16x16x32_bf16 v[64:67], a[64:67], a[16:19], v[64:67]
    ds_read_b64_tr_b16 a[40:41], v10 offset:0
    v_cvt_pk_bf16_f32 v227, v234, v235
    v_mfma_f32_16x16x32_bf16 v[68:71], a[64:67], a[20:23], v[68:71]
    ds_read_b64_tr_b16 a[42:43], v10 offset:512
    v_cvt_pk_bf16_f32 v228, v236, v237
    v_mfma_f32_16x16x32_bf16 v[80:83], a[64:67], a[24:27], v[80:83]
    ds_read_b64_tr_b16 a[44:45], v11 offset:0
    v_cvt_pk_bf16_f32 v229, v238, v239
    v_mfma_f32_16x16x32_bf16 v[84:87], a[64:67], a[28:31], v[84:87]
    ds_read_b64_tr_b16 a[46:47], v11 offset:512
    v_cvt_pk_bf16_f32 v218, v240, v241
    v_mfma_f32_16x16x32_bf16 v[72:75], a[68:71], a[16:19], v[72:75]
    v_cvt_pk_bf16_f32 v219, v242, v243
    v_cvt_pk_bf16_f32 v220, v244, v245
    v_mfma_f32_16x16x32_bf16 v[76:79], a[68:71], a[20:23], v[76:79]
    v_cvt_pk_bf16_f32 v221, v246, v247
    v_cvt_pk_bf16_f32 v230, v248, v249
    v_mfma_f32_16x16x32_bf16 v[88:91], a[68:71], a[24:27], v[88:91]
    v_cvt_pk_bf16_f32 v231, v250, v251
    v_cvt_pk_bf16_f32 v232, v252, v253
    v_mfma_f32_16x16x32_bf16 v[92:95], a[68:71], a[28:31], v[92:95]
    v_cvt_pk_bf16_f32 v233, v254, v255
    v_mov_b32 v222, v232
    s_waitcnt lgkmcnt(0)
    v_mfma_f32_16x16x32_bf16 v[176:179], a[32:35], a[8:11], v[176:179]
    ds_read_b128 a[16:19], v3 offset:0
    v_mov_b32 v223, v233
    v_mfma_f32_16x16x32_bf16 v[184:187], a[32:35], a[12:15], v[184:187]
    ds_read_b128 a[20:23], v3 offset:2048
    v_mfma_f32_16x16x32_bf16 v[180:183], a[36:39], a[8:11], v[180:183]
    ds_read_b128 a[24:27], v3 offset:4096
    buffer_store_dwordx4 v[120:123], v29, s[16:19], s25 offen offset:2048 sc1
    v_mfma_f32_16x16x32_bf16 v[188:191], a[36:39], a[12:15], v[188:191]
    ds_read_b128 a[28:31], v3 offset:6144
    v_mfma_f32_16x16x32_bf16 v[80:83], a[40:43], a[8:11], v[80:83]
    ds_read_b64_tr_b16 a[56:57], v10 offset:36864
    v_mfma_f32_16x16x32_bf16 v[84:87], a[40:43], a[12:15], v[84:87]
    ds_read_b64_tr_b16 a[58:59], v10 offset:37376
    v_mfma_f32_16x16x32_bf16 v[88:91], a[44:47], a[8:11], v[88:91]
    ds_read_b64_tr_b16 a[60:61], v11 offset:36864
    v_mfma_f32_16x16x32_bf16 v[92:95], a[44:47], a[12:15], v[92:95]
    ds_read_b64_tr_b16 a[62:63], v11 offset:37376
    v_mfma_f32_16x16x32_bf16 v[160:163], a[32:35], a[0:3], v[160:163]
    ds_read_b64_tr_b16 a[64:65], v10 offset:24576
    v_mfma_f32_16x16x32_bf16 v[168:171], a[32:35], a[4:7], v[168:171]
    ds_read_b64_tr_b16 a[66:67], v10 offset:25088
    v_mfma_f32_16x16x32_bf16 v[164:167], a[36:39], a[0:3], v[164:167]
    ds_read_b64_tr_b16 a[68:69], v11 offset:24576
    v_mfma_f32_16x16x32_bf16 v[172:175], a[36:39], a[4:7], v[172:175]
    ds_read_b64_tr_b16 a[70:71], v11 offset:25088
    v_mfma_f32_16x16x32_bf16 v[64:67], a[40:43], a[0:3], v[64:67]
    v_mfma_f32_16x16x32_bf16 v[68:71], a[40:43], a[4:7], v[68:71]
    v_mfma_f32_16x16x32_bf16 v[72:75], a[44:47], a[0:3], v[72:75]
    v_mfma_f32_16x16x32_bf16 v[76:79], a[44:47], a[4:7], v[76:79]
    s_waitcnt lgkmcnt(0)
    s_barrier
    v_mfma_f32_16x16x32_bf16 v[160:163], a[56:59], a[16:19], v[160:163]
    s_add_u32 s36, s27, 98304
    v_add_u32 v22, s36, v29
    v_add_u32 v57, s36, v56
    v_mfma_f32_16x16x32_bf16 v[168:171], a[56:59], a[20:23], v[168:171]
    v_add_u32 v5, 4096, v29
    v_accvgpr_read_b32 v9, a127
    v_mfma_f32_16x16x32_bf16 v[164:167], a[60:63], a[16:19], v[164:167]
    v_mfma_f32_16x16x32_bf16 v[172:175], a[60:63], a[20:23], v[172:175]
    ds_write_b128 v57, v[96:99] offset:0
    v_mfma_f32_16x16x32_bf16 v[176:179], a[56:59], a[24:27], v[176:179]
    v_mfma_f32_16x16x32_bf16 v[184:187], a[56:59], a[28:31], v[184:187]
    ds_write_b128 v57, v[100:103] offset:1024
    v_mfma_f32_16x16x32_bf16 v[180:183], a[60:63], a[24:27], v[180:183]
    v_mfma_f32_16x16x32_bf16 v[188:191], a[60:63], a[28:31], v[188:191]
    ds_write_b128 v22, v[104:107] offset:2048
    v_mfma_f32_16x16x32_bf16 v[64:67], a[64:67], a[16:19], v[64:67]
    v_mfma_f32_16x16x32_bf16 v[68:71], a[64:67], a[20:23], v[68:71]
    ds_write_b128 v22, v[108:111] offset:3072
    v_mfma_f32_16x16x32_bf16 v[72:75], a[68:71], a[16:19], v[72:75]
    v_mfma_f32_16x16x32_bf16 v[76:79], a[68:71], a[20:23], v[76:79]
    ds_write_b128 v57, v[112:115] offset:4096
    v_mfma_f32_16x16x32_bf16 v[80:83], a[64:67], a[24:27], v[80:83]
    v_mfma_f32_16x16x32_bf16 v[84:87], a[64:67], a[28:31], v[84:87]
    ds_write_b128 v57, v[116:119] offset:5120
    v_mfma_f32_16x16x32_bf16 v[88:91], a[68:71], a[24:27], v[88:91]
    v_mfma_f32_16x16x32_bf16 v[92:95], a[68:71], a[28:31], v[92:95]
    ds_write_b128 v22, v[120:123] offset:6144
    s_waitcnt vmcnt(17)
    v_readfirstlane_b32 s60, v21
    v_accvgpr_mov_b32 a72, a125
    v_accvgpr_mov_b32 a73, a125
    ds_write_b128 v22, v[124:127] offset:7168
    v_accvgpr_mov_b32 a74, a126
    v_accvgpr_mov_b32 a75, a126
    v_cvt_pk_bf16_f32 v160, v160, v161
    v_cvt_pk_bf16_f32 v161, v162, v163
    v_cvt_pk_bf16_f32 v162, v164, v165
    v_cvt_pk_bf16_f32 v163, v166, v167
    v_cvt_pk_bf16_f32 v164, v168, v169
    v_cvt_pk_bf16_f32 v165, v170, v171
    v_cvt_pk_bf16_f32 v166, v172, v173
    v_cvt_pk_bf16_f32 v167, v174, v175
    v_cvt_pk_bf16_f32 v168, v176, v177
    v_cvt_pk_bf16_f32 v169, v178, v179
    v_cvt_pk_bf16_f32 v170, v180, v181
    v_cvt_pk_bf16_f32 v171, v182, v183
    v_cvt_pk_bf16_f32 v172, v184, v185
    v_cvt_pk_bf16_f32 v173, v186, v187
    v_cvt_pk_bf16_f32 v174, v188, v189
    v_cvt_pk_bf16_f32 v175, v190, v191
    s_cmp_eq_u32 s60, 0
    s_cbranch_scc1 L_NONCE_S
L_NONCE_R:
    buffer_store_dwordx4 v[124:127], v29, s[16:19], s25 offen offset:3072 sc1
    v_mfma_f32_16x16x32_bf16 v[128:131], v[192:195], v[164:167], v[32:35]
    v_mfma_f32_16x16x32_bf16 v[136:139], v[196:199], v[168:171], v[32:35]
    v_mfma_f32_16x16x32_bf16 v[144:147], v[200:203], v[172:175], v[32:35]
    v_mfma_f32_16x16x32_bf16 v[132:135], v[196:199], v[164:167], v[36:39]
    v_mfma_f32_16x16x32_bf16 v[140:143], v[200:203], v[168:171], v[36:39]
    v_mfma_f32_16x16x32_bf16 v[148:151], v[204:207], v[172:175], v[36:39]
    v_pk_mul_f32 v[64:65], v[64:65], s[62:63]
    v_pk_mul_f32 v[66:67], v[66:67], s[62:63]
    v_pk_mul_f32 v[68:69], v[68:69], s[62:63]
    v_pk_mul_f32 v[70:71], v[70:71], s[62:63]
    v_pk_mul_f32 v[72:73], v[72:73], s[62:63]
    v_pk_mul_f32 v[74:75], v[74:75], s[62:63]
    v_pk_mul_f32 v[76:77], v[76:77], s[62:63]
    v_pk_mul_f32 v[78:79], v[78:79], s[62:63]
    v_cvt_pk_bf16_f32 v64, v64, v65
    v_cvt_pk_bf16_f32 v65, v66, v67
    v_cvt_pk_bf16_f32 v66, v68, v69
    v_cvt_pk_bf16_f32 v67, v70, v71
    v_cvt_pk_bf16_f32 v68, v72, v73
    v_cvt_pk_bf16_f32 v69, v74, v75
    v_cvt_pk_bf16_f32 v70, v76, v77
    v_cvt_pk_bf16_f32 v71, v78, v79
    v_permlane16_swap_b32 v64, v66
    v_permlane16_swap_b32 v65, v67
    v_permlane16_swap_b32 v68, v70
    v_permlane16_swap_b32 v69, v71
    v_max3_f32 v180, v128, v129, v130
    v_max3_f32 v182, v136, v137, v138
    v_max3_f32 v184, v144, v145, v146
    v_max3_f32 v180, v180, v131, v132
    v_max3_f32 v182, v182, v139, v140
    v_max3_f32 v184, v184, v147, v148
    v_max3_f32 v180, v180, v133, v134
    v_max3_f32 v182, v182, v141, v142
    v_max3_f32 v184, v184, v149, v150
    v_max_f32 v180, v180, v135
    v_max_f32 v182, v182, v143
    v_max_f32 v184, v184, v151
    v_mov_b32 v181, v180
    v_mov_b32 v183, v182
    buffer_store_dwordx4 v[204:207], v29, s[16:19], s93 offen sc1
    v_mov_b32 v185, v184
    v_permlane16_swap_b32 v180, v181
    v_permlane16_swap_b32 v182, v183
    v_permlane16_swap_b32 v184, v185
    v_max_f32 v180, v180, v181
    v_max_f32 v182, v182, v183
    v_max_f32 v184, v184, v185
    v_mov_b32 v181, v180
    v_mov_b32 v183, v182
    v_mov_b32 v185, v184
    v_permlane32_swap_b32 v180, v181
    v_permlane32_swap_b32 v182, v183
    v_permlane32_swap_b32 v184, v185
    v_max_f32 v180, v180, v181
    v_max_f32 v182, v182, v183
    v_max_f32 v184, v184, v185
    v_mul_f32 v180, s61, v180
    v_mul_f32 v182, s61, v182
    v_mul_f32 v184, s61, v184
    v_fma_f32 v128, v128, s61, -v180
    v_fma_f32 v136, v136, s61, -v182
    v_fma_f32 v144, v144, s61, -v184
    v_fma_f32 v129, v129, s61, -v180
    v_fma_f32 v137, v137, s61, -v182
    v_fma_f32 v145, v145, s61, -v184
    v_fma_f32 v130, v130, s61, -v180
    v_fma_f32 v138, v138, s61, -v182
    v_fma_f32 v146, v146, s61, -v184
    v_fma_f32 v131, v131, s61, -v180
    v_fma_f32 v139, v139, s61, -v182
    v_fma_f32 v147, v147, s61, -v184
    v_fma_f32 v132, v132, s61, -v180
    v_fma_f32 v140, v140, s61, -v182
    v_fma_f32 v148, v148, s61, -v184
    v_fma_f32 v133, v133, s61, -v180
    v_fma_f32 v141, v141, s61, -v182
    v_fma_f32 v149, v149, s61, -v184
    v_fma_f32 v134, v134, s61, -v180
    v_fma_f32 v142, v142, s61, -v182
    v_fma_f32 v150, v150, s61, -v184
    v_fma_f32 v135, v135, s61, -v180
    v_fma_f32 v143, v143, s61, -v182
    v_fma_f32 v151, v151, s61, -v184
    v_exp_f32 v128, v128
    v_exp_f32 v136, v136
    v_exp_f32 v144, v144
    v_exp_f32 v129, v129
    v_exp_f32 v137, v137
    v_exp_f32 v145, v145
    v_exp_f32 v130, v130
    buffer_store_dwordx4 v[220:223], v29, s[16:19], s93 offen offset:1024 sc1
    v_exp_f32 v138, v138
    v_exp_f32 v146, v146
    v_exp_f32 v131, v131
    v_exp_f32 v139, v139
    v_exp_f32 v147, v147
    v_exp_f32 v132, v132
    v_exp_f32 v140, v140
    v_exp_f32 v148, v148
    v_exp_f32 v133, v133
    v_exp_f32 v141, v141
    v_exp_f32 v149, v149
    v_exp_f32 v134, v134
    v_exp_f32 v142, v142
    v_exp_f32 v150, v150
    v_exp_f32 v135, v135
    v_exp_f32 v143, v143
    v_exp_f32 v151, v151
    v_cvt_pk_bf16_f32 v128, v128, v129
    v_cvt_pk_bf16_f32 v136, v136, v137
    v_cvt_pk_bf16_f32 v144, v144, v145
    v_cvt_pk_bf16_f32 v129, v130, v131
    v_cvt_pk_bf16_f32 v137, v138, v139
    v_cvt_pk_bf16_f32 v145, v146, v147
    v_cvt_pk_bf16_f32 v130, v132, v133
    v_cvt_pk_bf16_f32 v138, v140, v141
    v_cvt_pk_bf16_f32 v146, v148, v149
    v_cvt_pk_bf16_f32 v131, v134, v135
    v_cvt_pk_bf16_f32 v139, v142, v143
    v_cvt_pk_bf16_f32 v147, v150, v151
    v_mfma_f32_16x16x32_bf16 v[152:155], a[112:115], v[128:131], 0
    v_mfma_f32_16x16x32_bf16 v[156:159], a[112:115], v[136:139], 0
    v_mfma_f32_16x16x32_bf16 v[176:179], a[112:115], v[144:147], 0
    v_mfma_f32_16x16x32_bf16 v[40:43], v[214:217], v[128:131], 0
    v_mfma_f32_16x16x32_bf16 v[48:51], v[216:219], v[136:139], 0
    v_mfma_f32_16x16x32_bf16 v[56:59], v[218:221], v[144:147], 0
    v_mfma_f32_16x16x32_bf16 v[44:47], v[226:229], v[128:131], 0
    v_mfma_f32_16x16x32_bf16 v[52:55], v[228:231], v[136:139], 0
    v_mfma_f32_16x16x32_bf16 v[60:63], v[230:233], v[144:147], 0
    v_pk_mul_f32 v[80:81], v[80:81], s[62:63]
    v_pk_mul_f32 v[82:83], v[82:83], s[62:63]
    v_pk_mul_f32 v[84:85], v[84:85], s[62:63]
    v_pk_mul_f32 v[86:87], v[86:87], s[62:63]
    v_pk_mul_f32 v[88:89], v[88:89], s[62:63]
    v_pk_mul_f32 v[90:91], v[90:91], s[62:63]
    v_pk_mul_f32 v[92:93], v[92:93], s[62:63]
    v_pk_mul_f32 v[94:95], v[94:95], s[62:63]
    v_cvt_pk_bf16_f32 v80, v80, v81
    v_cvt_pk_bf16_f32 v81, v82, v83
    v_cvt_pk_bf16_f32 v82, v84, v85
    v_cvt_pk_bf16_f32 v83, v86, v87
    v_cvt_pk_bf16_f32 v84, v88, v89
    v_cvt_pk_bf16_f32 v85, v90, v91
    v_cvt_pk_bf16_f32 v86, v92, v93
    v_cvt_pk_bf16_f32 v87, v94, v95
    v_permlane16_swap_b32 v80, v82
    v_permlane16_swap_b32 v81, v83
    v_permlane16_swap_b32 v84, v86
    v_permlane16_swap_b32 v85, v87
    v_rcp_f32 v180, v152
    v_rcp_f32 v182, v156
    v_rcp_f32 v184, v176
    v_mul_f32 v40, v40, v180
    v_mul_f32 v48, v48, v182
    v_mul_f32 v56, v56, v184
    v_mul_f32 v41, v41, v180
    v_mul_f32 v49, v49, v182
    v_mul_f32 v57, v57, v184
    v_mul_f32 v42, v42, v180
    v_mul_f32 v50, v50, v182
    v_mul_f32 v58, v58, v184
    v_mul_f32 v43, v43, v180
    v_mul_f32 v51, v51, v182
    v_mul_f32 v59, v59, v184
    v_mul_f32 v44, v44, v180
    v_mul_f32 v52, v52, v182
    v_mul_f32 v60, v60, v184
    v_mul_f32 v45, v45, v180
    v_mul_f32 v53, v53, v182
    v_mul_f32 v61, v61, v184
    v_mul_f32 v46, v46, v180
    v_mul_f32 v54, v54, v182
    v_mul_f32 v62, v62, v184
    v_mul_f32 v47, v47, v180
    v_mul_f32 v55, v55, v182
    v_mul_f32 v63, v63, v184
    v_cvt_pk_bf16_f32 v40, v40, v41
    v_cvt_pk_bf16_f32 v48, v48, v49
    v_cvt_pk_bf16_f32 v56, v56, v57
    v_cvt_pk_bf16_f32 v41, v42, v43
    v_cvt_pk_bf16_f32 v49, v50, v51
    v_cvt_pk_bf16_f32 v57, v58, v59
    v_cvt_pk_bf16_f32 v42, v44, v45
    v_cvt_pk_bf16_f32 v50, v52, v53
    v_cvt_pk_bf16_f32 v58, v60, v61
    v_cvt_pk_bf16_f32 v43, v46, v47
    v_cvt_pk_bf16_f32 v51, v54, v55
    v_cvt_pk_bf16_f32 v59, v62, v63
    s_waitcnt vmcnt(2) lgkmcnt(0)
    v_mov_b32 v20, s60
    buffer_store_dword v20, v31, s[16:19], s32 offen sc1
    s_barrier
L_ATT0:
    ds_read_b128 a[0:3], v6 offset:0
    ds_read_b128 a[4:7], v6 offset:1024
    ds_read_b128 a[8:11], v6 offset:2048
    ds_read_b128 a[12:15], v6 offset:3072
    s_cmp_le_u32 s82, 0
    s_addc_u32 s36, s3, 0
    s_lshl_b32 s36, s36, 15
    s_add_u32 s98, s84, s36
    s_addc_u32 s99, s85, 0
    v_accvgpr_write_b32 a64, 0
    v_accvgpr_write_b32 a65, 0
    v_accvgpr_write_b32 a68, 0
    v_accvgpr_write_b32 a69, 0
    s_cmp_lg_u32 s83, 0
    s_cbranch_scc1 L_ATT1
    s_mov_b32 s4, s70
    s_and_b32 s5, s71, 0xffff
    s_mov_b32 s6, 2097152
    s_mov_b32 s7, 0x20000
    v_accvgpr_read_b32 v2, a116
    v_accvgpr_read_b32 v15, a117
    v_accvgpr_read_b32 v3, a118
    v_accvgpr_read_b32 v4, a119
    v_accvgpr_read_b32 v10, a120
    v_accvgpr_read_b32 v11, a121
    v_accvgpr_read_b32 v16, a122
    v_accvgpr_read_b32 v17, a123
    v_accvgpr_read_b32 v25, a124
    v_accvgpr_read_b32 v96, a80
    v_accvgpr_read_b32 v100, a96
    v_dot2_f32_bf16 v23, v96, v100, 0
    v_accvgpr_read_b32 v97, a81
    v_accvgpr_read_b32 v101, a97
    v_dot2_f32_bf16 v23, v97, v101, v23
    v_accvgpr_read_b32 v98, a82
    v_accvgpr_read_b32 v102, a98
    v_dot2_f32_bf16 v23, v98, v102, v23
    s_waitcnt lgkmcnt(0)
    v_mfma_f32_32x32x16_bf16 v[176:191], a[0:3], v[64:67], 0
    v_mfma_f32_32x32x16_bf16 v[240:255], a[0:3], v[80:83], 0
    v_mfma_f32_32x32x16_bf16 v[176:191], a[4:7], v[68:71], v[176:191]
    v_mfma_f32_32x32x16_bf16 v[240:255], a[4:7], v[84:87], v[240:255]
    v_accvgpr_read_b32 v99, a83
    v_accvgpr_read_b32 v103, a99
    v_dot2_f32_bf16 v23, v99, v103, v23
    v_accvgpr_read_b32 v96, a84
    v_accvgpr_read_b32 v100, a100
    v_dot2_f32_bf16 v23, v96, v100, v23
    v_accvgpr_read_b32 v97, a85
    v_accvgpr_read_b32 v101, a101
    v_dot2_f32_bf16 v23, v97, v101, v23
    v_accvgpr_read_b32 v98, a86
    v_accvgpr_read_b32 v102, a102
    v_dot2_f32_bf16 v23, v98, v102, v23
    v_accvgpr_read_b32 v99, a87
    v_accvgpr_read_b32 v103, a103
    v_dot2_f32_bf16 v23, v99, v103, v23
    v_accvgpr_read_b32 v96, a88
    v_accvgpr_read_b32 v100, a104
    v_dot2_f32_bf16 v23, v96, v100, v23
    v_accvgpr_read_b32 v97, a89
    v_accvgpr_read_b32 v101, a105
    v_dot2_f32_bf16 v23, v97, v101, v23
    v_accvgpr_read_b32 v98, a90
    v_accvgpr_read_b32 v102, a106
    v_dot2_f32_bf16 v23, v98, v102, v23
    v_accvgpr_read_b32 v99, a91
    v_accvgpr_read_b32 v103, a107
    v_max3_f32 v19, v176, v177, v178
    v_max3_f32 v19, v19, v179, v180
    v_max3_f32 v19, v19, v181, v182
    v_max3_f32 v19, v19, v183, v184
    v_max3_f32 v19, v19, v185, v186
    v_max3_f32 v19, v19, v187, v188
    v_max3_f32 v19, v19, v189, v190
    v_max_f32 v19, v19, v191
    v_max3_f32 v20, v240, v241, v242
    v_max3_f32 v20, v20, v243, v244
    v_max3_f32 v20, v20, v245, v246
    v_max3_f32 v20, v20, v247, v248
    v_max3_f32 v20, v20, v249, v250
    v_max3_f32 v20, v20, v251, v252
    v_max3_f32 v20, v20, v253, v254
    v_max_f32 v20, v20, v255
    v_mov_b32 v21, v19
    v_mov_b32 v22, v20
    s_nop 0
    v_permlane32_swap_b32 v19, v21
    v_permlane32_swap_b32 v20, v22
    v_max_f32 v19, v19, v21
    v_max_f32 v20, v20, v22
    v_sub_f32 v128, 0, v19
    v_sub_f32 v129, 0, v19
    v_sub_f32 v130, 0, v19
    v_sub_f32 v131, 0, v19
    v_sub_f32 v132, 0, v19
    v_sub_f32 v133, 0, v19
    v_sub_f32 v134, 0, v19
    v_sub_f32 v135, 0, v19
    v_sub_f32 v136, 0, v19
    v_sub_f32 v137, 0, v19
    v_sub_f32 v138, 0, v19
    v_sub_f32 v139, 0, v19
    v_sub_f32 v140, 0, v19
    v_sub_f32 v141, 0, v19
    v_sub_f32 v142, 0, v19
    v_sub_f32 v143, 0, v19
    v_dot2_f32_bf16 v23, v99, v103, v23
    v_accvgpr_read_b32 v96, a92
    v_mfma_f32_32x32x16_bf16 v[176:191], a[0:3], v[64:67], v[128:143]
    v_mfma_f32_32x32x16_bf16 v[176:191], a[4:7], v[68:71], v[176:191]
    v_sub_f32 v144, 0, v20
    v_sub_f32 v145, 0, v20
    v_sub_f32 v146, 0, v20
    v_sub_f32 v147, 0, v20
    v_sub_f32 v148, 0, v20
    v_sub_f32 v149, 0, v20
    v_sub_f32 v150, 0, v20
    v_sub_f32 v151, 0, v20
    v_sub_f32 v152, 0, v20
    v_sub_f32 v153, 0, v20
    v_sub_f32 v154, 0, v20
    v_sub_f32 v155, 0, v20
    v_sub_f32 v156, 0, v20
    v_sub_f32 v157, 0, v20
    v_sub_f32 v158, 0, v20
    v_sub_f32 v159, 0, v20
    v_accvgpr_read_b32 v100, a108
    v_dot2_f32_bf16 v23, v96, v100, v23
    v_accvgpr_read_b32 v97, a93
    v_accvgpr_read_b32 v101, a109
    v_dot2_f32_bf16 v23, v97, v101, v23
    v_accvgpr_read_b32 v98, a94
    v_accvgpr_read_b32 v102, a110
    v_dot2_f32_bf16 v23, v98, v102, v23
    v_accvgpr_read_b32 v99, a95
    v_accvgpr_read_b32 v103, a111
    v_dot2_f32_bf16 v23, v99, v103, v23
    s_nop 2
    v_add_f32_dpp v23, v23, v23 row_ror:8 row_mask:0xf bank_mask:0xf
    s_nop 1
    v_add_f32_dpp v23, v23, v23 row_ror:4 row_mask:0xf bank_mask:0xf
    s_nop 1
    v_add_f32_dpp v23, v23, v23 row_ror:2 row_mask:0xf bank_mask:0xf
    s_nop 1
    v_add_f32_dpp v23, v23, v23 row_ror:1 row_mask:0xf bank_mask:0xf
    s_nop 1
    v_mov_b32 v24, v23
    s_nop 1
    v_permlane16_swap_b32 v23, v24
    v_add_f32 v23, v23, v24
    v_mul_f32 v23, 3216550459, v23
    v_exp_f32 v23, v23
    v_and_b32 v24, 31, v1
    v_add_f32 v23, 1.0, v23
    v_rcp_f32 v23, v23
    v_min_u32 v24, 1, v24
    v_lshlrev_b32 v24, 31, v24
    v_lshl_or_b32 v24, v8, 2, v24
    s_mov_b32 s36, 20971520
    buffer_store_dword v23, v24, s[16:19], s36 offen sc1
    v_mov_b32 v18, 0
    s_add_u32 s30, s28, 22024192
    s_branch L_ATT2
L_ATT1:
    s_waitcnt lgkmcnt(0)
    v_mfma_f32_32x32x16_bf16 v[176:191], a[0:3], v[64:67], v[128:143]
    v_mfma_f32_32x32x16_bf16 v[176:191], a[4:7], v[68:71], v[176:191]
    s_nop 11
L_ATT2:
    v_mfma_f32_32x32x16_bf16 v[240:255], a[0:3], v[80:83], v[144:159]
    buffer_load_dword v21, v17, s[16:19], s31 offen sc1
    v_exp_f32 v176, v176
    v_exp_f32 v177, v177
    v_exp_f32 v178, v178
    v_mfma_f32_32x32x16_bf16 v[240:255], a[4:7], v[84:87], v[240:255]
    ds_read_b128 a[0:3], v6 offset:8192
    v_exp_f32 v179, v179
    v_cvt_pk_bf16_f32 v72, v176, v177
    v_cvt_pk_bf16_f32 v73, v178, v179
    v_exp_f32 v180, v180
    ds_read_b128 a[4:7], v6 offset:9216
    v_exp_f32 v181, v181
    v_exp_f32 v182, v182
    v_exp_f32 v183, v183
    s_nop 0
    v_cvt_pk_bf16_f32 v74, v180, v181
    v_cvt_pk_bf16_f32 v75, v182, v183
    v_exp_f32 v184, v184
    v_exp_f32 v185, v185
    v_exp_f32 v186, v186
    v_exp_f32 v187, v187
    v_cvt_pk_bf16_f32 v76, v184, v185
    v_cvt_pk_bf16_f32 v77, v186, v187
    s_waitcnt lgkmcnt(0)
    v_exp_f32 v188, v188
    v_exp_f32 v189, v189
    v_exp_f32 v190, v190
    v_exp_f32 v191, v191
    v_cvt_pk_bf16_f32 v78, v188, v189
    v_cvt_pk_bf16_f32 v79, v190, v191
    v_mfma_f32_32x32x16_bf16 v[176:191], a[0:3], v[64:67], v[128:143]
    ds_read_b128 a[16:19], v6 offset:10240
    v_exp_f32 v240, v240
    v_exp_f32 v241, v241
    v_exp_f32 v242, v242
    v_mfma_f32_32x32x16_bf16 v[176:191], a[4:7], v[68:71], v[176:191]
    ds_read_b128 a[20:23], v6 offset:11264
    v_exp_f32 v243, v243
    v_cvt_pk_bf16_f32 v88, v240, v241
    v_cvt_pk_bf16_f32 v89, v242, v243
    v_exp_f32 v244, v244
    v_mfma_f32_32x32x16_bf16 a[32:47], a[8:11], v[72:75], 0
    v_exp_f32 v245, v245
    v_exp_f32 v246, v246
    v_exp_f32 v247, v247
    v_mfma_f32_32x32x16_bf16 a[32:47], a[12:15], v[76:79], a[32:47]
    v_cvt_pk_bf16_f32 v90, v244, v245
    v_cvt_pk_bf16_f32 v91, v246, v247
    v_exp_f32 v248, v248
    v_exp_f32 v249, v249
    v_exp_f32 v250, v250
    v_exp_f32 v251, v251
    v_cvt_pk_bf16_f32 v92, v248, v249
    v_cvt_pk_bf16_f32 v93, v250, v251
    v_smfmac_f32_16x16x64_bf16 a[64:67], a[72:75], v[72:79], v9
    v_exp_f32 v252, v252
    v_exp_f32 v253, v253
    v_exp_f32 v254, v254
    v_exp_f32 v255, v255
    v_cvt_pk_bf16_f32 v94, v252, v253
    v_cvt_pk_bf16_f32 v95, v254, v255
    s_add_u32 m0, s27, 131072
    s_waitcnt vmcnt(0)
    v_cmp_ne_u32 vcc, s60, v21
    s_and_b32 s87, vcc_lo, 1
    s_cbranch_scc1 L_PKV_S
L_PKV_R:
    global_load_lds_dwordx4 v29, s[98:99] offset:0 sc1
    global_load_lds_dwordx4 v29, s[98:99] offset:1024 sc1
    v_mfma_f32_32x32x16_bf16 v[240:255], a[0:3], v[80:83], v[144:159]
    global_load_lds_dwordx4 v29, s[98:99] offset:2048 sc1
    v_exp_f32 v176, v176
    v_exp_f32 v177, v177
    v_exp_f32 v178, v178
    v_mfma_f32_32x32x16_bf16 v[240:255], a[4:7], v[84:87], v[240:255]
    ds_read_b128 a[0:3], v6 offset:4096
    v_exp_f32 v179, v179
    v_cvt_pk_bf16_f32 v72, v176, v177
    v_cvt_pk_bf16_f32 v73, v178, v179
    v_exp_f32 v180, v180
    v_mfma_f32_32x32x16_bf16 a[48:63], a[8:11], v[88:91], 0
    ds_read_b128 a[4:7], v6 offset:5120
    v_exp_f32 v181, v181
    v_exp_f32 v182, v182
    v_exp_f32 v183, v183
    v_mfma_f32_32x32x16_bf16 a[48:63], a[12:15], v[92:95], a[48:63]
    global_load_lds_dwordx4 v29, s[98:99] offset:3072 sc1
    v_cvt_pk_bf16_f32 v74, v180, v181
    v_cvt_pk_bf16_f32 v75, v182, v183
    v_exp_f32 v184, v184
    v_exp_f32 v185, v185
    v_exp_f32 v186, v186
    v_exp_f32 v187, v187
    v_cvt_pk_bf16_f32 v76, v184, v185
    v_cvt_pk_bf16_f32 v77, v186, v187
    v_smfmac_f32_16x16x64_bf16 a[68:71], a[72:75], v[88:95], v9
    buffer_load_dword v21, v17, s[16:19], s31 offen sc1
    s_waitcnt lgkmcnt(0)
    v_exp_f32 v188, v188
    v_exp_f32 v189, v189
    v_exp_f32 v190, v190
    v_exp_f32 v191, v191
    v_cvt_pk_bf16_f32 v78, v188, v189
    v_cvt_pk_bf16_f32 v79, v190, v191
    v_mfma_f32_32x32x16_bf16 v[176:191], a[0:3], v[64:67], v[128:143]
    ds_read_b128 a[8:11], v6 offset:6144
    v_exp_f32 v240, v240
    v_exp_f32 v241, v241
    v_exp_f32 v242, v242
    v_mfma_f32_32x32x16_bf16 v[176:191], a[4:7], v[68:71], v[176:191]
    ds_read_b128 a[12:15], v6 offset:7168
    v_exp_f32 v243, v243
    v_cvt_pk_bf16_f32 v88, v240, v241
    v_cvt_pk_bf16_f32 v89, v242, v243
    v_exp_f32 v244, v244
    v_mfma_f32_32x32x16_bf16 a[32:47], a[16:19], v[72:75], a[32:47]
    s_add_u32 m0, s27, 135168
    v_exp_f32 v245, v245
    v_exp_f32 v246, v246
    v_exp_f32 v247, v247
    v_mfma_f32_32x32x16_bf16 a[32:47], a[20:23], v[76:79], a[32:47]
    global_load_lds_dwordx4 v5, s[98:99] offset:0 sc1
    global_load_lds_dwordx4 v5, s[98:99] offset:1024 sc1
    v_cvt_pk_bf16_f32 v90, v244, v245
    v_cvt_pk_bf16_f32 v91, v246, v247
    v_exp_f32 v248, v248
    v_exp_f32 v249, v249
    v_exp_f32 v250, v250
    v_exp_f32 v251, v251
    v_cvt_pk_bf16_f32 v92, v248, v249
    v_cvt_pk_bf16_f32 v93, v250, v251
    v_smfmac_f32_16x16x64_bf16 a[64:67], a[72:75], v[72:79], v9
    global_load_lds_dwordx4 v5, s[98:99] offset:2048 sc1
    global_load_lds_dwordx4 v5, s[98:99] offset:3072 sc1
    v_exp_f32 v252, v252
    v_exp_f32 v253, v253
    v_exp_f32 v254, v254
    v_exp_f32 v255, v255
    v_cvt_pk_bf16_f32 v94, v252, v253
    v_cvt_pk_bf16_f32 v95, v254, v255
    v_mfma_f32_32x32x16_bf16 v[240:255], a[0:3], v[80:83], v[144:159]
    v_exp_f32 v176, v176
    v_exp_f32 v177, v177
    v_exp_f32 v178, v178
    v_mfma_f32_32x32x16_bf16 v[240:255], a[4:7], v[84:87], v[240:255]
    ds_read_b128 a[0:3], v6 offset:12288
    v_exp_f32 v179, v179
    v_cvt_pk_bf16_f32 v72, v176, v177
    v_cvt_pk_bf16_f32 v73, v178, v179
    v_exp_f32 v180, v180
    v_mfma_f32_32x32x16_bf16 a[48:63], a[16:19], v[88:91], a[48:63]
    ds_read_b128 a[4:7], v6 offset:13312
    v_exp_f32 v181, v181
    v_exp_f32 v182, v182
    v_exp_f32 v183, v183
    v_mfma_f32_32x32x16_bf16 a[48:63], a[20:23], v[92:95], a[48:63]
    v_cvt_pk_bf16_f32 v74, v180, v181
    v_cvt_pk_bf16_f32 v75, v182, v183
    v_exp_f32 v184, v184
    v_exp_f32 v185, v185
    v_exp_f32 v186, v186
    v_exp_f32 v187, v187
    v_cvt_pk_bf16_f32 v76, v184, v185
    v_cvt_pk_bf16_f32 v77, v186, v187
    v_smfmac_f32_16x16x64_bf16 a[68:71], a[72:75], v[88:95], v9
    s_waitcnt lgkmcnt(0)
    v_exp_f32 v188, v188
    v_exp_f32 v189, v189
    v_exp_f32 v190, v190
    v_exp_f32 v191, v191
    v_cvt_pk_bf16_f32 v78, v188, v189
    v_cvt_pk_bf16_f32 v79, v190, v191
    v_mfma_f32_32x32x16_bf16 v[176:191], a[0:3], v[64:67], v[128:143]
    ds_read_b128 a[16:19], v6 offset:14336
    v_exp_f32 v240, v240
    v_exp_f32 v241, v241
    v_exp_f32 v242, v242
    v_mfma_f32_32x32x16_bf16 v[176:191], a[4:7], v[68:71], v[176:191]
    ds_read_b128 a[20:23], v6 offset:15360
    v_exp_f32 v243, v243
    v_cvt_pk_bf16_f32 v88, v240, v241
    v_cvt_pk_bf16_f32 v89, v242, v243
    v_exp_f32 v244, v244
    v_mfma_f32_32x32x16_bf16 a[32:47], a[8:11], v[72:75], a[32:47]
    s_waitcnt vmcnt(12)
    v_mov_b32 v20, s60
    buffer_store_dword v20, v31, s[16:19], s30 offen sc1
    v_exp_f32 v245, v245
    v_exp_f32 v246, v246
    v_exp_f32 v247, v247
    v_mfma_f32_32x32x16_bf16 a[32:47], a[12:15], v[76:79], a[32:47]
    v_cvt_pk_bf16_f32 v90, v244, v245
    v_cvt_pk_bf16_f32 v91, v246, v247
    v_exp_f32 v248, v248
    v_exp_f32 v249, v249
    v_exp_f32 v250, v250
    v_exp_f32 v251, v251
    v_cvt_pk_bf16_f32 v92, v248, v249
    v_cvt_pk_bf16_f32 v93, v250, v251
    v_smfmac_f32_16x16x64_bf16 a[64:67], a[72:75], v[72:79], v9
    v_exp_f32 v252, v252
    v_exp_f32 v253, v253
    v_exp_f32 v254, v254
    v_exp_f32 v255, v255
    v_cvt_pk_bf16_f32 v94, v252, v253
    v_cvt_pk_bf16_f32 v95, v254, v255
    s_cmp_le_u32 s82, 1
    s_addc_u32 s36, s3, 1
    s_lshl_b32 s36, s36, 15
    s_add_u32 s98, s84, s36
    s_addc_u32 s99, s85, 0
    s_cmp_lg_u32 s83, 0
    s_cbranch_scc1 L_A4
    s_branch L_A5
L_A4:
    s_waitcnt vmcnt(0)
L_A5:
    s_waitcnt vmcnt(6) lgkmcnt(0)
    s_barrier
    s_waitcnt vmcnt(5)
    v_cmp_ne_u32 vcc, s60, v21
    s_and_b32 s87, vcc_lo, 2
    s_cbranch_scc1 L_PKV2_S
L_PKV2_R:
    v_mfma_f32_32x32x16_bf16 v[240:255], a[0:3], v[80:83], v[144:159]
    s_add_u32 m0, s27, 98304
    v_exp_f32 v176, v176
    v_exp_f32 v177, v177
    v_exp_f32 v178, v178
    v_mfma_f32_32x32x16_bf16 v[240:255], a[4:7], v[84:87], v[240:255]
    ds_read_b128 a[0:3], v7 offset:0
    v_exp_f32 v179, v179
    v_cvt_pk_bf16_f32 v72, v176, v177
    v_cvt_pk_bf16_f32 v73, v178, v179
    v_exp_f32 v180, v180
    v_mfma_f32_32x32x16_bf16 a[48:63], a[8:11], v[88:91], a[48:63]
    ds_read_b128 a[4:7], v7 offset:1024
    v_exp_f32 v181, v181
    v_exp_f32 v182, v182
    v_exp_f32 v183, v183
    v_mfma_f32_32x32x16_bf16 a[48:63], a[12:15], v[92:95], a[48:63]
    global_load_lds_dwordx4 v29, s[98:99] offset:0 sc1
    v_cvt_pk_bf16_f32 v74, v180, v181
    v_cvt_pk_bf16_f32 v75, v182, v183
    v_exp_f32 v184, v184
    v_exp_f32 v185, v185
    v_exp_f32 v186, v186
    v_exp_f32 v187, v187
    v_cvt_pk_bf16_f32 v76, v184, v185
    v_cvt_pk_bf16_f32 v77, v186, v187
    v_smfmac_f32_16x16x64_bf16 a[68:71], a[72:75], v[88:95], v9
    global_load_lds_dwordx4 v29, s[98:99] offset:1024 sc1
    s_waitcnt lgkmcnt(0)
    v_exp_f32 v188, v188
    v_exp_f32 v189, v189
    v_exp_f32 v190, v190
    v_exp_f32 v191, v191
    v_cvt_pk_bf16_f32 v78, v188, v189
    v_cvt_pk_bf16_f32 v79, v190, v191
    v_mfma_f32_32x32x16_bf16 v[176:191], a[0:3], v[64:67], v[128:143]
    ds_read_b128 a[8:11], v7 offset:2048
    v_exp_f32 v240, v240
    v_exp_f32 v241, v241
    v_exp_f32 v242, v242
    v_mfma_f32_32x32x16_bf16 v[176:191], a[4:7], v[68:71], v[176:191]
    ds_read_b128 a[12:15], v7 offset:3072
    v_exp_f32 v243, v243
    v_cvt_pk_bf16_f32 v88, v240, v241
    v_cvt_pk_bf16_f32 v89, v242, v243
    v_exp_f32 v244, v244
    v_mfma_f32_32x32x16_bf16 a[32:47], a[16:19], v[72:75], a[32:47]
    global_load_lds_dwordx4 v29, s[98:99] offset:2048 sc1
    v_exp_f32 v245, v245
    v_exp_f32 v246, v246
    v_exp_f32 v247, v247
    v_mfma_f32_32x32x16_bf16 a[32:47], a[20:23], v[76:79], a[32:47]
    global_load_lds_dwordx4 v29, s[98:99] offset:3072 sc1
    v_cvt_pk_bf16_f32 v90, v244, v245
    v_cvt_pk_bf16_f32 v91, v246, v247
    v_exp_f32 v248, v248
    v_exp_f32 v249, v249
    v_exp_f32 v250, v250
    v_exp_f32 v251, v251
    v_cvt_pk_bf16_f32 v92, v248, v249
    v_cvt_pk_bf16_f32 v93, v250, v251
    v_smfmac_f32_16x16x64_bf16 a[64:67], a[72:75], v[72:79], v9
    s_add_u32 m0, s27, 102400
    s_nop 0
    global_load_lds_dwordx4 v5, s[98:99] offset:0 sc1
    v_exp_f32 v252, v252
    v_exp_f32 v253, v253
    v_exp_f32 v254, v254
    v_exp_f32 v255, v255
    v_cvt_pk_bf16_f32 v94, v252, v253
    v_cvt_pk_bf16_f32 v95, v254, v255
    v_mfma_f32_32x32x16_bf16 v[240:255], a[0:3], v[80:83], v[144:159]
    global_load_lds_dwordx4 v5, s[98:99] offset:1024 sc1
    v_exp_f32 v176, v176
    v_exp_f32 v177, v177
    v_exp_f32 v178, v178
    v_mfma_f32_32x32x16_bf16 v[240:255], a[4:7], v[84:87], v[240:255]
    ds_read_b128 a[0:3], v7 offset:8192
    v_exp_f32 v179, v179
    v_cvt_pk_bf16_f32 v72, v176, v177
    v_cvt_pk_bf16_f32 v73, v178, v179
    v_exp_f32 v180, v180
    v_mfma_f32_32x32x16_bf16 a[48:63], a[16:19], v[88:91], a[48:63]
    ds_read_b128 a[4:7], v7 offset:9216
    v_exp_f32 v181, v181
    v_exp_f32 v182, v182
    v_exp_f32 v183, v183
    v_mfma_f32_32x32x16_bf16 a[48:63], a[20:23], v[92:95], a[48:63]
    global_load_lds_dwordx4 v5, s[98:99] offset:2048 sc1
    v_cvt_pk_bf16_f32 v74, v180, v181
    v_cvt_pk_bf16_f32 v75, v182, v183
    v_exp_f32 v184, v184
    v_exp_f32 v185, v185
    v_exp_f32 v186, v186
    v_exp_f32 v187, v187
    v_cvt_pk_bf16_f32 v76, v184, v185
    v_cvt_pk_bf16_f32 v77, v186, v187
    v_smfmac_f32_16x16x64_bf16 a[68:71], a[72:75], v[88:95], v9
    global_load_lds_dwordx4 v5, s[98:99] offset:3072 sc1
    s_waitcnt lgkmcnt(0)
    v_exp_f32 v188, v188
    v_exp_f32 v189, v189
    v_exp_f32 v190, v190
    v_exp_f32 v191, v191
    v_cvt_pk_bf16_f32 v78, v188, v189
    v_cvt_pk_bf16_f32 v79, v190, v191
    v_mfma_f32_32x32x16_bf16 v[176:191], a[0:3], v[64:67], v[128:143]
    ds_read_b128 a[16:19], v7 offset:10240
    v_exp_f32 v240, v240
    v_exp_f32 v241, v241
    v_exp_f32 v242, v242
    v_mfma_f32_32x32x16_bf16 v[176:191], a[4:7], v[68:71], v[176:191]
    ds_read_b128 a[20:23], v7 offset:11264
    v_exp_f32 v243, v243
    v_cvt_pk_bf16_f32 v88, v240, v241
    v_cvt_pk_bf16_f32 v89, v242, v243
    v_exp_f32 v244, v244
    v_mfma_f32_32x32x16_bf16 a[32:47], a[8:11], v[72:75], a[32:47]
    s_cmp_le_u32 s82, 2
    v_exp_f32 v245, v245
    v_exp_f32 v246, v246
    v_exp_f32 v247, v247
    v_mfma_f32_32x32x16_bf16 a[32:47], a[12:15], v[76:79], a[32:47]
    s_addc_u32 s36, s3, 2
    v_cvt_pk_bf16_f32 v90, v244, v245
    v_cvt_pk_bf16_f32 v91, v246, v247
    v_exp_f32 v248, v248
    v_exp_f32 v249, v249
    v_exp_f32 v250, v250
    v_exp_f32 v251, v251
    v_cvt_pk_bf16_f32 v92, v248, v249
    v_cvt_pk_bf16_f32 v93, v250, v251
    v_smfmac_f32_16x16x64_bf16 a[64:67], a[72:75], v[72:79], v9
    s_lshl_b32 s36, s36, 15
    s_waitcnt vmcnt(9)
    s_barrier
    v_exp_f32 v252, v252
    v_exp_f32 v253, v253
    v_exp_f32 v254, v254
    v_exp_f32 v255, v255
    v_cvt_pk_bf16_f32 v94, v252, v253
    v_cvt_pk_bf16_f32 v95, v254, v255
    v_mfma_f32_32x32x16_bf16 v[240:255], a[0:3], v[80:83], v[144:159]
    s_add_u32 s98, s84, s36
    v_exp_f32 v176, v176
    v_exp_f32 v177, v177
    v_exp_f32 v178, v178
    v_mfma_f32_32x32x16_bf16 v[240:255], a[4:7], v[84:87], v[240:255]
    ds_read_b128 a[0:3], v7 offset:4096
    v_exp_f32 v179, v179
    v_cvt_pk_bf16_f32 v72, v176, v177
    v_cvt_pk_bf16_f32 v73, v178, v179
    v_exp_f32 v180, v180
    v_mfma_f32_32x32x16_bf16 a[48:63], a[8:11], v[88:91], a[48:63]
    ds_read_b128 a[4:7], v7 offset:5120
    v_exp_f32 v181, v181
    v_exp_f32 v182, v182
    v_exp_f32 v183, v183
    v_mfma_f32_32x32x16_bf16 a[48:63], a[12:15], v[92:95], a[48:63]
    s_addc_u32 s99, s85, 0
    v_cvt_pk_bf16_f32 v74, v180, v181
    v_cvt_pk_bf16_f32 v75, v182, v183
    v_exp_f32 v184, v184
    v_exp_f32 v185, v185
    v_exp_f32 v186, v186
    v_exp_f32 v187, v187
    v_cvt_pk_bf16_f32 v76, v184, v185
    v_cvt_pk_bf16_f32 v77, v186, v187
    v_smfmac_f32_16x16x64_bf16 a[68:71], a[72:75], v[88:95], v9
    buffer_load_dword v21, v17, s[16:19], s31 offen sc1
    s_waitcnt lgkmcnt(0)
    v_exp_f32 v188, v188
    v_exp_f32 v189, v189
    v_exp_f32 v190, v190
    v_exp_f32 v191, v191
    v_cvt_pk_bf16_f32 v78, v188, v189
    v_cvt_pk_bf16_f32 v79, v190, v191
    v_mfma_f32_32x32x16_bf16 v[176:191], a[0:3], v[64:67], v[128:143]
    ds_read_b128 a[8:11], v7 offset:6144
    v_exp_f32 v240, v240
    v_exp_f32 v241, v241
    v_exp_f32 v242, v242
    v_mfma_f32_32x32x16_bf16 v[176:191], a[4:7], v[68:71], v[176:191]
    ds_read_b128 a[12:15], v7 offset:7168
    v_exp_f32 v243, v243
    v_cvt_pk_bf16_f32 v88, v240, v241
    v_cvt_pk_bf16_f32 v89, v242, v243
    v_exp_f32 v244, v244
    v_mfma_f32_32x32x16_bf16 a[32:47], a[16:19], v[72:75], a[32:47]
    v_exp_f32 v245, v245
    v_exp_f32 v246, v246
    v_exp_f32 v247, v247
    v_mfma_f32_32x32x16_bf16 a[32:47], a[20:23], v[76:79], a[32:47]
    v_cvt_pk_bf16_f32 v90, v244, v245
    v_cvt_pk_bf16_f32 v91, v246, v247
    v_exp_f32 v248, v248
    v_exp_f32 v249, v249
    v_exp_f32 v250, v250
    v_exp_f32 v251, v251
    v_cvt_pk_bf16_f32 v92, v248, v249
    v_cvt_pk_bf16_f32 v93, v250, v251
    v_smfmac_f32_16x16x64_bf16 a[64:67], a[72:75], v[72:79], v9
    buffer_load_dword v22, v18, s[16:19], s33 offen sc1
    s_mov_b32 s39, 0
    v_exp_f32 v252, v252
    v_exp_f32 v253, v253
    v_exp_f32 v254, v254
    v_exp_f32 v255, v255
    v_cvt_pk_bf16_f32 v94, v252, v253
    v_cvt_pk_bf16_f32 v95, v254, v255
    v_mfma_f32_32x32x16_bf16 v[240:255], a[0:3], v[80:83], v[144:159]
    s_add_u32 m0, s34, 0
    v_exp_f32 v176, v176
    v_exp_f32 v177, v177
    v_exp_f32 v178, v178
    v_mfma_f32_32x32x16_bf16 v[240:255], a[4:7], v[84:87], v[240:255]
    ds_read_b128 a[0:3], v7 offset:12288
    v_exp_f32 v179, v179
    v_cvt_pk_bf16_f32 v72, v176, v177
    v_cvt_pk_bf16_f32 v73, v178, v179
    v_exp_f32 v180, v180
    v_mfma_f32_32x32x16_bf16 a[48:63], a[16:19], v[88:91], a[48:63]
    ds_read_b128 a[4:7], v7 offset:13312
    v_exp_f32 v181, v181
    v_exp_f32 v182, v182
    v_exp_f32 v183, v183
    v_mfma_f32_32x32x16_bf16 a[48:63], a[20:23], v[92:95], a[48:63]
    buffer_load_dwordx4 v2, s[8:11], s39 offen lds
    v_cvt_pk_bf16_f32 v74, v180, v181
    v_cvt_pk_bf16_f32 v75, v182, v183
    v_exp_f32 v184, v184
    v_exp_f32 v185, v185
    v_exp_f32 v186, v186
    v_exp_f32 v187, v187
    v_cvt_pk_bf16_f32 v76, v184, v185
    v_cvt_pk_bf16_f32 v77, v186, v187
    v_smfmac_f32_16x16x64_bf16 a[68:71], a[72:75], v[88:95], v9
    s_mov_b32 s39, 65536
    s_waitcnt lgkmcnt(0)
    v_exp_f32 v188, v188
    v_exp_f32 v189, v189
    v_exp_f32 v190, v190
    v_exp_f32 v191, v191
    v_cvt_pk_bf16_f32 v78, v188, v189
    v_cvt_pk_bf16_f32 v79, v190, v191
    v_mfma_f32_32x32x16_bf16 v[176:191], a[0:3], v[64:67], v[128:143]
    ds_read_b128 a[16:19], v7 offset:14336
    v_exp_f32 v240, v240
    v_exp_f32 v241, v241
    v_exp_f32 v242, v242
    v_mfma_f32_32x32x16_bf16 v[176:191], a[4:7], v[68:71], v[176:191]
    ds_read_b128 a[20:23], v7 offset:15360
    v_exp_f32 v243, v243
    v_cvt_pk_bf16_f32 v88, v240, v241
    v_cvt_pk_bf16_f32 v89, v242, v243
    v_exp_f32 v244, v244
    v_mfma_f32_32x32x16_bf16 a[32:47], a[8:11], v[72:75], a[32:47]
    s_add_u32 m0, s34, 4096
    v_exp_f32 v245, v245
    v_exp_f32 v246, v246
    v_exp_f32 v247, v247
    v_mfma_f32_32x32x16_bf16 a[32:47], a[12:15], v[76:79], a[32:47]
    buffer_load_dwordx4 v2, s[8:11], s39 offen lds
    v_cvt_pk_bf16_f32 v90, v244, v245
    v_cvt_pk_bf16_f32 v91, v246, v247
    v_exp_f32 v248, v248
    v_exp_f32 v249, v249
    v_exp_f32 v250, v250
    v_exp_f32 v251, v251
    v_cvt_pk_bf16_f32 v92, v248, v249
    v_cvt_pk_bf16_f32 v93, v250, v251
    v_smfmac_f32_16x16x64_bf16 a[64:67], a[72:75], v[72:79], v9
    s_waitcnt vmcnt(4) lgkmcnt(0)
    s_barrier
    v_exp_f32 v252, v252
    v_exp_f32 v253, v253
    v_exp_f32 v254, v254
    v_exp_f32 v255, v255
    v_cvt_pk_bf16_f32 v94, v252, v253
    v_cvt_pk_bf16_f32 v95, v254, v255
    s_waitcnt vmcnt(3)
    v_cmp_ne_u32 vcc, s60, v21
    s_and_b32 s87, vcc_lo, 65535
    s_cbranch_scc1 L_PKV3_S
L_PKV3_R:
    s_waitcnt vmcnt(2)
    v_cmp_ne_u32 vcc, s60, v22
    s_and_b32 s87, vcc_lo, -1
    s_cbranch_scc1 L_PH_S
L_PH_R:
    s_sub_u32 s38, s93, 4096
    s_cmp_eq_u32 s94, 0
    s_cselect_b32 s38, 2147483648, s38
    buffer_load_dwordx4 v[208:211], v29, s[16:19], s38 offen sc1
    buffer_load_dwordx2 v[212:213], v29, s[16:19], s38 offen offset:1024 sc1
    buffer_load_dwordx2 v[224:225], v29, s[16:19], s38 offen offset:1032 sc1
    v_mfma_f32_32x32x16_bf16 v[240:255], a[0:3], v[80:83], v[144:159]
    s_add_u32 m0, s27, 131072
    v_exp_f32 v176, v176
    v_exp_f32 v177, v177
    v_exp_f32 v178, v178
    v_mfma_f32_32x32x16_bf16 v[240:255], a[4:7], v[84:87], v[240:255]
    ds_read_b128 a[0:3], v6 offset:0
    v_exp_f32 v179, v179
    v_cvt_pk_bf16_f32 v72, v176, v177
    v_cvt_pk_bf16_f32 v73, v178, v179
    v_exp_f32 v180, v180
    v_mfma_f32_32x32x16_bf16 a[48:63], a[8:11], v[88:91], a[48:63]
    ds_read_b128 a[4:7], v6 offset:1024
    v_exp_f32 v181, v181
    v_exp_f32 v182, v182
    v_exp_f32 v183, v183
    v_mfma_f32_32x32x16_bf16 a[48:63], a[12:15], v[92:95], a[48:63]
    global_load_lds_dwordx4 v29, s[98:99] offset:0 sc1
    v_cvt_pk_bf16_f32 v74, v180, v181
    v_cvt_pk_bf16_f32 v75, v182, v183
    v_exp_f32 v184, v184
    v_exp_f32 v185, v185
    v_exp_f32 v186, v186
    v_exp_f32 v187, v187
    v_cvt_pk_bf16_f32 v76, v184, v185
    v_cvt_pk_bf16_f32 v77, v186, v187
    v_smfmac_f32_16x16x64_bf16 a[68:71], a[72:75], v[88:95], v9
    global_load_lds_dwordx4 v29, s[98:99] offset:1024 sc1
    s_waitcnt lgkmcnt(0)
    v_exp_f32 v188, v188
    v_exp_f32 v189, v189
    v_exp_f32 v190, v190
    v_exp_f32 v191, v191
    v_cvt_pk_bf16_f32 v78, v188, v189
    v_cvt_pk_bf16_f32 v79, v190, v191
    v_mfma_f32_32x32x16_bf16 v[176:191], a[0:3], v[64:67], v[128:143]
    ds_read_b128 a[8:11], v6 offset:2048
    v_exp_f32 v240, v240
    v_exp_f32 v241, v241
    v_exp_f32 v242, v242
    v_mfma_f32_32x32x16_bf16 v[176:191], a[4:7], v[68:71], v[176:191]
    ds_read_b128 a[12:15], v6 offset:3072
    v_exp_f32 v243, v243
    v_cvt_pk_bf16_f32 v88, v240, v241
    v_cvt_pk_bf16_f32 v89, v242, v243
    v_exp_f32 v244, v244
    v_mfma_f32_32x32x16_bf16 a[32:47], a[16:19], v[72:75], a[32:47]
    global_load_lds_dwordx4 v29, s[98:99] offset:2048 sc1
    v_exp_f32 v245, v245
    v_exp_f32 v246, v246
    v_exp_f32 v247, v247
    v_mfma_f32_32x32x16_bf16 a[32:47], a[20:23], v[76:79], a[32:47]
    global_load_lds_dwordx4 v29, s[98:99] offset:3072 sc1
    v_cvt_pk_bf16_f32 v90, v244, v245
    v_cvt_pk_bf16_f32 v91, v246, v247
    v_exp_f32 v248, v248
    v_exp_f32 v249, v249
    v_exp_f32 v250, v250
    v_exp_f32 v251, v251
    v_cvt_pk_bf16_f32 v92, v248, v249
    v_cvt_pk_bf16_f32 v93, v250, v251
    v_smfmac_f32_16x16x64_bf16 a[64:67], a[72:75], v[72:79], v9
    s_add_u32 m0, s27, 135168
    s_nop 0
    global_load_lds_dwordx4 v5, s[98:99] offset:0 sc1
    v_exp_f32 v252, v252
    v_exp_f32 v253, v253
    v_exp_f32 v254, v254
    v_exp_f32 v255, v255
    v_cvt_pk_bf16_f32 v94, v252, v253
    v_cvt_pk_bf16_f32 v95, v254, v255
    v_mfma_f32_32x32x16_bf16 v[240:255], a[0:3], v[80:83], v[144:159]
    global_load_lds_dwordx4 v5, s[98:99] offset:1024 sc1
    v_exp_f32 v176, v176
    v_exp_f32 v177, v177
    v_exp_f32 v178, v178
    v_mfma_f32_32x32x16_bf16 v[240:255], a[4:7], v[84:87], v[240:255]
    ds_read_b128 a[0:3], v6 offset:8192
    v_exp_f32 v179, v179
    v_cvt_pk_bf16_f32 v72, v176, v177
    v_cvt_pk_bf16_f32 v73, v178, v179
    v_exp_f32 v180, v180
    v_mfma_f32_32x32x16_bf16 a[48:63], a[16:19], v[88:91], a[48:63]
    ds_read_b128 a[4:7], v6 offset:9216
    v_exp_f32 v181, v181
    v_exp_f32 v182, v182
    v_exp_f32 v183, v183
    v_mfma_f32_32x32x16_bf16 a[48:63], a[20:23], v[92:95], a[48:63]
    global_load_lds_dwordx4 v5, s[98:99] offset:2048 sc1
    v_cvt_pk_bf16_f32 v74, v180, v181
    v_cvt_pk_bf16_f32 v75, v182, v183
    v_exp_f32 v184, v184
    v_exp_f32 v185, v185
    v_exp_f32 v186, v186
    v_exp_f32 v187, v187
    v_cvt_pk_bf16_f32 v76, v184, v185
    v_cvt_pk_bf16_f32 v77, v186, v187
    v_smfmac_f32_16x16x64_bf16 a[68:71], a[72:75], v[88:95], v9
    global_load_lds_dwordx4 v5, s[98:99] offset:3072 sc1
    s_waitcnt lgkmcnt(0)
    v_exp_f32 v188, v188
    v_exp_f32 v189, v189
    v_exp_f32 v190, v190
    v_exp_f32 v191, v191
    v_cvt_pk_bf16_f32 v78, v188, v189
    v_cvt_pk_bf16_f32 v79, v190, v191
    v_mfma_f32_32x32x16_bf16 v[176:191], a[0:3], v[64:67], v[128:143]
    ds_read_b128 a[16:19], v6 offset:10240
    v_exp_f32 v240, v240
    v_exp_f32 v241, v241
    v_exp_f32 v242, v242
    v_mfma_f32_32x32x16_bf16 v[176:191], a[4:7], v[68:71], v[176:191]
    ds_read_b128 a[20:23], v6 offset:11264
    v_exp_f32 v243, v243
    v_cvt_pk_bf16_f32 v88, v240, v241
    v_cvt_pk_bf16_f32 v89, v242, v243
    v_exp_f32 v244, v244
    v_mfma_f32_32x32x16_bf16 a[32:47], a[8:11], v[72:75], a[32:47]
    s_cmp_le_u32 s82, 3
    v_exp_f32 v245, v245
    v_exp_f32 v246, v246
    v_exp_f32 v247, v247
    v_mfma_f32_32x32x16_bf16 a[32:47], a[12:15], v[76:79], a[32:47]
    s_addc_u32 s36, s3, 3
    v_cvt_pk_bf16_f32 v90, v244, v245
    v_cvt_pk_bf16_f32 v91, v246, v247
    v_exp_f32 v248, v248
    v_exp_f32 v249, v249
    v_exp_f32 v250, v250
    v_exp_f32 v251, v251
    v_cvt_pk_bf16_f32 v92, v248, v249
    v_cvt_pk_bf16_f32 v93, v250, v251
    v_smfmac_f32_16x16x64_bf16 a[64:67], a[72:75], v[72:79], v9
    s_lshl_b32 s36, s36, 15
    v_exp_f32 v252, v252
    v_exp_f32 v253, v253
    v_exp_f32 v254, v254
    v_exp_f32 v255, v255
    v_cvt_pk_bf16_f32 v94, v252, v253
    v_cvt_pk_bf16_f32 v95, v254, v255
    v_mfma_f32_32x32x16_bf16 v[240:255], a[0:3], v[80:83], v[144:159]
    s_add_u32 s98, s84, s36
    v_exp_f32 v176, v176
    v_exp_f32 v177, v177
    v_exp_f32 v178, v178
    v_mfma_f32_32x32x16_bf16 v[240:255], a[4:7], v[84:87], v[240:255]
    ds_read_b128 a[0:3], v6 offset:4096
    v_exp_f32 v179, v179
    v_cvt_pk_bf16_f32 v72, v176, v177
    v_cvt_pk_bf16_f32 v73, v178, v179
    v_exp_f32 v180, v180
    v_mfma_f32_32x32x16_bf16 a[48:63], a[8:11], v[88:91], a[48:63]
    ds_read_b128 a[4:7], v6 offset:5120
    v_exp_f32 v181, v181
    v_exp_f32 v182, v182
    v_exp_f32 v183, v183
    v_mfma_f32_32x32x16_bf16 a[48:63], a[12:15], v[92:95], a[48:63]
    s_addc_u32 s99, s85, 0
    v_cvt_pk_bf16_f32 v74, v180, v181
    v_cvt_pk_bf16_f32 v75, v182, v183
    v_exp_f32 v184, v184
    v_exp_f32 v185, v185
    v_exp_f32 v186, v186
    v_exp_f32 v187, v187
    v_cvt_pk_bf16_f32 v76, v184, v185
    v_cvt_pk_bf16_f32 v77, v186, v187
    v_smfmac_f32_16x16x64_bf16 a[68:71], a[72:75], v[88:95], v9
    global_load_dword v28, v25, s[70:71] offset:0
    s_waitcnt lgkmcnt(0)
    v_exp_f32 v188, v188
    v_exp_f32 v189, v189
    v_exp_f32 v190, v190
    v_exp_f32 v191, v191
    v_cvt_pk_bf16_f32 v78, v188, v189
    v_cvt_pk_bf16_f32 v79, v190, v191
    v_mfma_f32_32x32x16_bf16 v[176:191], a[0:3], v[64:67], v[128:143]
    ds_read_b128 a[8:11], v6 offset:6144
    v_exp_f32 v240, v240
    v_exp_f32 v241, v241
    v_exp_f32 v242, v242
    v_mfma_f32_32x32x16_bf16 v[176:191], a[4:7], v[68:71], v[176:191]
    ds_read_b128 a[12:15], v6 offset:7168
    v_exp_f32 v243, v243
    v_cvt_pk_bf16_f32 v88, v240, v241
    v_cvt_pk_bf16_f32 v89, v242, v243
    v_exp_f32 v244, v244
    v_mfma_f32_32x32x16_bf16 a[32:47], a[16:19], v[72:75], a[32:47]
    s_mov_b32 s39, 131072
    v_exp_f32 v245, v245
    v_exp_f32 v246, v246
    v_exp_f32 v247, v247
    v_mfma_f32_32x32x16_bf16 a[32:47], a[20:23], v[76:79], a[32:47]
    s_add_u32 m0, s34, 8192
    v_cvt_pk_bf16_f32 v90, v244, v245
    v_cvt_pk_bf16_f32 v91, v246, v247
    v_exp_f32 v248, v248
    v_exp_f32 v249, v249
    v_exp_f32 v250, v250
    v_exp_f32 v251, v251
    v_cvt_pk_bf16_f32 v92, v248, v249
    v_cvt_pk_bf16_f32 v93, v250, v251
    v_smfmac_f32_16x16x64_bf16 a[64:67], a[72:75], v[72:79], v9
    buffer_load_dwordx4 v2, s[8:11], s39 offen lds
    s_mov_b32 s39, 196608
    v_exp_f32 v252, v252
    v_exp_f32 v253, v253
    v_exp_f32 v254, v254
    v_exp_f32 v255, v255
    v_cvt_pk_bf16_f32 v94, v252, v253
    v_cvt_pk_bf16_f32 v95, v254, v255
    v_mfma_f32_32x32x16_bf16 v[240:255], a[0:3], v[80:83], v[144:159]
    s_add_u32 m0, s34, 12288
    v_exp_f32 v176, v176
    v_exp_f32 v177, v177
    v_exp_f32 v178, v178
    v_mfma_f32_32x32x16_bf16 v[240:255], a[4:7], v[84:87], v[240:255]
    ds_read_b128 a[0:3], v6 offset:12288
    v_exp_f32 v179, v179
    v_cvt_pk_bf16_f32 v72, v176, v177
    v_cvt_pk_bf16_f32 v73, v178, v179
    v_exp_f32 v180, v180
    v_mfma_f32_32x32x16_bf16 a[48:63], a[16:19], v[88:91], a[48:63]
    ds_read_b128 a[4:7], v6 offset:13312
    v_exp_f32 v181, v181
    v_exp_f32 v182, v182
    v_exp_f32 v183, v183
    v_mfma_f32_32x32x16_bf16 a[48:63], a[20:23], v[92:95], a[48:63]
    buffer_load_dwordx4 v2, s[8:11], s39 offen lds
    v_cvt_pk_bf16_f32 v74, v180, v181
    v_cvt_pk_bf16_f32 v75, v182, v183
    v_exp_f32 v184, v184
    v_exp_f32 v185, v185
    v_exp_f32 v186, v186
    v_exp_f32 v187, v187
    v_cvt_pk_bf16_f32 v76, v184, v185
    v_cvt_pk_bf16_f32 v77, v186, v187
    v_smfmac_f32_16x16x64_bf16 a[68:71], a[72:75], v[88:95], v9
    s_mov_b32 s39, 262144
    s_waitcnt lgkmcnt(0)
    v_exp_f32 v188, v188
    v_exp_f32 v189, v189
    v_exp_f32 v190, v190
    v_exp_f32 v191, v191
    v_cvt_pk_bf16_f32 v78, v188, v189
    v_cvt_pk_bf16_f32 v79, v190, v191
    v_mfma_f32_32x32x16_bf16 v[176:191], a[0:3], v[64:67], v[128:143]
    ds_read_b128 a[16:19], v6 offset:14336
    v_exp_f32 v240, v240
    v_exp_f32 v241, v241
    v_exp_f32 v242, v242
    v_mfma_f32_32x32x16_bf16 v[176:191], a[4:7], v[68:71], v[176:191]
    ds_read_b128 a[20:23], v6 offset:15360
    v_exp_f32 v243, v243
    v_cvt_pk_bf16_f32 v88, v240, v241
    v_cvt_pk_bf16_f32 v89, v242, v243
    v_exp_f32 v244, v244
    v_mfma_f32_32x32x16_bf16 a[32:47], a[8:11], v[72:75], a[32:47]
    s_add_u32 m0, s34, 16384
    v_exp_f32 v245, v245
    v_exp_f32 v246, v246
    v_exp_f32 v247, v247
    v_mfma_f32_32x32x16_bf16 a[32:47], a[12:15], v[76:79], a[32:47]
    buffer_load_dwordx4 v2, s[8:11], s39 offen lds
    v_cvt_pk_bf16_f32 v90, v244, v245
    v_cvt_pk_bf16_f32 v91, v246, v247
    v_exp_f32 v248, v248
    v_exp_f32 v249, v249
    v_exp_f32 v250, v250
    v_exp_f32 v251, v251
    v_cvt_pk_bf16_f32 v92, v248, v249
    v_cvt_pk_bf16_f32 v93, v250, v251
    v_smfmac_f32_16x16x64_bf16 a[64:67], a[72:75], v[72:79], v9
    s_waitcnt vmcnt(4) lgkmcnt(0)
    s_barrier
    v_exp_f32 v252, v252
    v_exp_f32 v253, v253
    v_exp_f32 v254, v254
    v_exp_f32 v255, v255
    v_cvt_pk_bf16_f32 v94, v252, v253
    v_cvt_pk_bf16_f32 v95, v254, v255
    s_cmp_lg_u32 s83, 0
    s_cbranch_scc1 L_LOC0X
    s_cmp_eq_u32 s94, 0
    s_cbranch_scc0 L_MASKOK
    v_mov_b32 v32, 4048155338
    v_mov_b32 v33, 4048155338
    v_mov_b32 v34, 4048155338
    v_mov_b32 v35, 4048155338
L_MASKOK:
    s_add_u32 s35, s86, 12582912
    s_add_u32 s38, s86, 12648448
    v_mfma_f32_16x16x32_bf16 v[96:99], v[208:211], v[160:163], v[32:35]
    v_mfma_f32_16x16x32_bf16 v[100:103], v[192:195], v[160:163], v[36:39]
    buffer_store_dwordx4 v[40:43], v29, s[16:19], s35 offen offset:1024 sc1
    buffer_store_dwordx4 v[48:51], v29, s[16:19], s38 offen offset:0 sc1
    s_nop 5
    v_max3_f32 v23, v96, v97, v98
    v_max3_f32 v23, v23, v99, v100
    v_max3_f32 v23, v23, v101, v102
    v_max_f32 v23, v23, v103
    v_mov_b32 v24, v23
    s_nop 1
    v_permlane16_swap_b32 v23, v24
    v_max_f32 v23, v23, v24
    v_mov_b32 v24, v23
    s_nop 1
    v_permlane32_swap_b32 v23, v24
    v_max_f32 v23, v23, v24
    v_mul_f32 v23, s61, v23
    v_fma_f32 v96, v96, s61, -v23
    v_fma_f32 v97, v97, s61, -v23
    v_fma_f32 v98, v98, s61, -v23
    v_fma_f32 v99, v99, s61, -v23
    v_fma_f32 v100, v100, s61, -v23
    v_fma_f32 v101, v101, s61, -v23
    v_fma_f32 v102, v102, s61, -v23
    v_fma_f32 v103, v103, s61, -v23
    v_exp_f32 v96, v96
    v_exp_f32 v97, v97
    v_exp_f32 v98, v98
    v_exp_f32 v99, v99
    v_exp_f32 v100, v100
    v_exp_f32 v101, v101
    v_exp_f32 v102, v102
    v_exp_f32 v103, v103
    v_cvt_pk_bf16_f32 v96, v96, v97
    v_cvt_pk_bf16_f32 v97, v98, v99
    v_cvt_pk_bf16_f32 v98, v100, v101
    v_cvt_pk_bf16_f32 v99, v102, v103
    s_nop 1
    v_mfma_f32_16x16x32_bf16 v[104:107], a[112:115], v[96:99], 0
    v_mfma_f32_16x16x32_bf16 v[108:111], v[212:215], v[96:99], 0
    v_mfma_f32_16x16x32_bf16 v[112:115], v[224:227], v[96:99], 0
    buffer_store_dwordx4 v[56:59], v29, s[16:19], s38 offen offset:1024 sc1
    s_nop 6
    v_rcp_f32 v23, v104
    s_nop 1
    v_mul_f32 v108, v108, v23
    v_mul_f32 v109, v109, v23
    v_mul_f32 v110, v110, v23
    v_mul_f32 v111, v111, v23
    v_mul_f32 v112, v112, v23
    v_mul_f32 v113, v113, v23
    v_mul_f32 v114, v114, v23
    v_mul_f32 v115, v115, v23
    v_cvt_pk_bf16_f32 v108, v108, v109
    v_cvt_pk_bf16_f32 v109, v110, v111
    v_cvt_pk_bf16_f32 v110, v112, v113
    v_cvt_pk_bf16_f32 v111, v114, v115
    buffer_store_dwordx4 v[108:111], v29, s[16:19], s35 offen offset:0 sc1
L_LOC0X:
    v_mfma_f32_32x32x16_bf16 v[240:255], a[0:3], v[80:83], v[144:159]
    s_add_u32 m0, s27, 98304
    v_exp_f32 v176, v176
    v_exp_f32 v177, v177
    v_exp_f32 v178, v178
    v_mfma_f32_32x32x16_bf16 v[240:255], a[4:7], v[84:87], v[240:255]
    ds_read_b128 a[0:3], v7 offset:0
    v_exp_f32 v179, v179
    v_cvt_pk_bf16_f32 v72, v176, v177
    v_cvt_pk_bf16_f32 v73, v178, v179
    v_exp_f32 v180, v180
    v_mfma_f32_32x32x16_bf16 a[48:63], a[8:11], v[88:91], a[48:63]
    ds_read_b128 a[4:7], v7 offset:1024
    v_exp_f32 v181, v181
    v_exp_f32 v182, v182
    v_exp_f32 v183, v183
    v_mfma_f32_32x32x16_bf16 a[48:63], a[12:15], v[92:95], a[48:63]
    global_load_lds_dwordx4 v29, s[98:99] offset:0 sc1
    v_cvt_pk_bf16_f32 v74, v180, v181
    v_cvt_pk_bf16_f32 v75, v182, v183
    v_exp_f32 v184, v184
    v_exp_f32 v185, v185
    v_exp_f32 v186, v186
    v_exp_f32 v187, v187
    v_cvt_pk_bf16_f32 v76, v184, v185
    v_cvt_pk_bf16_f32 v77, v186, v187
    v_smfmac_f32_16x16x64_bf16 a[68:71], a[72:75], v[88:95], v9
    global_load_lds_dwordx4 v29, s[98:99] offset:1024 sc1
    s_waitcnt lgkmcnt(0)
    v_exp_f32 v188, v188
    v_exp_f32 v189, v189
    v_exp_f32 v190, v190
    v_exp_f32 v191, v191
    v_cvt_pk_bf16_f32 v78, v188, v189
    v_cvt_pk_bf16_f32 v79, v190, v191
    v_mfma_f32_32x32x16_bf16 v[176:191], a[0:3], v[64:67], v[128:143]
    ds_read_b128 a[8:11], v7 offset:2048
    v_exp_f32 v240, v240
    v_exp_f32 v241, v241
    v_exp_f32 v242, v242
    v_mfma_f32_32x32x16_bf16 v[176:191], a[4:7], v[68:71], v[176:191]
    ds_read_b128 a[12:15], v7 offset:3072
    v_exp_f32 v243, v243
    v_cvt_pk_bf16_f32 v88, v240, v241
    v_cvt_pk_bf16_f32 v89, v242, v243
    v_exp_f32 v244, v244
    v_mfma_f32_32x32x16_bf16 a[32:47], a[16:19], v[72:75], a[32:47]
    global_load_lds_dwordx4 v29, s[98:99] offset:2048 sc1
    v_exp_f32 v245, v245
    v_exp_f32 v246, v246
    v_exp_f32 v247, v247
    v_mfma_f32_32x32x16_bf16 a[32:47], a[20:23], v[76:79], a[32:47]
    global_load_lds_dwordx4 v29, s[98:99] offset:3072 sc1
    v_cvt_pk_bf16_f32 v90, v244, v245
    v_cvt_pk_bf16_f32 v91, v246, v247
    v_exp_f32 v248, v248
    v_exp_f32 v249, v249
    v_exp_f32 v250, v250
    v_exp_f32 v251, v251
    v_cvt_pk_bf16_f32 v92, v248, v249
    v_cvt_pk_bf16_f32 v93, v250, v251
    v_smfmac_f32_16x16x64_bf16 a[64:67], a[72:75], v[72:79], v9
    s_add_u32 m0, s27, 102400
    s_nop 0
    global_load_lds_dwordx4 v5, s[98:99] offset:0 sc1
    v_exp_f32 v252, v252
    v_exp_f32 v253, v253
    v_exp_f32 v254, v254
    v_exp_f32 v255, v255
    v_cvt_pk_bf16_f32 v94, v252, v253
    v_cvt_pk_bf16_f32 v95, v254, v255
    v_mfma_f32_32x32x16_bf16 v[240:255], a[0:3], v[80:83], v[144:159]
    global_load_lds_dwordx4 v5, s[98:99] offset:1024 sc1
    v_exp_f32 v176, v176
    v_exp_f32 v177, v177
    v_exp_f32 v178, v178
    v_mfma_f32_32x32x16_bf16 v[240:255], a[4:7], v[84:87], v[240:255]
    ds_read_b128 a[0:3], v7 offset:8192
    v_exp_f32 v179, v179
    v_cvt_pk_bf16_f32 v72, v176, v177
    v_cvt_pk_bf16_f32 v73, v178, v179
    v_exp_f32 v180, v180
    v_mfma_f32_32x32x16_bf16 a[48:63], a[16:19], v[88:91], a[48:63]
    ds_read_b128 a[4:7], v7 offset:9216
    v_exp_f32 v181, v181
    v_exp_f32 v182, v182
    v_exp_f32 v183, v183
    v_mfma_f32_32x32x16_bf16 a[48:63], a[20:23], v[92:95], a[48:63]
    global_load_lds_dwordx4 v5, s[98:99] offset:2048 sc1
    v_cvt_pk_bf16_f32 v74, v180, v181
    v_cvt_pk_bf16_f32 v75, v182, v183
    v_exp_f32 v184, v184
    v_exp_f32 v185, v185
    v_exp_f32 v186, v186
    v_exp_f32 v187, v187
    v_cvt_pk_bf16_f32 v76, v184, v185
    v_cvt_pk_bf16_f32 v77, v186, v187
    v_smfmac_f32_16x16x64_bf16 a[68:71], a[72:75], v[88:95], v9
    global_load_lds_dwordx4 v5, s[98:99] offset:3072 sc1
    s_waitcnt lgkmcnt(0)
    v_exp_f32 v188, v188
    v_exp_f32 v189, v189
    v_exp_f32 v190, v190
    v_exp_f32 v191, v191
    v_cvt_pk_bf16_f32 v78, v188, v189
    v_cvt_pk_bf16_f32 v79, v190, v191
    v_mfma_f32_32x32x16_bf16 v[176:191], a[0:3], v[64:67], v[128:143]
    ds_read_b128 a[16:19], v7 offset:10240
    v_exp_f32 v240, v240
    v_exp_f32 v241, v241
    v_exp_f32 v242, v242
    v_mfma_f32_32x32x16_bf16 v[176:191], a[4:7], v[68:71], v[176:191]
    ds_read_b128 a[20:23], v7 offset:11264
    v_exp_f32 v243, v243
    v_cvt_pk_bf16_f32 v88, v240, v241
    v_cvt_pk_bf16_f32 v89, v242, v243
    v_exp_f32 v244, v244
    v_mfma_f32_32x32x16_bf16 a[32:47], a[8:11], v[72:75], a[32:47]
    s_cmp_le_u32 s82, 4
    v_exp_f32 v245, v245
    v_exp_f32 v246, v246
    v_exp_f32 v247, v247
    v_mfma_f32_32x32x16_bf16 a[32:47], a[12:15], v[76:79], a[32:47]
    s_addc_u32 s36, s3, 4
    v_cvt_pk_bf16_f32 v90, v244, v245
    v_cvt_pk_bf16_f32 v91, v246, v247
    v_exp_f32 v248, v248
    v_exp_f32 v249, v249
    v_exp_f32 v250, v250
    v_exp_f32 v251, v251
    v_cvt_pk_bf16_f32 v92, v248, v249
    v_cvt_pk_bf16_f32 v93, v250, v251
    v_smfmac_f32_16x16x64_bf16 a[64:67], a[72:75], v[72:79], v9
    s_lshl_b32 s36, s36, 15
    s_add_u32 s98, s84, s36
    v_exp_f32 v252, v252
    v_exp_f32 v253, v253
    v_exp_f32 v254, v254
    v_exp_f32 v255, v255
    v_cvt_pk_bf16_f32 v94, v252, v253
    v_cvt_pk_bf16_f32 v95, v254, v255
    v_mfma_f32_32x32x16_bf16 v[240:255], a[0:3], v[80:83], v[144:159]
    s_addc_u32 s99, s85, 0
    v_exp_f32 v176, v176
    v_exp_f32 v177, v177
    v_exp_f32 v178, v178
    v_mfma_f32_32x32x16_bf16 v[240:255], a[4:7], v[84:87], v[240:255]
    ds_read_b128 a[0:3], v7 offset:4096
    v_exp_f32 v179, v179
    v_cvt_pk_bf16_f32 v72, v176, v177
    v_cvt_pk_bf16_f32 v73, v178, v179
    v_exp_f32 v180, v180
    v_mfma_f32_32x32x16_bf16 a[48:63], a[8:11], v[88:91], a[48:63]
    ds_read_b128 a[4:7], v7 offset:5120
    v_exp_f32 v181, v181
    v_exp_f32 v182, v182
    v_exp_f32 v183, v183
    v_mfma_f32_32x32x16_bf16 a[48:63], a[12:15], v[92:95], a[48:63]
    s_mov_b32 s39, 327680
    v_cvt_pk_bf16_f32 v74, v180, v181
    v_cvt_pk_bf16_f32 v75, v182, v183
    v_exp_f32 v184, v184
    v_exp_f32 v185, v185
    v_exp_f32 v186, v186
    v_exp_f32 v187, v187
    v_cvt_pk_bf16_f32 v76, v184, v185
    v_cvt_pk_bf16_f32 v77, v186, v187
    v_smfmac_f32_16x16x64_bf16 a[68:71], a[72:75], v[88:95], v9
    s_add_u32 m0, s34, 20480
    s_waitcnt lgkmcnt(0)
    v_exp_f32 v188, v188
    v_exp_f32 v189, v189
    v_exp_f32 v190, v190
    v_exp_f32 v191, v191
    v_cvt_pk_bf16_f32 v78, v188, v189
    v_cvt_pk_bf16_f32 v79, v190, v191
    v_mfma_f32_32x32x16_bf16 v[176:191], a[0:3], v[64:67], v[128:143]
    ds_read_b128 a[8:11], v7 offset:6144
    v_exp_f32 v240, v240
    v_exp_f32 v241, v241
    v_exp_f32 v242, v242
    v_mfma_f32_32x32x16_bf16 v[176:191], a[4:7], v[68:71], v[176:191]
    ds_read_b128 a[12:15], v7 offset:7168
    v_exp_f32 v243, v243
    v_cvt_pk_bf16_f32 v88, v240, v241
    v_cvt_pk_bf16_f32 v89, v242, v243
    v_exp_f32 v244, v244
    v_mfma_f32_32x32x16_bf16 a[32:47], a[16:19], v[72:75], a[32:47]
    buffer_load_dwordx4 v2, s[8:11], s39 offen lds
    v_exp_f32 v245, v245
    v_exp_f32 v246, v246
    v_exp_f32 v247, v247
    v_mfma_f32_32x32x16_bf16 a[32:47], a[20:23], v[76:79], a[32:47]
    s_add_u32 m0, s34, 24576
    v_cvt_pk_bf16_f32 v90, v244, v245
    v_cvt_pk_bf16_f32 v91, v246, v247
    v_exp_f32 v248, v248
    v_exp_f32 v249, v249
    v_exp_f32 v250, v250
    v_exp_f32 v251, v251
    v_cvt_pk_bf16_f32 v92, v248, v249
    v_cvt_pk_bf16_f32 v93, v250, v251
    v_smfmac_f32_16x16x64_bf16 a[64:67], a[72:75], v[72:79], v9
    s_mov_b32 s39, 393216
    buffer_load_dwordx4 v2, s[8:11], s39 offen lds
    v_exp_f32 v252, v252
    v_exp_f32 v253, v253
    v_exp_f32 v254, v254
    v_exp_f32 v255, v255
    v_cvt_pk_bf16_f32 v94, v252, v253
    v_cvt_pk_bf16_f32 v95, v254, v255
    v_mfma_f32_32x32x16_bf16 v[240:255], a[0:3], v[80:83], v[144:159]
    s_mov_b32 s39, 458752
    v_exp_f32 v176, v176
    v_exp_f32 v177, v177
    v_exp_f32 v178, v178
    v_mfma_f32_32x32x16_bf16 v[240:255], a[4:7], v[84:87], v[240:255]
    ds_read_b128 a[0:3], v7 offset:12288
    v_exp_f32 v179, v179
    v_cvt_pk_bf16_f32 v72, v176, v177
    v_cvt_pk_bf16_f32 v73, v178, v179
    v_exp_f32 v180, v180
    v_mfma_f32_32x32x16_bf16 a[48:63], a[16:19], v[88:91], a[48:63]
    ds_read_b128 a[4:7], v7 offset:13312
    v_exp_f32 v181, v181
    v_exp_f32 v182, v182
    v_exp_f32 v183, v183
    v_mfma_f32_32x32x16_bf16 a[48:63], a[20:23], v[92:95], a[48:63]
    s_add_u32 m0, s34, 28672
    v_cvt_pk_bf16_f32 v74, v180, v181
    v_cvt_pk_bf16_f32 v75, v182, v183
    v_exp_f32 v184, v184
    v_exp_f32 v185, v185
    v_exp_f32 v186, v186
    v_exp_f32 v187, v187
    v_cvt_pk_bf16_f32 v76, v184, v185
    v_cvt_pk_bf16_f32 v77, v186, v187
    v_smfmac_f32_16x16x64_bf16 a[68:71], a[72:75], v[88:95], v9
    buffer_load_dwordx4 v2, s[8:11], s39 offen lds
    s_waitcnt lgkmcnt(0)
    v_exp_f32 v188, v188
    v_exp_f32 v189, v189
    v_exp_f32 v190, v190
    v_exp_f32 v191, v191
    v_cvt_pk_bf16_f32 v78, v188, v189
    v_cvt_pk_bf16_f32 v79, v190, v191
    v_mfma_f32_32x32x16_bf16 v[176:191], a[0:3], v[64:67], v[128:143]
    ds_read_b128 a[16:19], v7 offset:14336
    v_exp_f32 v240, v240
    v_exp_f32 v241, v241
    v_exp_f32 v242, v242
    v_mfma_f32_32x32x16_bf16 v[176:191], a[4:7], v[68:71], v[176:191]
    ds_read_b128 a[20:23], v7 offset:15360
    v_exp_f32 v243, v243
    v_cvt_pk_bf16_f32 v88, v240, v241
    v_cvt_pk_bf16_f32 v89, v242, v243
    v_exp_f32 v244, v244
    v_mfma_f32_32x32x16_bf16 a[32:47], a[8:11], v[72:75], a[32:47]
    s_mov_b32 s39, 524288
    v_exp_f32 v245, v245
    v_exp_f32 v246, v246
    v_exp_f32 v247, v247
    v_mfma_f32_32x32x16_bf16 a[32:47], a[12:15], v[76:79], a[32:47]
    s_add_u32 m0, s34, 32768
    v_cvt_pk_bf16_f32 v90, v244, v245
    v_cvt_pk_bf16_f32 v91, v246, v247
    v_exp_f32 v248, v248
    v_exp_f32 v249, v249
    v_exp_f32 v250, v250
    v_exp_f32 v251, v251
    v_cvt_pk_bf16_f32 v92, v248, v249
    v_cvt_pk_bf16_f32 v93, v250, v251
    v_smfmac_f32_16x16x64_bf16 a[64:67], a[72:75], v[72:79], v9
    buffer_load_dwordx4 v2, s[8:11], s39 offen lds
    s_waitcnt vmcnt(4) lgkmcnt(0)
    s_barrier
    v_exp_f32 v252, v252
    v_exp_f32 v253, v253
    v_exp_f32 v254, v254
    v_exp_f32 v255, v255
    v_cvt_pk_bf16_f32 v94, v252, v253
    v_cvt_pk_bf16_f32 v95, v254, v255
    v_mfma_f32_32x32x16_bf16 v[240:255], a[0:3], v[80:83], v[144:159]
    s_add_u32 m0, s27, 131072
    v_exp_f32 v176, v176
    v_exp_f32 v177, v177
    v_exp_f32 v178, v178
    v_mfma_f32_32x32x16_bf16 v[240:255], a[4:7], v[84:87], v[240:255]
    ds_read_b128 a[0:3], v6 offset:0
    v_exp_f32 v179, v179
    v_cvt_pk_bf16_f32 v72, v176, v177
    v_cvt_pk_bf16_f32 v73, v178, v179
    v_exp_f32 v180, v180
    v_mfma_f32_32x32x16_bf16 a[48:63], a[8:11], v[88:91], a[48:63]
    ds_read_b128 a[4:7], v6 offset:1024
    v_exp_f32 v181, v181
    v_exp_f32 v182, v182
    v_exp_f32 v183, v183
    v_mfma_f32_32x32x16_bf16 a[48:63], a[12:15], v[92:95], a[48:63]
    global_load_lds_dwordx4 v29, s[98:99] offset:0 sc1
    v_cvt_pk_bf16_f32 v74, v180, v181
    v_cvt_pk_bf16_f32 v75, v182, v183
    v_exp_f32 v184, v184
    v_exp_f32 v185, v185
    v_exp_f32 v186, v186
    v_exp_f32 v187, v187
    v_cvt_pk_bf16_f32 v76, v184, v185
    v_cvt_pk_bf16_f32 v77, v186, v187
    v_smfmac_f32_16x16x64_bf16 a[68:71], a[72:75], v[88:95], v9
    global_load_lds_dwordx4 v29, s[98:99] offset:1024 sc1
    s_waitcnt lgkmcnt(0)
    v_exp_f32 v188, v188
    v_exp_f32 v189, v189
    v_exp_f32 v190, v190
    v_exp_f32 v191, v191
    v_cvt_pk_bf16_f32 v78, v188, v189
    v_cvt_pk_bf16_f32 v79, v190, v191
    v_mfma_f32_32x32x16_bf16 v[176:191], a[0:3], v[64:67], v[128:143]
    ds_read_b128 a[8:11], v6 offset:2048
    v_exp_f32 v240, v240
    v_exp_f32 v241, v241
    v_exp_f32 v242, v242
    v_mfma_f32_32x32x16_bf16 v[176:191], a[4:7], v[68:71], v[176:191]
    ds_read_b128 a[12:15], v6 offset:3072
    v_exp_f32 v243, v243
    v_cvt_pk_bf16_f32 v88, v240, v241
    v_cvt_pk_bf16_f32 v89, v242, v243
    v_exp_f32 v244, v244
    v_mfma_f32_32x32x16_bf16 a[32:47], a[16:19], v[72:75], a[32:47]
    global_load_lds_dwordx4 v29, s[98:99] offset:2048 sc1
    v_exp_f32 v245, v245
    v_exp_f32 v246, v246
    v_exp_f32 v247, v247
    v_mfma_f32_32x32x16_bf16 a[32:47], a[20:23], v[76:79], a[32:47]
    global_load_lds_dwordx4 v29, s[98:99] offset:3072 sc1
    v_cvt_pk_bf16_f32 v90, v244, v245
    v_cvt_pk_bf16_f32 v91, v246, v247
    v_exp_f32 v248, v248
    v_exp_f32 v249, v249
    v_exp_f32 v250, v250
    v_exp_f32 v251, v251
    v_cvt_pk_bf16_f32 v92, v248, v249
    v_cvt_pk_bf16_f32 v93, v250, v251
    v_smfmac_f32_16x16x64_bf16 a[64:67], a[72:75], v[72:79], v9
    s_add_u32 m0, s27, 135168
    s_nop 0
    global_load_lds_dwordx4 v5, s[98:99] offset:0 sc1
    v_exp_f32 v252, v252
    v_exp_f32 v253, v253
    v_exp_f32 v254, v254
    v_exp_f32 v255, v255
    v_cvt_pk_bf16_f32 v94, v252, v253
    v_cvt_pk_bf16_f32 v95, v254, v255
    v_mfma_f32_32x32x16_bf16 v[240:255], a[0:3], v[80:83], v[144:159]
    global_load_lds_dwordx4 v5, s[98:99] offset:1024 sc1
    v_exp_f32 v176, v176
    v_exp_f32 v177, v177
    v_exp_f32 v178, v178
    v_mfma_f32_32x32x16_bf16 v[240:255], a[4:7], v[84:87], v[240:255]
    ds_read_b128 a[0:3], v6 offset:8192
    v_exp_f32 v179, v179
    v_cvt_pk_bf16_f32 v72, v176, v177
    v_cvt_pk_bf16_f32 v73, v178, v179
    v_exp_f32 v180, v180
    v_mfma_f32_32x32x16_bf16 a[48:63], a[16:19], v[88:91], a[48:63]
    ds_read_b128 a[4:7], v6 offset:9216
    v_exp_f32 v181, v181
    v_exp_f32 v182, v182
    v_exp_f32 v183, v183
    v_mfma_f32_32x32x16_bf16 a[48:63], a[20:23], v[92:95], a[48:63]
    global_load_lds_dwordx4 v5, s[98:99] offset:2048 sc1
    v_cvt_pk_bf16_f32 v74, v180, v181
    v_cvt_pk_bf16_f32 v75, v182, v183
    v_exp_f32 v184, v184
    v_exp_f32 v185, v185
    v_exp_f32 v186, v186
    v_exp_f32 v187, v187
    v_cvt_pk_bf16_f32 v76, v184, v185
    v_cvt_pk_bf16_f32 v77, v186, v187
    v_smfmac_f32_16x16x64_bf16 a[68:71], a[72:75], v[88:95], v9
    global_load_lds_dwordx4 v5, s[98:99] offset:3072 sc1
    s_waitcnt lgkmcnt(0)
    v_exp_f32 v188, v188
    v_exp_f32 v189, v189
    v_exp_f32 v190, v190
    v_exp_f32 v191, v191
    v_cvt_pk_bf16_f32 v78, v188, v189
    v_cvt_pk_bf16_f32 v79, v190, v191
    v_mfma_f32_32x32x16_bf16 v[176:191], a[0:3], v[64:67], v[128:143]
    ds_read_b128 a[16:19], v6 offset:10240
    v_exp_f32 v240, v240
    v_exp_f32 v241, v241
    v_exp_f32 v242, v242
    v_mfma_f32_32x32x16_bf16 v[176:191], a[4:7], v[68:71], v[176:191]
    ds_read_b128 a[20:23], v6 offset:11264
    v_exp_f32 v243, v243
    v_cvt_pk_bf16_f32 v88, v240, v241
    v_cvt_pk_bf16_f32 v89, v242, v243
    v_exp_f32 v244, v244
    v_mfma_f32_32x32x16_bf16 a[32:47], a[8:11], v[72:75], a[32:47]
    s_cmp_le_u32 s82, 5
    v_exp_f32 v245, v245
    v_exp_f32 v246, v246
    v_exp_f32 v247, v247
    v_mfma_f32_32x32x16_bf16 a[32:47], a[12:15], v[76:79], a[32:47]
    s_addc_u32 s36, s3, 5
    v_cvt_pk_bf16_f32 v90, v244, v245
    v_cvt_pk_bf16_f32 v91, v246, v247
    v_exp_f32 v248, v248
    v_exp_f32 v249, v249
    v_exp_f32 v250, v250
    v_exp_f32 v251, v251
    v_cvt_pk_bf16_f32 v92, v248, v249
    v_cvt_pk_bf16_f32 v93, v250, v251
    v_smfmac_f32_16x16x64_bf16 a[64:67], a[72:75], v[72:79], v9
    s_lshl_b32 s36, s36, 15
    s_add_u32 s98, s84, s36
    v_exp_f32 v252, v252
    v_exp_f32 v253, v253
    v_exp_f32 v254, v254
    v_exp_f32 v255, v255
    v_cvt_pk_bf16_f32 v94, v252, v253
    v_cvt_pk_bf16_f32 v95, v254, v255
    v_mfma_f32_32x32x16_bf16 v[240:255], a[0:3], v[80:83], v[144:159]
    s_addc_u32 s99, s85, 0
    v_exp_f32 v176, v176
    v_exp_f32 v177, v177
    v_exp_f32 v178, v178
    v_mfma_f32_32x32x16_bf16 v[240:255], a[4:7], v[84:87], v[240:255]
    ds_read_b128 a[0:3], v6 offset:4096
    v_exp_f32 v179, v179
    v_cvt_pk_bf16_f32 v72, v176, v177
    v_cvt_pk_bf16_f32 v73, v178, v179
    v_exp_f32 v180, v180
    v_mfma_f32_32x32x16_bf16 a[48:63], a[8:11], v[88:91], a[48:63]
    ds_read_b128 a[4:7], v6 offset:5120
    v_exp_f32 v181, v181
    v_exp_f32 v182, v182
    v_exp_f32 v183, v183
    v_mfma_f32_32x32x16_bf16 a[48:63], a[12:15], v[92:95], a[48:63]
    global_load_dword v28, v25, s[70:71] offset:1024
    v_cvt_pk_bf16_f32 v74, v180, v181
    v_cvt_pk_bf16_f32 v75, v182, v183
    v_exp_f32 v184, v184
    v_exp_f32 v185, v185
    v_exp_f32 v186, v186
    v_exp_f32 v187, v187
    v_cvt_pk_bf16_f32 v76, v184, v185
    v_cvt_pk_bf16_f32 v77, v186, v187
    v_smfmac_f32_16x16x64_bf16 a[68:71], a[72:75], v[88:95], v9
    s_lshl_b32 s38, s94, 7
    s_waitcnt lgkmcnt(0)
    v_exp_f32 v188, v188
    v_exp_f32 v189, v189
    v_exp_f32 v190, v190
    v_exp_f32 v191, v191
    v_cvt_pk_bf16_f32 v78, v188, v189
    v_cvt_pk_bf16_f32 v79, v190, v191
    v_mfma_f32_32x32x16_bf16 v[176:191], a[0:3], v[64:67], v[128:143]
    ds_read_b128 a[8:11], v6 offset:6144
    v_exp_f32 v240, v240
    v_exp_f32 v241, v241
    v_exp_f32 v242, v242
    v_mfma_f32_32x32x16_bf16 v[176:191], a[4:7], v[68:71], v[176:191]
    ds_read_b128 a[12:15], v6 offset:7168
    v_exp_f32 v243, v243
    v_cvt_pk_bf16_f32 v88, v240, v241
    v_cvt_pk_bf16_f32 v89, v242, v243
    v_exp_f32 v244, v244
    v_mfma_f32_32x32x16_bf16 a[32:47], a[16:19], v[72:75], a[32:47]
    s_lshl_b32 s39, s97, 2
    v_exp_f32 v245, v245
    v_exp_f32 v246, v246
    v_exp_f32 v247, v247
    v_mfma_f32_32x32x16_bf16 a[32:47], a[20:23], v[76:79], a[32:47]
    s_add_u32 s38, s38, s39
    v_cvt_pk_bf16_f32 v90, v244, v245
    v_cvt_pk_bf16_f32 v91, v246, v247
    v_exp_f32 v248, v248
    v_exp_f32 v249, v249
    v_exp_f32 v250, v250
    v_exp_f32 v251, v251
    v_cvt_pk_bf16_f32 v92, v248, v249
    v_cvt_pk_bf16_f32 v93, v250, v251
    v_smfmac_f32_16x16x64_bf16 a[64:67], a[72:75], v[72:79], v9
    s_add_u32 s35, s38, 22028288
    v_mov_b32 v20, s60
    buffer_store_dword v20, v31, s[16:19], s35 offen sc1
    v_exp_f32 v252, v252
    v_exp_f32 v253, v253
    v_exp_f32 v254, v254
    v_exp_f32 v255, v255
    v_cvt_pk_bf16_f32 v94, v252, v253
    v_cvt_pk_bf16_f32 v95, v254, v255
    v_mfma_f32_32x32x16_bf16 v[240:255], a[0:3], v[80:83], v[144:159]
    s_mov_b32 s39, 589824
    v_exp_f32 v176, v176
    v_exp_f32 v177, v177
    v_exp_f32 v178, v178
    v_mfma_f32_32x32x16_bf16 v[240:255], a[4:7], v[84:87], v[240:255]
    ds_read_b128 a[0:3], v6 offset:12288
    v_exp_f32 v179, v179
    v_cvt_pk_bf16_f32 v72, v176, v177
    v_cvt_pk_bf16_f32 v73, v178, v179
    v_exp_f32 v180, v180
    v_mfma_f32_32x32x16_bf16 a[48:63], a[16:19], v[88:91], a[48:63]
    ds_read_b128 a[4:7], v6 offset:13312
    v_exp_f32 v181, v181
    v_exp_f32 v182, v182
    v_exp_f32 v183, v183
    v_mfma_f32_32x32x16_bf16 a[48:63], a[20:23], v[92:95], a[48:63]
    s_add_u32 m0, s34, 36864
    v_cvt_pk_bf16_f32 v74, v180, v181
    v_cvt_pk_bf16_f32 v75, v182, v183
    v_exp_f32 v184, v184
    v_exp_f32 v185, v185
    v_exp_f32 v186, v186
    v_exp_f32 v187, v187
    v_cvt_pk_bf16_f32 v76, v184, v185
    v_cvt_pk_bf16_f32 v77, v186, v187
    v_smfmac_f32_16x16x64_bf16 a[68:71], a[72:75], v[88:95], v9
    buffer_load_dwordx4 v2, s[8:11], s39 offen lds
    s_waitcnt lgkmcnt(0)
    v_exp_f32 v188, v188
    v_exp_f32 v189, v189
    v_exp_f32 v190, v190
    v_exp_f32 v191, v191
    v_cvt_pk_bf16_f32 v78, v188, v189
    v_cvt_pk_bf16_f32 v79, v190, v191
    v_mfma_f32_32x32x16_bf16 v[176:191], a[0:3], v[64:67], v[128:143]
    ds_read_b128 a[16:19], v6 offset:14336
    v_exp_f32 v240, v240
    v_exp_f32 v241, v241
    v_exp_f32 v242, v242
    v_mfma_f32_32x32x16_bf16 v[176:191], a[4:7], v[68:71], v[176:191]
    ds_read_b128 a[20:23], v6 offset:15360
    v_exp_f32 v243, v243
    v_cvt_pk_bf16_f32 v88, v240, v241
    v_cvt_pk_bf16_f32 v89, v242, v243
    v_exp_f32 v244, v244
    v_mfma_f32_32x32x16_bf16 a[32:47], a[8:11], v[72:75], a[32:47]
    s_mov_b32 s39, 655360
    v_exp_f32 v245, v245
    v_exp_f32 v246, v246
    v_exp_f32 v247, v247
    v_mfma_f32_32x32x16_bf16 a[32:47], a[12:15], v[76:79], a[32:47]
    s_add_u32 m0, s34, 40960
    v_cvt_pk_bf16_f32 v90, v244, v245
    v_cvt_pk_bf16_f32 v91, v246, v247
    v_exp_f32 v248, v248
    v_exp_f32 v249, v249
    v_exp_f32 v250, v250
    v_exp_f32 v251, v251
    v_cvt_pk_bf16_f32 v92, v248, v249
    v_cvt_pk_bf16_f32 v93, v250, v251
    v_smfmac_f32_16x16x64_bf16 a[64:67], a[72:75], v[72:79], v9
    buffer_load_dwordx4 v2, s[8:11], s39 offen lds
    s_waitcnt vmcnt(4) lgkmcnt(0)
    s_barrier
    v_exp_f32 v252, v252
    v_exp_f32 v253, v253
    v_exp_f32 v254, v254
    v_exp_f32 v255, v255
    v_cvt_pk_bf16_f32 v94, v252, v253
    v_cvt_pk_bf16_f32 v95, v254, v255
    v_mfma_f32_32x32x16_bf16 v[240:255], a[0:3], v[80:83], v[144:159]
    s_add_u32 m0, s27, 98304
    v_exp_f32 v176, v176
    v_exp_f32 v177, v177
    v_exp_f32 v178, v178
    v_mfma_f32_32x32x16_bf16 v[240:255], a[4:7], v[84:87], v[240:255]
    ds_read_b128 a[0:3], v7 offset:0
    v_exp_f32 v179, v179
    v_cvt_pk_bf16_f32 v72, v176, v177
    v_cvt_pk_bf16_f32 v73, v178, v179
    v_exp_f32 v180, v180
    v_mfma_f32_32x32x16_bf16 a[48:63], a[8:11], v[88:91], a[48:63]
    ds_read_b128 a[4:7], v7 offset:1024
    v_exp_f32 v181, v181
    v_exp_f32 v182, v182
    v_exp_f32 v183, v183
    v_mfma_f32_32x32x16_bf16 a[48:63], a[12:15], v[92:95], a[48:63]
    global_load_lds_dwordx4 v29, s[98:99] offset:0 sc1
    v_cvt_pk_bf16_f32 v74, v180, v181
    v_cvt_pk_bf16_f32 v75, v182, v183
    v_exp_f32 v184, v184
    v_exp_f32 v185, v185
    v_exp_f32 v186, v186
    v_exp_f32 v187, v187
    v_cvt_pk_bf16_f32 v76, v184, v185
    v_cvt_pk_bf16_f32 v77, v186, v187
    v_smfmac_f32_16x16x64_bf16 a[68:71], a[72:75], v[88:95], v9
    global_load_lds_dwordx4 v29, s[98:99] offset:1024 sc1
    s_waitcnt lgkmcnt(0)
    v_exp_f32 v188, v188
    v_exp_f32 v189, v189
    v_exp_f32 v190, v190
    v_exp_f32 v191, v191
    v_cvt_pk_bf16_f32 v78, v188, v189
    v_cvt_pk_bf16_f32 v79, v190, v191
    v_mfma_f32_32x32x16_bf16 v[176:191], a[0:3], v[64:67], v[128:143]
    ds_read_b128 a[8:11], v7 offset:2048
    v_exp_f32 v240, v240
    v_exp_f32 v241, v241
    v_exp_f32 v242, v242
    v_mfma_f32_32x32x16_bf16 v[176:191], a[4:7], v[68:71], v[176:191]
    ds_read_b128 a[12:15], v7 offset:3072
    v_exp_f32 v243, v243
    v_cvt_pk_bf16_f32 v88, v240, v241
    v_cvt_pk_bf16_f32 v89, v242, v243
    v_exp_f32 v244, v244
    v_mfma_f32_32x32x16_bf16 a[32:47], a[16:19], v[72:75], a[32:47]
    global_load_lds_dwordx4 v29, s[98:99] offset:2048 sc1
    v_exp_f32 v245, v245
    v_exp_f32 v246, v246
    v_exp_f32 v247, v247
    v_mfma_f32_32x32x16_bf16 a[32:47], a[20:23], v[76:79], a[32:47]
    global_load_lds_dwordx4 v29, s[98:99] offset:3072 sc1
    v_cvt_pk_bf16_f32 v90, v244, v245
    v_cvt_pk_bf16_f32 v91, v246, v247
    v_exp_f32 v248, v248
    v_exp_f32 v249, v249
    v_exp_f32 v250, v250
    v_exp_f32 v251, v251
    v_cvt_pk_bf16_f32 v92, v248, v249
    v_cvt_pk_bf16_f32 v93, v250, v251
    v_smfmac_f32_16x16x64_bf16 a[64:67], a[72:75], v[72:79], v9
    s_add_u32 m0, s27, 102400
    s_nop 0
    global_load_lds_dwordx4 v5, s[98:99] offset:0 sc1
    v_exp_f32 v252, v252
    v_exp_f32 v253, v253
    v_exp_f32 v254, v254
    v_exp_f32 v255, v255
    v_cvt_pk_bf16_f32 v94, v252, v253
    v_cvt_pk_bf16_f32 v95, v254, v255
    v_mfma_f32_32x32x16_bf16 v[240:255], a[0:3], v[80:83], v[144:159]
    global_load_lds_dwordx4 v5, s[98:99] offset:1024 sc1
    v_exp_f32 v176, v176
    v_exp_f32 v177, v177
    v_exp_f32 v178, v178
    v_mfma_f32_32x32x16_bf16 v[240:255], a[4:7], v[84:87], v[240:255]
    ds_read_b128 a[0:3], v7 offset:8192
    v_exp_f32 v179, v179
    v_cvt_pk_bf16_f32 v72, v176, v177
    v_cvt_pk_bf16_f32 v73, v178, v179
    v_exp_f32 v180, v180
    v_mfma_f32_32x32x16_bf16 a[48:63], a[16:19], v[88:91], a[48:63]
    ds_read_b128 a[4:7], v7 offset:9216
    v_exp_f32 v181, v181
    v_exp_f32 v182, v182
    v_exp_f32 v183, v183
    v_mfma_f32_32x32x16_bf16 a[48:63], a[20:23], v[92:95], a[48:63]
    global_load_lds_dwordx4 v5, s[98:99] offset:2048 sc1
    v_cvt_pk_bf16_f32 v74, v180, v181
    v_cvt_pk_bf16_f32 v75, v182, v183
    v_exp_f32 v184, v184
    v_exp_f32 v185, v185
    v_exp_f32 v186, v186
    v_exp_f32 v187, v187
    v_cvt_pk_bf16_f32 v76, v184, v185
    v_cvt_pk_bf16_f32 v77, v186, v187
    v_smfmac_f32_16x16x64_bf16 a[68:71], a[72:75], v[88:95], v9
    global_load_lds_dwordx4 v5, s[98:99] offset:3072 sc1
    s_waitcnt lgkmcnt(0)
    v_exp_f32 v188, v188
    v_exp_f32 v189, v189
    v_exp_f32 v190, v190
    v_exp_f32 v191, v191
    v_cvt_pk_bf16_f32 v78, v188, v189
    v_cvt_pk_bf16_f32 v79, v190, v191
    v_mfma_f32_32x32x16_bf16 v[176:191], a[0:3], v[64:67], v[128:143]
    ds_read_b128 a[16:19], v7 offset:10240
    v_exp_f32 v240, v240
    v_exp_f32 v241, v241
    v_exp_f32 v242, v242
    v_mfma_f32_32x32x16_bf16 v[176:191], a[4:7], v[68:71], v[176:191]
    ds_read_b128 a[20:23], v7 offset:11264
    v_exp_f32 v243, v243
    v_cvt_pk_bf16_f32 v88, v240, v241
    v_cvt_pk_bf16_f32 v89, v242, v243
    v_exp_f32 v244, v244
    v_mfma_f32_32x32x16_bf16 a[32:47], a[8:11], v[72:75], a[32:47]
    s_cmp_le_u32 s82, 6
    v_exp_f32 v245, v245
    v_exp_f32 v246, v246
    v_exp_f32 v247, v247
    v_mfma_f32_32x32x16_bf16 a[32:47], a[12:15], v[76:79], a[32:47]
    s_addc_u32 s36, s3, 6
    v_cvt_pk_bf16_f32 v90, v244, v245
    v_cvt_pk_bf16_f32 v91, v246, v247
    v_exp_f32 v248, v248
    v_exp_f32 v249, v249
    v_exp_f32 v250, v250
    v_exp_f32 v251, v251
    v_cvt_pk_bf16_f32 v92, v248, v249
    v_cvt_pk_bf16_f32 v93, v250, v251
    v_smfmac_f32_16x16x64_bf16 a[64:67], a[72:75], v[72:79], v9
    s_lshl_b32 s36, s36, 15
    s_add_u32 s98, s84, s36
    v_exp_f32 v252, v252
    v_exp_f32 v253, v253
    v_exp_f32 v254, v254
    v_exp_f32 v255, v255
    v_cvt_pk_bf16_f32 v94, v252, v253
    v_cvt_pk_bf16_f32 v95, v254, v255
    v_mfma_f32_32x32x16_bf16 v[240:255], a[0:3], v[80:83], v[144:159]
    s_addc_u32 s99, s85, 0
    v_exp_f32 v176, v176
    v_exp_f32 v177, v177
    v_exp_f32 v178, v178
    v_mfma_f32_32x32x16_bf16 v[240:255], a[4:7], v[84:87], v[240:255]
    ds_read_b128 a[0:3], v7 offset:4096
    v_exp_f32 v179, v179
    v_cvt_pk_bf16_f32 v72, v176, v177
    v_cvt_pk_bf16_f32 v73, v178, v179
    v_exp_f32 v180, v180
    v_mfma_f32_32x32x16_bf16 a[48:63], a[8:11], v[88:91], a[48:63]
    ds_read_b128 a[4:7], v7 offset:5120
    v_exp_f32 v181, v181
    v_exp_f32 v182, v182
    v_exp_f32 v183, v183
    v_mfma_f32_32x32x16_bf16 a[48:63], a[12:15], v[92:95], a[48:63]
    s_add_u32 s47, s29, 22028288
    v_cvt_pk_bf16_f32 v74, v180, v181
    v_cvt_pk_bf16_f32 v75, v182, v183
    v_exp_f32 v184, v184
    v_exp_f32 v185, v185
    v_exp_f32 v186, v186
    v_exp_f32 v187, v187
    v_cvt_pk_bf16_f32 v76, v184, v185
    v_cvt_pk_bf16_f32 v77, v186, v187
    v_smfmac_f32_16x16x64_bf16 a[68:71], a[72:75], v[88:95], v9
    buffer_load_dword v21, v16, s[16:19], s47 offen sc1
    s_waitcnt lgkmcnt(0)
    v_exp_f32 v188, v188
    v_exp_f32 v189, v189
    v_exp_f32 v190, v190
    v_exp_f32 v191, v191
    v_cvt_pk_bf16_f32 v78, v188, v189
    v_cvt_pk_bf16_f32 v79, v190, v191
    v_mfma_f32_32x32x16_bf16 v[176:191], a[0:3], v[64:67], v[128:143]
    ds_read_b128 a[8:11], v7 offset:6144
    v_exp_f32 v240, v240
    v_exp_f32 v241, v241
    v_exp_f32 v242, v242
    v_mfma_f32_32x32x16_bf16 v[176:191], a[4:7], v[68:71], v[176:191]
    ds_read_b128 a[12:15], v7 offset:7168
    v_exp_f32 v243, v243
    v_cvt_pk_bf16_f32 v88, v240, v241
    v_cvt_pk_bf16_f32 v89, v242, v243
    v_exp_f32 v244, v244
    v_mfma_f32_32x32x16_bf16 a[32:47], a[16:19], v[72:75], a[32:47]
    s_mov_b32 s39, 720896
    v_exp_f32 v245, v245
    v_exp_f32 v246, v246
    v_exp_f32 v247, v247
    v_mfma_f32_32x32x16_bf16 a[32:47], a[20:23], v[76:79], a[32:47]
    s_add_u32 m0, s34, 45056
    v_cvt_pk_bf16_f32 v90, v244, v245
    v_cvt_pk_bf16_f32 v91, v246, v247
    v_exp_f32 v248, v248
    v_exp_f32 v249, v249
    v_exp_f32 v250, v250
    v_exp_f32 v251, v251
    v_cvt_pk_bf16_f32 v92, v248, v249
    v_cvt_pk_bf16_f32 v93, v250, v251
    v_smfmac_f32_16x16x64_bf16 a[64:67], a[72:75], v[72:79], v9
    buffer_load_dwordx4 v2, s[8:11], s39 offen lds
    s_mov_b32 s39, 786432
    v_exp_f32 v252, v252
    v_exp_f32 v253, v253
    v_exp_f32 v254, v254
    v_exp_f32 v255, v255
    v_cvt_pk_bf16_f32 v94, v252, v253
    v_cvt_pk_bf16_f32 v95, v254, v255
    v_mfma_f32_32x32x16_bf16 v[240:255], a[0:3], v[80:83], v[144:159]
    s_add_u32 m0, s34, 49152
    v_exp_f32 v176, v176
    v_exp_f32 v177, v177
    v_exp_f32 v178, v178
    v_mfma_f32_32x32x16_bf16 v[240:255], a[4:7], v[84:87], v[240:255]
    ds_read_b128 a[0:3], v7 offset:12288
    v_exp_f32 v179, v179
    v_cvt_pk_bf16_f32 v72, v176, v177
    v_cvt_pk_bf16_f32 v73, v178, v179
    v_exp_f32 v180, v180
    v_mfma_f32_32x32x16_bf16 a[48:63], a[16:19], v[88:91], a[48:63]
    ds_read_b128 a[4:7], v7 offset:13312
    v_exp_f32 v181, v181
    v_exp_f32 v182, v182
    v_exp_f32 v183, v183
    v_mfma_f32_32x32x16_bf16 a[48:63], a[20:23], v[92:95], a[48:63]
    buffer_load_dwordx4 v2, s[8:11], s39 offen lds
    v_cvt_pk_bf16_f32 v74, v180, v181
    v_cvt_pk_bf16_f32 v75, v182, v183
    v_exp_f32 v184, v184
    v_exp_f32 v185, v185
    v_exp_f32 v186, v186
    v_exp_f32 v187, v187
    v_cvt_pk_bf16_f32 v76, v184, v185
    v_cvt_pk_bf16_f32 v77, v186, v187
    v_smfmac_f32_16x16x64_bf16 a[68:71], a[72:75], v[88:95], v9
    s_mov_b32 s39, 851968
    s_waitcnt lgkmcnt(0)
    v_exp_f32 v188, v188
    v_exp_f32 v189, v189
    v_exp_f32 v190, v190
    v_exp_f32 v191, v191
    v_cvt_pk_bf16_f32 v78, v188, v189
    v_cvt_pk_bf16_f32 v79, v190, v191
    v_mfma_f32_32x32x16_bf16 v[176:191], a[0:3], v[64:67], v[128:143]
    ds_read_b128 a[16:19], v7 offset:14336
    v_exp_f32 v240, v240
    v_exp_f32 v241, v241
    v_exp_f32 v242, v242
    v_mfma_f32_32x32x16_bf16 v[176:191], a[4:7], v[68:71], v[176:191]
    ds_read_b128 a[20:23], v7 offset:15360
    v_exp_f32 v243, v243
    v_cvt_pk_bf16_f32 v88, v240, v241
    v_cvt_pk_bf16_f32 v89, v242, v243
    v_exp_f32 v244, v244
    v_mfma_f32_32x32x16_bf16 a[32:47], a[8:11], v[72:75], a[32:47]
    s_add_u32 m0, s34, 53248
    v_exp_f32 v245, v245
    v_exp_f32 v246, v246
    v_exp_f32 v247, v247
    v_mfma_f32_32x32x16_bf16 a[32:47], a[12:15], v[76:79], a[32:47]
    buffer_load_dwordx4 v2, s[8:11], s39 offen lds
    v_cvt_pk_bf16_f32 v90, v244, v245
    v_cvt_pk_bf16_f32 v91, v246, v247
    v_exp_f32 v248, v248
    v_exp_f32 v249, v249
    v_exp_f32 v250, v250
    v_exp_f32 v251, v251
    v_cvt_pk_bf16_f32 v92, v248, v249
    v_cvt_pk_bf16_f32 v93, v250, v251
    v_smfmac_f32_16x16x64_bf16 a[64:67], a[72:75], v[72:79], v9
    s_waitcnt vmcnt(4) lgkmcnt(0)
    s_barrier
    v_exp_f32 v252, v252
    v_exp_f32 v253, v253
    v_exp_f32 v254, v254
    v_exp_f32 v255, v255
    v_cvt_pk_bf16_f32 v94, v252, v253
    v_cvt_pk_bf16_f32 v95, v254, v255
    s_waitcnt vmcnt(3)
    v_cmp_ne_u32 vcc, s60, v21
    s_and_b32 s87, vcc_lo, -1
    s_cbranch_scc1 L_POB_S
L_POB_R:
    v_mfma_f32_32x32x16_bf16 v[240:255], a[0:3], v[80:83], v[144:159]
    s_add_u32 m0, s27, 131072
    v_exp_f32 v176, v176
    v_exp_f32 v177, v177
    v_exp_f32 v178, v178
    v_mfma_f32_32x32x16_bf16 v[240:255], a[4:7], v[84:87], v[240:255]
    ds_read_b128 a[0:3], v6 offset:0
    v_exp_f32 v179, v179
    v_cvt_pk_bf16_f32 v72, v176, v177
    v_cvt_pk_bf16_f32 v73, v178, v179
    v_exp_f32 v180, v180
    v_mfma_f32_32x32x16_bf16 a[48:63], a[8:11], v[88:91], a[48:63]
    ds_read_b128 a[4:7], v6 offset:1024
    v_exp_f32 v181, v181
    v_exp_f32 v182, v182
    v_exp_f32 v183, v183
    v_mfma_f32_32x32x16_bf16 a[48:63], a[12:15], v[92:95], a[48:63]
    global_load_lds_dwordx4 v29, s[98:99] offset:0 sc1
    v_cvt_pk_bf16_f32 v74, v180, v181
    v_cvt_pk_bf16_f32 v75, v182, v183
    v_exp_f32 v184, v184
    v_exp_f32 v185, v185
    v_exp_f32 v186, v186
    v_exp_f32 v187, v187
    v_cvt_pk_bf16_f32 v76, v184, v185
    v_cvt_pk_bf16_f32 v77, v186, v187
    v_smfmac_f32_16x16x64_bf16 a[68:71], a[72:75], v[88:95], v9
    global_load_lds_dwordx4 v29, s[98:99] offset:1024 sc1
    s_waitcnt lgkmcnt(0)
    v_exp_f32 v188, v188
    v_exp_f32 v189, v189
    v_exp_f32 v190, v190
    v_exp_f32 v191, v191
    v_cvt_pk_bf16_f32 v78, v188, v189
    v_cvt_pk_bf16_f32 v79, v190, v191
    v_mfma_f32_32x32x16_bf16 v[176:191], a[0:3], v[64:67], v[128:143]
    ds_read_b128 a[8:11], v6 offset:2048
    v_exp_f32 v240, v240
    v_exp_f32 v241, v241
    v_exp_f32 v242, v242
    v_mfma_f32_32x32x16_bf16 v[176:191], a[4:7], v[68:71], v[176:191]
    ds_read_b128 a[12:15], v6 offset:3072
    v_exp_f32 v243, v243
    v_cvt_pk_bf16_f32 v88, v240, v241
    v_cvt_pk_bf16_f32 v89, v242, v243
    v_exp_f32 v244, v244
    v_mfma_f32_32x32x16_bf16 a[32:47], a[16:19], v[72:75], a[32:47]
    global_load_lds_dwordx4 v29, s[98:99] offset:2048 sc1
    v_exp_f32 v245, v245
    v_exp_f32 v246, v246
    v_exp_f32 v247, v247
    v_mfma_f32_32x32x16_bf16 a[32:47], a[20:23], v[76:79], a[32:47]
    global_load_lds_dwordx4 v29, s[98:99] offset:3072 sc1
    v_cvt_pk_bf16_f32 v90, v244, v245
    v_cvt_pk_bf16_f32 v91, v246, v247
    v_exp_f32 v248, v248
    v_exp_f32 v249, v249
    v_exp_f32 v250, v250
    v_exp_f32 v251, v251
    v_cvt_pk_bf16_f32 v92, v248, v249
    v_cvt_pk_bf16_f32 v93, v250, v251
    v_smfmac_f32_16x16x64_bf16 a[64:67], a[72:75], v[72:79], v9
    s_add_u32 m0, s27, 135168
    s_nop 0
    global_load_lds_dwordx4 v5, s[98:99] offset:0 sc1
    v_exp_f32 v252, v252
    v_exp_f32 v253, v253
    v_exp_f32 v254, v254
    v_exp_f32 v255, v255
    v_cvt_pk_bf16_f32 v94, v252, v253
    v_cvt_pk_bf16_f32 v95, v254, v255
    v_mfma_f32_32x32x16_bf16 v[240:255], a[0:3], v[80:83], v[144:159]
    global_load_lds_dwordx4 v5, s[98:99] offset:1024 sc1
    v_exp_f32 v176, v176
    v_exp_f32 v177, v177
    v_exp_f32 v178, v178
    v_mfma_f32_32x32x16_bf16 v[240:255], a[4:7], v[84:87], v[240:255]
    ds_read_b128 a[0:3], v6 offset:8192
    v_exp_f32 v179, v179
    v_cvt_pk_bf16_f32 v72, v176, v177
    v_cvt_pk_bf16_f32 v73, v178, v179
    v_exp_f32 v180, v180
    v_mfma_f32_32x32x16_bf16 a[48:63], a[16:19], v[88:91], a[48:63]
    ds_read_b128 a[4:7], v6 offset:9216
    v_exp_f32 v181, v181
    v_exp_f32 v182, v182
    v_exp_f32 v183, v183
    v_mfma_f32_32x32x16_bf16 a[48:63], a[20:23], v[92:95], a[48:63]
    global_load_lds_dwordx4 v5, s[98:99] offset:2048 sc1
    v_cvt_pk_bf16_f32 v74, v180, v181
    v_cvt_pk_bf16_f32 v75, v182, v183
    v_exp_f32 v184, v184
    v_exp_f32 v185, v185
    v_exp_f32 v186, v186
    v_exp_f32 v187, v187
    v_cvt_pk_bf16_f32 v76, v184, v185
    v_cvt_pk_bf16_f32 v77, v186, v187
    v_smfmac_f32_16x16x64_bf16 a[68:71], a[72:75], v[88:95], v9
    global_load_lds_dwordx4 v5, s[98:99] offset:3072 sc1
    s_waitcnt lgkmcnt(0)
    v_exp_f32 v188, v188
    v_exp_f32 v189, v189
    v_exp_f32 v190, v190
    v_exp_f32 v191, v191
    v_cvt_pk_bf16_f32 v78, v188, v189
    v_cvt_pk_bf16_f32 v79, v190, v191
    v_mfma_f32_32x32x16_bf16 v[176:191], a[0:3], v[64:67], v[128:143]
    ds_read_b128 a[16:19], v6 offset:10240
    v_exp_f32 v240, v240
    v_exp_f32 v241, v241
    v_exp_f32 v242, v242
    v_mfma_f32_32x32x16_bf16 v[176:191], a[4:7], v[68:71], v[176:191]
    ds_read_b128 a[20:23], v6 offset:11264
    v_exp_f32 v243, v243
    v_cvt_pk_bf16_f32 v88, v240, v241
    v_cvt_pk_bf16_f32 v89, v242, v243
    v_exp_f32 v244, v244
    v_mfma_f32_32x32x16_bf16 a[32:47], a[8:11], v[72:75], a[32:47]
    s_add_u32 s36, s3, 8
    v_exp_f32 v245, v245
    v_exp_f32 v246, v246
    v_exp_f32 v247, v247
    v_mfma_f32_32x32x16_bf16 a[32:47], a[12:15], v[76:79], a[32:47]
    s_and_b32 s36, s36, 15
    v_cvt_pk_bf16_f32 v90, v244, v245
    v_cvt_pk_bf16_f32 v91, v246, v247
    v_exp_f32 v248, v248
    v_exp_f32 v249, v249
    v_exp_f32 v250, v250
    v_exp_f32 v251, v251
    v_cvt_pk_bf16_f32 v92, v248, v249
    v_cvt_pk_bf16_f32 v93, v250, v251
    v_smfmac_f32_16x16x64_bf16 a[64:67], a[72:75], v[72:79], v9
    s_lshl_b32 s36, s36, 15
    s_add_u32 s98, s84, s36
    v_exp_f32 v252, v252
    v_exp_f32 v253, v253
    v_exp_f32 v254, v254
    v_exp_f32 v255, v255
    v_cvt_pk_bf16_f32 v94, v252, v253
    v_cvt_pk_bf16_f32 v95, v254, v255
    v_mfma_f32_32x32x16_bf16 v[240:255], a[0:3], v[80:83], v[144:159]
    s_addc_u32 s99, s85, 0
    v_exp_f32 v176, v176
    v_exp_f32 v177, v177
    v_exp_f32 v178, v178
    v_mfma_f32_32x32x16_bf16 v[240:255], a[4:7], v[84:87], v[240:255]
    ds_read_b128 a[0:3], v6 offset:4096
    v_exp_f32 v179, v179
    v_cvt_pk_bf16_f32 v72, v176, v177
    v_cvt_pk_bf16_f32 v73, v178, v179
    v_exp_f32 v180, v180
    v_mfma_f32_32x32x16_bf16 a[48:63], a[8:11], v[88:91], a[48:63]
    ds_read_b128 a[4:7], v6 offset:5120
    v_exp_f32 v181, v181
    v_exp_f32 v182, v182
    v_exp_f32 v183, v183
    v_mfma_f32_32x32x16_bf16 a[48:63], a[12:15], v[92:95], a[48:63]
    s_mov_b32 s39, 917504
    v_cvt_pk_bf16_f32 v74, v180, v181
    v_cvt_pk_bf16_f32 v75, v182, v183
    v_exp_f32 v184, v184
    v_exp_f32 v185, v185
    v_exp_f32 v186, v186
    v_exp_f32 v187, v187
    v_cvt_pk_bf16_f32 v76, v184, v185
    v_cvt_pk_bf16_f32 v77, v186, v187
    v_smfmac_f32_16x16x64_bf16 a[68:71], a[72:75], v[88:95], v9
    s_add_u32 m0, s34, 57344
    s_waitcnt lgkmcnt(0)
    v_exp_f32 v188, v188
    v_exp_f32 v189, v189
    v_exp_f32 v190, v190
    v_exp_f32 v191, v191
    v_cvt_pk_bf16_f32 v78, v188, v189
    v_cvt_pk_bf16_f32 v79, v190, v191
    v_mfma_f32_32x32x16_bf16 v[176:191], a[0:3], v[64:67], v[128:143]
    ds_read_b128 a[8:11], v6 offset:6144
    v_exp_f32 v240, v240
    v_exp_f32 v241, v241
    v_exp_f32 v242, v242
    v_mfma_f32_32x32x16_bf16 v[176:191], a[4:7], v[68:71], v[176:191]
    ds_read_b128 a[12:15], v6 offset:7168
    v_exp_f32 v243, v243
    v_cvt_pk_bf16_f32 v88, v240, v241
    v_cvt_pk_bf16_f32 v89, v242, v243
    v_exp_f32 v244, v244
    v_mfma_f32_32x32x16_bf16 a[32:47], a[16:19], v[72:75], a[32:47]
    buffer_load_dwordx4 v2, s[8:11], s39 offen lds
    v_exp_f32 v245, v245
    v_exp_f32 v246, v246
    v_exp_f32 v247, v247
    v_mfma_f32_32x32x16_bf16 a[32:47], a[20:23], v[76:79], a[32:47]
    s_add_u32 m0, s34, 61440
    v_cvt_pk_bf16_f32 v90, v244, v245
    v_cvt_pk_bf16_f32 v91, v246, v247
    v_exp_f32 v248, v248
    v_exp_f32 v249, v249
    v_exp_f32 v250, v250
    v_exp_f32 v251, v251
    v_cvt_pk_bf16_f32 v92, v248, v249
    v_cvt_pk_bf16_f32 v93, v250, v251
    v_smfmac_f32_16x16x64_bf16 a[64:67], a[72:75], v[72:79], v9
    s_mov_b32 s39, 983040
    buffer_load_dwordx4 v2, s[8:11], s39 offen lds
    v_exp_f32 v252, v252
    v_exp_f32 v253, v253
    v_exp_f32 v254, v254
    v_exp_f32 v255, v255
    v_cvt_pk_bf16_f32 v94, v252, v253
    v_cvt_pk_bf16_f32 v95, v254, v255
    v_mfma_f32_32x32x16_bf16 v[240:255], a[0:3], v[80:83], v[144:159]
    s_mov_b32 s39, 1048576
    v_exp_f32 v176, v176
    v_exp_f32 v177, v177
    v_exp_f32 v178, v178
    v_mfma_f32_32x32x16_bf16 v[240:255], a[4:7], v[84:87], v[240:255]
    ds_read_b128 a[0:3], v6 offset:12288
    v_exp_f32 v179, v179
    v_cvt_pk_bf16_f32 v72, v176, v177
    v_cvt_pk_bf16_f32 v73, v178, v179
    v_exp_f32 v180, v180
    v_mfma_f32_32x32x16_bf16 a[48:63], a[16:19], v[88:91], a[48:63]
    ds_read_b128 a[4:7], v6 offset:13312
    v_exp_f32 v181, v181
    v_exp_f32 v182, v182
    v_exp_f32 v183, v183
    v_mfma_f32_32x32x16_bf16 a[48:63], a[20:23], v[92:95], a[48:63]
    s_add_u32 m0, s34, 65536
    v_cvt_pk_bf16_f32 v74, v180, v181
    v_cvt_pk_bf16_f32 v75, v182, v183
    v_exp_f32 v184, v184
    v_exp_f32 v185, v185
    v_exp_f32 v186, v186
    v_exp_f32 v187, v187
    v_cvt_pk_bf16_f32 v76, v184, v185
    v_cvt_pk_bf16_f32 v77, v186, v187
    v_smfmac_f32_16x16x64_bf16 a[68:71], a[72:75], v[88:95], v9
    buffer_load_dwordx4 v2, s[8:11], s39 offen lds
    s_waitcnt lgkmcnt(0)
    v_exp_f32 v188, v188
    v_exp_f32 v189, v189
    v_exp_f32 v190, v190
    v_exp_f32 v191, v191
    v_cvt_pk_bf16_f32 v78, v188, v189
    v_cvt_pk_bf16_f32 v79, v190, v191
    v_mfma_f32_32x32x16_bf16 v[176:191], a[0:3], v[64:67], v[128:143]
    ds_read_b128 a[16:19], v6 offset:14336
    v_exp_f32 v240, v240
    v_exp_f32 v241, v241
    v_exp_f32 v242, v242
    v_mfma_f32_32x32x16_bf16 v[176:191], a[4:7], v[68:71], v[176:191]
    ds_read_b128 a[20:23], v6 offset:15360
    v_exp_f32 v243, v243
    v_cvt_pk_bf16_f32 v88, v240, v241
    v_cvt_pk_bf16_f32 v89, v242, v243
    v_exp_f32 v244, v244
    v_mfma_f32_32x32x16_bf16 a[32:47], a[8:11], v[72:75], a[32:47]
    s_mov_b32 s39, 1114112
    v_exp_f32 v245, v245
    v_exp_f32 v246, v246
    v_exp_f32 v247, v247
    v_mfma_f32_32x32x16_bf16 a[32:47], a[12:15], v[76:79], a[32:47]
    s_add_u32 m0, s34, 69632
    v_cvt_pk_bf16_f32 v90, v244, v245
    v_cvt_pk_bf16_f32 v91, v246, v247
    v_exp_f32 v248, v248
    v_exp_f32 v249, v249
    v_exp_f32 v250, v250
    v_exp_f32 v251, v251
    v_cvt_pk_bf16_f32 v92, v248, v249
    v_cvt_pk_bf16_f32 v93, v250, v251
    v_smfmac_f32_16x16x64_bf16 a[64:67], a[72:75], v[72:79], v9
    buffer_load_dwordx4 v2, s[8:11], s39 offen lds
    s_waitcnt vmcnt(4) lgkmcnt(0)
    s_barrier
    v_exp_f32 v252, v252
    v_exp_f32 v253, v253
    v_exp_f32 v254, v254
    v_exp_f32 v255, v255
    v_cvt_pk_bf16_f32 v94, v252, v253
    v_cvt_pk_bf16_f32 v95, v254, v255
    v_mfma_f32_32x32x16_bf16 v[240:255], a[0:3], v[80:83], v[144:159]
    s_add_u32 m0, s27, 98304
    v_exp_f32 v176, v176
    v_exp_f32 v177, v177
    v_exp_f32 v178, v178
    v_mfma_f32_32x32x16_bf16 v[240:255], a[4:7], v[84:87], v[240:255]
    ds_read_b128 a[0:3], v7 offset:0
    v_exp_f32 v179, v179
    v_cvt_pk_bf16_f32 v72, v176, v177
    v_cvt_pk_bf16_f32 v73, v178, v179
    v_exp_f32 v180, v180
    v_mfma_f32_32x32x16_bf16 a[48:63], a[8:11], v[88:91], a[48:63]
    ds_read_b128 a[4:7], v7 offset:1024
    v_exp_f32 v181, v181
    v_exp_f32 v182, v182
    v_exp_f32 v183, v183
    v_mfma_f32_32x32x16_bf16 a[48:63], a[12:15], v[92:95], a[48:63]
    global_load_lds_dwordx4 v29, s[98:99] offset:0 sc1
    v_cvt_pk_bf16_f32 v74, v180, v181
    v_cvt_pk_bf16_f32 v75, v182, v183
    v_exp_f32 v184, v184
    v_exp_f32 v185, v185
    v_exp_f32 v186, v186
    v_exp_f32 v187, v187
    v_cvt_pk_bf16_f32 v76, v184, v185
    v_cvt_pk_bf16_f32 v77, v186, v187
    v_smfmac_f32_16x16x64_bf16 a[68:71], a[72:75], v[88:95], v9
    global_load_lds_dwordx4 v29, s[98:99] offset:1024 sc1
    s_waitcnt lgkmcnt(0)
    v_exp_f32 v188, v188
    v_exp_f32 v189, v189
    v_exp_f32 v190, v190
    v_exp_f32 v191, v191
    v_cvt_pk_bf16_f32 v78, v188, v189
    v_cvt_pk_bf16_f32 v79, v190, v191
    v_mfma_f32_32x32x16_bf16 v[176:191], a[0:3], v[64:67], v[128:143]
    ds_read_b128 a[8:11], v7 offset:2048
    v_exp_f32 v240, v240
    v_exp_f32 v241, v241
    v_exp_f32 v242, v242
    v_mfma_f32_32x32x16_bf16 v[176:191], a[4:7], v[68:71], v[176:191]
    ds_read_b128 a[12:15], v7 offset:3072
    v_exp_f32 v243, v243
    v_cvt_pk_bf16_f32 v88, v240, v241
    v_cvt_pk_bf16_f32 v89, v242, v243
    v_exp_f32 v244, v244
    v_mfma_f32_32x32x16_bf16 a[32:47], a[16:19], v[72:75], a[32:47]
    global_load_lds_dwordx4 v29, s[98:99] offset:2048 sc1
    v_exp_f32 v245, v245
    v_exp_f32 v246, v246
    v_exp_f32 v247, v247
    v_mfma_f32_32x32x16_bf16 a[32:47], a[20:23], v[76:79], a[32:47]
    global_load_lds_dwordx4 v29, s[98:99] offset:3072 sc1
    v_cvt_pk_bf16_f32 v90, v244, v245
    v_cvt_pk_bf16_f32 v91, v246, v247
    v_exp_f32 v248, v248
    v_exp_f32 v249, v249
    v_exp_f32 v250, v250
    v_exp_f32 v251, v251
    v_cvt_pk_bf16_f32 v92, v248, v249
    v_cvt_pk_bf16_f32 v93, v250, v251
    v_smfmac_f32_16x16x64_bf16 a[64:67], a[72:75], v[72:79], v9
    s_add_u32 m0, s27, 102400
    s_nop 0
    global_load_lds_dwordx4 v5, s[98:99] offset:0 sc1
    v_exp_f32 v252, v252
    v_exp_f32 v253, v253
    v_exp_f32 v254, v254
    v_exp_f32 v255, v255
    v_cvt_pk_bf16_f32 v94, v252, v253
    v_cvt_pk_bf16_f32 v95, v254, v255
    v_mfma_f32_32x32x16_bf16 v[240:255], a[0:3], v[80:83], v[144:159]
    global_load_lds_dwordx4 v5, s[98:99] offset:1024 sc1
    v_exp_f32 v176, v176
    v_exp_f32 v177, v177
    v_exp_f32 v178, v178
    v_mfma_f32_32x32x16_bf16 v[240:255], a[4:7], v[84:87], v[240:255]
    ds_read_b128 a[0:3], v7 offset:8192
    v_exp_f32 v179, v179
    v_cvt_pk_bf16_f32 v72, v176, v177
    v_cvt_pk_bf16_f32 v73, v178, v179
    v_exp_f32 v180, v180
    v_mfma_f32_32x32x16_bf16 a[48:63], a[16:19], v[88:91], a[48:63]
    ds_read_b128 a[4:7], v7 offset:9216
    v_exp_f32 v181, v181
    v_exp_f32 v182, v182
    v_exp_f32 v183, v183
    v_mfma_f32_32x32x16_bf16 a[48:63], a[20:23], v[92:95], a[48:63]
    global_load_lds_dwordx4 v5, s[98:99] offset:2048 sc1
    v_cvt_pk_bf16_f32 v74, v180, v181
    v_cvt_pk_bf16_f32 v75, v182, v183
    v_exp_f32 v184, v184
    v_exp_f32 v185, v185
    v_exp_f32 v186, v186
    v_exp_f32 v187, v187
    v_cvt_pk_bf16_f32 v76, v184, v185
    v_cvt_pk_bf16_f32 v77, v186, v187
    v_smfmac_f32_16x16x64_bf16 a[68:71], a[72:75], v[88:95], v9
    global_load_lds_dwordx4 v5, s[98:99] offset:3072 sc1
    s_waitcnt lgkmcnt(0)
    v_exp_f32 v188, v188
    v_exp_f32 v189, v189
    v_exp_f32 v190, v190
    v_exp_f32 v191, v191
    v_cvt_pk_bf16_f32 v78, v188, v189
    v_cvt_pk_bf16_f32 v79, v190, v191
    v_mfma_f32_32x32x16_bf16 v[176:191], a[0:3], v[64:67], v[128:143]
    ds_read_b128 a[16:19], v7 offset:10240
    v_exp_f32 v240, v240
    v_exp_f32 v241, v241
    v_exp_f32 v242, v242
    v_mfma_f32_32x32x16_bf16 v[176:191], a[4:7], v[68:71], v[176:191]
    ds_read_b128 a[20:23], v7 offset:11264
    v_exp_f32 v243, v243
    v_cvt_pk_bf16_f32 v88, v240, v241
    v_cvt_pk_bf16_f32 v89, v242, v243
    v_exp_f32 v244, v244
    v_mfma_f32_32x32x16_bf16 a[32:47], a[8:11], v[72:75], a[32:47]
    s_add_u32 s36, s3, 9
    v_exp_f32 v245, v245
    v_exp_f32 v246, v246
    v_exp_f32 v247, v247
    v_mfma_f32_32x32x16_bf16 a[32:47], a[12:15], v[76:79], a[32:47]
    s_and_b32 s36, s36, 15
    v_cvt_pk_bf16_f32 v90, v244, v245
    v_cvt_pk_bf16_f32 v91, v246, v247
    v_exp_f32 v248, v248
    v_exp_f32 v249, v249
    v_exp_f32 v250, v250
    v_exp_f32 v251, v251
    v_cvt_pk_bf16_f32 v92, v248, v249
    v_cvt_pk_bf16_f32 v93, v250, v251
    v_smfmac_f32_16x16x64_bf16 a[64:67], a[72:75], v[72:79], v9
    s_lshl_b32 s36, s36, 15
    s_add_u32 s98, s84, s36
    v_exp_f32 v252, v252
    v_exp_f32 v253, v253
    v_exp_f32 v254, v254
    v_exp_f32 v255, v255
    v_cvt_pk_bf16_f32 v94, v252, v253
    v_cvt_pk_bf16_f32 v95, v254, v255
    v_mfma_f32_32x32x16_bf16 v[240:255], a[0:3], v[80:83], v[144:159]
    s_addc_u32 s99, s85, 0
    v_exp_f32 v176, v176
    v_exp_f32 v177, v177
    v_exp_f32 v178, v178
    v_mfma_f32_32x32x16_bf16 v[240:255], a[4:7], v[84:87], v[240:255]
    ds_read_b128 a[0:3], v7 offset:4096
    v_exp_f32 v179, v179
    v_cvt_pk_bf16_f32 v72, v176, v177
    v_cvt_pk_bf16_f32 v73, v178, v179
    v_exp_f32 v180, v180
    v_mfma_f32_32x32x16_bf16 a[48:63], a[8:11], v[88:91], a[48:63]
    ds_read_b128 a[4:7], v7 offset:5120
    v_exp_f32 v181, v181
    v_exp_f32 v182, v182
    v_exp_f32 v183, v183
    v_mfma_f32_32x32x16_bf16 a[48:63], a[12:15], v[92:95], a[48:63]
    global_load_dwordx4 a[76:79], v29, s[100:101] offset:0 sc1
    v_cvt_pk_bf16_f32 v74, v180, v181
    v_cvt_pk_bf16_f32 v75, v182, v183
    v_exp_f32 v184, v184
    v_exp_f32 v185, v185
    v_exp_f32 v186, v186
    v_exp_f32 v187, v187
    v_cvt_pk_bf16_f32 v76, v184, v185
    v_cvt_pk_bf16_f32 v77, v186, v187
    v_smfmac_f32_16x16x64_bf16 a[68:71], a[72:75], v[88:95], v9
    global_load_dwordx4 a[80:83], v29, s[100:101] offset:1024 sc1
    s_waitcnt lgkmcnt(0)
    v_exp_f32 v188, v188
    v_exp_f32 v189, v189
    v_exp_f32 v190, v190
    v_exp_f32 v191, v191
    v_cvt_pk_bf16_f32 v78, v188, v189
    v_cvt_pk_bf16_f32 v79, v190, v191
    v_mfma_f32_32x32x16_bf16 v[176:191], a[0:3], v[64:67], v[128:143]
    ds_read_b128 a[8:11], v7 offset:6144
    v_exp_f32 v240, v240
    v_exp_f32 v241, v241
    v_exp_f32 v242, v242
    v_mfma_f32_32x32x16_bf16 v[176:191], a[4:7], v[68:71], v[176:191]
    ds_read_b128 a[12:15], v7 offset:7168
    v_exp_f32 v243, v243
    v_cvt_pk_bf16_f32 v88, v240, v241
    v_cvt_pk_bf16_f32 v89, v242, v243
    v_exp_f32 v244, v244
    v_mfma_f32_32x32x16_bf16 a[32:47], a[16:19], v[72:75], a[32:47]
    global_load_dwordx4 a[84:87], v29, s[100:101] offset:2048 sc1
    v_exp_f32 v245, v245
    v_exp_f32 v246, v246
    v_exp_f32 v247, v247
    v_mfma_f32_32x32x16_bf16 a[32:47], a[20:23], v[76:79], a[32:47]
    global_load_dwordx4 a[88:91], v29, s[100:101] offset:3072 sc1
    v_cvt_pk_bf16_f32 v90, v244, v245
    v_cvt_pk_bf16_f32 v91, v246, v247
    v_exp_f32 v248, v248
    v_exp_f32 v249, v249
    v_exp_f32 v250, v250
    v_exp_f32 v251, v251
    v_cvt_pk_bf16_f32 v92, v248, v249
    v_cvt_pk_bf16_f32 v93, v250, v251
    v_smfmac_f32_16x16x64_bf16 a[64:67], a[72:75], v[72:79], v9
    global_load_dwordx4 a[92:95], v5, s[100:101] offset:0 sc1
    global_load_dwordx4 a[96:99], v5, s[100:101] offset:1024 sc1
    v_exp_f32 v252, v252
    v_exp_f32 v253, v253
    v_exp_f32 v254, v254
    v_exp_f32 v255, v255
    v_cvt_pk_bf16_f32 v94, v252, v253
    v_cvt_pk_bf16_f32 v95, v254, v255
    v_mfma_f32_32x32x16_bf16 v[240:255], a[0:3], v[80:83], v[144:159]
    global_load_dwordx4 a[100:103], v5, s[100:101] offset:2048 sc1
    v_exp_f32 v176, v176
    v_exp_f32 v177, v177
    v_exp_f32 v178, v178
    v_mfma_f32_32x32x16_bf16 v[240:255], a[4:7], v[84:87], v[240:255]
    ds_read_b128 a[0:3], v7 offset:12288
    v_exp_f32 v179, v179
    v_cvt_pk_bf16_f32 v72, v176, v177
    v_cvt_pk_bf16_f32 v73, v178, v179
    v_exp_f32 v180, v180
    v_mfma_f32_32x32x16_bf16 a[48:63], a[16:19], v[88:91], a[48:63]
    ds_read_b128 a[4:7], v7 offset:13312
    v_exp_f32 v181, v181
    v_exp_f32 v182, v182
    v_exp_f32 v183, v183
    v_mfma_f32_32x32x16_bf16 a[48:63], a[20:23], v[92:95], a[48:63]
    global_load_dwordx4 a[104:107], v5, s[100:101] offset:3072 sc1
    v_cvt_pk_bf16_f32 v74, v180, v181
    v_cvt_pk_bf16_f32 v75, v182, v183
    v_exp_f32 v184, v184
    v_exp_f32 v185, v185
    v_exp_f32 v186, v186
    v_exp_f32 v187, v187
    v_cvt_pk_bf16_f32 v76, v184, v185
    v_cvt_pk_bf16_f32 v77, v186, v187
    v_smfmac_f32_16x16x64_bf16 a[68:71], a[72:75], v[88:95], v9
    s_add_u32 s100, s100, 8192
    s_waitcnt lgkmcnt(0)
    v_exp_f32 v188, v188
    v_exp_f32 v189, v189
    v_exp_f32 v190, v190
    v_exp_f32 v191, v191
    v_cvt_pk_bf16_f32 v78, v188, v189
    v_cvt_pk_bf16_f32 v79, v190, v191
    v_mfma_f32_32x32x16_bf16 v[176:191], a[0:3], v[64:67], v[128:143]
    ds_read_b128 a[16:19], v7 offset:14336
    v_exp_f32 v240, v240
    v_exp_f32 v241, v241
    v_exp_f32 v242, v242
    v_mfma_f32_32x32x16_bf16 v[176:191], a[4:7], v[68:71], v[176:191]
    ds_read_b128 a[20:23], v7 offset:15360
    v_exp_f32 v243, v243
    v_cvt_pk_bf16_f32 v88, v240, v241
    v_cvt_pk_bf16_f32 v89, v242, v243
    v_exp_f32 v244, v244
    v_mfma_f32_32x32x16_bf16 a[32:47], a[8:11], v[72:75], a[32:47]
    s_addc_u32 s101, s101, 0
    v_exp_f32 v245, v245
    v_exp_f32 v246, v246
    v_exp_f32 v247, v247
    v_mfma_f32_32x32x16_bf16 a[32:47], a[12:15], v[76:79], a[32:47]
    global_load_dword v28, v0, s[70:71] offset:0
    v_cvt_pk_bf16_f32 v90, v244, v245
    v_cvt_pk_bf16_f32 v91, v246, v247
    v_exp_f32 v248, v248
    v_exp_f32 v249, v249
    v_exp_f32 v250, v250
    v_exp_f32 v251, v251
    v_cvt_pk_bf16_f32 v92, v248, v249
    v_cvt_pk_bf16_f32 v93, v250, v251
    v_smfmac_f32_16x16x64_bf16 a[64:67], a[72:75], v[72:79], v9
    s_waitcnt vmcnt(9) lgkmcnt(0)
    s_barrier
    v_exp_f32 v252, v252
    v_exp_f32 v253, v253
    v_exp_f32 v254, v254
    v_exp_f32 v255, v255
    v_cvt_pk_bf16_f32 v94, v252, v253
    v_cvt_pk_bf16_f32 v95, v254, v255
    v_mfma_f32_32x32x16_bf16 v[240:255], a[0:3], v[80:83], v[144:159]
    s_add_u32 m0, s27, 131072
    v_exp_f32 v176, v176
    v_exp_f32 v177, v177
    v_exp_f32 v178, v178
    v_mfma_f32_32x32x16_bf16 v[240:255], a[4:7], v[84:87], v[240:255]
    ds_read_b128 a[0:3], v6 offset:0
    v_exp_f32 v179, v179
    v_cvt_pk_bf16_f32 v72, v176, v177
    v_cvt_pk_bf16_f32 v73, v178, v179
    v_exp_f32 v180, v180
    v_mfma_f32_32x32x16_bf16 a[48:63], a[8:11], v[88:91], a[48:63]
    ds_read_b128 a[4:7], v6 offset:1024
    v_exp_f32 v181, v181
    v_exp_f32 v182, v182
    v_exp_f32 v183, v183
    v_mfma_f32_32x32x16_bf16 a[48:63], a[12:15], v[92:95], a[48:63]
    global_load_lds_dwordx4 v29, s[98:99] offset:0 sc1
    v_cvt_pk_bf16_f32 v74, v180, v181
    v_cvt_pk_bf16_f32 v75, v182, v183
    v_exp_f32 v184, v184
    v_exp_f32 v185, v185
    v_exp_f32 v186, v186
    v_exp_f32 v187, v187
    v_cvt_pk_bf16_f32 v76, v184, v185
    v_cvt_pk_bf16_f32 v77, v186, v187
    v_smfmac_f32_16x16x64_bf16 a[68:71], a[72:75], v[88:95], v9
    global_load_lds_dwordx4 v29, s[98:99] offset:1024 sc1
    s_waitcnt lgkmcnt(0)
    v_exp_f32 v188, v188
    v_exp_f32 v189, v189
    v_exp_f32 v190, v190
    v_exp_f32 v191, v191
    v_cvt_pk_bf16_f32 v78, v188, v189
    v_cvt_pk_bf16_f32 v79, v190, v191
    v_mfma_f32_32x32x16_bf16 v[176:191], a[0:3], v[64:67], v[128:143]
    ds_read_b128 a[8:11], v6 offset:2048
    v_exp_f32 v240, v240
    v_exp_f32 v241, v241
    v_exp_f32 v242, v242
    v_mfma_f32_32x32x16_bf16 v[176:191], a[4:7], v[68:71], v[176:191]
    ds_read_b128 a[12:15], v6 offset:3072
    v_exp_f32 v243, v243
    v_cvt_pk_bf16_f32 v88, v240, v241
    v_cvt_pk_bf16_f32 v89, v242, v243
    v_exp_f32 v244, v244
    v_mfma_f32_32x32x16_bf16 a[32:47], a[16:19], v[72:75], a[32:47]
    global_load_lds_dwordx4 v29, s[98:99] offset:2048 sc1
    v_exp_f32 v245, v245
    v_exp_f32 v246, v246
    v_exp_f32 v247, v247
    v_mfma_f32_32x32x16_bf16 a[32:47], a[20:23], v[76:79], a[32:47]
    global_load_lds_dwordx4 v29, s[98:99] offset:3072 sc1
    v_cvt_pk_bf16_f32 v90, v244, v245
    v_cvt_pk_bf16_f32 v91, v246, v247
    v_exp_f32 v248, v248
    v_exp_f32 v249, v249
    v_exp_f32 v250, v250
    v_exp_f32 v251, v251
    v_cvt_pk_bf16_f32 v92, v248, v249
    v_cvt_pk_bf16_f32 v93, v250, v251
    v_smfmac_f32_16x16x64_bf16 a[64:67], a[72:75], v[72:79], v9
    s_add_u32 m0, s27, 135168
    s_nop 0
    global_load_lds_dwordx4 v5, s[98:99] offset:0 sc1
    v_exp_f32 v252, v252
    v_exp_f32 v253, v253
    v_exp_f32 v254, v254
    v_exp_f32 v255, v255
    v_cvt_pk_bf16_f32 v94, v252, v253
    v_cvt_pk_bf16_f32 v95, v254, v255
    v_mfma_f32_32x32x16_bf16 v[240:255], a[0:3], v[80:83], v[144:159]
    global_load_lds_dwordx4 v5, s[98:99] offset:1024 sc1
    v_exp_f32 v176, v176
    v_exp_f32 v177, v177
    v_exp_f32 v178, v178
    v_mfma_f32_32x32x16_bf16 v[240:255], a[4:7], v[84:87], v[240:255]
    ds_read_b128 a[0:3], v6 offset:8192
    v_exp_f32 v179, v179
    v_cvt_pk_bf16_f32 v72, v176, v177
    v_cvt_pk_bf16_f32 v73, v178, v179
    v_exp_f32 v180, v180
    v_mfma_f32_32x32x16_bf16 a[48:63], a[16:19], v[88:91], a[48:63]
    ds_read_b128 a[4:7], v6 offset:9216
    v_exp_f32 v181, v181
    v_exp_f32 v182, v182
    v_exp_f32 v183, v183
    v_mfma_f32_32x32x16_bf16 a[48:63], a[20:23], v[92:95], a[48:63]
    global_load_lds_dwordx4 v5, s[98:99] offset:2048 sc1
    v_cvt_pk_bf16_f32 v74, v180, v181
    v_cvt_pk_bf16_f32 v75, v182, v183
    v_exp_f32 v184, v184
    v_exp_f32 v185, v185
    v_exp_f32 v186, v186
    v_exp_f32 v187, v187
    v_cvt_pk_bf16_f32 v76, v184, v185
    v_cvt_pk_bf16_f32 v77, v186, v187
    v_smfmac_f32_16x16x64_bf16 a[68:71], a[72:75], v[88:95], v9
    global_load_lds_dwordx4 v5, s[98:99] offset:3072 sc1
    s_waitcnt lgkmcnt(0)
    v_exp_f32 v188, v188
    v_exp_f32 v189, v189
    v_exp_f32 v190, v190
    v_exp_f32 v191, v191
    v_cvt_pk_bf16_f32 v78, v188, v189
    v_cvt_pk_bf16_f32 v79, v190, v191
    v_mfma_f32_32x32x16_bf16 v[176:191], a[0:3], v[64:67], v[128:143]
    ds_read_b128 a[16:19], v6 offset:10240
    v_exp_f32 v240, v240
    v_exp_f32 v241, v241
    v_exp_f32 v242, v242
    v_mfma_f32_32x32x16_bf16 v[176:191], a[4:7], v[68:71], v[176:191]
    ds_read_b128 a[20:23], v6 offset:11264
    v_exp_f32 v243, v243
    v_cvt_pk_bf16_f32 v88, v240, v241
    v_cvt_pk_bf16_f32 v89, v242, v243
    v_exp_f32 v244, v244
    v_mfma_f32_32x32x16_bf16 a[32:47], a[8:11], v[72:75], a[32:47]
    s_add_u32 s36, s3, 10
    v_exp_f32 v245, v245
    v_exp_f32 v246, v246
    v_exp_f32 v247, v247
    v_mfma_f32_32x32x16_bf16 a[32:47], a[12:15], v[76:79], a[32:47]
    s_and_b32 s36, s36, 15
    v_cvt_pk_bf16_f32 v90, v244, v245
    v_cvt_pk_bf16_f32 v91, v246, v247
    v_exp_f32 v248, v248
    v_exp_f32 v249, v249
    v_exp_f32 v250, v250
    v_exp_f32 v251, v251
    v_cvt_pk_bf16_f32 v92, v248, v249
    v_cvt_pk_bf16_f32 v93, v250, v251
    v_smfmac_f32_16x16x64_bf16 a[64:67], a[72:75], v[72:79], v9
    s_lshl_b32 s36, s36, 15
    s_add_u32 s98, s84, s36
    v_exp_f32 v252, v252
    v_exp_f32 v253, v253
    v_exp_f32 v254, v254
    v_exp_f32 v255, v255
    v_cvt_pk_bf16_f32 v94, v252, v253
    v_cvt_pk_bf16_f32 v95, v254, v255
    v_mfma_f32_32x32x16_bf16 v[240:255], a[0:3], v[80:83], v[144:159]
    s_addc_u32 s99, s85, 0
    v_exp_f32 v176, v176
    v_exp_f32 v177, v177
    v_exp_f32 v178, v178
    v_mfma_f32_32x32x16_bf16 v[240:255], a[4:7], v[84:87], v[240:255]
    ds_read_b128 a[0:3], v6 offset:4096
    v_exp_f32 v179, v179
    v_cvt_pk_bf16_f32 v72, v176, v177
    v_cvt_pk_bf16_f32 v73, v178, v179
    v_exp_f32 v180, v180
    v_mfma_f32_32x32x16_bf16 a[48:63], a[8:11], v[88:91], a[48:63]
    ds_read_b128 a[4:7], v6 offset:5120
    v_exp_f32 v181, v181
    v_exp_f32 v182, v182
    v_exp_f32 v183, v183
    v_mfma_f32_32x32x16_bf16 a[48:63], a[12:15], v[92:95], a[48:63]
    global_load_dwordx4 a[108:111], v29, s[100:101] offset:0 sc1
    v_cvt_pk_bf16_f32 v74, v180, v181
    v_cvt_pk_bf16_f32 v75, v182, v183
    v_exp_f32 v184, v184
    v_exp_f32 v185, v185
    v_exp_f32 v186, v186
    v_exp_f32 v187, v187
    v_cvt_pk_bf16_f32 v76, v184, v185
    v_cvt_pk_bf16_f32 v77, v186, v187
    v_smfmac_f32_16x16x64_bf16 a[68:71], a[72:75], v[88:95], v9
    global_load_dwordx4 a[112:115], v29, s[100:101] offset:1024 sc1
    s_waitcnt lgkmcnt(0)
    v_exp_f32 v188, v188
    v_exp_f32 v189, v189
    v_exp_f32 v190, v190
    v_exp_f32 v191, v191
    v_cvt_pk_bf16_f32 v78, v188, v189
    v_cvt_pk_bf16_f32 v79, v190, v191
    v_mfma_f32_32x32x16_bf16 v[176:191], a[0:3], v[64:67], v[128:143]
    ds_read_b128 a[8:11], v6 offset:6144
    v_exp_f32 v240, v240
    v_exp_f32 v241, v241
    v_exp_f32 v242, v242
    v_mfma_f32_32x32x16_bf16 v[176:191], a[4:7], v[68:71], v[176:191]
    ds_read_b128 a[12:15], v6 offset:7168
    v_exp_f32 v243, v243
    v_cvt_pk_bf16_f32 v88, v240, v241
    v_cvt_pk_bf16_f32 v89, v242, v243
    v_exp_f32 v244, v244
    v_mfma_f32_32x32x16_bf16 a[32:47], a[16:19], v[72:75], a[32:47]
    global_load_dwordx4 a[116:119], v29, s[100:101] offset:2048 sc1
    v_exp_f32 v245, v245
    v_exp_f32 v246, v246
    v_exp_f32 v247, v247
    v_mfma_f32_32x32x16_bf16 a[32:47], a[20:23], v[76:79], a[32:47]
    global_load_dwordx4 a[120:123], v29, s[100:101] offset:3072 sc1
    v_cvt_pk_bf16_f32 v90, v244, v245
    v_cvt_pk_bf16_f32 v91, v246, v247
    v_exp_f32 v248, v248
    v_exp_f32 v249, v249
    v_exp_f32 v250, v250
    v_exp_f32 v251, v251
    v_cvt_pk_bf16_f32 v92, v248, v249
    v_cvt_pk_bf16_f32 v93, v250, v251
    v_smfmac_f32_16x16x64_bf16 a[64:67], a[72:75], v[72:79], v9
    global_load_dwordx4 a[124:127], v5, s[100:101] offset:0 sc1
    global_load_dwordx4 a[128:131], v5, s[100:101] offset:1024 sc1
    v_exp_f32 v252, v252
    v_exp_f32 v253, v253
    v_exp_f32 v254, v254
    v_exp_f32 v255, v255
    v_cvt_pk_bf16_f32 v94, v252, v253
    v_cvt_pk_bf16_f32 v95, v254, v255
    v_mfma_f32_32x32x16_bf16 v[240:255], a[0:3], v[80:83], v[144:159]
    global_load_dwordx4 a[132:135], v5, s[100:101] offset:2048 sc1
    v_exp_f32 v176, v176
    v_exp_f32 v177, v177
    v_exp_f32 v178, v178
    v_mfma_f32_32x32x16_bf16 v[240:255], a[4:7], v[84:87], v[240:255]
    ds_read_b128 a[0:3], v6 offset:12288
    v_exp_f32 v179, v179
    v_cvt_pk_bf16_f32 v72, v176, v177
    v_cvt_pk_bf16_f32 v73, v178, v179
    v_exp_f32 v180, v180
    v_mfma_f32_32x32x16_bf16 a[48:63], a[16:19], v[88:91], a[48:63]
    ds_read_b128 a[4:7], v6 offset:13312
    v_exp_f32 v181, v181
    v_exp_f32 v182, v182
    v_exp_f32 v183, v183
    v_mfma_f32_32x32x16_bf16 a[48:63], a[20:23], v[92:95], a[48:63]
    global_load_dwordx4 a[136:139], v5, s[100:101] offset:3072 sc1
    v_cvt_pk_bf16_f32 v74, v180, v181
    v_cvt_pk_bf16_f32 v75, v182, v183
    v_exp_f32 v184, v184
    v_exp_f32 v185, v185
    v_exp_f32 v186, v186
    v_exp_f32 v187, v187
    v_cvt_pk_bf16_f32 v76, v184, v185
    v_cvt_pk_bf16_f32 v77, v186, v187
    v_smfmac_f32_16x16x64_bf16 a[68:71], a[72:75], v[88:95], v9
    s_add_u32 s100, s100, 8192
    s_waitcnt lgkmcnt(0)
    v_exp_f32 v188, v188
    v_exp_f32 v189, v189
    v_exp_f32 v190, v190
    v_exp_f32 v191, v191
    v_cvt_pk_bf16_f32 v78, v188, v189
    v_cvt_pk_bf16_f32 v79, v190, v191
    v_mfma_f32_32x32x16_bf16 v[176:191], a[0:3], v[64:67], v[128:143]
    ds_read_b128 a[16:19], v6 offset:14336
    v_exp_f32 v240, v240
    v_exp_f32 v241, v241
    v_exp_f32 v242, v242
    v_mfma_f32_32x32x16_bf16 v[176:191], a[4:7], v[68:71], v[176:191]
    ds_read_b128 a[20:23], v6 offset:15360
    v_exp_f32 v243, v243
    v_cvt_pk_bf16_f32 v88, v240, v241
    v_cvt_pk_bf16_f32 v89, v242, v243
    v_exp_f32 v244, v244
    v_mfma_f32_32x32x16_bf16 a[32:47], a[8:11], v[72:75], a[32:47]
    s_addc_u32 s101, s101, 0
    v_exp_f32 v245, v245
    v_exp_f32 v246, v246
    v_exp_f32 v247, v247
    v_mfma_f32_32x32x16_bf16 a[32:47], a[12:15], v[76:79], a[32:47]
    global_load_dword v28, v0, s[70:71] offset:2048
    v_add_u32 v0, 4096, v0
    v_cvt_pk_bf16_f32 v90, v244, v245
    v_cvt_pk_bf16_f32 v91, v246, v247
    v_exp_f32 v248, v248
    v_exp_f32 v249, v249
    v_exp_f32 v250, v250
    v_exp_f32 v251, v251
    v_cvt_pk_bf16_f32 v92, v248, v249
    v_cvt_pk_bf16_f32 v93, v250, v251
    v_smfmac_f32_16x16x64_bf16 a[64:67], a[72:75], v[72:79], v9
    s_waitcnt vmcnt(9) lgkmcnt(0)
    s_barrier
    v_exp_f32 v252, v252
    v_exp_f32 v253, v253
    v_exp_f32 v254, v254
    v_exp_f32 v255, v255
    v_cvt_pk_bf16_f32 v94, v252, v253
    v_cvt_pk_bf16_f32 v95, v254, v255
    v_mfma_f32_32x32x16_bf16 v[240:255], a[0:3], v[80:83], v[144:159]
    s_add_u32 m0, s27, 98304
    v_exp_f32 v176, v176
    v_exp_f32 v177, v177
    v_exp_f32 v178, v178
    v_mfma_f32_32x32x16_bf16 v[240:255], a[4:7], v[84:87], v[240:255]
    ds_read_b128 a[0:3], v7 offset:0
    v_exp_f32 v179, v179
    v_cvt_pk_bf16_f32 v72, v176, v177
    v_cvt_pk_bf16_f32 v73, v178, v179
    v_exp_f32 v180, v180
    v_mfma_f32_32x32x16_bf16 a[48:63], a[8:11], v[88:91], a[48:63]
    ds_read_b128 a[4:7], v7 offset:1024
    v_exp_f32 v181, v181
    v_exp_f32 v182, v182
    v_exp_f32 v183, v183
    v_mfma_f32_32x32x16_bf16 a[48:63], a[12:15], v[92:95], a[48:63]
    global_load_lds_dwordx4 v29, s[98:99] offset:0 sc1
    v_cvt_pk_bf16_f32 v74, v180, v181
    v_cvt_pk_bf16_f32 v75, v182, v183
    v_exp_f32 v184, v184
    v_exp_f32 v185, v185
    v_exp_f32 v186, v186
    v_exp_f32 v187, v187
    v_cvt_pk_bf16_f32 v76, v184, v185
    v_cvt_pk_bf16_f32 v77, v186, v187
    v_smfmac_f32_16x16x64_bf16 a[68:71], a[72:75], v[88:95], v9
    global_load_lds_dwordx4 v29, s[98:99] offset:1024 sc1
    s_waitcnt lgkmcnt(0)
    v_exp_f32 v188, v188
    v_exp_f32 v189, v189
    v_exp_f32 v190, v190
    v_exp_f32 v191, v191
    v_cvt_pk_bf16_f32 v78, v188, v189
    v_cvt_pk_bf16_f32 v79, v190, v191
    v_mfma_f32_32x32x16_bf16 v[176:191], a[0:3], v[64:67], v[128:143]
    ds_read_b128 a[8:11], v7 offset:2048
    v_exp_f32 v240, v240
    v_exp_f32 v241, v241
    v_exp_f32 v242, v242
    v_mfma_f32_32x32x16_bf16 v[176:191], a[4:7], v[68:71], v[176:191]
    ds_read_b128 a[12:15], v7 offset:3072
    v_exp_f32 v243, v243
    v_cvt_pk_bf16_f32 v88, v240, v241
    v_cvt_pk_bf16_f32 v89, v242, v243
    v_exp_f32 v244, v244
    v_mfma_f32_32x32x16_bf16 a[32:47], a[16:19], v[72:75], a[32:47]
    global_load_lds_dwordx4 v29, s[98:99] offset:2048 sc1
    v_exp_f32 v245, v245
    v_exp_f32 v246, v246
    v_exp_f32 v247, v247
    v_mfma_f32_32x32x16_bf16 a[32:47], a[20:23], v[76:79], a[32:47]
    global_load_lds_dwordx4 v29, s[98:99] offset:3072 sc1
    v_cvt_pk_bf16_f32 v90, v244, v245
    v_cvt_pk_bf16_f32 v91, v246, v247
    v_exp_f32 v248, v248
    v_exp_f32 v249, v249
    v_exp_f32 v250, v250
    v_exp_f32 v251, v251
    v_cvt_pk_bf16_f32 v92, v248, v249
    v_cvt_pk_bf16_f32 v93, v250, v251
    v_smfmac_f32_16x16x64_bf16 a[64:67], a[72:75], v[72:79], v9
    s_add_u32 m0, s27, 102400
    s_nop 0
    global_load_lds_dwordx4 v5, s[98:99] offset:0 sc1
    v_exp_f32 v252, v252
    v_exp_f32 v253, v253
    v_exp_f32 v254, v254
    v_exp_f32 v255, v255
    v_cvt_pk_bf16_f32 v94, v252, v253
    v_cvt_pk_bf16_f32 v95, v254, v255
    v_mfma_f32_32x32x16_bf16 v[240:255], a[0:3], v[80:83], v[144:159]
    global_load_lds_dwordx4 v5, s[98:99] offset:1024 sc1
    v_exp_f32 v176, v176
    v_exp_f32 v177, v177
    v_exp_f32 v178, v178
    v_mfma_f32_32x32x16_bf16 v[240:255], a[4:7], v[84:87], v[240:255]
    ds_read_b128 a[0:3], v7 offset:8192
    v_exp_f32 v179, v179
    v_cvt_pk_bf16_f32 v72, v176, v177
    v_cvt_pk_bf16_f32 v73, v178, v179
    v_exp_f32 v180, v180
    v_mfma_f32_32x32x16_bf16 a[48:63], a[16:19], v[88:91], a[48:63]
    ds_read_b128 a[4:7], v7 offset:9216
    v_exp_f32 v181, v181
    v_exp_f32 v182, v182
    v_exp_f32 v183, v183
    v_mfma_f32_32x32x16_bf16 a[48:63], a[20:23], v[92:95], a[48:63]
    global_load_lds_dwordx4 v5, s[98:99] offset:2048 sc1
    v_cvt_pk_bf16_f32 v74, v180, v181
    v_cvt_pk_bf16_f32 v75, v182, v183
    v_exp_f32 v184, v184
    v_exp_f32 v185, v185
    v_exp_f32 v186, v186
    v_exp_f32 v187, v187
    v_cvt_pk_bf16_f32 v76, v184, v185
    v_cvt_pk_bf16_f32 v77, v186, v187
    v_smfmac_f32_16x16x64_bf16 a[68:71], a[72:75], v[88:95], v9
    global_load_lds_dwordx4 v5, s[98:99] offset:3072 sc1
    s_waitcnt lgkmcnt(0)
    v_exp_f32 v188, v188
    v_exp_f32 v189, v189
    v_exp_f32 v190, v190
    v_exp_f32 v191, v191
    v_cvt_pk_bf16_f32 v78, v188, v189
    v_cvt_pk_bf16_f32 v79, v190, v191
    v_mfma_f32_32x32x16_bf16 v[176:191], a[0:3], v[64:67], v[128:143]
    ds_read_b128 a[16:19], v7 offset:10240
    v_exp_f32 v240, v240
    v_exp_f32 v241, v241
    v_exp_f32 v242, v242
    v_mfma_f32_32x32x16_bf16 v[176:191], a[4:7], v[68:71], v[176:191]
    ds_read_b128 a[20:23], v7 offset:11264
    v_exp_f32 v243, v243
    v_cvt_pk_bf16_f32 v88, v240, v241
    v_cvt_pk_bf16_f32 v89, v242, v243
    v_exp_f32 v244, v244
    v_mfma_f32_32x32x16_bf16 a[32:47], a[8:11], v[72:75], a[32:47]
    s_add_u32 s36, s3, 11
    v_exp_f32 v245, v245
    v_exp_f32 v246, v246
    v_exp_f32 v247, v247
    v_mfma_f32_32x32x16_bf16 a[32:47], a[12:15], v[76:79], a[32:47]
    s_and_b32 s36, s36, 15
    v_cvt_pk_bf16_f32 v90, v244, v245
    v_cvt_pk_bf16_f32 v91, v246, v247
    v_exp_f32 v248, v248
    v_exp_f32 v249, v249
    v_exp_f32 v250, v250
    v_exp_f32 v251, v251
    v_cvt_pk_bf16_f32 v92, v248, v249
    v_cvt_pk_bf16_f32 v93, v250, v251
    v_smfmac_f32_16x16x64_bf16 a[64:67], a[72:75], v[72:79], v9
    s_lshl_b32 s36, s36, 15
    s_add_u32 s98, s84, s36
    v_exp_f32 v252, v252
    v_exp_f32 v253, v253
    v_exp_f32 v254, v254
    v_exp_f32 v255, v255
    v_cvt_pk_bf16_f32 v94, v252, v253
    v_cvt_pk_bf16_f32 v95, v254, v255
    v_mfma_f32_32x32x16_bf16 v[240:255], a[0:3], v[80:83], v[144:159]
    s_addc_u32 s99, s85, 0
    v_exp_f32 v176, v176
    v_exp_f32 v177, v177
    v_exp_f32 v178, v178
    v_mfma_f32_32x32x16_bf16 v[240:255], a[4:7], v[84:87], v[240:255]
    ds_read_b128 a[0:3], v7 offset:4096
    v_exp_f32 v179, v179
    v_cvt_pk_bf16_f32 v72, v176, v177
    v_cvt_pk_bf16_f32 v73, v178, v179
    v_exp_f32 v180, v180
    v_mfma_f32_32x32x16_bf16 a[48:63], a[8:11], v[88:91], a[48:63]
    ds_read_b128 a[4:7], v7 offset:5120
    v_exp_f32 v181, v181
    v_exp_f32 v182, v182
    v_exp_f32 v183, v183
    v_mfma_f32_32x32x16_bf16 a[48:63], a[12:15], v[92:95], a[48:63]
    global_load_dwordx4 a[140:143], v29, s[100:101] offset:0 sc1
    v_cvt_pk_bf16_f32 v74, v180, v181
    v_cvt_pk_bf16_f32 v75, v182, v183
    v_exp_f32 v184, v184
    v_exp_f32 v185, v185
    v_exp_f32 v186, v186
    v_exp_f32 v187, v187
    v_cvt_pk_bf16_f32 v76, v184, v185
    v_cvt_pk_bf16_f32 v77, v186, v187
    v_smfmac_f32_16x16x64_bf16 a[68:71], a[72:75], v[88:95], v9
    global_load_dwordx4 a[144:147], v29, s[100:101] offset:1024 sc1
    s_waitcnt lgkmcnt(0)
    v_exp_f32 v188, v188
    v_exp_f32 v189, v189
    v_exp_f32 v190, v190
    v_exp_f32 v191, v191
    v_cvt_pk_bf16_f32 v78, v188, v189
    v_cvt_pk_bf16_f32 v79, v190, v191
    v_mfma_f32_32x32x16_bf16 v[176:191], a[0:3], v[64:67], v[128:143]
    ds_read_b128 a[8:11], v7 offset:6144
    v_exp_f32 v240, v240
    v_exp_f32 v241, v241
    v_exp_f32 v242, v242
    v_mfma_f32_32x32x16_bf16 v[176:191], a[4:7], v[68:71], v[176:191]
    ds_read_b128 a[12:15], v7 offset:7168
    v_exp_f32 v243, v243
    v_cvt_pk_bf16_f32 v88, v240, v241
    v_cvt_pk_bf16_f32 v89, v242, v243
    v_exp_f32 v244, v244
    v_mfma_f32_32x32x16_bf16 a[32:47], a[16:19], v[72:75], a[32:47]
    global_load_dwordx4 a[148:151], v29, s[100:101] offset:2048 sc1
    v_exp_f32 v245, v245
    v_exp_f32 v246, v246
    v_exp_f32 v247, v247
    v_mfma_f32_32x32x16_bf16 a[32:47], a[20:23], v[76:79], a[32:47]
    global_load_dwordx4 a[152:155], v29, s[100:101] offset:3072 sc1
    v_cvt_pk_bf16_f32 v90, v244, v245
    v_cvt_pk_bf16_f32 v91, v246, v247
    v_exp_f32 v248, v248
    v_exp_f32 v249, v249
    v_exp_f32 v250, v250
    v_exp_f32 v251, v251
    v_cvt_pk_bf16_f32 v92, v248, v249
    v_cvt_pk_bf16_f32 v93, v250, v251
    v_smfmac_f32_16x16x64_bf16 a[64:67], a[72:75], v[72:79], v9
    global_load_dwordx4 a[156:159], v5, s[100:101] offset:0 sc1
    global_load_dwordx4 a[160:163], v5, s[100:101] offset:1024 sc1
    v_exp_f32 v252, v252
    v_exp_f32 v253, v253
    v_exp_f32 v254, v254
    v_exp_f32 v255, v255
    v_cvt_pk_bf16_f32 v94, v252, v253
    v_cvt_pk_bf16_f32 v95, v254, v255
    v_mfma_f32_32x32x16_bf16 v[240:255], a[0:3], v[80:83], v[144:159]
    global_load_dwordx4 a[164:167], v5, s[100:101] offset:2048 sc1
    v_exp_f32 v176, v176
    v_exp_f32 v177, v177
    v_exp_f32 v178, v178
    v_mfma_f32_32x32x16_bf16 v[240:255], a[4:7], v[84:87], v[240:255]
    ds_read_b128 a[0:3], v7 offset:12288
    v_exp_f32 v179, v179
    v_cvt_pk_bf16_f32 v72, v176, v177
    v_cvt_pk_bf16_f32 v73, v178, v179
    v_exp_f32 v180, v180
    v_mfma_f32_32x32x16_bf16 a[48:63], a[16:19], v[88:91], a[48:63]
    ds_read_b128 a[4:7], v7 offset:13312
    v_exp_f32 v181, v181
    v_exp_f32 v182, v182
    v_exp_f32 v183, v183
    v_mfma_f32_32x32x16_bf16 a[48:63], a[20:23], v[92:95], a[48:63]
    global_load_dwordx4 a[168:171], v5, s[100:101] offset:3072 sc1
    v_cvt_pk_bf16_f32 v74, v180, v181
    v_cvt_pk_bf16_f32 v75, v182, v183
    v_exp_f32 v184, v184
    v_exp_f32 v185, v185
    v_exp_f32 v186, v186
    v_exp_f32 v187, v187
    v_cvt_pk_bf16_f32 v76, v184, v185
    v_cvt_pk_bf16_f32 v77, v186, v187
    v_smfmac_f32_16x16x64_bf16 a[68:71], a[72:75], v[88:95], v9
    s_add_u32 s100, s100, 8192
    s_waitcnt lgkmcnt(0)
    v_exp_f32 v188, v188
    v_exp_f32 v189, v189
    v_exp_f32 v190, v190
    v_exp_f32 v191, v191
    v_cvt_pk_bf16_f32 v78, v188, v189
    v_cvt_pk_bf16_f32 v79, v190, v191
    v_mfma_f32_32x32x16_bf16 v[176:191], a[0:3], v[64:67], v[128:143]
    ds_read_b128 a[16:19], v7 offset:14336
    v_exp_f32 v240, v240
    v_exp_f32 v241, v241
    v_exp_f32 v242, v242
    v_mfma_f32_32x32x16_bf16 v[176:191], a[4:7], v[68:71], v[176:191]
    ds_read_b128 a[20:23], v7 offset:15360
    v_exp_f32 v243, v243
    v_cvt_pk_bf16_f32 v88, v240, v241
    v_cvt_pk_bf16_f32 v89, v242, v243
    v_exp_f32 v244, v244
    v_mfma_f32_32x32x16_bf16 a[32:47], a[8:11], v[72:75], a[32:47]
    s_addc_u32 s101, s101, 0
    v_exp_f32 v245, v245
    v_exp_f32 v246, v246
    v_exp_f32 v247, v247
    v_mfma_f32_32x32x16_bf16 a[32:47], a[12:15], v[76:79], a[32:47]
    global_load_dword v28, v0, s[70:71] offset:0
    v_cvt_pk_bf16_f32 v90, v244, v245
    v_cvt_pk_bf16_f32 v91, v246, v247
    v_exp_f32 v248, v248
    v_exp_f32 v249, v249
    v_exp_f32 v250, v250
    v_exp_f32 v251, v251
    v_cvt_pk_bf16_f32 v92, v248, v249
    v_cvt_pk_bf16_f32 v93, v250, v251
    v_smfmac_f32_16x16x64_bf16 a[64:67], a[72:75], v[72:79], v9
    s_waitcnt vmcnt(9) lgkmcnt(0)
    s_barrier
    v_exp_f32 v252, v252
    v_exp_f32 v253, v253
    v_exp_f32 v254, v254
    v_exp_f32 v255, v255
    v_cvt_pk_bf16_f32 v94, v252, v253
    v_cvt_pk_bf16_f32 v95, v254, v255
    v_mfma_f32_32x32x16_bf16 v[240:255], a[0:3], v[80:83], v[144:159]
    s_add_u32 m0, s27, 131072
    v_exp_f32 v176, v176
    v_exp_f32 v177, v177
    v_exp_f32 v178, v178
    v_mfma_f32_32x32x16_bf16 v[240:255], a[4:7], v[84:87], v[240:255]
    ds_read_b128 a[0:3], v6 offset:0
    v_exp_f32 v179, v179
    v_cvt_pk_bf16_f32 v72, v176, v177
    v_cvt_pk_bf16_f32 v73, v178, v179
    v_exp_f32 v180, v180
    v_mfma_f32_32x32x16_bf16 a[48:63], a[8:11], v[88:91], a[48:63]
    ds_read_b128 a[4:7], v6 offset:1024
    v_exp_f32 v181, v181
    v_exp_f32 v182, v182
    v_exp_f32 v183, v183
    v_mfma_f32_32x32x16_bf16 a[48:63], a[12:15], v[92:95], a[48:63]
    global_load_lds_dwordx4 v29, s[98:99] offset:0 sc1
    v_cvt_pk_bf16_f32 v74, v180, v181
    v_cvt_pk_bf16_f32 v75, v182, v183
    v_exp_f32 v184, v184
    v_exp_f32 v185, v185
    v_exp_f32 v186, v186
    v_exp_f32 v187, v187
    v_cvt_pk_bf16_f32 v76, v184, v185
    v_cvt_pk_bf16_f32 v77, v186, v187
    v_smfmac_f32_16x16x64_bf16 a[68:71], a[72:75], v[88:95], v9
    global_load_lds_dwordx4 v29, s[98:99] offset:1024 sc1
    s_waitcnt lgkmcnt(0)
    v_exp_f32 v188, v188
    v_exp_f32 v189, v189
    v_exp_f32 v190, v190
    v_exp_f32 v191, v191
    v_cvt_pk_bf16_f32 v78, v188, v189
    v_cvt_pk_bf16_f32 v79, v190, v191
    v_mfma_f32_32x32x16_bf16 v[176:191], a[0:3], v[64:67], v[128:143]
    ds_read_b128 a[8:11], v6 offset:2048
    v_exp_f32 v240, v240
    v_exp_f32 v241, v241
    v_exp_f32 v242, v242
    v_mfma_f32_32x32x16_bf16 v[176:191], a[4:7], v[68:71], v[176:191]
    ds_read_b128 a[12:15], v6 offset:3072
    v_exp_f32 v243, v243
    v_cvt_pk_bf16_f32 v88, v240, v241
    v_cvt_pk_bf16_f32 v89, v242, v243
    v_exp_f32 v244, v244
    v_mfma_f32_32x32x16_bf16 a[32:47], a[16:19], v[72:75], a[32:47]
    global_load_lds_dwordx4 v29, s[98:99] offset:2048 sc1
    v_exp_f32 v245, v245
    v_exp_f32 v246, v246
    v_exp_f32 v247, v247
    v_mfma_f32_32x32x16_bf16 a[32:47], a[20:23], v[76:79], a[32:47]
    global_load_lds_dwordx4 v29, s[98:99] offset:3072 sc1
    v_cvt_pk_bf16_f32 v90, v244, v245
    v_cvt_pk_bf16_f32 v91, v246, v247
    v_exp_f32 v248, v248
    v_exp_f32 v249, v249
    v_exp_f32 v250, v250
    v_exp_f32 v251, v251
    v_cvt_pk_bf16_f32 v92, v248, v249
    v_cvt_pk_bf16_f32 v93, v250, v251
    v_smfmac_f32_16x16x64_bf16 a[64:67], a[72:75], v[72:79], v9
    s_add_u32 m0, s27, 135168
    s_nop 0
    global_load_lds_dwordx4 v5, s[98:99] offset:0 sc1
    v_exp_f32 v252, v252
    v_exp_f32 v253, v253
    v_exp_f32 v254, v254
    v_exp_f32 v255, v255
    v_cvt_pk_bf16_f32 v94, v252, v253
    v_cvt_pk_bf16_f32 v95, v254, v255
    v_mfma_f32_32x32x16_bf16 v[240:255], a[0:3], v[80:83], v[144:159]
    global_load_lds_dwordx4 v5, s[98:99] offset:1024 sc1
    v_exp_f32 v176, v176
    v_exp_f32 v177, v177
    v_exp_f32 v178, v178
    v_mfma_f32_32x32x16_bf16 v[240:255], a[4:7], v[84:87], v[240:255]
    ds_read_b128 a[0:3], v6 offset:8192
    v_exp_f32 v179, v179
    v_cvt_pk_bf16_f32 v72, v176, v177
    v_cvt_pk_bf16_f32 v73, v178, v179
    v_exp_f32 v180, v180
    v_mfma_f32_32x32x16_bf16 a[48:63], a[16:19], v[88:91], a[48:63]
    ds_read_b128 a[4:7], v6 offset:9216
    v_exp_f32 v181, v181
    v_exp_f32 v182, v182
    v_exp_f32 v183, v183
    v_mfma_f32_32x32x16_bf16 a[48:63], a[20:23], v[92:95], a[48:63]
    global_load_lds_dwordx4 v5, s[98:99] offset:2048 sc1
    v_cvt_pk_bf16_f32 v74, v180, v181
    v_cvt_pk_bf16_f32 v75, v182, v183
    v_exp_f32 v184, v184
    v_exp_f32 v185, v185
    v_exp_f32 v186, v186
    v_exp_f32 v187, v187
    v_cvt_pk_bf16_f32 v76, v184, v185
    v_cvt_pk_bf16_f32 v77, v186, v187
    v_smfmac_f32_16x16x64_bf16 a[68:71], a[72:75], v[88:95], v9
    global_load_lds_dwordx4 v5, s[98:99] offset:3072 sc1
    s_waitcnt lgkmcnt(0)
    v_exp_f32 v188, v188
    v_exp_f32 v189, v189
    v_exp_f32 v190, v190
    v_exp_f32 v191, v191
    v_cvt_pk_bf16_f32 v78, v188, v189
    v_cvt_pk_bf16_f32 v79, v190, v191
    v_mfma_f32_32x32x16_bf16 v[176:191], a[0:3], v[64:67], v[128:143]
    ds_read_b128 a[16:19], v6 offset:10240
    v_exp_f32 v240, v240
    v_exp_f32 v241, v241
    v_exp_f32 v242, v242
    v_mfma_f32_32x32x16_bf16 v[176:191], a[4:7], v[68:71], v[176:191]
    ds_read_b128 a[20:23], v6 offset:11264
    v_exp_f32 v243, v243
    v_cvt_pk_bf16_f32 v88, v240, v241
    v_cvt_pk_bf16_f32 v89, v242, v243
    v_exp_f32 v244, v244
    v_mfma_f32_32x32x16_bf16 a[32:47], a[8:11], v[72:75], a[32:47]
    s_add_u32 s36, s3, 12
    v_exp_f32 v245, v245
    v_exp_f32 v246, v246
    v_exp_f32 v247, v247
    v_mfma_f32_32x32x16_bf16 a[32:47], a[12:15], v[76:79], a[32:47]
    s_and_b32 s36, s36, 15
    v_cvt_pk_bf16_f32 v90, v244, v245
    v_cvt_pk_bf16_f32 v91, v246, v247
    v_exp_f32 v248, v248
    v_exp_f32 v249, v249
    v_exp_f32 v250, v250
    v_exp_f32 v251, v251
    v_cvt_pk_bf16_f32 v92, v248, v249
    v_cvt_pk_bf16_f32 v93, v250, v251
    v_smfmac_f32_16x16x64_bf16 a[64:67], a[72:75], v[72:79], v9
    s_lshl_b32 s36, s36, 15
    s_add_u32 s98, s84, s36
    v_exp_f32 v252, v252
    v_exp_f32 v253, v253
    v_exp_f32 v254, v254
    v_exp_f32 v255, v255
    v_cvt_pk_bf16_f32 v94, v252, v253
    v_cvt_pk_bf16_f32 v95, v254, v255
    v_mfma_f32_32x32x16_bf16 v[240:255], a[0:3], v[80:83], v[144:159]
    s_addc_u32 s99, s85, 0
    v_exp_f32 v176, v176
    v_exp_f32 v177, v177
    v_exp_f32 v178, v178
    v_mfma_f32_32x32x16_bf16 v[240:255], a[4:7], v[84:87], v[240:255]
    ds_read_b128 a[0:3], v6 offset:4096
    v_exp_f32 v179, v179
    v_cvt_pk_bf16_f32 v72, v176, v177
    v_cvt_pk_bf16_f32 v73, v178, v179
    v_exp_f32 v180, v180
    v_mfma_f32_32x32x16_bf16 a[48:63], a[8:11], v[88:91], a[48:63]
    ds_read_b128 a[4:7], v6 offset:5120
    v_exp_f32 v181, v181
    v_exp_f32 v182, v182
    v_exp_f32 v183, v183
    v_mfma_f32_32x32x16_bf16 a[48:63], a[12:15], v[92:95], a[48:63]
    global_load_dwordx4 a[172:175], v29, s[100:101] offset:0 sc1
    v_cvt_pk_bf16_f32 v74, v180, v181
    v_cvt_pk_bf16_f32 v75, v182, v183
    v_exp_f32 v184, v184
    v_exp_f32 v185, v185
    v_exp_f32 v186, v186
    v_exp_f32 v187, v187
    v_cvt_pk_bf16_f32 v76, v184, v185
    v_cvt_pk_bf16_f32 v77, v186, v187
    v_smfmac_f32_16x16x64_bf16 a[68:71], a[72:75], v[88:95], v9
    global_load_dwordx4 a[176:179], v29, s[100:101] offset:1024 sc1
    s_waitcnt lgkmcnt(0)
    v_exp_f32 v188, v188
    v_exp_f32 v189, v189
    v_exp_f32 v190, v190
    v_exp_f32 v191, v191
    v_cvt_pk_bf16_f32 v78, v188, v189
    v_cvt_pk_bf16_f32 v79, v190, v191
    v_mfma_f32_32x32x16_bf16 v[176:191], a[0:3], v[64:67], v[128:143]
    ds_read_b128 a[8:11], v6 offset:6144
    v_exp_f32 v240, v240
    v_exp_f32 v241, v241
    v_exp_f32 v242, v242
    v_mfma_f32_32x32x16_bf16 v[176:191], a[4:7], v[68:71], v[176:191]
    ds_read_b128 a[12:15], v6 offset:7168
    v_exp_f32 v243, v243
    v_cvt_pk_bf16_f32 v88, v240, v241
    v_cvt_pk_bf16_f32 v89, v242, v243
    v_exp_f32 v244, v244
    v_mfma_f32_32x32x16_bf16 a[32:47], a[16:19], v[72:75], a[32:47]
    global_load_dwordx4 a[180:183], v29, s[100:101] offset:2048 sc1
    v_exp_f32 v245, v245
    v_exp_f32 v246, v246
    v_exp_f32 v247, v247
    v_mfma_f32_32x32x16_bf16 a[32:47], a[20:23], v[76:79], a[32:47]
    global_load_dwordx4 a[184:187], v29, s[100:101] offset:3072 sc1
    v_cvt_pk_bf16_f32 v90, v244, v245
    v_cvt_pk_bf16_f32 v91, v246, v247
    v_exp_f32 v248, v248
    v_exp_f32 v249, v249
    v_exp_f32 v250, v250
    v_exp_f32 v251, v251
    v_cvt_pk_bf16_f32 v92, v248, v249
    v_cvt_pk_bf16_f32 v93, v250, v251
    v_smfmac_f32_16x16x64_bf16 a[64:67], a[72:75], v[72:79], v9
    global_load_dwordx4 a[188:191], v5, s[100:101] offset:0 sc1
    global_load_dwordx4 a[192:195], v5, s[100:101] offset:1024 sc1
    v_exp_f32 v252, v252
    v_exp_f32 v253, v253
    v_exp_f32 v254, v254
    v_exp_f32 v255, v255
    v_cvt_pk_bf16_f32 v94, v252, v253
    v_cvt_pk_bf16_f32 v95, v254, v255
    v_mfma_f32_32x32x16_bf16 v[240:255], a[0:3], v[80:83], v[144:159]
    global_load_dwordx4 a[196:199], v5, s[100:101] offset:2048 sc1
    v_exp_f32 v176, v176
    v_exp_f32 v177, v177
    v_exp_f32 v178, v178
    v_mfma_f32_32x32x16_bf16 v[240:255], a[4:7], v[84:87], v[240:255]
    ds_read_b128 a[0:3], v6 offset:12288
    v_exp_f32 v179, v179
    v_cvt_pk_bf16_f32 v72, v176, v177
    v_cvt_pk_bf16_f32 v73, v178, v179
    v_exp_f32 v180, v180
    v_mfma_f32_32x32x16_bf16 a[48:63], a[16:19], v[88:91], a[48:63]
    ds_read_b128 a[4:7], v6 offset:13312
    v_exp_f32 v181, v181
    v_exp_f32 v182, v182
    v_exp_f32 v183, v183
    v_mfma_f32_32x32x16_bf16 a[48:63], a[20:23], v[92:95], a[48:63]
    global_load_dwordx4 a[200:203], v5, s[100:101] offset:3072 sc1
    v_cvt_pk_bf16_f32 v74, v180, v181
    v_cvt_pk_bf16_f32 v75, v182, v183
    v_exp_f32 v184, v184
    v_exp_f32 v185, v185
    v_exp_f32 v186, v186
    v_exp_f32 v187, v187
    v_cvt_pk_bf16_f32 v76, v184, v185
    v_cvt_pk_bf16_f32 v77, v186, v187
    v_smfmac_f32_16x16x64_bf16 a[68:71], a[72:75], v[88:95], v9
    s_add_u32 s100, s100, 8192
    s_waitcnt lgkmcnt(0)
    v_exp_f32 v188, v188
    v_exp_f32 v189, v189
    v_exp_f32 v190, v190
    v_exp_f32 v191, v191
    v_cvt_pk_bf16_f32 v78, v188, v189
    v_cvt_pk_bf16_f32 v79, v190, v191
    v_mfma_f32_32x32x16_bf16 v[176:191], a[0:3], v[64:67], v[128:143]
    ds_read_b128 a[16:19], v6 offset:14336
    v_exp_f32 v240, v240
    v_exp_f32 v241, v241
    v_exp_f32 v242, v242
    v_mfma_f32_32x32x16_bf16 v[176:191], a[4:7], v[68:71], v[176:191]
    ds_read_b128 a[20:23], v6 offset:15360
    v_exp_f32 v243, v243
    v_cvt_pk_bf16_f32 v88, v240, v241
    v_cvt_pk_bf16_f32 v89, v242, v243
    v_exp_f32 v244, v244
    v_mfma_f32_32x32x16_bf16 a[32:47], a[8:11], v[72:75], a[32:47]
    s_addc_u32 s101, s101, 0
    v_exp_f32 v245, v245
    v_exp_f32 v246, v246
    v_exp_f32 v247, v247
    v_mfma_f32_32x32x16_bf16 a[32:47], a[12:15], v[76:79], a[32:47]
    global_load_dword v28, v0, s[70:71] offset:2048
    v_add_u32 v0, 4096, v0
    v_cvt_pk_bf16_f32 v90, v244, v245
    v_cvt_pk_bf16_f32 v91, v246, v247
    v_exp_f32 v248, v248
    v_exp_f32 v249, v249
    v_exp_f32 v250, v250
    v_exp_f32 v251, v251
    v_cvt_pk_bf16_f32 v92, v248, v249
    v_cvt_pk_bf16_f32 v93, v250, v251
    v_smfmac_f32_16x16x64_bf16 a[64:67], a[72:75], v[72:79], v9
    s_waitcnt vmcnt(9) lgkmcnt(0)
    s_barrier
    v_exp_f32 v252, v252
    v_exp_f32 v253, v253
    v_exp_f32 v254, v254
    v_exp_f32 v255, v255
    v_cvt_pk_bf16_f32 v94, v252, v253
    v_cvt_pk_bf16_f32 v95, v254, v255
    v_mfma_f32_32x32x16_bf16 v[240:255], a[0:3], v[80:83], v[144:159]
    s_add_u32 m0, s27, 98304
    v_exp_f32 v176, v176
    v_exp_f32 v177, v177
    v_exp_f32 v178, v178
    v_mfma_f32_32x32x16_bf16 v[240:255], a[4:7], v[84:87], v[240:255]
    ds_read_b128 a[0:3], v7 offset:0
    v_exp_f32 v179, v179
    v_cvt_pk_bf16_f32 v72, v176, v177
    v_cvt_pk_bf16_f32 v73, v178, v179
    v_exp_f32 v180, v180
    v_mfma_f32_32x32x16_bf16 a[48:63], a[8:11], v[88:91], a[48:63]
    ds_read_b128 a[4:7], v7 offset:1024
    v_exp_f32 v181, v181
    v_exp_f32 v182, v182
    v_exp_f32 v183, v183
    v_mfma_f32_32x32x16_bf16 a[48:63], a[12:15], v[92:95], a[48:63]
    global_load_lds_dwordx4 v29, s[98:99] offset:0 sc1
    v_cvt_pk_bf16_f32 v74, v180, v181
    v_cvt_pk_bf16_f32 v75, v182, v183
    v_exp_f32 v184, v184
    v_exp_f32 v185, v185
    v_exp_f32 v186, v186
    v_exp_f32 v187, v187
    v_cvt_pk_bf16_f32 v76, v184, v185
    v_cvt_pk_bf16_f32 v77, v186, v187
    v_smfmac_f32_16x16x64_bf16 a[68:71], a[72:75], v[88:95], v9
    global_load_lds_dwordx4 v29, s[98:99] offset:1024 sc1
    s_waitcnt lgkmcnt(0)
    v_exp_f32 v188, v188
    v_exp_f32 v189, v189
    v_exp_f32 v190, v190
    v_exp_f32 v191, v191
    v_cvt_pk_bf16_f32 v78, v188, v189
    v_cvt_pk_bf16_f32 v79, v190, v191
    v_mfma_f32_32x32x16_bf16 v[176:191], a[0:3], v[64:67], v[128:143]
    ds_read_b128 a[8:11], v7 offset:2048
    v_exp_f32 v240, v240
    v_exp_f32 v241, v241
    v_exp_f32 v242, v242
    v_mfma_f32_32x32x16_bf16 v[176:191], a[4:7], v[68:71], v[176:191]
    ds_read_b128 a[12:15], v7 offset:3072
    v_exp_f32 v243, v243
    v_cvt_pk_bf16_f32 v88, v240, v241
    v_cvt_pk_bf16_f32 v89, v242, v243
    v_exp_f32 v244, v244
    v_mfma_f32_32x32x16_bf16 a[32:47], a[16:19], v[72:75], a[32:47]
    global_load_lds_dwordx4 v29, s[98:99] offset:2048 sc1
    v_exp_f32 v245, v245
    v_exp_f32 v246, v246
    v_exp_f32 v247, v247
    v_mfma_f32_32x32x16_bf16 a[32:47], a[20:23], v[76:79], a[32:47]
    global_load_lds_dwordx4 v29, s[98:99] offset:3072 sc1
    v_cvt_pk_bf16_f32 v90, v244, v245
    v_cvt_pk_bf16_f32 v91, v246, v247
    v_exp_f32 v248, v248
    v_exp_f32 v249, v249
    v_exp_f32 v250, v250
    v_exp_f32 v251, v251
    v_cvt_pk_bf16_f32 v92, v248, v249
    v_cvt_pk_bf16_f32 v93, v250, v251
    v_smfmac_f32_16x16x64_bf16 a[64:67], a[72:75], v[72:79], v9
    s_add_u32 m0, s27, 102400
    s_nop 0
    global_load_lds_dwordx4 v5, s[98:99] offset:0 sc1
    v_exp_f32 v252, v252
    v_exp_f32 v253, v253
    v_exp_f32 v254, v254
    v_exp_f32 v255, v255
    v_cvt_pk_bf16_f32 v94, v252, v253
    v_cvt_pk_bf16_f32 v95, v254, v255
    v_mfma_f32_32x32x16_bf16 v[240:255], a[0:3], v[80:83], v[144:159]
    global_load_lds_dwordx4 v5, s[98:99] offset:1024 sc1
    v_exp_f32 v176, v176
    v_exp_f32 v177, v177
    v_exp_f32 v178, v178
    v_mfma_f32_32x32x16_bf16 v[240:255], a[4:7], v[84:87], v[240:255]
    ds_read_b128 a[0:3], v7 offset:8192
    v_exp_f32 v179, v179
    v_cvt_pk_bf16_f32 v72, v176, v177
    v_cvt_pk_bf16_f32 v73, v178, v179
    v_exp_f32 v180, v180
    v_mfma_f32_32x32x16_bf16 a[48:63], a[16:19], v[88:91], a[48:63]
    ds_read_b128 a[4:7], v7 offset:9216
    v_exp_f32 v181, v181
    v_exp_f32 v182, v182
    v_exp_f32 v183, v183
    v_mfma_f32_32x32x16_bf16 a[48:63], a[20:23], v[92:95], a[48:63]
    global_load_lds_dwordx4 v5, s[98:99] offset:2048 sc1
    v_cvt_pk_bf16_f32 v74, v180, v181
    v_cvt_pk_bf16_f32 v75, v182, v183
    v_exp_f32 v184, v184
    v_exp_f32 v185, v185
    v_exp_f32 v186, v186
    v_exp_f32 v187, v187
    v_cvt_pk_bf16_f32 v76, v184, v185
    v_cvt_pk_bf16_f32 v77, v186, v187
    v_smfmac_f32_16x16x64_bf16 a[68:71], a[72:75], v[88:95], v9
    global_load_lds_dwordx4 v5, s[98:99] offset:3072 sc1
    s_waitcnt lgkmcnt(0)
    v_exp_f32 v188, v188
    v_exp_f32 v189, v189
    v_exp_f32 v190, v190
    v_exp_f32 v191, v191
    v_cvt_pk_bf16_f32 v78, v188, v189
    v_cvt_pk_bf16_f32 v79, v190, v191
    v_mfma_f32_32x32x16_bf16 v[176:191], a[0:3], v[64:67], v[128:143]
    ds_read_b128 a[16:19], v7 offset:10240
    v_exp_f32 v240, v240
    v_exp_f32 v241, v241
    v_exp_f32 v242, v242
    v_mfma_f32_32x32x16_bf16 v[176:191], a[4:7], v[68:71], v[176:191]
    ds_read_b128 a[20:23], v7 offset:11264
    v_exp_f32 v243, v243
    v_cvt_pk_bf16_f32 v88, v240, v241
    v_cvt_pk_bf16_f32 v89, v242, v243
    v_exp_f32 v244, v244
    v_mfma_f32_32x32x16_bf16 a[32:47], a[8:11], v[72:75], a[32:47]
    s_add_u32 s36, s3, 13
    v_exp_f32 v245, v245
    v_exp_f32 v246, v246
    v_exp_f32 v247, v247
    v_mfma_f32_32x32x16_bf16 a[32:47], a[12:15], v[76:79], a[32:47]
    s_and_b32 s36, s36, 15
    v_cvt_pk_bf16_f32 v90, v244, v245
    v_cvt_pk_bf16_f32 v91, v246, v247
    v_exp_f32 v248, v248
    v_exp_f32 v249, v249
    v_exp_f32 v250, v250
    v_exp_f32 v251, v251
    v_cvt_pk_bf16_f32 v92, v248, v249
    v_cvt_pk_bf16_f32 v93, v250, v251
    v_smfmac_f32_16x16x64_bf16 a[64:67], a[72:75], v[72:79], v9
    s_lshl_b32 s36, s36, 15
    s_add_u32 s98, s84, s36
    v_exp_f32 v252, v252
    v_exp_f32 v253, v253
    v_exp_f32 v254, v254
    v_exp_f32 v255, v255
    v_cvt_pk_bf16_f32 v94, v252, v253
    v_cvt_pk_bf16_f32 v95, v254, v255
    v_mfma_f32_32x32x16_bf16 v[240:255], a[0:3], v[80:83], v[144:159]
    s_addc_u32 s99, s85, 0
    v_exp_f32 v176, v176
    v_exp_f32 v177, v177
    v_exp_f32 v178, v178
    v_mfma_f32_32x32x16_bf16 v[240:255], a[4:7], v[84:87], v[240:255]
    ds_read_b128 a[0:3], v7 offset:4096
    v_exp_f32 v179, v179
    v_cvt_pk_bf16_f32 v72, v176, v177
    v_cvt_pk_bf16_f32 v73, v178, v179
    v_exp_f32 v180, v180
    v_mfma_f32_32x32x16_bf16 a[48:63], a[8:11], v[88:91], a[48:63]
    ds_read_b128 a[4:7], v7 offset:5120
    v_exp_f32 v181, v181
    v_exp_f32 v182, v182
    v_exp_f32 v183, v183
    v_mfma_f32_32x32x16_bf16 a[48:63], a[12:15], v[92:95], a[48:63]
    global_load_dwordx4 a[204:207], v29, s[100:101] offset:0 sc1
    v_cvt_pk_bf16_f32 v74, v180, v181
    v_cvt_pk_bf16_f32 v75, v182, v183
    v_exp_f32 v184, v184
    v_exp_f32 v185, v185
    v_exp_f32 v186, v186
    v_exp_f32 v187, v187
    v_cvt_pk_bf16_f32 v76, v184, v185
    v_cvt_pk_bf16_f32 v77, v186, v187
    v_smfmac_f32_16x16x64_bf16 a[68:71], a[72:75], v[88:95], v9
    global_load_dwordx4 a[208:211], v29, s[100:101] offset:1024 sc1
    s_waitcnt lgkmcnt(0)
    v_exp_f32 v188, v188
    v_exp_f32 v189, v189
    v_exp_f32 v190, v190
    v_exp_f32 v191, v191
    v_cvt_pk_bf16_f32 v78, v188, v189
    v_cvt_pk_bf16_f32 v79, v190, v191
    v_mfma_f32_32x32x16_bf16 v[176:191], a[0:3], v[64:67], v[128:143]
    ds_read_b128 a[8:11], v7 offset:6144
    v_exp_f32 v240, v240
    v_exp_f32 v241, v241
    v_exp_f32 v242, v242
    v_mfma_f32_32x32x16_bf16 v[176:191], a[4:7], v[68:71], v[176:191]
    ds_read_b128 a[12:15], v7 offset:7168
    v_exp_f32 v243, v243
    v_cvt_pk_bf16_f32 v88, v240, v241
    v_cvt_pk_bf16_f32 v89, v242, v243
    v_exp_f32 v244, v244
    v_mfma_f32_32x32x16_bf16 a[32:47], a[16:19], v[72:75], a[32:47]
    global_load_dwordx4 a[212:215], v29, s[100:101] offset:2048 sc1
    v_exp_f32 v245, v245
    v_exp_f32 v246, v246
    v_exp_f32 v247, v247
    v_mfma_f32_32x32x16_bf16 a[32:47], a[20:23], v[76:79], a[32:47]
    global_load_dwordx4 a[216:219], v29, s[100:101] offset:3072 sc1
    v_cvt_pk_bf16_f32 v90, v244, v245
    v_cvt_pk_bf16_f32 v91, v246, v247
    v_exp_f32 v248, v248
    v_exp_f32 v249, v249
    v_exp_f32 v250, v250
    v_exp_f32 v251, v251
    v_cvt_pk_bf16_f32 v92, v248, v249
    v_cvt_pk_bf16_f32 v93, v250, v251
    v_smfmac_f32_16x16x64_bf16 a[64:67], a[72:75], v[72:79], v9
    global_load_dwordx4 a[220:223], v5, s[100:101] offset:0 sc1
    global_load_dwordx4 a[224:227], v5, s[100:101] offset:1024 sc1
    v_exp_f32 v252, v252
    v_exp_f32 v253, v253
    v_exp_f32 v254, v254
    v_exp_f32 v255, v255
    v_cvt_pk_bf16_f32 v94, v252, v253
    v_cvt_pk_bf16_f32 v95, v254, v255
    v_mfma_f32_32x32x16_bf16 v[240:255], a[0:3], v[80:83], v[144:159]
    global_load_dwordx4 a[228:231], v5, s[100:101] offset:2048 sc1
    v_exp_f32 v176, v176
    v_exp_f32 v177, v177
    v_exp_f32 v178, v178
    v_mfma_f32_32x32x16_bf16 v[240:255], a[4:7], v[84:87], v[240:255]
    ds_read_b128 a[0:3], v7 offset:12288
    v_exp_f32 v179, v179
    v_cvt_pk_bf16_f32 v72, v176, v177
    v_cvt_pk_bf16_f32 v73, v178, v179
    v_exp_f32 v180, v180
    v_mfma_f32_32x32x16_bf16 a[48:63], a[16:19], v[88:91], a[48:63]
    ds_read_b128 a[4:7], v7 offset:13312
    v_exp_f32 v181, v181
    v_exp_f32 v182, v182
    v_exp_f32 v183, v183
    v_mfma_f32_32x32x16_bf16 a[48:63], a[20:23], v[92:95], a[48:63]
    global_load_dwordx4 a[232:235], v5, s[100:101] offset:3072 sc1
    v_cvt_pk_bf16_f32 v74, v180, v181
    v_cvt_pk_bf16_f32 v75, v182, v183
    v_exp_f32 v184, v184
    v_exp_f32 v185, v185
    v_exp_f32 v186, v186
    v_exp_f32 v187, v187
    v_cvt_pk_bf16_f32 v76, v184, v185
    v_cvt_pk_bf16_f32 v77, v186, v187
    v_smfmac_f32_16x16x64_bf16 a[68:71], a[72:75], v[88:95], v9
    s_add_u32 s100, s100, 8192
    s_waitcnt lgkmcnt(0)
    v_exp_f32 v188, v188
    v_exp_f32 v189, v189
    v_exp_f32 v190, v190
    v_exp_f32 v191, v191
    v_cvt_pk_bf16_f32 v78, v188, v189
    v_cvt_pk_bf16_f32 v79, v190, v191
    v_mfma_f32_32x32x16_bf16 v[176:191], a[0:3], v[64:67], v[128:143]
    ds_read_b128 a[16:19], v7 offset:14336
    v_exp_f32 v240, v240
    v_exp_f32 v241, v241
    v_exp_f32 v242, v242
    v_mfma_f32_32x32x16_bf16 v[176:191], a[4:7], v[68:71], v[176:191]
    ds_read_b128 a[20:23], v7 offset:15360
    v_exp_f32 v243, v243
    v_cvt_pk_bf16_f32 v88, v240, v241
    v_cvt_pk_bf16_f32 v89, v242, v243
    v_exp_f32 v244, v244
    v_mfma_f32_32x32x16_bf16 a[32:47], a[8:11], v[72:75], a[32:47]
    s_addc_u32 s101, s101, 0
    v_exp_f32 v245, v245
    v_exp_f32 v246, v246
    v_exp_f32 v247, v247
    v_mfma_f32_32x32x16_bf16 a[32:47], a[12:15], v[76:79], a[32:47]
    global_load_dword v28, v0, s[70:71] offset:0
    v_cvt_pk_bf16_f32 v90, v244, v245
    v_cvt_pk_bf16_f32 v91, v246, v247
    v_exp_f32 v248, v248
    v_exp_f32 v249, v249
    v_exp_f32 v250, v250
    v_exp_f32 v251, v251
    v_cvt_pk_bf16_f32 v92, v248, v249
    v_cvt_pk_bf16_f32 v93, v250, v251
    v_smfmac_f32_16x16x64_bf16 a[64:67], a[72:75], v[72:79], v9
    s_waitcnt vmcnt(9) lgkmcnt(0)
    s_barrier
    v_exp_f32 v252, v252
    v_exp_f32 v253, v253
    v_exp_f32 v254, v254
    v_exp_f32 v255, v255
    v_cvt_pk_bf16_f32 v94, v252, v253
    v_cvt_pk_bf16_f32 v95, v254, v255
    v_mfma_f32_32x32x16_bf16 v[240:255], a[0:3], v[80:83], v[144:159]
    s_add_u32 m0, s27, 131072
    v_exp_f32 v176, v176
    v_exp_f32 v177, v177
    v_exp_f32 v178, v178
    v_mfma_f32_32x32x16_bf16 v[240:255], a[4:7], v[84:87], v[240:255]
    ds_read_b128 a[0:3], v6 offset:0
    v_exp_f32 v179, v179
    v_cvt_pk_bf16_f32 v72, v176, v177
    v_cvt_pk_bf16_f32 v73, v178, v179
    v_exp_f32 v180, v180
    v_mfma_f32_32x32x16_bf16 a[48:63], a[8:11], v[88:91], a[48:63]
    ds_read_b128 a[4:7], v6 offset:1024
    v_exp_f32 v181, v181
    v_exp_f32 v182, v182
    v_exp_f32 v183, v183
    v_mfma_f32_32x32x16_bf16 a[48:63], a[12:15], v[92:95], a[48:63]
    global_load_lds_dwordx4 v29, s[98:99] offset:0 sc1
    v_cvt_pk_bf16_f32 v74, v180, v181
    v_cvt_pk_bf16_f32 v75, v182, v183
    v_exp_f32 v184, v184
    v_exp_f32 v185, v185
    v_exp_f32 v186, v186
    v_exp_f32 v187, v187
    v_cvt_pk_bf16_f32 v76, v184, v185
    v_cvt_pk_bf16_f32 v77, v186, v187
    v_smfmac_f32_16x16x64_bf16 a[68:71], a[72:75], v[88:95], v9
    global_load_lds_dwordx4 v29, s[98:99] offset:1024 sc1
    s_waitcnt lgkmcnt(0)
    v_exp_f32 v188, v188
    v_exp_f32 v189, v189
    v_exp_f32 v190, v190
    v_exp_f32 v191, v191
    v_cvt_pk_bf16_f32 v78, v188, v189
    v_cvt_pk_bf16_f32 v79, v190, v191
    v_mfma_f32_32x32x16_bf16 v[176:191], a[0:3], v[64:67], v[128:143]
    ds_read_b128 a[8:11], v6 offset:2048
    v_exp_f32 v240, v240
    v_exp_f32 v241, v241
    v_exp_f32 v242, v242
    v_mfma_f32_32x32x16_bf16 v[176:191], a[4:7], v[68:71], v[176:191]
    ds_read_b128 a[12:15], v6 offset:3072
    v_exp_f32 v243, v243
    v_cvt_pk_bf16_f32 v88, v240, v241
    v_cvt_pk_bf16_f32 v89, v242, v243
    v_exp_f32 v244, v244
    v_mfma_f32_32x32x16_bf16 a[32:47], a[16:19], v[72:75], a[32:47]
    global_load_lds_dwordx4 v29, s[98:99] offset:2048 sc1
    v_exp_f32 v245, v245
    v_exp_f32 v246, v246
    v_exp_f32 v247, v247
    v_mfma_f32_32x32x16_bf16 a[32:47], a[20:23], v[76:79], a[32:47]
    global_load_lds_dwordx4 v29, s[98:99] offset:3072 sc1
    v_cvt_pk_bf16_f32 v90, v244, v245
    v_cvt_pk_bf16_f32 v91, v246, v247
    v_exp_f32 v248, v248
    v_exp_f32 v249, v249
    v_exp_f32 v250, v250
    v_exp_f32 v251, v251
    v_cvt_pk_bf16_f32 v92, v248, v249
    v_cvt_pk_bf16_f32 v93, v250, v251
    v_smfmac_f32_16x16x64_bf16 a[64:67], a[72:75], v[72:79], v9
    s_add_u32 m0, s27, 135168
    s_nop 0
    global_load_lds_dwordx4 v5, s[98:99] offset:0 sc1
    v_exp_f32 v252, v252
    v_exp_f32 v253, v253
    v_exp_f32 v254, v254
    v_exp_f32 v255, v255
    v_cvt_pk_bf16_f32 v94, v252, v253
    v_cvt_pk_bf16_f32 v95, v254, v255
    v_mfma_f32_32x32x16_bf16 v[240:255], a[0:3], v[80:83], v[144:159]
    global_load_lds_dwordx4 v5, s[98:99] offset:1024 sc1
    v_exp_f32 v176, v176
    v_exp_f32 v177, v177
    v_exp_f32 v178, v178
    v_mfma_f32_32x32x16_bf16 v[240:255], a[4:7], v[84:87], v[240:255]
    ds_read_b128 a[0:3], v6 offset:8192
    v_exp_f32 v179, v179
    v_cvt_pk_bf16_f32 v72, v176, v177
    v_cvt_pk_bf16_f32 v73, v178, v179
    v_exp_f32 v180, v180
    v_mfma_f32_32x32x16_bf16 a[48:63], a[16:19], v[88:91], a[48:63]
    ds_read_b128 a[4:7], v6 offset:9216
    v_exp_f32 v181, v181
    v_exp_f32 v182, v182
    v_exp_f32 v183, v183
    v_mfma_f32_32x32x16_bf16 a[48:63], a[20:23], v[92:95], a[48:63]
    global_load_lds_dwordx4 v5, s[98:99] offset:2048 sc1
    v_cvt_pk_bf16_f32 v74, v180, v181
    v_cvt_pk_bf16_f32 v75, v182, v183
    v_exp_f32 v184, v184
    v_exp_f32 v185, v185
    v_exp_f32 v186, v186
    v_exp_f32 v187, v187
    v_cvt_pk_bf16_f32 v76, v184, v185
    v_cvt_pk_bf16_f32 v77, v186, v187
    v_smfmac_f32_16x16x64_bf16 a[68:71], a[72:75], v[88:95], v9
    global_load_lds_dwordx4 v5, s[98:99] offset:3072 sc1
    s_waitcnt lgkmcnt(0)
    v_exp_f32 v188, v188
    v_exp_f32 v189, v189
    v_exp_f32 v190, v190
    v_exp_f32 v191, v191
    v_cvt_pk_bf16_f32 v78, v188, v189
    v_cvt_pk_bf16_f32 v79, v190, v191
    v_mfma_f32_32x32x16_bf16 v[176:191], a[0:3], v[64:67], v[128:143]
    ds_read_b128 a[16:19], v6 offset:10240
    v_exp_f32 v240, v240
    v_exp_f32 v241, v241
    v_exp_f32 v242, v242
    v_mfma_f32_32x32x16_bf16 v[176:191], a[4:7], v[68:71], v[176:191]
    ds_read_b128 a[20:23], v6 offset:11264
    v_exp_f32 v243, v243
    v_cvt_pk_bf16_f32 v88, v240, v241
    v_cvt_pk_bf16_f32 v89, v242, v243
    v_exp_f32 v244, v244
    v_mfma_f32_32x32x16_bf16 a[32:47], a[8:11], v[72:75], a[32:47]
    s_add_u32 s36, s3, 14
    v_exp_f32 v245, v245
    v_exp_f32 v246, v246
    v_exp_f32 v247, v247
    v_mfma_f32_32x32x16_bf16 a[32:47], a[12:15], v[76:79], a[32:47]
    s_and_b32 s36, s36, 15
    v_cvt_pk_bf16_f32 v90, v244, v245
    v_cvt_pk_bf16_f32 v91, v246, v247
    v_exp_f32 v248, v248
    v_exp_f32 v249, v249
    v_exp_f32 v250, v250
    v_exp_f32 v251, v251
    v_cvt_pk_bf16_f32 v92, v248, v249
    v_cvt_pk_bf16_f32 v93, v250, v251
    v_smfmac_f32_16x16x64_bf16 a[64:67], a[72:75], v[72:79], v9
    s_lshl_b32 s36, s36, 15
    s_add_u32 s98, s84, s36
    v_exp_f32 v252, v252
    v_exp_f32 v253, v253
    v_exp_f32 v254, v254
    v_exp_f32 v255, v255
    v_cvt_pk_bf16_f32 v94, v252, v253
    v_cvt_pk_bf16_f32 v95, v254, v255
    v_mfma_f32_32x32x16_bf16 v[240:255], a[0:3], v[80:83], v[144:159]
    s_addc_u32 s99, s85, 0
    v_exp_f32 v176, v176
    v_exp_f32 v177, v177
    v_exp_f32 v178, v178
    v_mfma_f32_32x32x16_bf16 v[240:255], a[4:7], v[84:87], v[240:255]
    ds_read_b128 a[0:3], v6 offset:4096
    v_exp_f32 v179, v179
    v_cvt_pk_bf16_f32 v72, v176, v177
    v_cvt_pk_bf16_f32 v73, v178, v179
    v_exp_f32 v180, v180
    v_mfma_f32_32x32x16_bf16 a[48:63], a[8:11], v[88:91], a[48:63]
    ds_read_b128 a[4:7], v6 offset:5120
    v_exp_f32 v181, v181
    v_exp_f32 v182, v182
    v_exp_f32 v183, v183
    v_mfma_f32_32x32x16_bf16 a[48:63], a[12:15], v[92:95], a[48:63]
    buffer_load_dword v28, v26, s[40:43], 0 offen
    v_cvt_pk_bf16_f32 v74, v180, v181
    v_cvt_pk_bf16_f32 v75, v182, v183
    v_exp_f32 v184, v184
    v_exp_f32 v185, v185
    v_exp_f32 v186, v186
    v_exp_f32 v187, v187
    v_cvt_pk_bf16_f32 v76, v184, v185
    v_cvt_pk_bf16_f32 v77, v186, v187
    v_smfmac_f32_16x16x64_bf16 a[68:71], a[72:75], v[88:95], v9
    global_load_dwordx4 a[236:239], v29, s[100:101] offset:0 sc1
    s_waitcnt lgkmcnt(0)
    v_exp_f32 v188, v188
    v_exp_f32 v189, v189
    v_exp_f32 v190, v190
    v_exp_f32 v191, v191
    v_cvt_pk_bf16_f32 v78, v188, v189
    v_cvt_pk_bf16_f32 v79, v190, v191
    v_mfma_f32_32x32x16_bf16 v[176:191], a[0:3], v[64:67], v[128:143]
    ds_read_b128 a[8:11], v6 offset:6144
    v_exp_f32 v240, v240
    v_exp_f32 v241, v241
    v_exp_f32 v242, v242
    v_mfma_f32_32x32x16_bf16 v[176:191], a[4:7], v[68:71], v[176:191]
    ds_read_b128 a[12:15], v6 offset:7168
    v_exp_f32 v243, v243
    v_cvt_pk_bf16_f32 v88, v240, v241
    v_cvt_pk_bf16_f32 v89, v242, v243
    v_exp_f32 v244, v244
    v_mfma_f32_32x32x16_bf16 a[32:47], a[16:19], v[72:75], a[32:47]
    global_load_dwordx4 a[240:243], v29, s[100:101] offset:1024 sc1
    v_exp_f32 v245, v245
    v_exp_f32 v246, v246
    v_exp_f32 v247, v247
    v_mfma_f32_32x32x16_bf16 a[32:47], a[20:23], v[76:79], a[32:47]
    global_load_dwordx4 a[244:247], v29, s[100:101] offset:2048 sc1
    v_cvt_pk_bf16_f32 v90, v244, v245
    v_cvt_pk_bf16_f32 v91, v246, v247
    v_exp_f32 v248, v248
    v_exp_f32 v249, v249
    v_exp_f32 v250, v250
    v_exp_f32 v251, v251
    v_cvt_pk_bf16_f32 v92, v248, v249
    v_cvt_pk_bf16_f32 v93, v250, v251
    v_smfmac_f32_16x16x64_bf16 a[64:67], a[72:75], v[72:79], v9
    global_load_dwordx4 a[248:251], v29, s[100:101] offset:3072 sc1
    global_load_dwordx4 a[252:255], v5, s[100:101] offset:0 sc1
    v_exp_f32 v252, v252
    v_exp_f32 v253, v253
    v_exp_f32 v254, v254
    v_exp_f32 v255, v255
    v_cvt_pk_bf16_f32 v94, v252, v253
    v_cvt_pk_bf16_f32 v95, v254, v255
    v_mfma_f32_32x32x16_bf16 v[240:255], a[0:3], v[80:83], v[144:159]
    global_load_dwordx4 v[96:99], v5, s[100:101] offset:1024 sc1
    v_exp_f32 v176, v176
    v_exp_f32 v177, v177
    v_exp_f32 v178, v178
    v_mfma_f32_32x32x16_bf16 v[240:255], a[4:7], v[84:87], v[240:255]
    ds_read_b128 a[0:3], v6 offset:12288
    v_exp_f32 v179, v179
    v_cvt_pk_bf16_f32 v72, v176, v177
    v_cvt_pk_bf16_f32 v73, v178, v179
    v_exp_f32 v180, v180
    v_mfma_f32_32x32x16_bf16 a[48:63], a[16:19], v[88:91], a[48:63]
    ds_read_b128 a[4:7], v6 offset:13312
    v_exp_f32 v181, v181
    v_exp_f32 v182, v182
    v_exp_f32 v183, v183
    v_mfma_f32_32x32x16_bf16 a[48:63], a[20:23], v[92:95], a[48:63]
    global_load_dwordx4 v[100:103], v5, s[100:101] offset:2048 sc1
    v_cvt_pk_bf16_f32 v74, v180, v181
    v_cvt_pk_bf16_f32 v75, v182, v183
    v_exp_f32 v184, v184
    v_exp_f32 v185, v185
    v_exp_f32 v186, v186
    v_exp_f32 v187, v187
    v_cvt_pk_bf16_f32 v76, v184, v185
    v_cvt_pk_bf16_f32 v77, v186, v187
    v_smfmac_f32_16x16x64_bf16 a[68:71], a[72:75], v[88:95], v9
    global_load_dwordx4 v[104:107], v5, s[100:101] offset:3072 sc1
    s_waitcnt lgkmcnt(0)
    v_exp_f32 v188, v188
    v_exp_f32 v189, v189
    v_exp_f32 v190, v190
    v_exp_f32 v191, v191
    v_cvt_pk_bf16_f32 v78, v188, v189
    v_cvt_pk_bf16_f32 v79, v190, v191
    v_mfma_f32_32x32x16_bf16 v[176:191], a[0:3], v[64:67], v[128:143]
    ds_read_b128 a[16:19], v6 offset:14336
    v_exp_f32 v240, v240
    v_exp_f32 v241, v241
    v_exp_f32 v242, v242
    v_mfma_f32_32x32x16_bf16 v[176:191], a[4:7], v[68:71], v[176:191]
    ds_read_b128 a[20:23], v6 offset:15360
    v_exp_f32 v243, v243
    v_cvt_pk_bf16_f32 v88, v240, v241
    v_cvt_pk_bf16_f32 v89, v242, v243
    v_exp_f32 v244, v244
    v_mfma_f32_32x32x16_bf16 a[32:47], a[8:11], v[72:75], a[32:47]
    s_add_u32 s100, s100, 8192
    v_exp_f32 v245, v245
    v_exp_f32 v246, v246
    v_exp_f32 v247, v247
    v_mfma_f32_32x32x16_bf16 a[32:47], a[12:15], v[76:79], a[32:47]
    s_addc_u32 s101, s101, 0
    v_cvt_pk_bf16_f32 v90, v244, v245
    v_cvt_pk_bf16_f32 v91, v246, v247
    v_exp_f32 v248, v248
    v_exp_f32 v249, v249
    v_exp_f32 v250, v250
    v_exp_f32 v251, v251
    v_cvt_pk_bf16_f32 v92, v248, v249
    v_cvt_pk_bf16_f32 v93, v250, v251
    v_smfmac_f32_16x16x64_bf16 a[64:67], a[72:75], v[72:79], v9
    global_load_dword v28, v0, s[70:71] offset:2048
    v_add_u32 v0, 4096, v0
    s_waitcnt vmcnt(10) lgkmcnt(0)
    s_barrier
    v_exp_f32 v252, v252
    v_exp_f32 v253, v253
    v_exp_f32 v254, v254
    v_exp_f32 v255, v255
    v_cvt_pk_bf16_f32 v94, v252, v253
    v_cvt_pk_bf16_f32 v95, v254, v255
    v_mfma_f32_32x32x16_bf16 v[240:255], a[0:3], v[80:83], v[144:159]
    s_add_u32 m0, s27, 98304
    v_exp_f32 v176, v176
    v_exp_f32 v177, v177
    v_exp_f32 v178, v178
    v_mfma_f32_32x32x16_bf16 v[240:255], a[4:7], v[84:87], v[240:255]
    ds_read_b128 a[0:3], v7 offset:0
    v_exp_f32 v179, v179
    v_cvt_pk_bf16_f32 v72, v176, v177
    v_cvt_pk_bf16_f32 v73, v178, v179
    v_exp_f32 v180, v180
    v_mfma_f32_32x32x16_bf16 a[48:63], a[8:11], v[88:91], a[48:63]
    ds_read_b128 a[4:7], v7 offset:1024
    v_exp_f32 v181, v181
    v_exp_f32 v182, v182
    v_exp_f32 v183, v183
    v_mfma_f32_32x32x16_bf16 a[48:63], a[12:15], v[92:95], a[48:63]
    global_load_lds_dwordx4 v29, s[98:99] offset:0 sc1
    v_cvt_pk_bf16_f32 v74, v180, v181
    v_cvt_pk_bf16_f32 v75, v182, v183
    v_exp_f32 v184, v184
    v_exp_f32 v185, v185
    v_exp_f32 v186, v186
    v_exp_f32 v187, v187
    v_cvt_pk_bf16_f32 v76, v184, v185
    v_cvt_pk_bf16_f32 v77, v186, v187
    v_smfmac_f32_16x16x64_bf16 a[68:71], a[72:75], v[88:95], v9
    global_load_lds_dwordx4 v29, s[98:99] offset:1024 sc1
    s_waitcnt lgkmcnt(0)
    v_exp_f32 v188, v188
    v_exp_f32 v189, v189
    v_exp_f32 v190, v190
    v_exp_f32 v191, v191
    v_cvt_pk_bf16_f32 v78, v188, v189
    v_cvt_pk_bf16_f32 v79, v190, v191
    v_mfma_f32_32x32x16_bf16 v[176:191], a[0:3], v[64:67], v[128:143]
    ds_read_b128 a[8:11], v7 offset:2048
    v_exp_f32 v240, v240
    v_exp_f32 v241, v241
    v_exp_f32 v242, v242
    v_mfma_f32_32x32x16_bf16 v[176:191], a[4:7], v[68:71], v[176:191]
    ds_read_b128 a[12:15], v7 offset:3072
    v_exp_f32 v243, v243
    v_cvt_pk_bf16_f32 v88, v240, v241
    v_cvt_pk_bf16_f32 v89, v242, v243
    v_exp_f32 v244, v244
    v_mfma_f32_32x32x16_bf16 a[32:47], a[16:19], v[72:75], a[32:47]
    global_load_lds_dwordx4 v29, s[98:99] offset:2048 sc1
    v_exp_f32 v245, v245
    v_exp_f32 v246, v246
    v_exp_f32 v247, v247
    v_mfma_f32_32x32x16_bf16 a[32:47], a[20:23], v[76:79], a[32:47]
    global_load_lds_dwordx4 v29, s[98:99] offset:3072 sc1
    v_cvt_pk_bf16_f32 v90, v244, v245
    v_cvt_pk_bf16_f32 v91, v246, v247
    v_exp_f32 v248, v248
    v_exp_f32 v249, v249
    v_exp_f32 v250, v250
    v_exp_f32 v251, v251
    v_cvt_pk_bf16_f32 v92, v248, v249
    v_cvt_pk_bf16_f32 v93, v250, v251
    v_smfmac_f32_16x16x64_bf16 a[64:67], a[72:75], v[72:79], v9
    s_add_u32 m0, s27, 102400
    s_nop 0
    global_load_lds_dwordx4 v5, s[98:99] offset:0 sc1
    v_exp_f32 v252, v252
    v_exp_f32 v253, v253
    v_exp_f32 v254, v254
    v_exp_f32 v255, v255
    v_cvt_pk_bf16_f32 v94, v252, v253
    v_cvt_pk_bf16_f32 v95, v254, v255
    v_mfma_f32_32x32x16_bf16 v[240:255], a[0:3], v[80:83], v[144:159]
    global_load_lds_dwordx4 v5, s[98:99] offset:1024 sc1
    v_exp_f32 v176, v176
    v_exp_f32 v177, v177
    v_exp_f32 v178, v178
    v_mfma_f32_32x32x16_bf16 v[240:255], a[4:7], v[84:87], v[240:255]
    ds_read_b128 a[0:3], v7 offset:8192
    v_exp_f32 v179, v179
    v_cvt_pk_bf16_f32 v72, v176, v177
    v_cvt_pk_bf16_f32 v73, v178, v179
    v_exp_f32 v180, v180
    v_mfma_f32_32x32x16_bf16 a[48:63], a[16:19], v[88:91], a[48:63]
    ds_read_b128 a[4:7], v7 offset:9216
    v_exp_f32 v181, v181
    v_exp_f32 v182, v182
    v_exp_f32 v183, v183
    v_mfma_f32_32x32x16_bf16 a[48:63], a[20:23], v[92:95], a[48:63]
    global_load_lds_dwordx4 v5, s[98:99] offset:2048 sc1
    v_cvt_pk_bf16_f32 v74, v180, v181
    v_cvt_pk_bf16_f32 v75, v182, v183
    v_exp_f32 v184, v184
    v_exp_f32 v185, v185
    v_exp_f32 v186, v186
    v_exp_f32 v187, v187
    v_cvt_pk_bf16_f32 v76, v184, v185
    v_cvt_pk_bf16_f32 v77, v186, v187
    v_smfmac_f32_16x16x64_bf16 a[68:71], a[72:75], v[88:95], v9
    global_load_lds_dwordx4 v5, s[98:99] offset:3072 sc1
    s_waitcnt lgkmcnt(0)
    v_exp_f32 v188, v188
    v_exp_f32 v189, v189
    v_exp_f32 v190, v190
    v_exp_f32 v191, v191
    v_cvt_pk_bf16_f32 v78, v188, v189
    v_cvt_pk_bf16_f32 v79, v190, v191
    v_mfma_f32_32x32x16_bf16 v[176:191], a[0:3], v[64:67], v[128:143]
    ds_read_b128 a[16:19], v7 offset:10240
    v_exp_f32 v240, v240
    v_exp_f32 v241, v241
    v_exp_f32 v242, v242
    v_mfma_f32_32x32x16_bf16 v[176:191], a[4:7], v[68:71], v[176:191]
    ds_read_b128 a[20:23], v7 offset:11264
    v_exp_f32 v243, v243
    v_cvt_pk_bf16_f32 v88, v240, v241
    v_cvt_pk_bf16_f32 v89, v242, v243
    v_exp_f32 v244, v244
    v_mfma_f32_32x32x16_bf16 a[32:47], a[8:11], v[72:75], a[32:47]
    s_add_u32 s36, s3, 15
    v_exp_f32 v245, v245
    v_exp_f32 v246, v246
    v_exp_f32 v247, v247
    v_mfma_f32_32x32x16_bf16 a[32:47], a[12:15], v[76:79], a[32:47]
    s_and_b32 s36, s36, 15
    v_cvt_pk_bf16_f32 v90, v244, v245
    v_cvt_pk_bf16_f32 v91, v246, v247
    v_exp_f32 v248, v248
    v_exp_f32 v249, v249
    v_exp_f32 v250, v250
    v_exp_f32 v251, v251
    v_cvt_pk_bf16_f32 v92, v248, v249
    v_cvt_pk_bf16_f32 v93, v250, v251
    v_smfmac_f32_16x16x64_bf16 a[64:67], a[72:75], v[72:79], v9
    s_lshl_b32 s36, s36, 15
    s_add_u32 s98, s84, s36
    v_exp_f32 v252, v252
    v_exp_f32 v253, v253
    v_exp_f32 v254, v254
    v_exp_f32 v255, v255
    v_cvt_pk_bf16_f32 v94, v252, v253
    v_cvt_pk_bf16_f32 v95, v254, v255
    v_mfma_f32_32x32x16_bf16 v[240:255], a[0:3], v[80:83], v[144:159]
    s_addc_u32 s99, s85, 0
    v_exp_f32 v176, v176
    v_exp_f32 v177, v177
    v_exp_f32 v178, v178
    v_mfma_f32_32x32x16_bf16 v[240:255], a[4:7], v[84:87], v[240:255]
    ds_read_b128 a[0:3], v7 offset:4096
    v_exp_f32 v179, v179
    v_cvt_pk_bf16_f32 v72, v176, v177
    v_cvt_pk_bf16_f32 v73, v178, v179
    v_exp_f32 v180, v180
    v_mfma_f32_32x32x16_bf16 a[48:63], a[8:11], v[88:91], a[48:63]
    ds_read_b128 a[4:7], v7 offset:5120
    v_exp_f32 v181, v181
    v_exp_f32 v182, v182
    v_exp_f32 v183, v183
    v_mfma_f32_32x32x16_bf16 a[48:63], a[12:15], v[92:95], a[48:63]
    global_load_dwordx4 v[108:111], v29, s[100:101] offset:0 sc1
    v_cvt_pk_bf16_f32 v74, v180, v181
    v_cvt_pk_bf16_f32 v75, v182, v183
    v_exp_f32 v184, v184
    v_exp_f32 v185, v185
    v_exp_f32 v186, v186
    v_exp_f32 v187, v187
    v_cvt_pk_bf16_f32 v76, v184, v185
    v_cvt_pk_bf16_f32 v77, v186, v187
    v_smfmac_f32_16x16x64_bf16 a[68:71], a[72:75], v[88:95], v9
    global_load_dwordx4 v[112:115], v29, s[100:101] offset:1024 sc1
    s_waitcnt lgkmcnt(0)
    v_exp_f32 v188, v188
    v_exp_f32 v189, v189
    v_exp_f32 v190, v190
    v_exp_f32 v191, v191
    v_cvt_pk_bf16_f32 v78, v188, v189
    v_cvt_pk_bf16_f32 v79, v190, v191
    v_mfma_f32_32x32x16_bf16 v[176:191], a[0:3], v[64:67], v[128:143]
    ds_read_b128 a[8:11], v7 offset:6144
    v_exp_f32 v240, v240
    v_exp_f32 v241, v241
    v_exp_f32 v242, v242
    v_mfma_f32_32x32x16_bf16 v[176:191], a[4:7], v[68:71], v[176:191]
    ds_read_b128 a[12:15], v7 offset:7168
    v_exp_f32 v243, v243
    v_cvt_pk_bf16_f32 v88, v240, v241
    v_cvt_pk_bf16_f32 v89, v242, v243
    v_exp_f32 v244, v244
    v_mfma_f32_32x32x16_bf16 a[32:47], a[16:19], v[72:75], a[32:47]
    global_load_dwordx4 v[116:119], v29, s[100:101] offset:2048 sc1
    v_exp_f32 v245, v245
    v_exp_f32 v246, v246
    v_exp_f32 v247, v247
    v_mfma_f32_32x32x16_bf16 a[32:47], a[20:23], v[76:79], a[32:47]
    global_load_dwordx4 v[120:123], v29, s[100:101] offset:3072 sc1
    v_cvt_pk_bf16_f32 v90, v244, v245
    v_cvt_pk_bf16_f32 v91, v246, v247
    v_exp_f32 v248, v248
    v_exp_f32 v249, v249
    v_exp_f32 v250, v250
    v_exp_f32 v251, v251
    v_cvt_pk_bf16_f32 v92, v248, v249
    v_cvt_pk_bf16_f32 v93, v250, v251
    v_smfmac_f32_16x16x64_bf16 a[64:67], a[72:75], v[72:79], v9
    global_load_dwordx4 v[124:127], v5, s[100:101] offset:0 sc1
    global_load_dwordx4 v[160:163], v5, s[100:101] offset:1024 sc1
    v_exp_f32 v252, v252
    v_exp_f32 v253, v253
    v_exp_f32 v254, v254
    v_exp_f32 v255, v255
    v_cvt_pk_bf16_f32 v94, v252, v253
    v_cvt_pk_bf16_f32 v95, v254, v255
    v_mfma_f32_32x32x16_bf16 v[240:255], a[0:3], v[80:83], v[144:159]
    global_load_dwordx4 v[164:167], v5, s[100:101] offset:2048 sc1
    v_exp_f32 v176, v176
    v_exp_f32 v177, v177
    v_exp_f32 v178, v178
    v_mfma_f32_32x32x16_bf16 v[240:255], a[4:7], v[84:87], v[240:255]
    ds_read_b128 a[0:3], v7 offset:12288
    v_exp_f32 v179, v179
    v_cvt_pk_bf16_f32 v72, v176, v177
    v_cvt_pk_bf16_f32 v73, v178, v179
    v_exp_f32 v180, v180
    v_mfma_f32_32x32x16_bf16 a[48:63], a[16:19], v[88:91], a[48:63]
    ds_read_b128 a[4:7], v7 offset:13312
    v_exp_f32 v181, v181
    v_exp_f32 v182, v182
    v_exp_f32 v183, v183
    v_mfma_f32_32x32x16_bf16 a[48:63], a[20:23], v[92:95], a[48:63]
    global_load_dwordx4 v[168:171], v5, s[100:101] offset:3072 sc1
    v_cvt_pk_bf16_f32 v74, v180, v181
    v_cvt_pk_bf16_f32 v75, v182, v183
    v_exp_f32 v184, v184
    v_exp_f32 v185, v185
    v_exp_f32 v186, v186
    v_exp_f32 v187, v187
    v_cvt_pk_bf16_f32 v76, v184, v185
    v_cvt_pk_bf16_f32 v77, v186, v187
    v_smfmac_f32_16x16x64_bf16 a[68:71], a[72:75], v[88:95], v9
    s_add_u32 s100, s100, 8192
    s_waitcnt lgkmcnt(0)
    v_exp_f32 v188, v188
    v_exp_f32 v189, v189
    v_exp_f32 v190, v190
    v_exp_f32 v191, v191
    v_cvt_pk_bf16_f32 v78, v188, v189
    v_cvt_pk_bf16_f32 v79, v190, v191
    v_mfma_f32_32x32x16_bf16 v[176:191], a[0:3], v[64:67], v[128:143]
    ds_read_b128 a[16:19], v7 offset:14336
    v_exp_f32 v240, v240
    v_exp_f32 v241, v241
    v_exp_f32 v242, v242
    v_mfma_f32_32x32x16_bf16 v[176:191], a[4:7], v[68:71], v[176:191]
    ds_read_b128 a[20:23], v7 offset:15360
    v_exp_f32 v243, v243
    v_cvt_pk_bf16_f32 v88, v240, v241
    v_cvt_pk_bf16_f32 v89, v242, v243
    v_exp_f32 v244, v244
    v_mfma_f32_32x32x16_bf16 a[32:47], a[8:11], v[72:75], a[32:47]
    s_addc_u32 s101, s101, 0
    v_exp_f32 v245, v245
    v_exp_f32 v246, v246
    v_exp_f32 v247, v247
    v_mfma_f32_32x32x16_bf16 a[32:47], a[12:15], v[76:79], a[32:47]
    global_load_dword v28, v0, s[70:71] offset:0
    v_cvt_pk_bf16_f32 v90, v244, v245
    v_cvt_pk_bf16_f32 v91, v246, v247
    v_exp_f32 v248, v248
    v_exp_f32 v249, v249
    v_exp_f32 v250, v250
    v_exp_f32 v251, v251
    v_cvt_pk_bf16_f32 v92, v248, v249
    v_cvt_pk_bf16_f32 v93, v250, v251
    v_smfmac_f32_16x16x64_bf16 a[64:67], a[72:75], v[72:79], v9
    s_waitcnt vmcnt(9) lgkmcnt(0)
    s_barrier
    v_exp_f32 v252, v252
    v_exp_f32 v253, v253
    v_exp_f32 v254, v254
    v_exp_f32 v255, v255
    v_cvt_pk_bf16_f32 v94, v252, v253
    v_cvt_pk_bf16_f32 v95, v254, v255
    v_mfma_f32_32x32x16_bf16 v[240:255], a[0:3], v[80:83], v[144:159]
    s_add_u32 m0, s27, 131072
    v_exp_f32 v176, v176
    v_exp_f32 v177, v177
    v_exp_f32 v178, v178
    v_mfma_f32_32x32x16_bf16 v[240:255], a[4:7], v[84:87], v[240:255]
    ds_read_b128 a[0:3], v6 offset:0
    v_exp_f32 v179, v179
    v_cvt_pk_bf16_f32 v72, v176, v177
    v_cvt_pk_bf16_f32 v73, v178, v179
    v_exp_f32 v180, v180
    v_mfma_f32_32x32x16_bf16 a[48:63], a[8:11], v[88:91], a[48:63]
    ds_read_b128 a[4:7], v6 offset:1024
    v_exp_f32 v181, v181
    v_exp_f32 v182, v182
    v_exp_f32 v183, v183
    v_mfma_f32_32x32x16_bf16 a[48:63], a[12:15], v[92:95], a[48:63]
    global_load_lds_dwordx4 v29, s[98:99] offset:0 sc1
    v_cvt_pk_bf16_f32 v74, v180, v181
    v_cvt_pk_bf16_f32 v75, v182, v183
    v_exp_f32 v184, v184
    v_exp_f32 v185, v185
    v_exp_f32 v186, v186
    v_exp_f32 v187, v187
    v_cvt_pk_bf16_f32 v76, v184, v185
    v_cvt_pk_bf16_f32 v77, v186, v187
    v_smfmac_f32_16x16x64_bf16 a[68:71], a[72:75], v[88:95], v9
    global_load_lds_dwordx4 v29, s[98:99] offset:1024 sc1
    s_waitcnt lgkmcnt(0)
    v_exp_f32 v188, v188
    v_exp_f32 v189, v189
    v_exp_f32 v190, v190
    v_exp_f32 v191, v191
    v_cvt_pk_bf16_f32 v78, v188, v189
    v_cvt_pk_bf16_f32 v79, v190, v191
    v_mfma_f32_32x32x16_bf16 v[176:191], a[0:3], v[64:67], v[128:143]
    ds_read_b128 a[8:11], v6 offset:2048
    v_exp_f32 v240, v240
    v_exp_f32 v241, v241
    v_exp_f32 v242, v242
    v_mfma_f32_32x32x16_bf16 v[176:191], a[4:7], v[68:71], v[176:191]
    ds_read_b128 a[12:15], v6 offset:3072
    v_exp_f32 v243, v243
    v_cvt_pk_bf16_f32 v88, v240, v241
    v_cvt_pk_bf16_f32 v89, v242, v243
    v_exp_f32 v244, v244
    v_mfma_f32_32x32x16_bf16 a[32:47], a[16:19], v[72:75], a[32:47]
    global_load_lds_dwordx4 v29, s[98:99] offset:2048 sc1
    v_exp_f32 v245, v245
    v_exp_f32 v246, v246
    v_exp_f32 v247, v247
    v_mfma_f32_32x32x16_bf16 a[32:47], a[20:23], v[76:79], a[32:47]
    global_load_lds_dwordx4 v29, s[98:99] offset:3072 sc1
    v_cvt_pk_bf16_f32 v90, v244, v245
    v_cvt_pk_bf16_f32 v91, v246, v247
    v_exp_f32 v248, v248
    v_exp_f32 v249, v249
    v_exp_f32 v250, v250
    v_exp_f32 v251, v251
    v_cvt_pk_bf16_f32 v92, v248, v249
    v_cvt_pk_bf16_f32 v93, v250, v251
    v_smfmac_f32_16x16x64_bf16 a[64:67], a[72:75], v[72:79], v9
    s_add_u32 m0, s27, 135168
    s_nop 0
    global_load_lds_dwordx4 v5, s[98:99] offset:0 sc1
    v_exp_f32 v252, v252
    v_exp_f32 v253, v253
    v_exp_f32 v254, v254
    v_exp_f32 v255, v255
    v_cvt_pk_bf16_f32 v94, v252, v253
    v_cvt_pk_bf16_f32 v95, v254, v255
    v_mfma_f32_32x32x16_bf16 v[240:255], a[0:3], v[80:83], v[144:159]
    global_load_lds_dwordx4 v5, s[98:99] offset:1024 sc1
    v_exp_f32 v176, v176
    v_exp_f32 v177, v177
    v_exp_f32 v178, v178
    v_mfma_f32_32x32x16_bf16 v[240:255], a[4:7], v[84:87], v[240:255]
    ds_read_b128 a[0:3], v6 offset:8192
    v_exp_f32 v179, v179
    v_cvt_pk_bf16_f32 v72, v176, v177
    v_cvt_pk_bf16_f32 v73, v178, v179
    v_exp_f32 v180, v180
    v_mfma_f32_32x32x16_bf16 a[48:63], a[16:19], v[88:91], a[48:63]
    ds_read_b128 a[4:7], v6 offset:9216
    v_exp_f32 v181, v181
    v_exp_f32 v182, v182
    v_exp_f32 v183, v183
    v_mfma_f32_32x32x16_bf16 a[48:63], a[20:23], v[92:95], a[48:63]
    global_load_lds_dwordx4 v5, s[98:99] offset:2048 sc1
    v_cvt_pk_bf16_f32 v74, v180, v181
    v_cvt_pk_bf16_f32 v75, v182, v183
    v_exp_f32 v184, v184
    v_exp_f32 v185, v185
    v_exp_f32 v186, v186
    v_exp_f32 v187, v187
    v_cvt_pk_bf16_f32 v76, v184, v185
    v_cvt_pk_bf16_f32 v77, v186, v187
    v_smfmac_f32_16x16x64_bf16 a[68:71], a[72:75], v[88:95], v9
    global_load_lds_dwordx4 v5, s[98:99] offset:3072 sc1
    s_waitcnt lgkmcnt(0)
    v_exp_f32 v188, v188
    v_exp_f32 v189, v189
    v_exp_f32 v190, v190
    v_exp_f32 v191, v191
    v_cvt_pk_bf16_f32 v78, v188, v189
    v_cvt_pk_bf16_f32 v79, v190, v191
    v_mfma_f32_32x32x16_bf16 v[176:191], a[0:3], v[64:67], v[128:143]
    ds_read_b128 a[16:19], v6 offset:10240
    v_exp_f32 v240, v240
    v_exp_f32 v241, v241
    v_exp_f32 v242, v242
    v_mfma_f32_32x32x16_bf16 v[176:191], a[4:7], v[68:71], v[176:191]
    ds_read_b128 a[20:23], v6 offset:11264
    v_exp_f32 v243, v243
    v_cvt_pk_bf16_f32 v88, v240, v241
    v_cvt_pk_bf16_f32 v89, v242, v243
    v_exp_f32 v244, v244
    v_mfma_f32_32x32x16_bf16 a[32:47], a[8:11], v[72:75], a[32:47]
    global_load_dwordx4 v[172:175], v29, s[100:101] offset:0 sc1
    v_exp_f32 v245, v245
    v_exp_f32 v246, v246
    v_exp_f32 v247, v247
    v_mfma_f32_32x32x16_bf16 a[32:47], a[12:15], v[76:79], a[32:47]
    global_load_dwordx4 v[192:195], v29, s[100:101] offset:1024 sc1
    v_cvt_pk_bf16_f32 v90, v244, v245
    v_cvt_pk_bf16_f32 v91, v246, v247
    v_exp_f32 v248, v248
    v_exp_f32 v249, v249
    v_exp_f32 v250, v250
    v_exp_f32 v251, v251
    v_cvt_pk_bf16_f32 v92, v248, v249
    v_cvt_pk_bf16_f32 v93, v250, v251
    v_smfmac_f32_16x16x64_bf16 a[64:67], a[72:75], v[72:79], v9
    global_load_dwordx4 v[196:199], v29, s[100:101] offset:2048 sc1
    global_load_dwordx4 v[200:203], v29, s[100:101] offset:3072 sc1
    v_exp_f32 v252, v252
    v_exp_f32 v253, v253
    v_exp_f32 v254, v254
    v_exp_f32 v255, v255
    v_cvt_pk_bf16_f32 v94, v252, v253
    v_cvt_pk_bf16_f32 v95, v254, v255
    v_mfma_f32_32x32x16_bf16 v[240:255], a[0:3], v[80:83], v[144:159]
    global_load_dwordx4 v[204:207], v5, s[100:101] offset:0 sc1
    v_exp_f32 v176, v176
    v_exp_f32 v177, v177
    v_exp_f32 v178, v178
    v_mfma_f32_32x32x16_bf16 v[240:255], a[4:7], v[84:87], v[240:255]
    ds_read_b128 a[0:3], v6 offset:4096
    v_exp_f32 v179, v179
    v_cvt_pk_bf16_f32 v72, v176, v177
    v_cvt_pk_bf16_f32 v73, v178, v179
    v_exp_f32 v180, v180
    v_mfma_f32_32x32x16_bf16 a[48:63], a[8:11], v[88:91], a[48:63]
    ds_read_b128 a[4:7], v6 offset:5120
    v_exp_f32 v181, v181
    v_exp_f32 v182, v182
    v_exp_f32 v183, v183
    v_mfma_f32_32x32x16_bf16 a[48:63], a[12:15], v[92:95], a[48:63]
    global_load_dwordx4 v[208:211], v5, s[100:101] offset:1024 sc1
    v_cvt_pk_bf16_f32 v74, v180, v181
    v_cvt_pk_bf16_f32 v75, v182, v183
    v_exp_f32 v184, v184
    v_exp_f32 v185, v185
    v_exp_f32 v186, v186
    v_exp_f32 v187, v187
    v_cvt_pk_bf16_f32 v76, v184, v185
    v_cvt_pk_bf16_f32 v77, v186, v187
    v_smfmac_f32_16x16x64_bf16 a[68:71], a[72:75], v[88:95], v9
    global_load_dwordx4 v[212:215], v5, s[100:101] offset:2048 sc1
    s_waitcnt lgkmcnt(0)
    v_exp_f32 v188, v188
    v_exp_f32 v189, v189
    v_exp_f32 v190, v190
    v_exp_f32 v191, v191
    v_cvt_pk_bf16_f32 v78, v188, v189
    v_cvt_pk_bf16_f32 v79, v190, v191
    v_mfma_f32_32x32x16_bf16 v[176:191], a[0:3], v[64:67], v[128:143]
    ds_read_b128 a[8:11], v6 offset:6144
    v_exp_f32 v240, v240
    v_exp_f32 v241, v241
    v_exp_f32 v242, v242
    v_mfma_f32_32x32x16_bf16 v[176:191], a[4:7], v[68:71], v[176:191]
    ds_read_b128 a[12:15], v6 offset:7168
    v_exp_f32 v243, v243
    v_cvt_pk_bf16_f32 v88, v240, v241
    v_cvt_pk_bf16_f32 v89, v242, v243
    v_exp_f32 v244, v244
    v_mfma_f32_32x32x16_bf16 a[32:47], a[16:19], v[72:75], a[32:47]
    global_load_dwordx4 v[216:219], v5, s[100:101] offset:3072 sc1
    v_exp_f32 v245, v245
    v_exp_f32 v246, v246
    v_exp_f32 v247, v247
    v_mfma_f32_32x32x16_bf16 a[32:47], a[20:23], v[76:79], a[32:47]
    s_add_u32 s100, s100, 8192
    v_cvt_pk_bf16_f32 v90, v244, v245
    v_cvt_pk_bf16_f32 v91, v246, v247
    v_exp_f32 v248, v248
    v_exp_f32 v249, v249
    v_exp_f32 v250, v250
    v_exp_f32 v251, v251
    v_cvt_pk_bf16_f32 v92, v248, v249
    v_cvt_pk_bf16_f32 v93, v250, v251
    v_smfmac_f32_16x16x64_bf16 a[64:67], a[72:75], v[72:79], v9
    s_addc_u32 s101, s101, 0
    global_load_dword v28, v0, s[70:71] offset:2048
    v_add_u32 v0, 4096, v0
    v_exp_f32 v252, v252
    v_exp_f32 v253, v253
    v_exp_f32 v254, v254
    v_exp_f32 v255, v255
    v_cvt_pk_bf16_f32 v94, v252, v253
    v_cvt_pk_bf16_f32 v95, v254, v255
    v_mfma_f32_32x32x16_bf16 v[240:255], a[0:3], v[80:83], v[144:159]
    s_mov_b32 s39, 1179648
    v_exp_f32 v176, v176
    v_exp_f32 v177, v177
    v_exp_f32 v178, v178
    v_mfma_f32_32x32x16_bf16 v[240:255], a[4:7], v[84:87], v[240:255]
    ds_read_b128 a[0:3], v6 offset:12288
    v_exp_f32 v179, v179
    v_cvt_pk_bf16_f32 v72, v176, v177
    v_cvt_pk_bf16_f32 v73, v178, v179
    v_exp_f32 v180, v180
    v_mfma_f32_32x32x16_bf16 a[48:63], a[16:19], v[88:91], a[48:63]
    ds_read_b128 a[4:7], v6 offset:13312
    v_exp_f32 v181, v181
    v_exp_f32 v182, v182
    v_exp_f32 v183, v183
    v_mfma_f32_32x32x16_bf16 a[48:63], a[20:23], v[92:95], a[48:63]
    s_add_u32 m0, s34, 73728
    v_cvt_pk_bf16_f32 v74, v180, v181
    v_cvt_pk_bf16_f32 v75, v182, v183
    v_exp_f32 v184, v184
    v_exp_f32 v185, v185
    v_exp_f32 v186, v186
    v_exp_f32 v187, v187
    v_cvt_pk_bf16_f32 v76, v184, v185
    v_cvt_pk_bf16_f32 v77, v186, v187
    v_smfmac_f32_16x16x64_bf16 a[68:71], a[72:75], v[88:95], v9
    buffer_load_dwordx4 v2, s[8:11], s39 offen lds
    s_waitcnt lgkmcnt(0)
    v_exp_f32 v188, v188
    v_exp_f32 v189, v189
    v_exp_f32 v190, v190
    v_exp_f32 v191, v191
    v_cvt_pk_bf16_f32 v78, v188, v189
    v_cvt_pk_bf16_f32 v79, v190, v191
    v_mfma_f32_32x32x16_bf16 v[176:191], a[0:3], v[64:67], v[128:143]
    ds_read_b128 a[16:19], v6 offset:14336
    v_exp_f32 v240, v240
    v_exp_f32 v241, v241
    v_exp_f32 v242, v242
    v_mfma_f32_32x32x16_bf16 v[176:191], a[4:7], v[68:71], v[176:191]
    ds_read_b128 a[20:23], v6 offset:15360
    v_exp_f32 v243, v243
    v_cvt_pk_bf16_f32 v88, v240, v241
    v_cvt_pk_bf16_f32 v89, v242, v243
    v_exp_f32 v244, v244
    v_mfma_f32_32x32x16_bf16 a[32:47], a[8:11], v[72:75], a[32:47]
    s_mov_b32 s39, 1245184
    v_exp_f32 v245, v245
    v_exp_f32 v246, v246
    v_exp_f32 v247, v247
    v_mfma_f32_32x32x16_bf16 a[32:47], a[12:15], v[76:79], a[32:47]
    s_add_u32 m0, s34, 77824
    v_cvt_pk_bf16_f32 v90, v244, v245
    v_cvt_pk_bf16_f32 v91, v246, v247
    v_exp_f32 v248, v248
    v_exp_f32 v249, v249
    v_exp_f32 v250, v250
    v_exp_f32 v251, v251
    v_cvt_pk_bf16_f32 v92, v248, v249
    v_cvt_pk_bf16_f32 v93, v250, v251
    v_smfmac_f32_16x16x64_bf16 a[64:67], a[72:75], v[72:79], v9
    buffer_load_dwordx4 v2, s[8:11], s39 offen lds
    s_waitcnt vmcnt(11) lgkmcnt(0)
    s_barrier
    v_exp_f32 v252, v252
    v_exp_f32 v253, v253
    v_exp_f32 v254, v254
    v_exp_f32 v255, v255
    v_cvt_pk_bf16_f32 v94, v252, v253
    v_cvt_pk_bf16_f32 v95, v254, v255
    v_mfma_f32_32x32x16_bf16 v[240:255], a[0:3], v[80:83], v[144:159]
    s_mov_b32 s39, 1310720
    s_add_u32 m0, s34, 81920
    v_exp_f32 v176, v176
    v_exp_f32 v177, v177
    v_exp_f32 v178, v178
    v_mfma_f32_32x32x16_bf16 v[240:255], a[4:7], v[84:87], v[240:255]
    ds_read_b128 a[0:3], v7 offset:0
    v_exp_f32 v179, v179
    v_cvt_pk_bf16_f32 v72, v176, v177
    v_cvt_pk_bf16_f32 v73, v178, v179
    v_exp_f32 v180, v180
    v_mfma_f32_32x32x16_bf16 a[48:63], a[8:11], v[88:91], a[48:63]
    ds_read_b128 a[4:7], v7 offset:1024
    v_exp_f32 v181, v181
    v_exp_f32 v182, v182
    v_exp_f32 v183, v183
    v_mfma_f32_32x32x16_bf16 a[48:63], a[12:15], v[92:95], a[48:63]
    buffer_load_dwordx4 v2, s[8:11], s39 offen lds
    v_cvt_pk_bf16_f32 v74, v180, v181
    v_cvt_pk_bf16_f32 v75, v182, v183
    v_exp_f32 v184, v184
    v_exp_f32 v185, v185
    v_exp_f32 v186, v186
    v_exp_f32 v187, v187
    v_cvt_pk_bf16_f32 v76, v184, v185
    v_cvt_pk_bf16_f32 v77, v186, v187
    v_smfmac_f32_16x16x64_bf16 a[68:71], a[72:75], v[88:95], v9
    s_mov_b32 s39, 1376256
    s_add_u32 m0, s34, 86016
    s_waitcnt lgkmcnt(0)
    v_exp_f32 v188, v188
    v_exp_f32 v189, v189
    v_exp_f32 v190, v190
    v_exp_f32 v191, v191
    v_cvt_pk_bf16_f32 v78, v188, v189
    v_cvt_pk_bf16_f32 v79, v190, v191
    v_mfma_f32_32x32x16_bf16 v[176:191], a[0:3], v[64:67], v[128:143]
    ds_read_b128 a[8:11], v7 offset:2048
    v_exp_f32 v240, v240
    v_exp_f32 v241, v241
    v_exp_f32 v242, v242
    v_mfma_f32_32x32x16_bf16 v[176:191], a[4:7], v[68:71], v[176:191]
    ds_read_b128 a[12:15], v7 offset:3072
    v_exp_f32 v243, v243
    v_cvt_pk_bf16_f32 v88, v240, v241
    v_cvt_pk_bf16_f32 v89, v242, v243
    v_exp_f32 v244, v244
    v_mfma_f32_32x32x16_bf16 a[32:47], a[16:19], v[72:75], a[32:47]
    buffer_load_dwordx4 v2, s[8:11], s39 offen lds
    v_exp_f32 v245, v245
    v_exp_f32 v246, v246
    v_exp_f32 v247, v247
    v_mfma_f32_32x32x16_bf16 a[32:47], a[20:23], v[76:79], a[32:47]
    s_mov_b32 s39, 1441792
    s_add_u32 m0, s34, 90112
    v_cvt_pk_bf16_f32 v90, v244, v245
    v_cvt_pk_bf16_f32 v91, v246, v247
    v_exp_f32 v248, v248
    v_exp_f32 v249, v249
    v_exp_f32 v250, v250
    v_exp_f32 v251, v251
    v_cvt_pk_bf16_f32 v92, v248, v249
    v_cvt_pk_bf16_f32 v93, v250, v251
    v_smfmac_f32_16x16x64_bf16 a[64:67], a[72:75], v[72:79], v9
    buffer_load_dwordx4 v2, s[8:11], s39 offen lds
    s_mov_b32 s39, 1507328
    s_add_u32 m0, s34, 94208
    v_exp_f32 v252, v252
    v_exp_f32 v253, v253
    v_exp_f32 v254, v254
    v_exp_f32 v255, v255
    v_cvt_pk_bf16_f32 v94, v252, v253
    v_cvt_pk_bf16_f32 v95, v254, v255
    v_mfma_f32_32x32x16_bf16 v[240:255], a[0:3], v[80:83], v[144:159]
    buffer_load_dwordx4 v2, s[8:11], s39 offen lds
    v_exp_f32 v176, v176
    v_exp_f32 v177, v177
    v_exp_f32 v178, v178
    v_mfma_f32_32x32x16_bf16 v[240:255], a[4:7], v[84:87], v[240:255]
    ds_read_b128 a[0:3], v7 offset:8192
    v_exp_f32 v179, v179
    v_cvt_pk_bf16_f32 v72, v176, v177
    v_cvt_pk_bf16_f32 v73, v178, v179
    v_exp_f32 v180, v180
    v_mfma_f32_32x32x16_bf16 a[48:63], a[16:19], v[88:91], a[48:63]
    ds_read_b128 a[4:7], v7 offset:9216
    v_exp_f32 v181, v181
    v_exp_f32 v182, v182
    v_exp_f32 v183, v183
    v_mfma_f32_32x32x16_bf16 a[48:63], a[20:23], v[92:95], a[48:63]
    s_mov_b32 s39, 1572864
    s_add_u32 m0, s34, 98304
    v_cvt_pk_bf16_f32 v74, v180, v181
    v_cvt_pk_bf16_f32 v75, v182, v183
    v_exp_f32 v184, v184
    v_exp_f32 v185, v185
    v_exp_f32 v186, v186
    v_exp_f32 v187, v187
    v_cvt_pk_bf16_f32 v76, v184, v185
    v_cvt_pk_bf16_f32 v77, v186, v187
    v_smfmac_f32_16x16x64_bf16 a[68:71], a[72:75], v[88:95], v9
    buffer_load_dwordx4 v2, s[8:11], s39 offen lds
    s_waitcnt lgkmcnt(0)
    v_exp_f32 v188, v188
    v_exp_f32 v189, v189
    v_exp_f32 v190, v190
    v_exp_f32 v191, v191
    v_cvt_pk_bf16_f32 v78, v188, v189
    v_cvt_pk_bf16_f32 v79, v190, v191
    v_mfma_f32_32x32x16_bf16 v[176:191], a[0:3], v[64:67], v[128:143]
    ds_read_b128 a[16:19], v7 offset:10240
    v_exp_f32 v240, v240
    v_exp_f32 v241, v241
    v_exp_f32 v242, v242
    v_mfma_f32_32x32x16_bf16 v[176:191], a[4:7], v[68:71], v[176:191]
    ds_read_b128 a[20:23], v7 offset:11264
    v_exp_f32 v243, v243
    v_cvt_pk_bf16_f32 v88, v240, v241
    v_cvt_pk_bf16_f32 v89, v242, v243
    v_exp_f32 v244, v244
    v_mfma_f32_32x32x16_bf16 a[32:47], a[8:11], v[72:75], a[32:47]
    s_mov_b32 s39, 1638400
    s_add_u32 m0, s34, 102400
    v_exp_f32 v245, v245
    v_exp_f32 v246, v246
    v_exp_f32 v247, v247
    v_mfma_f32_32x32x16_bf16 a[32:47], a[12:15], v[76:79], a[32:47]
    buffer_load_dwordx4 v2, s[8:11], s39 offen lds
    v_cvt_pk_bf16_f32 v90, v244, v245
    v_cvt_pk_bf16_f32 v91, v246, v247
    v_exp_f32 v248, v248
    v_exp_f32 v249, v249
    v_exp_f32 v250, v250
    v_exp_f32 v251, v251
    v_cvt_pk_bf16_f32 v92, v248, v249
    v_cvt_pk_bf16_f32 v93, v250, v251
    v_smfmac_f32_16x16x64_bf16 a[64:67], a[72:75], v[72:79], v9
    s_mov_b32 s39, 1703936
    s_add_u32 m0, s34, 106496
    s_nop 0
    buffer_load_dwordx4 v2, s[8:11], s39 offen lds
    v_exp_f32 v252, v252
    v_exp_f32 v253, v253
    v_exp_f32 v254, v254
    v_exp_f32 v255, v255
    v_cvt_pk_bf16_f32 v94, v252, v253
    v_cvt_pk_bf16_f32 v95, v254, v255
    v_mfma_f32_32x32x16_bf16 v[240:255], a[0:3], v[80:83], v[144:159]
    s_mov_b32 s39, 1769472
    s_add_u32 m0, s34, 110592
    v_exp_f32 v176, v176
    v_exp_f32 v177, v177
    v_exp_f32 v178, v178
    v_mfma_f32_32x32x16_bf16 v[240:255], a[4:7], v[84:87], v[240:255]
    ds_read_b128 a[0:3], v7 offset:4096
    v_exp_f32 v179, v179
    v_cvt_pk_bf16_f32 v72, v176, v177
    v_cvt_pk_bf16_f32 v73, v178, v179
    v_exp_f32 v180, v180
    v_mfma_f32_32x32x16_bf16 a[48:63], a[8:11], v[88:91], a[48:63]
    ds_read_b128 a[4:7], v7 offset:5120
    v_exp_f32 v181, v181
    v_exp_f32 v182, v182
    v_exp_f32 v183, v183
    v_mfma_f32_32x32x16_bf16 a[48:63], a[12:15], v[92:95], a[48:63]
    buffer_load_dwordx4 v2, s[8:11], s39 offen lds
    v_cvt_pk_bf16_f32 v74, v180, v181
    v_cvt_pk_bf16_f32 v75, v182, v183
    v_exp_f32 v184, v184
    v_exp_f32 v185, v185
    v_exp_f32 v186, v186
    v_exp_f32 v187, v187
    v_cvt_pk_bf16_f32 v76, v184, v185
    v_cvt_pk_bf16_f32 v77, v186, v187
    v_smfmac_f32_16x16x64_bf16 a[68:71], a[72:75], v[88:95], v9
    s_mov_b32 s39, 1835008
    s_add_u32 m0, s34, 114688
    s_waitcnt lgkmcnt(0)
    v_exp_f32 v188, v188
    v_exp_f32 v189, v189
    v_exp_f32 v190, v190
    v_exp_f32 v191, v191
    v_cvt_pk_bf16_f32 v78, v188, v189
    v_cvt_pk_bf16_f32 v79, v190, v191
    v_mfma_f32_32x32x16_bf16 v[176:191], a[0:3], v[64:67], v[128:143]
    ds_read_b128 a[8:11], v7 offset:6144
    v_exp_f32 v240, v240
    v_exp_f32 v241, v241
    v_exp_f32 v242, v242
    v_mfma_f32_32x32x16_bf16 v[176:191], a[4:7], v[68:71], v[176:191]
    ds_read_b128 a[12:15], v7 offset:7168
    v_exp_f32 v243, v243
    v_cvt_pk_bf16_f32 v88, v240, v241
    v_cvt_pk_bf16_f32 v89, v242, v243
    v_exp_f32 v244, v244
    v_mfma_f32_32x32x16_bf16 a[32:47], a[16:19], v[72:75], a[32:47]
    buffer_load_dwordx4 v2, s[8:11], s39 offen lds
    v_exp_f32 v245, v245
    v_exp_f32 v246, v246
    v_exp_f32 v247, v247
    v_mfma_f32_32x32x16_bf16 a[32:47], a[20:23], v[76:79], a[32:47]
    s_add_u32 m0, s34, 118784
    v_cvt_pk_bf16_f32 v90, v244, v245
    v_cvt_pk_bf16_f32 v91, v246, v247
    v_exp_f32 v248, v248
    v_exp_f32 v249, v249
    v_exp_f32 v250, v250
    v_exp_f32 v251, v251
    v_cvt_pk_bf16_f32 v92, v248, v249
    v_cvt_pk_bf16_f32 v93, v250, v251
    v_smfmac_f32_16x16x64_bf16 a[64:67], a[72:75], v[72:79], v9
    s_mov_b32 s39, 1900544
    buffer_load_dwordx4 v2, s[8:11], s39 offen lds
    v_exp_f32 v252, v252
    v_exp_f32 v253, v253
    v_exp_f32 v254, v254
    v_exp_f32 v255, v255
    v_cvt_pk_bf16_f32 v94, v252, v253
    v_cvt_pk_bf16_f32 v95, v254, v255
    v_mfma_f32_32x32x16_bf16 v[240:255], a[0:3], v[80:83], v[144:159]
    s_mov_b32 s39, 1966080
    v_exp_f32 v176, v176
    v_exp_f32 v177, v177
    v_exp_f32 v178, v178
    v_mfma_f32_32x32x16_bf16 v[240:255], a[4:7], v[84:87], v[240:255]
    ds_read_b128 a[0:3], v7 offset:12288
    v_exp_f32 v179, v179
    v_cvt_pk_bf16_f32 v72, v176, v177
    v_cvt_pk_bf16_f32 v73, v178, v179
    v_exp_f32 v180, v180
    v_mfma_f32_32x32x16_bf16 a[48:63], a[16:19], v[88:91], a[48:63]
    ds_read_b128 a[4:7], v7 offset:13312
    v_exp_f32 v181, v181
    v_exp_f32 v182, v182
    v_exp_f32 v183, v183
    v_mfma_f32_32x32x16_bf16 a[48:63], a[20:23], v[92:95], a[48:63]
    s_add_u32 m0, s34, 122880
    v_cvt_pk_bf16_f32 v74, v180, v181
    v_cvt_pk_bf16_f32 v75, v182, v183
    v_exp_f32 v184, v184
    v_exp_f32 v185, v185
    v_exp_f32 v186, v186
    v_exp_f32 v187, v187
    v_cvt_pk_bf16_f32 v76, v184, v185
    v_cvt_pk_bf16_f32 v77, v186, v187
    v_smfmac_f32_16x16x64_bf16 a[68:71], a[72:75], v[88:95], v9
    buffer_load_dwordx4 v2, s[8:11], s39 offen lds
    s_waitcnt lgkmcnt(0)
    v_exp_f32 v188, v188
    v_exp_f32 v189, v189
    v_exp_f32 v190, v190
    v_exp_f32 v191, v191
    v_cvt_pk_bf16_f32 v78, v188, v189
    v_cvt_pk_bf16_f32 v79, v190, v191
    v_mfma_f32_32x32x16_bf16 v[176:191], a[0:3], v[64:67], v[128:143]
    ds_read_b128 a[16:19], v7 offset:14336
    v_exp_f32 v240, v240
    v_exp_f32 v241, v241
    v_exp_f32 v242, v242
    v_mfma_f32_32x32x16_bf16 v[176:191], a[4:7], v[68:71], v[176:191]
    ds_read_b128 a[20:23], v7 offset:15360
    v_exp_f32 v243, v243
    v_cvt_pk_bf16_f32 v88, v240, v241
    v_cvt_pk_bf16_f32 v89, v242, v243
    v_exp_f32 v244, v244
    v_mfma_f32_32x32x16_bf16 a[32:47], a[8:11], v[72:75], a[32:47]
    s_mov_b32 s39, 2031616
    v_exp_f32 v245, v245
    v_exp_f32 v246, v246
    v_exp_f32 v247, v247
    v_mfma_f32_32x32x16_bf16 a[32:47], a[12:15], v[76:79], a[32:47]
    s_add_u32 m0, s34, 126976
    v_cvt_pk_bf16_f32 v90, v244, v245
    v_cvt_pk_bf16_f32 v91, v246, v247
    v_exp_f32 v248, v248
    v_exp_f32 v249, v249
    v_exp_f32 v250, v250
    v_exp_f32 v251, v251
    v_cvt_pk_bf16_f32 v92, v248, v249
    v_cvt_pk_bf16_f32 v93, v250, v251
    v_smfmac_f32_16x16x64_bf16 a[64:67], a[72:75], v[72:79], v9
    buffer_load_dwordx4 v2, s[8:11], s39 offen lds
    s_waitcnt vmcnt(15) lgkmcnt(0)
    s_barrier
    v_exp_f32 v252, v252
    v_exp_f32 v253, v253
    v_exp_f32 v254, v254
    v_exp_f32 v255, v255
    v_cvt_pk_bf16_f32 v94, v252, v253
    v_cvt_pk_bf16_f32 v95, v254, v255
    v_mfma_f32_32x32x16_bf16 v[240:255], a[0:3], v[80:83], v[144:159]
    ds_read_b64_tr_b16 v[32:33], v3 offset:0
    ds_read_b64_tr_b16 v[34:35], v3 offset:2048
    v_exp_f32 v176, v176
    v_exp_f32 v177, v177
    v_exp_f32 v178, v178
    v_mfma_f32_32x32x16_bf16 v[240:255], a[4:7], v[84:87], v[240:255]
    v_exp_f32 v179, v179
    v_cvt_pk_bf16_f32 v72, v176, v177
    v_cvt_pk_bf16_f32 v73, v178, v179
    v_exp_f32 v180, v180
    v_mfma_f32_32x32x16_bf16 a[48:63], a[8:11], v[88:91], a[48:63]
    v_exp_f32 v181, v181
    v_exp_f32 v182, v182
    v_exp_f32 v183, v183
    v_mfma_f32_32x32x16_bf16 a[48:63], a[12:15], v[92:95], a[48:63]
    ds_read_b64_tr_b16 v[36:37], v4 offset:0
    ds_read_b64_tr_b16 v[38:39], v4 offset:2048
    v_cvt_pk_bf16_f32 v74, v180, v181
    v_cvt_pk_bf16_f32 v75, v182, v183
    v_exp_f32 v184, v184
    v_exp_f32 v185, v185
    v_exp_f32 v186, v186
    v_exp_f32 v187, v187
    v_cvt_pk_bf16_f32 v76, v184, v185
    v_cvt_pk_bf16_f32 v77, v186, v187
    v_smfmac_f32_16x16x64_bf16 a[68:71], a[72:75], v[88:95], v9
    ds_read_b64_tr_b16 v[40:41], v10 offset:0
    ds_read_b64_tr_b16 v[42:43], v10 offset:2048
    v_exp_f32 v188, v188
    v_exp_f32 v189, v189
    v_exp_f32 v190, v190
    v_exp_f32 v191, v191
    v_cvt_pk_bf16_f32 v78, v188, v189
    v_cvt_pk_bf16_f32 v79, v190, v191
    v_exp_f32 v240, v240
    v_exp_f32 v241, v241
    v_exp_f32 v242, v242
    v_exp_f32 v243, v243
    v_cvt_pk_bf16_f32 v88, v240, v241
    v_cvt_pk_bf16_f32 v89, v242, v243
    v_exp_f32 v244, v244
    v_mfma_f32_32x32x16_bf16 a[32:47], a[16:19], v[72:75], a[32:47]
    ds_read_b64_tr_b16 v[44:45], v11 offset:0
    ds_read_b64_tr_b16 v[46:47], v11 offset:2048
    v_exp_f32 v245, v245
    v_exp_f32 v246, v246
    v_exp_f32 v247, v247
    v_mfma_f32_32x32x16_bf16 a[32:47], a[20:23], v[76:79], a[32:47]
    ds_read_b64_tr_b16 v[48:49], v3 offset:4096
    ds_read_b64_tr_b16 v[50:51], v3 offset:6144
    v_cvt_pk_bf16_f32 v90, v244, v245
    v_cvt_pk_bf16_f32 v91, v246, v247
    v_exp_f32 v248, v248
    v_exp_f32 v249, v249
    v_exp_f32 v250, v250
    v_exp_f32 v251, v251
    v_cvt_pk_bf16_f32 v92, v248, v249
    v_cvt_pk_bf16_f32 v93, v250, v251
    v_smfmac_f32_16x16x64_bf16 a[64:67], a[72:75], v[72:79], v9
    ds_read_b64_tr_b16 v[52:53], v4 offset:4096
    ds_read_b64_tr_b16 v[54:55], v4 offset:6144
    ds_read_b64_tr_b16 v[56:57], v10 offset:4096
    ds_read_b64_tr_b16 v[58:59], v10 offset:6144
    ds_read_b64_tr_b16 v[60:61], v11 offset:4096
    ds_read_b64_tr_b16 v[62:63], v11 offset:6144
    v_exp_f32 v252, v252
    v_exp_f32 v253, v253
    v_exp_f32 v254, v254
    v_exp_f32 v255, v255
    v_cvt_pk_bf16_f32 v94, v252, v253
    v_cvt_pk_bf16_f32 v95, v254, v255
    s_add_u32 s36, s86, 8388608
    s_add_u32 s37, s86, 8454144
    v_mfma_f32_32x32x16_bf16 a[48:63], a[16:19], v[88:91], a[48:63]
    v_smfmac_f32_16x16x64_bf16 a[68:71], a[72:75], v[88:95], v9
    v_mfma_f32_32x32x16_bf16 a[48:63], a[20:23], v[92:95], a[48:63]
    s_waitcnt lgkmcnt(0)
    v_mfma_f32_16x16x32_bf16 v[128:131], v[32:35], a[76:79], 0
    ds_read_b64_tr_b16 a[0:1], v3 offset:8192
    v_accvgpr_read_b32 v19, a64
    v_accvgpr_read_b32 v21, a65
    v_accvgpr_read_b32 v176, a32
    v_mfma_f32_16x16x32_bf16 v[144:147], v[32:35], a[80:83], 0
    ds_read_b64_tr_b16 a[2:3], v3 offset:10240
    v_accvgpr_read_b32 v177, a33
    v_accvgpr_read_b32 v178, a34
    v_accvgpr_read_b32 v179, a35
    v_mfma_f32_16x16x32_bf16 v[132:135], v[36:39], a[76:79], 0
    ds_read_b64_tr_b16 a[4:5], v4 offset:8192
    v_accvgpr_read_b32 v180, a36
    v_accvgpr_read_b32 v181, a37
    v_accvgpr_read_b32 v182, a38
    v_mfma_f32_16x16x32_bf16 v[148:151], v[36:39], a[80:83], 0
    ds_read_b64_tr_b16 a[6:7], v4 offset:10240
    v_accvgpr_read_b32 v183, a39
    v_accvgpr_read_b32 v184, a40
    v_accvgpr_read_b32 v185, a41
    v_mfma_f32_16x16x32_bf16 v[136:139], v[40:43], a[76:79], 0
    ds_read_b64_tr_b16 a[8:9], v10 offset:8192
    v_accvgpr_read_b32 v186, a42
    v_accvgpr_read_b32 v187, a43
    v_accvgpr_read_b32 v188, a44
    v_mfma_f32_16x16x32_bf16 v[152:155], v[40:43], a[80:83], 0
    ds_read_b64_tr_b16 a[10:11], v10 offset:10240
    v_accvgpr_read_b32 v189, a45
    v_accvgpr_read_b32 v190, a46
    v_accvgpr_read_b32 v191, a47
    v_mfma_f32_16x16x32_bf16 v[140:143], v[44:47], a[76:79], 0
    ds_read_b64_tr_b16 a[12:13], v11 offset:8192
    v_add_f32 v19, v19, v21
    v_accvgpr_read_b32 v20, a68
    v_rcp_f32 v23, v19
    v_mfma_f32_16x16x32_bf16 v[156:159], v[44:47], a[80:83], 0
    ds_read_b64_tr_b16 a[14:15], v11 offset:10240
    v_accvgpr_read_b32 v21, a69
    v_add_f32 v20, v20, v21
    v_mul_f32 v176, v176, v23
    v_mfma_f32_16x16x32_bf16 v[128:131], v[48:51], a[84:87], v[128:131]
    ds_read_b64_tr_b16 v[32:33], v3 offset:12288
    v_mul_f32 v177, v177, v23
    v_mul_f32 v178, v178, v23
    v_mul_f32 v179, v179, v23
    v_mfma_f32_16x16x32_bf16 v[144:147], v[48:51], a[88:91], v[144:147]
    ds_read_b64_tr_b16 v[34:35], v3 offset:14336
    v_mul_f32 v180, v180, v23
    v_mul_f32 v181, v181, v23
    v_mul_f32 v182, v182, v23
    v_mfma_f32_16x16x32_bf16 v[132:135], v[52:55], a[84:87], v[132:135]
    ds_read_b64_tr_b16 v[36:37], v4 offset:12288
    v_mul_f32 v183, v183, v23
    v_mul_f32 v184, v184, v23
    v_mul_f32 v185, v185, v23
    v_mfma_f32_16x16x32_bf16 v[148:151], v[52:55], a[88:91], v[148:151]
    ds_read_b64_tr_b16 v[38:39], v4 offset:14336
    v_mul_f32 v186, v186, v23
    v_mul_f32 v187, v187, v23
    v_mul_f32 v188, v188, v23
    v_mfma_f32_16x16x32_bf16 v[136:139], v[56:59], a[84:87], v[136:139]
    ds_read_b64_tr_b16 v[40:41], v10 offset:12288
    v_mul_f32 v189, v189, v23
    v_mul_f32 v190, v190, v23
    v_mul_f32 v191, v191, v23
    v_mfma_f32_16x16x32_bf16 v[152:155], v[56:59], a[88:91], v[152:155]
    ds_read_b64_tr_b16 v[42:43], v10 offset:14336
    v_cvt_pk_bf16_f32 v176, v176, v177
    v_cvt_pk_bf16_f32 v177, v178, v179
    v_cvt_pk_bf16_f32 v178, v180, v181
    v_mfma_f32_16x16x32_bf16 v[140:143], v[60:63], a[84:87], v[140:143]
    ds_read_b64_tr_b16 v[44:45], v11 offset:12288
    v_cvt_pk_bf16_f32 v179, v182, v183
    v_cvt_pk_bf16_f32 v180, v184, v185
    v_cvt_pk_bf16_f32 v181, v186, v187
    v_mfma_f32_16x16x32_bf16 v[156:159], v[60:63], a[88:91], v[156:159]
    ds_read_b64_tr_b16 v[46:47], v11 offset:14336
    v_cvt_pk_bf16_f32 v182, v188, v189
    v_cvt_pk_bf16_f32 v183, v190, v191
    s_nop 0
    s_waitcnt lgkmcnt(8)
    v_mfma_f32_16x16x32_bf16 v[128:131], a[0:3], a[92:95], v[128:131]
    ds_read_b64_tr_b16 v[48:49], v3 offset:16384
    v_permlane16_swap_b32 v176, v180
    v_permlane16_swap_b32 v177, v181
    v_permlane16_swap_b32 v178, v182
    v_mfma_f32_16x16x32_bf16 v[144:147], a[0:3], a[96:99], v[144:147]
    ds_read_b64_tr_b16 v[50:51], v3 offset:18432
    v_permlane16_swap_b32 v179, v183
    v_rcp_f32 v24, v20
    buffer_store_dwordx4 v[176:179], v29, s[16:19], s36 offen sc1
    v_mfma_f32_16x16x32_bf16 v[132:135], a[4:7], a[92:95], v[132:135]
    ds_read_b64_tr_b16 v[52:53], v4 offset:16384
    buffer_store_dwordx4 v[180:183], v29, s[16:19], s36 offen offset:1024 sc1
    v_accvgpr_read_b32 v240, a48
    v_accvgpr_read_b32 v241, a49
    v_mfma_f32_16x16x32_bf16 v[148:151], a[4:7], a[96:99], v[148:151]
    ds_read_b64_tr_b16 v[54:55], v4 offset:18432
    v_accvgpr_read_b32 v242, a50
    v_accvgpr_read_b32 v243, a51
    v_accvgpr_read_b32 v244, a52
    v_mfma_f32_16x16x32_bf16 v[136:139], a[8:11], a[92:95], v[136:139]
    ds_read_b64_tr_b16 v[56:57], v10 offset:16384
    v_accvgpr_read_b32 v245, a53
    v_accvgpr_read_b32 v246, a54
    v_accvgpr_read_b32 v247, a55
    v_mfma_f32_16x16x32_bf16 v[152:155], a[8:11], a[96:99], v[152:155]
    ds_read_b64_tr_b16 v[58:59], v10 offset:18432
    v_accvgpr_read_b32 v248, a56
    v_accvgpr_read_b32 v249, a57
    v_accvgpr_read_b32 v250, a58
    v_mfma_f32_16x16x32_bf16 v[140:143], a[12:15], a[92:95], v[140:143]
    ds_read_b64_tr_b16 v[60:61], v11 offset:16384
    v_accvgpr_read_b32 v251, a59
    v_accvgpr_read_b32 v252, a60
    v_accvgpr_read_b32 v253, a61
    v_mfma_f32_16x16x32_bf16 v[156:159], a[12:15], a[96:99], v[156:159]
    ds_read_b64_tr_b16 v[62:63], v11 offset:18432
    v_accvgpr_read_b32 v254, a62
    v_accvgpr_read_b32 v255, a63
    v_mul_f32 v240, v240, v24
    s_waitcnt lgkmcnt(8)
    v_mfma_f32_16x16x32_bf16 v[128:131], v[32:35], a[100:103], v[128:131]
    ds_read_b64_tr_b16 a[0:1], v3 offset:20480
    v_mul_f32 v241, v241, v24
    v_mul_f32 v242, v242, v24
    v_mul_f32 v243, v243, v24
    v_mfma_f32_16x16x32_bf16 v[144:147], v[32:35], a[104:107], v[144:147]
    ds_read_b64_tr_b16 a[2:3], v3 offset:22528
    v_mul_f32 v244, v244, v24
    v_mul_f32 v245, v245, v24
    v_mul_f32 v246, v246, v24
    v_mfma_f32_16x16x32_bf16 v[132:135], v[36:39], a[100:103], v[132:135]
    ds_read_b64_tr_b16 a[4:5], v4 offset:20480
    v_mul_f32 v247, v247, v24
    v_mul_f32 v248, v248, v24
    v_mul_f32 v249, v249, v24
    v_mfma_f32_16x16x32_bf16 v[148:151], v[36:39], a[104:107], v[148:151]
    ds_read_b64_tr_b16 a[6:7], v4 offset:22528
    v_mul_f32 v250, v250, v24
    v_mul_f32 v251, v251, v24
    v_mul_f32 v252, v252, v24
    v_mfma_f32_16x16x32_bf16 v[136:139], v[40:43], a[100:103], v[136:139]
    ds_read_b64_tr_b16 a[8:9], v10 offset:20480
    v_mul_f32 v253, v253, v24
    v_mul_f32 v254, v254, v24
    v_mul_f32 v255, v255, v24
    v_mfma_f32_16x16x32_bf16 v[152:155], v[40:43], a[104:107], v[152:155]
    ds_read_b64_tr_b16 a[10:11], v10 offset:22528
    v_cvt_pk_bf16_f32 v240, v240, v241
    v_cvt_pk_bf16_f32 v241, v242, v243
    v_cvt_pk_bf16_f32 v242, v244, v245
    v_mfma_f32_16x16x32_bf16 v[140:143], v[44:47], a[100:103], v[140:143]
    ds_read_b64_tr_b16 a[12:13], v11 offset:20480
    v_cvt_pk_bf16_f32 v243, v246, v247
    v_cvt_pk_bf16_f32 v244, v248, v249
    v_cvt_pk_bf16_f32 v245, v250, v251
    v_mfma_f32_16x16x32_bf16 v[156:159], v[44:47], a[104:107], v[156:159]
    ds_read_b64_tr_b16 a[14:15], v11 offset:22528
    v_cvt_pk_bf16_f32 v246, v252, v253
    v_cvt_pk_bf16_f32 v247, v254, v255
    s_nop 0
    s_waitcnt lgkmcnt(8)
    v_mfma_f32_16x16x32_bf16 v[128:131], v[48:51], a[108:111], v[128:131]
    ds_read_b64_tr_b16 v[32:33], v3 offset:24576
    v_permlane16_swap_b32 v240, v244
    v_permlane16_swap_b32 v241, v245
    v_permlane16_swap_b32 v242, v246
    v_mfma_f32_16x16x32_bf16 v[144:147], v[48:51], a[112:115], v[144:147]
    ds_read_b64_tr_b16 v[34:35], v3 offset:26624
    v_permlane16_swap_b32 v243, v247
    s_mov_b32 s36, 1602224128
    buffer_store_dwordx4 v[240:243], v29, s[16:19], s37 offen sc1
    v_mfma_f32_16x16x32_bf16 v[132:135], v[52:55], a[108:111], v[132:135]
    ds_read_b64_tr_b16 v[36:37], v4 offset:24576
    buffer_store_dwordx4 v[244:247], v29, s[16:19], s37 offen offset:1024 sc1
    v_mov_b32 v21, 0
    v_dot2_f32_bf16 v19, v176, v21, v19
    v_mfma_f32_16x16x32_bf16 v[148:151], v[52:55], a[112:115], v[148:151]
    ds_read_b64_tr_b16 v[38:39], v4 offset:26624
    v_dot2_f32_bf16 v19, v177, v21, v19
    v_dot2_f32_bf16 v19, v178, v21, v19
    v_dot2_f32_bf16 v19, v179, v21, v19
    v_mfma_f32_16x16x32_bf16 v[136:139], v[56:59], a[108:111], v[136:139]
    ds_read_b64_tr_b16 v[40:41], v10 offset:24576
    v_dot2_f32_bf16 v19, v180, v21, v19
    v_dot2_f32_bf16 v19, v181, v21, v19
    v_dot2_f32_bf16 v19, v182, v21, v19
    v_dot2_f32_bf16 v19, v183, v21, v19
    v_mfma_f32_16x16x32_bf16 v[152:155], v[56:59], a[112:115], v[152:155]
    ds_read_b64_tr_b16 v[42:43], v10 offset:26624
    v_dot2_f32_bf16 v20, v240, v21, v20
    v_dot2_f32_bf16 v20, v241, v21, v20
    s_add_u32 s39, s91, 0
    s_and_b32 s39, s39, 0x1fffff
    s_add_u32 m0, s34, 131072
    v_mfma_f32_16x16x32_bf16 v[140:143], v[60:63], a[108:111], v[140:143]
    ds_read_b64_tr_b16 v[44:45], v11 offset:24576
    v_dot2_f32_bf16 v20, v242, v21, v20
    v_dot2_f32_bf16 v20, v243, v21, v20
    v_dot2_f32_bf16 v20, v244, v21, v20
    v_mfma_f32_16x16x32_bf16 v[156:159], v[60:63], a[112:115], v[156:159]
    ds_read_b64_tr_b16 v[46:47], v11 offset:26624
    v_dot2_f32_bf16 v20, v245, v21, v20
    v_dot2_f32_bf16 v20, v246, v21, v20
    v_dot2_f32_bf16 v20, v247, v21, v20
    buffer_load_dwordx4 v15, s[4:7], s39 offen lds
    s_waitcnt lgkmcnt(8)
    v_mfma_f32_16x16x32_bf16 v[128:131], a[0:3], a[116:119], v[128:131]
    ds_read_b64_tr_b16 v[48:49], v3 offset:28672
    s_nop 2
    v_cmp_nge_f32 s[56:57], s36, v19
    v_cmp_nge_f32 vcc, s36, v20
    s_lshl_b32 s37, s20, 2
    v_mfma_f32_16x16x32_bf16 v[144:147], a[0:3], a[120:123], v[144:147]
    ds_read_b64_tr_b16 v[50:51], v3 offset:30720
    s_add_u32 s37, s37, 163824
    v_mov_b32 v22, s37
    s_add_u32 s39, s91, 65536
    s_and_b32 s39, s39, 0x1fffff
    s_add_u32 m0, s34, 135168
    v_mfma_f32_16x16x32_bf16 v[132:135], a[4:7], a[116:119], v[132:135]
    ds_read_b64_tr_b16 v[52:53], v4 offset:28672
    s_nop 1
    s_or_b64 vcc, vcc, s[56:57]
    s_cmp_lg_u64 vcc, 0
    s_cselect_b32 s36, 1, 0
    s_andn2_b32 s36, s36, s83
    v_mfma_f32_16x16x32_bf16 v[148:151], a[4:7], a[120:123], v[148:151]
    ds_read_b64_tr_b16 v[54:55], v4 offset:30720
    v_mov_b32 v21, s36
    ds_write_b32 v22, v21
    v_mov_b32 v22, 163824
    buffer_load_dwordx4 v15, s[4:7], s39 offen lds
    v_mfma_f32_16x16x32_bf16 v[136:139], a[8:11], a[116:119], v[136:139]
    ds_read_b64_tr_b16 v[56:57], v10 offset:28672
    s_add_u32 s39, s91, 131072
    v_mfma_f32_16x16x32_bf16 v[152:155], a[8:11], a[120:123], v[152:155]
    ds_read_b64_tr_b16 v[58:59], v10 offset:30720
    s_and_b32 s39, s39, 0x1fffff
    s_add_u32 m0, s34, 139264
    v_mfma_f32_16x16x32_bf16 v[140:143], a[12:15], a[116:119], v[140:143]
    ds_read_b64_tr_b16 v[60:61], v11 offset:28672
    v_mfma_f32_16x16x32_bf16 v[156:159], a[12:15], a[120:123], v[156:159]
    ds_read_b64_tr_b16 v[62:63], v11 offset:30720
    buffer_load_dwordx4 v15, s[4:7], s39 offen lds
    s_waitcnt vmcnt(63) lgkmcnt(4)
    s_barrier
    v_mfma_f32_16x16x32_bf16 v[128:131], v[32:35], a[124:127], v[128:131]
    ds_read_b128 v[20:23], v22
    ds_read_b64_tr_b16 a[0:1], v3 offset:32768
    s_add_u32 s39, s91, 196608
    v_mfma_f32_16x16x32_bf16 v[144:147], v[32:35], a[128:131], v[144:147]
    ds_read_b64_tr_b16 a[2:3], v3 offset:34816
    s_and_b32 s39, s39, 0x1fffff
    s_add_u32 m0, s34, 143360
    v_mfma_f32_16x16x32_bf16 v[132:135], v[36:39], a[124:127], v[132:135]
    ds_read_b64_tr_b16 a[4:5], v4 offset:32768
    s_lshl_b32 s38, s94, 7
    v_mfma_f32_16x16x32_bf16 v[148:151], v[36:39], a[128:131], v[148:151]
    ds_read_b64_tr_b16 a[6:7], v4 offset:34816
    s_lshl_b32 s47, s97, 2
    buffer_load_dwordx4 v15, s[4:7], s39 offen lds
    v_mfma_f32_16x16x32_bf16 v[136:139], v[40:43], a[124:127], v[136:139]
    ds_read_b64_tr_b16 a[8:9], v10 offset:32768
    s_add_u32 s38, s38, s47
    s_add_u32 s35, s38, 22032384
    v_mfma_f32_16x16x32_bf16 v[152:155], v[40:43], a[128:131], v[152:155]
    ds_read_b64_tr_b16 a[10:11], v10 offset:34816
    s_add_u32 s39, s91, 262144
    s_and_b32 s39, s39, 0x1fffff
    s_add_u32 m0, s34, 147456
    v_mfma_f32_16x16x32_bf16 v[140:143], v[44:47], a[124:127], v[140:143]
    ds_read_b64_tr_b16 a[12:13], v11 offset:32768
    s_add_u32 s47, s29, 22032384
    v_mfma_f32_16x16x32_bf16 v[156:159], v[44:47], a[128:131], v[156:159]
    ds_read_b64_tr_b16 a[14:15], v11 offset:34816
    s_lshl_b32 s36, s88, 9
    buffer_load_dwordx4 v15, s[4:7], s39 offen lds
    s_waitcnt lgkmcnt(9)
    v_mfma_f32_16x16x32_bf16 v[128:131], v[48:51], a[132:135], v[128:131]
    ds_read_b64_tr_b16 v[32:33], v3 offset:36864
    s_lshl_b32 s37, s20, 7
    s_add_u32 s36, s36, s37
    v_mfma_f32_16x16x32_bf16 v[144:147], v[48:51], a[136:139], v[144:147]
    ds_read_b64_tr_b16 v[34:35], v3 offset:38912
    s_add_u32 s39, s91, 327680
    s_and_b32 s39, s39, 0x1fffff
    s_add_u32 m0, s34, 151552
    v_mfma_f32_16x16x32_bf16 v[132:135], v[52:55], a[132:135], v[132:135]
    ds_read_b64_tr_b16 v[36:37], v4 offset:36864
    s_add_u32 s36, s36, 20971520
    v_mfma_f32_16x16x32_bf16 v[148:151], v[52:55], a[136:139], v[148:151]
    ds_read_b64_tr_b16 v[38:39], v4 offset:38912
    v_and_b32 v24, 60, v16
    buffer_load_dwordx4 v15, s[4:7], s39 offen lds
    v_mfma_f32_16x16x32_bf16 v[136:139], v[56:59], a[132:135], v[136:139]
    ds_read_b64_tr_b16 v[40:41], v10 offset:36864
    buffer_load_dword v12, v24, s[16:19], s36 offen sc1
    buffer_load_dword v13, v24, s[16:19], s36 offen offset:64 sc1
    v_mfma_f32_16x16x32_bf16 v[152:155], v[56:59], a[136:139], v[152:155]
    ds_read_b64_tr_b16 v[42:43], v10 offset:38912
    s_add_u32 s39, s91, 393216
    s_and_b32 s39, s39, 0x1fffff
    s_add_u32 m0, s34, 155648
    v_mfma_f32_16x16x32_bf16 v[140:143], v[60:63], a[132:135], v[140:143]
    ds_read_b64_tr_b16 v[44:45], v11 offset:36864
    v_mfma_f32_16x16x32_bf16 v[156:159], v[60:63], a[136:139], v[156:159]
    ds_read_b64_tr_b16 v[46:47], v11 offset:38912
    buffer_load_dwordx4 v15, s[4:7], s39 offen lds
    s_waitcnt lgkmcnt(8)
    v_mfma_f32_16x16x32_bf16 v[128:131], a[0:3], a[140:143], v[128:131]
    ds_read_b64_tr_b16 v[48:49], v3 offset:40960
    v_or_b32 v20, v20, v21
    v_or3_b32 v20, v20, v22, v23
    v_mfma_f32_16x16x32_bf16 v[144:147], a[0:3], a[144:147], v[144:147]
    ds_read_b64_tr_b16 v[50:51], v3 offset:43008
    s_add_u32 s39, s91, 524288
    s_and_b32 s39, s39, 0x1fffff
    s_add_u32 m0, s34, 0
    v_mfma_f32_16x16x32_bf16 v[132:135], a[4:7], a[140:143], v[132:135]
    ds_read_b64_tr_b16 v[52:53], v4 offset:40960
    v_readfirstlane_b32 s38, v20
    v_mfma_f32_16x16x32_bf16 v[148:151], a[4:7], a[144:147], v[148:151]
    ds_read_b64_tr_b16 v[54:55], v4 offset:43008
    buffer_load_dwordx4 v15, s[4:7], s39 offen lds
    v_mfma_f32_16x16x32_bf16 v[136:139], a[8:11], a[140:143], v[136:139]
    ds_read_b64_tr_b16 v[56:57], v10 offset:40960
    s_add_u32 s39, s91, 589824
    v_mfma_f32_16x16x32_bf16 v[152:155], a[8:11], a[144:147], v[152:155]
    ds_read_b64_tr_b16 v[58:59], v10 offset:43008
    s_and_b32 s39, s39, 0x1fffff
    s_add_u32 m0, s34, 4096
    v_mfma_f32_16x16x32_bf16 v[140:143], a[12:15], a[140:143], v[140:143]
    ds_read_b64_tr_b16 v[60:61], v11 offset:40960
    s_cmp_lg_u32 s38, 0
    s_cbranch_scc1 L_FALLBACK
    v_mfma_f32_16x16x32_bf16 v[156:159], a[12:15], a[144:147], v[156:159]
    ds_read_b64_tr_b16 v[62:63], v11 offset:43008
    buffer_load_dwordx4 v15, s[4:7], s39 offen lds
    s_waitcnt lgkmcnt(8)
    v_mfma_f32_16x16x32_bf16 v[128:131], v[32:35], a[148:151], v[128:131]
    ds_read_b64_tr_b16 a[0:1], v3 offset:45056
    s_add_u32 s39, s91, 655360
    v_mfma_f32_16x16x32_bf16 v[144:147], v[32:35], a[152:155], v[144:147]
    ds_read_b64_tr_b16 a[2:3], v3 offset:47104
    s_and_b32 s39, s39, 0x1fffff
    s_add_u32 m0, s34, 8192
    v_mfma_f32_16x16x32_bf16 v[132:135], v[36:39], a[148:151], v[132:135]
    ds_read_b64_tr_b16 a[4:5], v4 offset:45056
    s_add_u32 s38, s96, 8388608
    v_mfma_f32_16x16x32_bf16 v[148:151], v[36:39], a[152:155], v[148:151]
    ds_read_b64_tr_b16 a[6:7], v4 offset:47104
    s_add_u32 s98, s54, s38
    s_addc_u32 s99, s55, 0
    buffer_load_dwordx4 v15, s[4:7], s39 offen lds
    v_mfma_f32_16x16x32_bf16 v[136:139], v[40:43], a[148:151], v[136:139]
    ds_read_b64_tr_b16 a[8:9], v10 offset:45056
    s_add_u32 s100, s98, s90
    s_addc_u32 s101, s99, 0
    s_add_u32 s39, s91, 720896
    v_mfma_f32_16x16x32_bf16 v[152:155], v[40:43], a[152:155], v[152:155]
    ds_read_b64_tr_b16 a[10:11], v10 offset:47104
    s_and_b32 s39, s39, 0x1fffff
    s_add_u32 m0, s34, 12288
    v_mfma_f32_16x16x32_bf16 v[140:143], v[44:47], a[148:151], v[140:143]
    ds_read_b64_tr_b16 a[12:13], v11 offset:45056
    v_mfma_f32_16x16x32_bf16 v[156:159], v[44:47], a[152:155], v[156:159]
    ds_read_b64_tr_b16 a[14:15], v11 offset:47104
    buffer_load_dwordx4 v15, s[4:7], s39 offen lds
    s_waitcnt lgkmcnt(8)
    v_mfma_f32_16x16x32_bf16 v[128:131], v[48:51], a[156:159], v[128:131]
    ds_read_b64_tr_b16 v[32:33], v3 offset:49152
    s_waitcnt vmcnt(13)
    s_add_u32 s39, s91, 786432
    v_mfma_f32_16x16x32_bf16 v[144:147], v[48:51], a[160:163], v[144:147]
    ds_read_b64_tr_b16 v[34:35], v3 offset:51200
    s_and_b32 s39, s39, 0x1fffff
    s_add_u32 m0, s34, 16384
    v_mfma_f32_16x16x32_bf16 v[132:135], v[52:55], a[156:159], v[132:135]
    ds_read_b64_tr_b16 v[36:37], v4 offset:49152
    v_mov_b32 v20, s60
    v_mfma_f32_16x16x32_bf16 v[148:151], v[52:55], a[160:163], v[148:151]
    ds_read_b64_tr_b16 v[38:39], v4 offset:51200
    buffer_store_dword v20, v31, s[16:19], s35 offen sc1
    buffer_load_dwordx4 v15, s[4:7], s39 offen lds
    v_mfma_f32_16x16x32_bf16 v[136:139], v[56:59], a[156:159], v[136:139]
    ds_read_b64_tr_b16 v[40:41], v10 offset:49152
    s_add_u32 s39, s91, 851968
    v_mfma_f32_16x16x32_bf16 v[152:155], v[56:59], a[160:163], v[152:155]
    ds_read_b64_tr_b16 v[42:43], v10 offset:51200
    s_and_b32 s39, s39, 0x1fffff
    s_add_u32 m0, s34, 20480
    v_mfma_f32_16x16x32_bf16 v[140:143], v[60:63], a[156:159], v[140:143]
    ds_read_b64_tr_b16 v[44:45], v11 offset:49152
    v_mfma_f32_16x16x32_bf16 v[156:159], v[60:63], a[160:163], v[156:159]
    ds_read_b64_tr_b16 v[46:47], v11 offset:51200
    buffer_load_dwordx4 v15, s[4:7], s39 offen lds
    s_waitcnt lgkmcnt(8)
    v_mfma_f32_16x16x32_bf16 v[128:131], a[0:3], a[164:167], v[128:131]
    ds_read_b64_tr_b16 v[48:49], v3 offset:53248
    s_add_u32 s39, s91, 917504
    v_mfma_f32_16x16x32_bf16 v[144:147], a[0:3], a[168:171], v[144:147]
    ds_read_b64_tr_b16 v[50:51], v3 offset:55296
    s_and_b32 s39, s39, 0x1fffff
    s_add_u32 m0, s34, 24576
    v_mfma_f32_16x16x32_bf16 v[132:135], a[4:7], a[164:167], v[132:135]
    ds_read_b64_tr_b16 v[52:53], v4 offset:53248
    v_mfma_f32_16x16x32_bf16 v[148:151], a[4:7], a[168:171], v[148:151]
    ds_read_b64_tr_b16 v[54:55], v4 offset:55296
    buffer_load_dwordx4 v15, s[4:7], s39 offen lds
    v_mfma_f32_16x16x32_bf16 v[136:139], a[8:11], a[164:167], v[136:139]
    ds_read_b64_tr_b16 v[56:57], v10 offset:53248
    v_mfma_f32_16x16x32_bf16 v[152:155], a[8:11], a[168:171], v[152:155]
    ds_read_b64_tr_b16 v[58:59], v10 offset:55296
    v_mfma_f32_16x16x32_bf16 v[140:143], a[12:15], a[164:167], v[140:143]
    ds_read_b64_tr_b16 v[60:61], v11 offset:53248
    v_mfma_f32_16x16x32_bf16 v[156:159], a[12:15], a[168:171], v[156:159]
    ds_read_b64_tr_b16 v[62:63], v11 offset:55296
    s_waitcnt lgkmcnt(8)
    v_mfma_f32_16x16x32_bf16 v[128:131], v[32:35], a[172:175], v[128:131]
    ds_read_b64_tr_b16 a[0:1], v3 offset:57344
    v_mfma_f32_16x16x32_bf16 v[144:147], v[32:35], a[176:179], v[144:147]
    ds_read_b64_tr_b16 a[2:3], v3 offset:59392
    v_mfma_f32_16x16x32_bf16 v[132:135], v[36:39], a[172:175], v[132:135]
    ds_read_b64_tr_b16 a[4:5], v4 offset:57344
    v_mfma_f32_16x16x32_bf16 v[148:151], v[36:39], a[176:179], v[148:151]
    ds_read_b64_tr_b16 a[6:7], v4 offset:59392
    v_mfma_f32_16x16x32_bf16 v[136:139], v[40:43], a[172:175], v[136:139]
    ds_read_b64_tr_b16 a[8:9], v10 offset:57344
    v_mfma_f32_16x16x32_bf16 v[152:155], v[40:43], a[176:179], v[152:155]
    ds_read_b64_tr_b16 a[10:11], v10 offset:59392
    v_mfma_f32_16x16x32_bf16 v[140:143], v[44:47], a[172:175], v[140:143]
    ds_read_b64_tr_b16 a[12:13], v11 offset:57344
    v_mfma_f32_16x16x32_bf16 v[156:159], v[44:47], a[176:179], v[156:159]
    ds_read_b64_tr_b16 a[14:15], v11 offset:59392
    s_waitcnt lgkmcnt(8)
    v_mfma_f32_16x16x32_bf16 v[128:131], v[48:51], a[180:183], v[128:131]
    ds_read_b64_tr_b16 v[32:33], v3 offset:61440
    v_mfma_f32_16x16x32_bf16 v[144:147], v[48:51], a[184:187], v[144:147]
    ds_read_b64_tr_b16 v[34:35], v3 offset:63488
    v_add_u32 v3, 65536, v3
    v_mfma_f32_16x16x32_bf16 v[132:135], v[52:55], a[180:183], v[132:135]
    ds_read_b64_tr_b16 v[36:37], v4 offset:61440
    v_mfma_f32_16x16x32_bf16 v[148:151], v[52:55], a[184:187], v[148:151]
    ds_read_b64_tr_b16 v[38:39], v4 offset:63488
    v_add_u32 v4, 65536, v4
    v_mfma_f32_16x16x32_bf16 v[136:139], v[56:59], a[180:183], v[136:139]
    ds_read_b64_tr_b16 v[40:41], v10 offset:61440
    v_mfma_f32_16x16x32_bf16 v[152:155], v[56:59], a[184:187], v[152:155]
    ds_read_b64_tr_b16 v[42:43], v10 offset:63488
    v_add_u32 v10, 65536, v10
    v_mfma_f32_16x16x32_bf16 v[140:143], v[60:63], a[180:183], v[140:143]
    ds_read_b64_tr_b16 v[44:45], v11 offset:61440
    v_mfma_f32_16x16x32_bf16 v[156:159], v[60:63], a[184:187], v[156:159]
    ds_read_b64_tr_b16 v[46:47], v11 offset:63488
    v_add_u32 v11, 65536, v11
    s_waitcnt vmcnt(29) lgkmcnt(8)
    s_barrier
    v_mfma_f32_16x16x32_bf16 v[128:131], a[0:3], a[188:191], v[128:131]
    ds_read_b64_tr_b16 v[48:49], v3 offset:0
    s_add_u32 s39, s91, 458752
    v_mfma_f32_16x16x32_bf16 v[144:147], a[0:3], a[192:195], v[144:147]
    ds_read_b64_tr_b16 v[50:51], v3 offset:2048
    s_and_b32 s39, s39, 0x1fffff
    s_add_u32 m0, s34, 159744
    v_mfma_f32_16x16x32_bf16 v[132:135], a[4:7], a[188:191], v[132:135]
    ds_read_b64_tr_b16 v[52:53], v4 offset:0
    v_mfma_f32_16x16x32_bf16 v[148:151], a[4:7], a[192:195], v[148:151]
    ds_read_b64_tr_b16 v[54:55], v4 offset:2048
    buffer_load_dwordx4 v15, s[4:7], s39 offen lds
    v_mfma_f32_16x16x32_bf16 v[136:139], a[8:11], a[188:191], v[136:139]
    ds_read_b64_tr_b16 v[56:57], v10 offset:0
    s_add_u32 s39, s91, 983040
    v_mfma_f32_16x16x32_bf16 v[152:155], a[8:11], a[192:195], v[152:155]
    ds_read_b64_tr_b16 v[58:59], v10 offset:2048
    s_and_b32 s39, s39, 0x1fffff
    s_add_u32 m0, s34, 28672
    v_mfma_f32_16x16x32_bf16 v[140:143], a[12:15], a[188:191], v[140:143]
    ds_read_b64_tr_b16 v[60:61], v11 offset:0
    v_mfma_f32_16x16x32_bf16 v[156:159], a[12:15], a[192:195], v[156:159]
    ds_read_b64_tr_b16 v[62:63], v11 offset:2048
    buffer_load_dwordx4 v15, s[4:7], s39 offen lds
    s_waitcnt lgkmcnt(8)
    v_mfma_f32_16x16x32_bf16 v[128:131], v[32:35], a[196:199], v[128:131]
    ds_read_b64_tr_b16 a[0:1], v3 offset:4096
    s_add_u32 s39, s91, 1048576
    v_mfma_f32_16x16x32_bf16 v[144:147], v[32:35], a[200:203], v[144:147]
    ds_read_b64_tr_b16 a[2:3], v3 offset:6144
    s_and_b32 s39, s39, 0x1fffff
    s_add_u32 m0, s34, 32768
    v_mfma_f32_16x16x32_bf16 v[132:135], v[36:39], a[196:199], v[132:135]
    ds_read_b64_tr_b16 a[4:5], v4 offset:4096
    v_mfma_f32_16x16x32_bf16 v[148:151], v[36:39], a[200:203], v[148:151]
    ds_read_b64_tr_b16 a[6:7], v4 offset:6144
    buffer_load_dwordx4 v15, s[4:7], s39 offen lds
    v_mfma_f32_16x16x32_bf16 v[136:139], v[40:43], a[196:199], v[136:139]
    ds_read_b64_tr_b16 a[8:9], v10 offset:4096
    s_add_u32 s39, s91, 1114112
    v_mfma_f32_16x16x32_bf16 v[152:155], v[40:43], a[200:203], v[152:155]
    ds_read_b64_tr_b16 a[10:11], v10 offset:6144
    s_and_b32 s39, s39, 0x1fffff
    s_add_u32 m0, s34, 36864
    v_mfma_f32_16x16x32_bf16 v[140:143], v[44:47], a[196:199], v[140:143]
    ds_read_b64_tr_b16 a[12:13], v11 offset:4096
    v_mfma_f32_16x16x32_bf16 v[156:159], v[44:47], a[200:203], v[156:159]
    ds_read_b64_tr_b16 a[14:15], v11 offset:6144
    buffer_load_dwordx4 v15, s[4:7], s39 offen lds
    s_waitcnt lgkmcnt(8)
    v_mfma_f32_16x16x32_bf16 v[128:131], v[48:51], a[204:207], v[128:131]
    ds_read_b64_tr_b16 v[32:33], v3 offset:8192
    s_add_u32 s39, s91, 1179648
    v_mfma_f32_16x16x32_bf16 v[144:147], v[48:51], a[208:211], v[144:147]
    ds_read_b64_tr_b16 v[34:35], v3 offset:10240
    s_and_b32 s39, s39, 0x1fffff
    s_add_u32 m0, s34, 40960
    v_mfma_f32_16x16x32_bf16 v[132:135], v[52:55], a[204:207], v[132:135]
    ds_read_b64_tr_b16 v[36:37], v4 offset:8192
    v_mfma_f32_16x16x32_bf16 v[148:151], v[52:55], a[208:211], v[148:151]
    ds_read_b64_tr_b16 v[38:39], v4 offset:10240
    buffer_load_dwordx4 v15, s[4:7], s39 offen lds
    v_mfma_f32_16x16x32_bf16 v[136:139], v[56:59], a[204:207], v[136:139]
    ds_read_b64_tr_b16 v[40:41], v10 offset:8192
    s_add_u32 s39, s91, 1245184
    v_mfma_f32_16x16x32_bf16 v[152:155], v[56:59], a[208:211], v[152:155]
    ds_read_b64_tr_b16 v[42:43], v10 offset:10240
    s_and_b32 s39, s39, 0x1fffff
    s_add_u32 m0, s34, 45056
    v_mfma_f32_16x16x32_bf16 v[140:143], v[60:63], a[204:207], v[140:143]
    ds_read_b64_tr_b16 v[44:45], v11 offset:8192
    v_mfma_f32_16x16x32_bf16 v[156:159], v[60:63], a[208:211], v[156:159]
    ds_read_b64_tr_b16 v[46:47], v11 offset:10240
    buffer_load_dwordx4 v15, s[4:7], s39 offen lds
    s_waitcnt lgkmcnt(8)
    v_mfma_f32_16x16x32_bf16 v[128:131], a[0:3], a[212:215], v[128:131]
    ds_read_b64_tr_b16 v[48:49], v3 offset:12288
    s_add_u32 s39, s91, 1310720
    v_mfma_f32_16x16x32_bf16 v[144:147], a[0:3], a[216:219], v[144:147]
    ds_read_b64_tr_b16 v[50:51], v3 offset:14336
    s_and_b32 s39, s39, 0x1fffff
    s_add_u32 m0, s34, 49152
    v_mfma_f32_16x16x32_bf16 v[132:135], a[4:7], a[212:215], v[132:135]
    ds_read_b64_tr_b16 v[52:53], v4 offset:12288
    v_mfma_f32_16x16x32_bf16 v[148:151], a[4:7], a[216:219], v[148:151]
    ds_read_b64_tr_b16 v[54:55], v4 offset:14336
    buffer_load_dwordx4 v15, s[4:7], s39 offen lds
    v_mfma_f32_16x16x32_bf16 v[136:139], a[8:11], a[212:215], v[136:139]
    ds_read_b64_tr_b16 v[56:57], v10 offset:12288
    s_add_u32 s39, s91, 1376256
    v_mfma_f32_16x16x32_bf16 v[152:155], a[8:11], a[216:219], v[152:155]
    ds_read_b64_tr_b16 v[58:59], v10 offset:14336
    s_and_b32 s39, s39, 0x1fffff
    s_add_u32 m0, s34, 53248
    v_mfma_f32_16x16x32_bf16 v[140:143], a[12:15], a[212:215], v[140:143]
    ds_read_b64_tr_b16 v[60:61], v11 offset:12288
    v_mfma_f32_16x16x32_bf16 v[156:159], a[12:15], a[216:219], v[156:159]
    ds_read_b64_tr_b16 v[62:63], v11 offset:14336
    buffer_load_dwordx4 v15, s[4:7], s39 offen lds
    s_waitcnt lgkmcnt(8)
    v_mfma_f32_16x16x32_bf16 v[128:131], v[32:35], a[220:223], v[128:131]
    ds_read_b64_tr_b16 a[0:1], v3 offset:16384
    s_add_u32 s39, s91, 1441792
    v_mfma_f32_16x16x32_bf16 v[144:147], v[32:35], a[224:227], v[144:147]
    ds_read_b64_tr_b16 a[2:3], v3 offset:18432
    s_and_b32 s39, s39, 0x1fffff
    s_add_u32 m0, s34, 57344
    v_mfma_f32_16x16x32_bf16 v[132:135], v[36:39], a[220:223], v[132:135]
    ds_read_b64_tr_b16 a[4:5], v4 offset:16384
    v_mfma_f32_16x16x32_bf16 v[148:151], v[36:39], a[224:227], v[148:151]
    ds_read_b64_tr_b16 a[6:7], v4 offset:18432
    buffer_load_dwordx4 v15, s[4:7], s39 offen lds
    v_mfma_f32_16x16x32_bf16 v[136:139], v[40:43], a[220:223], v[136:139]
    ds_read_b64_tr_b16 a[8:9], v10 offset:16384
    v_mfma_f32_16x16x32_bf16 v[152:155], v[40:43], a[224:227], v[152:155]
    ds_read_b64_tr_b16 a[10:11], v10 offset:18432
    v_mfma_f32_16x16x32_bf16 v[140:143], v[44:47], a[220:223], v[140:143]
    ds_read_b64_tr_b16 a[12:13], v11 offset:16384
    v_mfma_f32_16x16x32_bf16 v[156:159], v[44:47], a[224:227], v[156:159]
    ds_read_b64_tr_b16 a[14:15], v11 offset:18432
    s_waitcnt lgkmcnt(8)
    v_mfma_f32_16x16x32_bf16 v[128:131], v[48:51], a[228:231], v[128:131]
    ds_read_b64_tr_b16 v[32:33], v3 offset:20480
    v_mfma_f32_16x16x32_bf16 v[144:147], v[48:51], a[232:235], v[144:147]
    ds_read_b64_tr_b16 v[34:35], v3 offset:22528
    v_mfma_f32_16x16x32_bf16 v[132:135], v[52:55], a[228:231], v[132:135]
    ds_read_b64_tr_b16 v[36:37], v4 offset:20480
    v_mfma_f32_16x16x32_bf16 v[148:151], v[52:55], a[232:235], v[148:151]
    ds_read_b64_tr_b16 v[38:39], v4 offset:22528
    v_mfma_f32_16x16x32_bf16 v[136:139], v[56:59], a[228:231], v[136:139]
    ds_read_b64_tr_b16 v[40:41], v10 offset:20480
    v_mfma_f32_16x16x32_bf16 v[152:155], v[56:59], a[232:235], v[152:155]
    ds_read_b64_tr_b16 v[42:43], v10 offset:22528
    v_mfma_f32_16x16x32_bf16 v[140:143], v[60:63], a[228:231], v[140:143]
    ds_read_b64_tr_b16 v[44:45], v11 offset:20480
    v_mfma_f32_16x16x32_bf16 v[156:159], v[60:63], a[232:235], v[156:159]
    ds_read_b64_tr_b16 v[46:47], v11 offset:22528
    s_waitcnt lgkmcnt(8)
    v_mfma_f32_16x16x32_bf16 v[128:131], a[0:3], a[236:239], v[128:131]
    ds_read_b64_tr_b16 v[48:49], v3 offset:24576
    v_mfma_f32_16x16x32_bf16 v[144:147], a[0:3], a[240:243], v[144:147]
    ds_read_b64_tr_b16 v[50:51], v3 offset:26624
    v_mfma_f32_16x16x32_bf16 v[132:135], a[4:7], a[236:239], v[132:135]
    ds_read_b64_tr_b16 v[52:53], v4 offset:24576
    v_mfma_f32_16x16x32_bf16 v[148:151], a[4:7], a[240:243], v[148:151]
    ds_read_b64_tr_b16 v[54:55], v4 offset:26624
    v_mfma_f32_16x16x32_bf16 v[136:139], a[8:11], a[236:239], v[136:139]
    ds_read_b64_tr_b16 v[56:57], v10 offset:24576
    v_mfma_f32_16x16x32_bf16 v[152:155], a[8:11], a[240:243], v[152:155]
    ds_read_b64_tr_b16 v[58:59], v10 offset:26624
    v_mfma_f32_16x16x32_bf16 v[140:143], a[12:15], a[236:239], v[140:143]
    ds_read_b64_tr_b16 v[60:61], v11 offset:24576
    v_mfma_f32_16x16x32_bf16 v[156:159], a[12:15], a[240:243], v[156:159]
    ds_read_b64_tr_b16 v[62:63], v11 offset:26624
    s_waitcnt lgkmcnt(8)
    v_mfma_f32_16x16x32_bf16 v[128:131], v[32:35], a[244:247], v[128:131]
    ds_read_b64_tr_b16 a[0:1], v3 offset:28672
    v_mfma_f32_16x16x32_bf16 v[144:147], v[32:35], a[248:251], v[144:147]
    ds_read_b64_tr_b16 a[2:3], v3 offset:30720
    buffer_load_dword v21, v16, s[16:19], s47 offen sc1
    v_mfma_f32_16x16x32_bf16 v[132:135], v[36:39], a[244:247], v[132:135]
    ds_read_b64_tr_b16 a[4:5], v4 offset:28672
    v_mfma_f32_16x16x32_bf16 v[148:151], v[36:39], a[248:251], v[148:151]
    ds_read_b64_tr_b16 a[6:7], v4 offset:30720
    v_mfma_f32_16x16x32_bf16 v[136:139], v[40:43], a[244:247], v[136:139]
    ds_read_b64_tr_b16 a[8:9], v10 offset:28672
    v_mfma_f32_16x16x32_bf16 v[152:155], v[40:43], a[248:251], v[152:155]
    ds_read_b64_tr_b16 a[10:11], v10 offset:30720
    v_mfma_f32_16x16x32_bf16 v[140:143], v[44:47], a[244:247], v[140:143]
    ds_read_b64_tr_b16 a[12:13], v11 offset:28672
    v_mfma_f32_16x16x32_bf16 v[156:159], v[44:47], a[248:251], v[156:159]
    ds_read_b64_tr_b16 a[14:15], v11 offset:30720
    s_waitcnt vmcnt(31) lgkmcnt(8)
    s_barrier
    v_mfma_f32_16x16x32_bf16 v[128:131], v[48:51], a[252:255], v[128:131]
    ds_read_b64_tr_b16 v[32:33], v3 offset:32768
    s_add_u32 s39, s91, 1507328
    v_mfma_f32_16x16x32_bf16 v[144:147], v[48:51], v[96:99], v[144:147]
    ds_read_b64_tr_b16 v[34:35], v3 offset:34816
    s_and_b32 s39, s39, 0x1fffff
    s_add_u32 m0, s34, 61440
    v_mfma_f32_16x16x32_bf16 v[132:135], v[52:55], a[252:255], v[132:135]
    ds_read_b64_tr_b16 v[36:37], v4 offset:32768
    v_mfma_f32_16x16x32_bf16 v[148:151], v[52:55], v[96:99], v[148:151]
    ds_read_b64_tr_b16 v[38:39], v4 offset:34816
    buffer_load_dwordx4 v15, s[4:7], s39 offen lds
    v_mfma_f32_16x16x32_bf16 v[136:139], v[56:59], a[252:255], v[136:139]
    ds_read_b64_tr_b16 v[40:41], v10 offset:32768
    s_add_u32 s39, s91, 1572864
    v_mfma_f32_16x16x32_bf16 v[152:155], v[56:59], v[96:99], v[152:155]
    ds_read_b64_tr_b16 v[42:43], v10 offset:34816
    s_and_b32 s39, s39, 0x1fffff
    s_add_u32 m0, s34, 65536
    v_mfma_f32_16x16x32_bf16 v[140:143], v[60:63], a[252:255], v[140:143]
    ds_read_b64_tr_b16 v[44:45], v11 offset:32768
    v_mfma_f32_16x16x32_bf16 v[156:159], v[60:63], v[96:99], v[156:159]
    ds_read_b64_tr_b16 v[46:47], v11 offset:34816
    buffer_load_dwordx4 v15, s[4:7], s39 offen lds
    s_waitcnt lgkmcnt(8)
    v_mfma_f32_16x16x32_bf16 v[128:131], a[0:3], v[100:103], v[128:131]
    ds_read_b64_tr_b16 v[48:49], v3 offset:36864
    s_add_u32 s39, s91, 1638400
    v_mfma_f32_16x16x32_bf16 v[144:147], a[0:3], v[104:107], v[144:147]
    ds_read_b64_tr_b16 v[50:51], v3 offset:38912
    s_and_b32 s39, s39, 0x1fffff
    s_add_u32 m0, s34, 69632
    v_mfma_f32_16x16x32_bf16 v[132:135], a[4:7], v[100:103], v[132:135]
    ds_read_b64_tr_b16 v[52:53], v4 offset:36864
    v_mfma_f32_16x16x32_bf16 v[148:151], a[4:7], v[104:107], v[148:151]
    ds_read_b64_tr_b16 v[54:55], v4 offset:38912
    buffer_load_dwordx4 v15, s[4:7], s39 offen lds
    v_mfma_f32_16x16x32_bf16 v[136:139], a[8:11], v[100:103], v[136:139]
    ds_read_b64_tr_b16 v[56:57], v10 offset:36864
    s_add_u32 s39, s91, 1703936
    v_mfma_f32_16x16x32_bf16 v[152:155], a[8:11], v[104:107], v[152:155]
    ds_read_b64_tr_b16 v[58:59], v10 offset:38912
    s_and_b32 s39, s39, 0x1fffff
    s_add_u32 m0, s34, 73728
    v_mfma_f32_16x16x32_bf16 v[140:143], a[12:15], v[100:103], v[140:143]
    ds_read_b64_tr_b16 v[60:61], v11 offset:36864
    v_mfma_f32_16x16x32_bf16 v[156:159], a[12:15], v[104:107], v[156:159]
    ds_read_b64_tr_b16 v[62:63], v11 offset:38912
    buffer_load_dwordx4 v15, s[4:7], s39 offen lds
    s_waitcnt lgkmcnt(8)
    v_mfma_f32_16x16x32_bf16 v[128:131], v[32:35], v[108:111], v[128:131]
    ds_read_b64_tr_b16 a[0:1], v3 offset:40960
    v_mfma_f32_16x16x32_bf16 v[144:147], v[32:35], v[112:115], v[144:147]
    ds_read_b64_tr_b16 a[2:3], v3 offset:43008
    s_waitcnt vmcnt(4)
    v_cmp_ne_u32 vcc, s60, v21
    s_and_b32 s87, vcc_lo, -1
    s_cbranch_scc1 L_POA_S
L_POA_R:
    v_mfma_f32_16x16x32_bf16 v[132:135], v[36:39], v[108:111], v[132:135]
    ds_read_b64_tr_b16 a[4:5], v4 offset:40960
    v_mfma_f32_16x16x32_bf16 v[148:151], v[36:39], v[112:115], v[148:151]
    ds_read_b64_tr_b16 a[6:7], v4 offset:43008
    global_load_dwordx4 a[76:79], v29, s[100:101] offset:0 sc1
    v_mfma_f32_16x16x32_bf16 v[136:139], v[40:43], v[108:111], v[136:139]
    ds_read_b64_tr_b16 a[8:9], v10 offset:40960
    v_mfma_f32_16x16x32_bf16 v[152:155], v[40:43], v[112:115], v[152:155]
    ds_read_b64_tr_b16 a[10:11], v10 offset:43008
    v_mfma_f32_16x16x32_bf16 v[140:143], v[44:47], v[108:111], v[140:143]
    ds_read_b64_tr_b16 a[12:13], v11 offset:40960
    v_mfma_f32_16x16x32_bf16 v[156:159], v[44:47], v[112:115], v[156:159]
    ds_read_b64_tr_b16 a[14:15], v11 offset:43008
    global_load_dwordx4 a[80:83], v29, s[100:101] offset:1024 sc1
    s_waitcnt lgkmcnt(8)
    v_mfma_f32_16x16x32_bf16 v[128:131], v[48:51], v[116:119], v[128:131]
    ds_read_b64_tr_b16 v[32:33], v3 offset:45056
    v_mfma_f32_16x16x32_bf16 v[144:147], v[48:51], v[120:123], v[144:147]
    ds_read_b64_tr_b16 v[34:35], v3 offset:47104
    v_bfe_u32 v22, v1, 2, 2
    v_mfma_f32_16x16x32_bf16 v[132:135], v[52:55], v[116:119], v[132:135]
    ds_read_b64_tr_b16 v[36:37], v4 offset:45056
    v_lshrrev_b32 v23, 5, v1
    v_mfma_f32_16x16x32_bf16 v[148:151], v[52:55], v[120:123], v[148:151]
    ds_read_b64_tr_b16 v[38:39], v4 offset:47104
    global_load_dwordx4 a[84:87], v29, s[100:101] offset:2048 sc1
    v_mfma_f32_16x16x32_bf16 v[136:139], v[56:59], v[116:119], v[136:139]
    ds_read_b64_tr_b16 v[40:41], v10 offset:45056
    v_mfma_f32_16x16x32_bf16 v[152:155], v[56:59], v[120:123], v[152:155]
    ds_read_b64_tr_b16 v[42:43], v10 offset:47104
    v_lshl_add_u32 v22, v23, 2, v22
    v_mfma_f32_16x16x32_bf16 v[140:143], v[60:63], v[116:119], v[140:143]
    ds_read_b64_tr_b16 v[44:45], v11 offset:45056
    v_and_b32 v23, 16, v1
    v_mfma_f32_16x16x32_bf16 v[156:159], v[60:63], v[120:123], v[156:159]
    ds_read_b64_tr_b16 v[46:47], v11 offset:47104
    global_load_dwordx4 a[88:91], v29, s[100:101] offset:3072 sc1
    s_waitcnt lgkmcnt(8)
    v_mfma_f32_16x16x32_bf16 v[128:131], a[0:3], v[124:127], v[128:131]
    ds_read_b64_tr_b16 v[48:49], v3 offset:49152
    v_mfma_f32_16x16x32_bf16 v[144:147], a[0:3], v[160:163], v[144:147]
    ds_read_b64_tr_b16 v[50:51], v3 offset:51200
    v_add_u32 v22, v22, v23
    v_mfma_f32_16x16x32_bf16 v[132:135], a[4:7], v[124:127], v[132:135]
    ds_read_b64_tr_b16 v[52:53], v4 offset:49152
    v_lshlrev_b32 v22, 7, v22
    v_mfma_f32_16x16x32_bf16 v[148:151], a[4:7], v[160:163], v[148:151]
    ds_read_b64_tr_b16 v[54:55], v4 offset:51200
    global_load_dwordx4 a[92:95], v5, s[100:101] offset:0 sc1
    v_mfma_f32_16x16x32_bf16 v[136:139], a[8:11], v[124:127], v[136:139]
    ds_read_b64_tr_b16 v[56:57], v10 offset:49152
    v_mfma_f32_16x16x32_bf16 v[152:155], a[8:11], v[160:163], v[152:155]
    ds_read_b64_tr_b16 v[58:59], v10 offset:51200
    v_lshl_add_u32 v22, v23, 2, v22
    v_mfma_f32_16x16x32_bf16 v[140:143], a[12:15], v[124:127], v[140:143]
    ds_read_b64_tr_b16 v[60:61], v11 offset:49152
    v_and_b32 v23, 8, v1
    v_mfma_f32_16x16x32_bf16 v[156:159], a[12:15], v[160:163], v[156:159]
    ds_read_b64_tr_b16 v[62:63], v11 offset:51200
    global_load_dwordx4 a[96:99], v5, s[100:101] offset:1024 sc1
    s_waitcnt lgkmcnt(8)
    v_mfma_f32_16x16x32_bf16 v[128:131], v[32:35], v[164:167], v[128:131]
    ds_read_b64_tr_b16 a[0:1], v3 offset:53248
    v_mfma_f32_16x16x32_bf16 v[144:147], v[32:35], v[168:171], v[144:147]
    ds_read_b64_tr_b16 a[2:3], v3 offset:55296
    v_lshl_add_u32 v22, v23, 2, v22
    v_mfma_f32_16x16x32_bf16 v[132:135], v[36:39], v[164:167], v[132:135]
    ds_read_b64_tr_b16 a[4:5], v4 offset:53248
    v_and_b32 v23, 3, v1
    v_mfma_f32_16x16x32_bf16 v[148:151], v[36:39], v[168:171], v[148:151]
    ds_read_b64_tr_b16 a[6:7], v4 offset:55296
    global_load_dwordx4 a[100:103], v5, s[100:101] offset:2048 sc1
    v_mfma_f32_16x16x32_bf16 v[136:139], v[40:43], v[164:167], v[136:139]
    ds_read_b64_tr_b16 a[8:9], v10 offset:53248
    v_mfma_f32_16x16x32_bf16 v[152:155], v[40:43], v[168:171], v[152:155]
    ds_read_b64_tr_b16 a[10:11], v10 offset:55296
    v_lshl_add_u32 v22, v23, 3, v22
    v_mfma_f32_16x16x32_bf16 v[140:143], v[44:47], v[164:167], v[140:143]
    ds_read_b64_tr_b16 a[12:13], v11 offset:53248
    v_add_u32 v22, 131072, v22
    v_mfma_f32_16x16x32_bf16 v[156:159], v[44:47], v[168:171], v[156:159]
    ds_read_b64_tr_b16 a[14:15], v11 offset:55296
    global_load_dwordx4 a[104:107], v5, s[100:101] offset:3072 sc1
    s_waitcnt lgkmcnt(8)
    v_mfma_f32_16x16x32_bf16 v[128:131], v[48:51], v[172:175], v[128:131]
    ds_read_b64_tr_b16 v[32:33], v3 offset:57344
    s_add_u32 s90, s90, 8192
    v_mfma_f32_16x16x32_bf16 v[144:147], v[48:51], v[192:195], v[144:147]
    ds_read_b64_tr_b16 v[34:35], v3 offset:59392
    s_and_b32 s90, s90, 0xffff
    s_add_u32 s100, s98, s90
    s_addc_u32 s101, s99, 0
    v_mfma_f32_16x16x32_bf16 v[132:135], v[52:55], v[172:175], v[132:135]
    ds_read_b64_tr_b16 v[36:37], v4 offset:57344
    v_mfma_f32_16x16x32_bf16 v[148:151], v[52:55], v[192:195], v[148:151]
    ds_read_b64_tr_b16 v[38:39], v4 offset:59392
    global_load_dwordx4 a[108:111], v29, s[100:101] offset:0 sc1
    v_mfma_f32_16x16x32_bf16 v[136:139], v[56:59], v[172:175], v[136:139]
    ds_read_b64_tr_b16 v[40:41], v10 offset:57344
    v_mfma_f32_16x16x32_bf16 v[152:155], v[56:59], v[192:195], v[152:155]
    ds_read_b64_tr_b16 v[42:43], v10 offset:59392
    v_mfma_f32_16x16x32_bf16 v[140:143], v[60:63], v[172:175], v[140:143]
    ds_read_b64_tr_b16 v[44:45], v11 offset:57344
    v_mfma_f32_16x16x32_bf16 v[156:159], v[60:63], v[192:195], v[156:159]
    ds_read_b64_tr_b16 v[46:47], v11 offset:59392
    global_load_dwordx4 a[112:115], v29, s[100:101] offset:1024 sc1
    s_waitcnt lgkmcnt(8)
    v_mfma_f32_16x16x32_bf16 v[128:131], a[0:3], v[196:199], v[128:131]
    ds_read_b64_tr_b16 v[48:49], v3 offset:61440
    v_mfma_f32_16x16x32_bf16 v[144:147], a[0:3], v[200:203], v[144:147]
    ds_read_b64_tr_b16 v[50:51], v3 offset:63488
    v_xor_b32 v3, 0, v22
    v_mfma_f32_16x16x32_bf16 v[132:135], a[4:7], v[196:199], v[132:135]
    ds_read_b64_tr_b16 v[52:53], v4 offset:61440
    v_mfma_f32_16x16x32_bf16 v[148:151], a[4:7], v[200:203], v[148:151]
    ds_read_b64_tr_b16 v[54:55], v4 offset:63488
    v_xor_b32 v4, 32, v22
    global_load_dwordx4 a[116:119], v29, s[100:101] offset:2048 sc1
    v_mfma_f32_16x16x32_bf16 v[136:139], a[8:11], v[196:199], v[136:139]
    ds_read_b64_tr_b16 v[56:57], v10 offset:61440
    v_mfma_f32_16x16x32_bf16 v[152:155], a[8:11], v[200:203], v[152:155]
    ds_read_b64_tr_b16 v[58:59], v10 offset:63488
    v_xor_b32 v10, 64, v22
    v_mfma_f32_16x16x32_bf16 v[140:143], a[12:15], v[196:199], v[140:143]
    ds_read_b64_tr_b16 v[60:61], v11 offset:61440
    v_mfma_f32_16x16x32_bf16 v[156:159], a[12:15], v[200:203], v[156:159]
    ds_read_b64_tr_b16 v[62:63], v11 offset:63488
    v_xor_b32 v11, 96, v22
    global_load_dwordx4 a[120:123], v29, s[100:101] offset:3072 sc1
    s_waitcnt vmcnt(25) lgkmcnt(8)
    s_barrier
    v_mfma_f32_16x16x32_bf16 v[128:131], v[32:35], v[204:207], v[128:131]
    ds_read_b64_tr_b16 a[0:1], v3 offset:0
    v_mfma_f32_16x16x32_bf16 v[144:147], v[32:35], v[208:211], v[144:147]
    ds_read_b64_tr_b16 a[2:3], v3 offset:1024
    v_mfma_f32_16x16x32_bf16 v[132:135], v[36:39], v[204:207], v[132:135]
    ds_read_b64_tr_b16 a[4:5], v4 offset:0
    v_mfma_f32_16x16x32_bf16 v[148:151], v[36:39], v[208:211], v[148:151]
    ds_read_b64_tr_b16 a[6:7], v4 offset:1024
    global_load_dwordx4 a[124:127], v5, s[100:101] offset:0 sc1
    v_mfma_f32_16x16x32_bf16 v[136:139], v[40:43], v[204:207], v[136:139]
    ds_read_b64_tr_b16 a[8:9], v10 offset:0
    v_mfma_f32_16x16x32_bf16 v[152:155], v[40:43], v[208:211], v[152:155]
    ds_read_b64_tr_b16 a[10:11], v10 offset:1024
    v_mfma_f32_16x16x32_bf16 v[140:143], v[44:47], v[204:207], v[140:143]
    ds_read_b64_tr_b16 a[12:13], v11 offset:0
    v_mfma_f32_16x16x32_bf16 v[156:159], v[44:47], v[208:211], v[156:159]
    ds_read_b64_tr_b16 a[14:15], v11 offset:1024
    global_load_dwordx4 a[128:131], v5, s[100:101] offset:1024 sc1
    s_waitcnt lgkmcnt(8)
    v_mfma_f32_16x16x32_bf16 v[128:131], v[48:51], v[212:215], v[128:131]
    ds_read_b64_tr_b16 v[32:33], v3 offset:4096
    v_mfma_f32_16x16x32_bf16 v[144:147], v[48:51], v[216:219], v[144:147]
    ds_read_b64_tr_b16 v[34:35], v3 offset:5120
    v_mfma_f32_16x16x32_bf16 v[132:135], v[52:55], v[212:215], v[132:135]
    ds_read_b64_tr_b16 v[36:37], v4 offset:4096
    v_mfma_f32_16x16x32_bf16 v[148:151], v[52:55], v[216:219], v[148:151]
    ds_read_b64_tr_b16 v[38:39], v4 offset:5120
    global_load_dwordx4 a[132:135], v5, s[100:101] offset:2048 sc1
    v_mfma_f32_16x16x32_bf16 v[136:139], v[56:59], v[212:215], v[136:139]
    ds_read_b64_tr_b16 v[40:41], v10 offset:4096
    v_mfma_f32_16x16x32_bf16 v[152:155], v[56:59], v[216:219], v[152:155]
    ds_read_b64_tr_b16 v[42:43], v10 offset:5120
    v_mfma_f32_16x16x32_bf16 v[140:143], v[60:63], v[212:215], v[140:143]
    ds_read_b64_tr_b16 v[44:45], v11 offset:4096
    v_mfma_f32_16x16x32_bf16 v[156:159], v[60:63], v[216:219], v[156:159]
    ds_read_b64_tr_b16 v[46:47], v11 offset:5120
    global_load_dwordx4 a[136:139], v5, s[100:101] offset:3072 sc1
    s_waitcnt vmcnt(14) lgkmcnt(8)
    v_mfma_f32_16x16x32_bf16 v[64:67], a[0:3], a[76:79], 0
    ds_read_b64_tr_b16 v[48:49], v3 offset:8192
    s_add_u32 s90, s90, 8192
    v_mfma_f32_16x16x32_bf16 v[80:83], a[0:3], a[80:83], 0
    ds_read_b64_tr_b16 v[50:51], v3 offset:9216
    s_and_b32 s90, s90, 0xffff
    s_add_u32 s100, s98, s90
    s_addc_u32 s101, s99, 0
    v_mfma_f32_16x16x32_bf16 v[68:71], a[4:7], a[76:79], 0
    ds_read_b64_tr_b16 v[52:53], v4 offset:8192
    v_mfma_f32_16x16x32_bf16 v[84:87], a[4:7], a[80:83], 0
    ds_read_b64_tr_b16 v[54:55], v4 offset:9216
    global_load_dwordx4 a[140:143], v29, s[100:101] offset:0 sc1
    v_mfma_f32_16x16x32_bf16 v[72:75], a[8:11], a[76:79], 0
    ds_read_b64_tr_b16 v[56:57], v10 offset:8192
    v_sub_f32 v14, 1.0, v12
    v_mfma_f32_16x16x32_bf16 v[88:91], a[8:11], a[80:83], 0
    ds_read_b64_tr_b16 v[58:59], v10 offset:9216
    v_sub_f32 v8, 1.0, v13
    v_mfma_f32_16x16x32_bf16 v[76:79], a[12:15], a[76:79], 0
    ds_read_b64_tr_b16 v[60:61], v11 offset:8192
    v_mfma_f32_16x16x32_bf16 v[92:95], a[12:15], a[80:83], 0
    ds_read_b64_tr_b16 v[62:63], v11 offset:9216
    global_load_dwordx4 a[144:147], v29, s[100:101] offset:1024 sc1
    s_waitcnt vmcnt(14) lgkmcnt(8)
    v_mfma_f32_16x16x32_bf16 v[64:67], v[32:35], a[84:87], v[64:67]
    ds_read_b64_tr_b16 a[0:1], v3 offset:12288
    v_mfma_f32_16x16x32_bf16 v[80:83], v[32:35], a[88:91], v[80:83]
    ds_read_b64_tr_b16 a[2:3], v3 offset:13312
    v_mfma_f32_16x16x32_bf16 v[68:71], v[36:39], a[84:87], v[68:71]
    ds_read_b64_tr_b16 a[4:5], v4 offset:12288
    v_mfma_f32_16x16x32_bf16 v[84:87], v[36:39], a[88:91], v[84:87]
    ds_read_b64_tr_b16 a[6:7], v4 offset:13312
    global_load_dwordx4 a[148:151], v29, s[100:101] offset:2048 sc1
    v_mfma_f32_16x16x32_bf16 v[72:75], v[40:43], a[84:87], v[72:75]
    ds_read_b64_tr_b16 a[8:9], v10 offset:12288
    v_mul_f32 v128, v128, v14
    v_mfma_f32_16x16x32_bf16 v[88:91], v[40:43], a[88:91], v[88:91]
    ds_read_b64_tr_b16 a[10:11], v10 offset:13312
    v_mul_f32 v129, v129, v14
    v_mfma_f32_16x16x32_bf16 v[76:79], v[44:47], a[84:87], v[76:79]
    ds_read_b64_tr_b16 a[12:13], v11 offset:12288
    v_mul_f32 v130, v130, v14
    v_mfma_f32_16x16x32_bf16 v[92:95], v[44:47], a[88:91], v[92:95]
    ds_read_b64_tr_b16 a[14:15], v11 offset:13312
    v_mul_f32 v131, v131, v14
    global_load_dwordx4 a[152:155], v29, s[100:101] offset:3072 sc1
    s_waitcnt vmcnt(14) lgkmcnt(8)
    v_mfma_f32_16x16x32_bf16 v[64:67], v[48:51], a[92:95], v[64:67]
    ds_read_b64_tr_b16 v[32:33], v3 offset:16384
    v_mul_f32 v132, v132, v14
    v_mfma_f32_16x16x32_bf16 v[80:83], v[48:51], a[96:99], v[80:83]
    ds_read_b64_tr_b16 v[34:35], v3 offset:17408
    v_mul_f32 v133, v133, v14
    v_mfma_f32_16x16x32_bf16 v[68:71], v[52:55], a[92:95], v[68:71]
    ds_read_b64_tr_b16 v[36:37], v4 offset:16384
    v_mul_f32 v134, v134, v14
    v_mfma_f32_16x16x32_bf16 v[84:87], v[52:55], a[96:99], v[84:87]
    ds_read_b64_tr_b16 v[38:39], v4 offset:17408
    v_mul_f32 v135, v135, v14
    global_load_dwordx4 a[156:159], v5, s[100:101] offset:0 sc1
    v_mfma_f32_16x16x32_bf16 v[72:75], v[56:59], a[92:95], v[72:75]
    ds_read_b64_tr_b16 v[40:41], v10 offset:16384
    v_mul_f32 v136, v136, v14
    v_mfma_f32_16x16x32_bf16 v[88:91], v[56:59], a[96:99], v[88:91]
    ds_read_b64_tr_b16 v[42:43], v10 offset:17408
    v_mul_f32 v137, v137, v14
    v_mfma_f32_16x16x32_bf16 v[76:79], v[60:63], a[92:95], v[76:79]
    ds_read_b64_tr_b16 v[44:45], v11 offset:16384
    v_mul_f32 v138, v138, v14
    v_mfma_f32_16x16x32_bf16 v[92:95], v[60:63], a[96:99], v[92:95]
    ds_read_b64_tr_b16 v[46:47], v11 offset:17408
    v_mul_f32 v139, v139, v14
    global_load_dwordx4 a[160:163], v5, s[100:101] offset:1024 sc1
    s_waitcnt vmcnt(14) lgkmcnt(8)
    v_mfma_f32_16x16x32_bf16 v[64:67], a[0:3], a[100:103], v[64:67]
    ds_read_b64_tr_b16 v[48:49], v3 offset:20480
    v_mul_f32 v140, v140, v14
    v_mfma_f32_16x16x32_bf16 v[80:83], a[0:3], a[104:107], v[80:83]
    ds_read_b64_tr_b16 v[50:51], v3 offset:21504
    v_mul_f32 v141, v141, v14
    v_mfma_f32_16x16x32_bf16 v[68:71], a[4:7], a[100:103], v[68:71]
    ds_read_b64_tr_b16 v[52:53], v4 offset:20480
    v_mul_f32 v142, v142, v14
    v_mfma_f32_16x16x32_bf16 v[84:87], a[4:7], a[104:107], v[84:87]
    ds_read_b64_tr_b16 v[54:55], v4 offset:21504
    v_mul_f32 v143, v143, v14
    global_load_dwordx4 a[164:167], v5, s[100:101] offset:2048 sc1
    v_mfma_f32_16x16x32_bf16 v[72:75], a[8:11], a[100:103], v[72:75]
    ds_read_b64_tr_b16 v[56:57], v10 offset:20480
    v_mul_f32 v144, v144, v8
    v_mfma_f32_16x16x32_bf16 v[88:91], a[8:11], a[104:107], v[88:91]
    ds_read_b64_tr_b16 v[58:59], v10 offset:21504
    v_mul_f32 v145, v145, v8
    v_mfma_f32_16x16x32_bf16 v[76:79], a[12:15], a[100:103], v[76:79]
    ds_read_b64_tr_b16 v[60:61], v11 offset:20480
    v_mul_f32 v146, v146, v8
    v_mfma_f32_16x16x32_bf16 v[92:95], a[12:15], a[104:107], v[92:95]
    ds_read_b64_tr_b16 v[62:63], v11 offset:21504
    v_mul_f32 v147, v147, v8
    global_load_dwordx4 a[168:171], v5, s[100:101] offset:3072 sc1
    s_waitcnt vmcnt(14) lgkmcnt(8)
    v_mfma_f32_16x16x32_bf16 v[64:67], v[32:35], a[108:111], v[64:67]
    ds_read_b64_tr_b16 a[0:1], v3 offset:24576
    v_mul_f32 v148, v148, v8
    v_mul_f32 v149, v149, v8
    v_mfma_f32_16x16x32_bf16 v[80:83], v[32:35], a[112:115], v[80:83]
    ds_read_b64_tr_b16 a[2:3], v3 offset:25600
    s_add_u32 s90, s90, 8192
    s_and_b32 s90, s90, 0xffff
    s_add_u32 s100, s98, s90
    s_addc_u32 s101, s99, 0
    v_mfma_f32_16x16x32_bf16 v[68:71], v[36:39], a[108:111], v[68:71]
    ds_read_b64_tr_b16 a[4:5], v4 offset:24576
    v_mul_f32 v150, v150, v8
    v_mfma_f32_16x16x32_bf16 v[84:87], v[36:39], a[112:115], v[84:87]
    ds_read_b64_tr_b16 a[6:7], v4 offset:25600
    v_mul_f32 v151, v151, v8
    global_load_dwordx4 a[172:175], v29, s[100:101] offset:0 sc1
    v_mfma_f32_16x16x32_bf16 v[72:75], v[40:43], a[108:111], v[72:75]
    ds_read_b64_tr_b16 a[8:9], v10 offset:24576
    v_mul_f32 v152, v152, v8
    v_mfma_f32_16x16x32_bf16 v[88:91], v[40:43], a[112:115], v[88:91]
    ds_read_b64_tr_b16 a[10:11], v10 offset:25600
    v_mul_f32 v153, v153, v8
    v_mfma_f32_16x16x32_bf16 v[76:79], v[44:47], a[108:111], v[76:79]
    ds_read_b64_tr_b16 a[12:13], v11 offset:24576
    v_mul_f32 v154, v154, v8
    v_mfma_f32_16x16x32_bf16 v[92:95], v[44:47], a[112:115], v[92:95]
    ds_read_b64_tr_b16 a[14:15], v11 offset:25600
    v_mul_f32 v155, v155, v8
    global_load_dwordx4 a[176:179], v29, s[100:101] offset:1024 sc1
    s_waitcnt vmcnt(14) lgkmcnt(8)
    v_mfma_f32_16x16x32_bf16 v[64:67], v[48:51], a[116:119], v[64:67]
    ds_read_b64_tr_b16 v[32:33], v3 offset:28672
    v_mul_f32 v156, v156, v8
    v_mfma_f32_16x16x32_bf16 v[80:83], v[48:51], a[120:123], v[80:83]
    ds_read_b64_tr_b16 v[34:35], v3 offset:29696
    v_add_u32 v3, -131072, v3
    v_mul_f32 v157, v157, v8
    v_mfma_f32_16x16x32_bf16 v[68:71], v[52:55], a[116:119], v[68:71]
    ds_read_b64_tr_b16 v[36:37], v4 offset:28672
    v_mul_f32 v158, v158, v8
    v_mfma_f32_16x16x32_bf16 v[84:87], v[52:55], a[120:123], v[84:87]
    ds_read_b64_tr_b16 v[38:39], v4 offset:29696
    v_add_u32 v4, -131072, v4
    v_mul_f32 v159, v159, v8
    global_load_dwordx4 a[180:183], v29, s[100:101] offset:2048 sc1
    v_mfma_f32_16x16x32_bf16 v[72:75], v[56:59], a[116:119], v[72:75]
    ds_read_b64_tr_b16 v[40:41], v10 offset:28672
    v_mfma_f32_16x16x32_bf16 v[88:91], v[56:59], a[120:123], v[88:91]
    ds_read_b64_tr_b16 v[42:43], v10 offset:29696
    v_add_u32 v10, -131072, v10
    v_mfma_f32_16x16x32_bf16 v[76:79], v[60:63], a[116:119], v[76:79]
    ds_read_b64_tr_b16 v[44:45], v11 offset:28672
    v_mfma_f32_16x16x32_bf16 v[92:95], v[60:63], a[120:123], v[92:95]
    ds_read_b64_tr_b16 v[46:47], v11 offset:29696
    v_add_u32 v11, -131072, v11
    global_load_dwordx4 a[184:187], v29, s[100:101] offset:3072 sc1
    s_waitcnt vmcnt(14) lgkmcnt(8)
    s_barrier
    v_mfma_f32_16x16x32_bf16 v[64:67], a[0:3], a[124:127], v[64:67]
    ds_read_b64_tr_b16 v[48:49], v3 offset:0
    v_mfma_f32_16x16x32_bf16 v[80:83], a[0:3], a[128:131], v[80:83]
    ds_read_b64_tr_b16 v[50:51], v3 offset:1024
    v_mfma_f32_16x16x32_bf16 v[68:71], a[4:7], a[124:127], v[68:71]
    ds_read_b64_tr_b16 v[52:53], v4 offset:0
    v_mfma_f32_16x16x32_bf16 v[84:87], a[4:7], a[128:131], v[84:87]
    ds_read_b64_tr_b16 v[54:55], v4 offset:1024
    global_load_dwordx4 a[188:191], v5, s[100:101] offset:0 sc1
    v_mfma_f32_16x16x32_bf16 v[72:75], a[8:11], a[124:127], v[72:75]
    ds_read_b64_tr_b16 v[56:57], v10 offset:0
    v_mfma_f32_16x16x32_bf16 v[88:91], a[8:11], a[128:131], v[88:91]
    ds_read_b64_tr_b16 v[58:59], v10 offset:1024
    v_mfma_f32_16x16x32_bf16 v[76:79], a[12:15], a[124:127], v[76:79]
    ds_read_b64_tr_b16 v[60:61], v11 offset:0
    v_mfma_f32_16x16x32_bf16 v[92:95], a[12:15], a[128:131], v[92:95]
    ds_read_b64_tr_b16 v[62:63], v11 offset:1024
    global_load_dwordx4 a[192:195], v5, s[100:101] offset:1024 sc1
    s_waitcnt vmcnt(14) lgkmcnt(8)
    v_mfma_f32_16x16x32_bf16 v[64:67], v[32:35], a[132:135], v[64:67]
    ds_read_b64_tr_b16 a[0:1], v3 offset:4096
    v_mfma_f32_16x16x32_bf16 v[80:83], v[32:35], a[136:139], v[80:83]
    ds_read_b64_tr_b16 a[2:3], v3 offset:5120
    v_mfma_f32_16x16x32_bf16 v[68:71], v[36:39], a[132:135], v[68:71]
    ds_read_b64_tr_b16 a[4:5], v4 offset:4096
    v_mfma_f32_16x16x32_bf16 v[84:87], v[36:39], a[136:139], v[84:87]
    ds_read_b64_tr_b16 a[6:7], v4 offset:5120
    global_load_dwordx4 a[196:199], v5, s[100:101] offset:2048 sc1
    v_mfma_f32_16x16x32_bf16 v[72:75], v[40:43], a[132:135], v[72:75]
    ds_read_b64_tr_b16 a[8:9], v10 offset:4096
    v_mfma_f32_16x16x32_bf16 v[88:91], v[40:43], a[136:139], v[88:91]
    ds_read_b64_tr_b16 a[10:11], v10 offset:5120
    v_mfma_f32_16x16x32_bf16 v[76:79], v[44:47], a[132:135], v[76:79]
    ds_read_b64_tr_b16 a[12:13], v11 offset:4096
    v_mfma_f32_16x16x32_bf16 v[92:95], v[44:47], a[136:139], v[92:95]
    ds_read_b64_tr_b16 a[14:15], v11 offset:5120
    global_load_dwordx4 a[200:203], v5, s[100:101] offset:3072 sc1
    s_waitcnt vmcnt(14) lgkmcnt(8)
    v_mfma_f32_16x16x32_bf16 v[64:67], v[48:51], a[140:143], v[64:67]
    ds_read_b64_tr_b16 v[32:33], v3 offset:8192
    s_add_u32 s90, s90, 8192
    v_mfma_f32_16x16x32_bf16 v[80:83], v[48:51], a[144:147], v[80:83]
    ds_read_b64_tr_b16 v[34:35], v3 offset:9216
    s_and_b32 s90, s90, 0xffff
    s_add_u32 s100, s98, s90
    s_addc_u32 s101, s99, 0
    v_mfma_f32_16x16x32_bf16 v[68:71], v[52:55], a[140:143], v[68:71]
    ds_read_b64_tr_b16 v[36:37], v4 offset:8192
    v_mfma_f32_16x16x32_bf16 v[84:87], v[52:55], a[144:147], v[84:87]
    ds_read_b64_tr_b16 v[38:39], v4 offset:9216
    global_load_dwordx4 a[204:207], v29, s[100:101] offset:0 sc1
    v_mfma_f32_16x16x32_bf16 v[72:75], v[56:59], a[140:143], v[72:75]
    ds_read_b64_tr_b16 v[40:41], v10 offset:8192
    v_mfma_f32_16x16x32_bf16 v[88:91], v[56:59], a[144:147], v[88:91]
    ds_read_b64_tr_b16 v[42:43], v10 offset:9216
    v_mfma_f32_16x16x32_bf16 v[76:79], v[60:63], a[140:143], v[76:79]
    ds_read_b64_tr_b16 v[44:45], v11 offset:8192
    v_mfma_f32_16x16x32_bf16 v[92:95], v[60:63], a[144:147], v[92:95]
    ds_read_b64_tr_b16 v[46:47], v11 offset:9216
    global_load_dwordx4 a[208:211], v29, s[100:101] offset:1024 sc1
    s_waitcnt vmcnt(14) lgkmcnt(8)
    v_mfma_f32_16x16x32_bf16 v[64:67], a[0:3], a[148:151], v[64:67]
    ds_read_b64_tr_b16 v[48:49], v3 offset:12288
    v_mfma_f32_16x16x32_bf16 v[80:83], a[0:3], a[152:155], v[80:83]
    ds_read_b64_tr_b16 v[50:51], v3 offset:13312
    v_mfma_f32_16x16x32_bf16 v[68:71], a[4:7], a[148:151], v[68:71]
    ds_read_b64_tr_b16 v[52:53], v4 offset:12288
    v_mfma_f32_16x16x32_bf16 v[84:87], a[4:7], a[152:155], v[84:87]
    ds_read_b64_tr_b16 v[54:55], v4 offset:13312
    global_load_dwordx4 a[212:215], v29, s[100:101] offset:2048 sc1
    v_mfma_f32_16x16x32_bf16 v[72:75], a[8:11], a[148:151], v[72:75]
    ds_read_b64_tr_b16 v[56:57], v10 offset:12288
    v_mfma_f32_16x16x32_bf16 v[88:91], a[8:11], a[152:155], v[88:91]
    ds_read_b64_tr_b16 v[58:59], v10 offset:13312
    v_mfma_f32_16x16x32_bf16 v[76:79], a[12:15], a[148:151], v[76:79]
    ds_read_b64_tr_b16 v[60:61], v11 offset:12288
    v_mfma_f32_16x16x32_bf16 v[92:95], a[12:15], a[152:155], v[92:95]
    ds_read_b64_tr_b16 v[62:63], v11 offset:13312
    global_load_dwordx4 a[216:219], v29, s[100:101] offset:3072 sc1
    s_waitcnt vmcnt(14) lgkmcnt(8)
    v_mfma_f32_16x16x32_bf16 v[64:67], v[32:35], a[156:159], v[64:67]
    ds_read_b64_tr_b16 a[0:1], v3 offset:16384
    v_mfma_f32_16x16x32_bf16 v[80:83], v[32:35], a[160:163], v[80:83]
    ds_read_b64_tr_b16 a[2:3], v3 offset:17408
    v_mfma_f32_16x16x32_bf16 v[68:71], v[36:39], a[156:159], v[68:71]
    ds_read_b64_tr_b16 a[4:5], v4 offset:16384
    v_mfma_f32_16x16x32_bf16 v[84:87], v[36:39], a[160:163], v[84:87]
    ds_read_b64_tr_b16 a[6:7], v4 offset:17408
    global_load_dwordx4 a[220:223], v5, s[100:101] offset:0 sc1
    v_mfma_f32_16x16x32_bf16 v[72:75], v[40:43], a[156:159], v[72:75]
    ds_read_b64_tr_b16 a[8:9], v10 offset:16384
    v_mfma_f32_16x16x32_bf16 v[88:91], v[40:43], a[160:163], v[88:91]
    ds_read_b64_tr_b16 a[10:11], v10 offset:17408
    v_mfma_f32_16x16x32_bf16 v[76:79], v[44:47], a[156:159], v[76:79]
    ds_read_b64_tr_b16 a[12:13], v11 offset:16384
    v_mfma_f32_16x16x32_bf16 v[92:95], v[44:47], a[160:163], v[92:95]
    ds_read_b64_tr_b16 a[14:15], v11 offset:17408
    global_load_dwordx4 a[224:227], v5, s[100:101] offset:1024 sc1
    s_waitcnt vmcnt(14) lgkmcnt(8)
    v_mfma_f32_16x16x32_bf16 v[64:67], v[48:51], a[164:167], v[64:67]
    ds_read_b64_tr_b16 v[32:33], v3 offset:20480
    v_mfma_f32_16x16x32_bf16 v[80:83], v[48:51], a[168:171], v[80:83]
    ds_read_b64_tr_b16 v[34:35], v3 offset:21504
    v_mfma_f32_16x16x32_bf16 v[68:71], v[52:55], a[164:167], v[68:71]
    ds_read_b64_tr_b16 v[36:37], v4 offset:20480
    v_mfma_f32_16x16x32_bf16 v[84:87], v[52:55], a[168:171], v[84:87]
    ds_read_b64_tr_b16 v[38:39], v4 offset:21504
    global_load_dwordx4 a[228:231], v5, s[100:101] offset:2048 sc1
    v_mfma_f32_16x16x32_bf16 v[72:75], v[56:59], a[164:167], v[72:75]
    ds_read_b64_tr_b16 v[40:41], v10 offset:20480
    v_mfma_f32_16x16x32_bf16 v[88:91], v[56:59], a[168:171], v[88:91]
    ds_read_b64_tr_b16 v[42:43], v10 offset:21504
    v_mfma_f32_16x16x32_bf16 v[76:79], v[60:63], a[164:167], v[76:79]
    ds_read_b64_tr_b16 v[44:45], v11 offset:20480
    v_mfma_f32_16x16x32_bf16 v[92:95], v[60:63], a[168:171], v[92:95]
    ds_read_b64_tr_b16 v[46:47], v11 offset:21504
    global_load_dwordx4 a[232:235], v5, s[100:101] offset:3072 sc1
    s_waitcnt vmcnt(14) lgkmcnt(8)
    v_mfma_f32_16x16x32_bf16 v[64:67], a[0:3], a[172:175], v[64:67]
    ds_read_b64_tr_b16 v[48:49], v3 offset:24576
    s_add_u32 s90, s90, 8192
    v_mfma_f32_16x16x32_bf16 v[80:83], a[0:3], a[176:179], v[80:83]
    ds_read_b64_tr_b16 v[50:51], v3 offset:25600
    s_and_b32 s90, s90, 0xffff
    s_add_u32 s100, s98, s90
    s_addc_u32 s101, s99, 0
    v_mfma_f32_16x16x32_bf16 v[68:71], a[4:7], a[172:175], v[68:71]
    ds_read_b64_tr_b16 v[52:53], v4 offset:24576
    v_mfma_f32_16x16x32_bf16 v[84:87], a[4:7], a[176:179], v[84:87]
    ds_read_b64_tr_b16 v[54:55], v4 offset:25600
    global_load_dwordx4 a[236:239], v29, s[100:101] offset:0 sc1
    v_mfma_f32_16x16x32_bf16 v[72:75], a[8:11], a[172:175], v[72:75]
    ds_read_b64_tr_b16 v[56:57], v10 offset:24576
    v_mfma_f32_16x16x32_bf16 v[88:91], a[8:11], a[176:179], v[88:91]
    ds_read_b64_tr_b16 v[58:59], v10 offset:25600
    v_mfma_f32_16x16x32_bf16 v[76:79], a[12:15], a[172:175], v[76:79]
    ds_read_b64_tr_b16 v[60:61], v11 offset:24576
    v_mfma_f32_16x16x32_bf16 v[92:95], a[12:15], a[176:179], v[92:95]
    ds_read_b64_tr_b16 v[62:63], v11 offset:25600
    global_load_dwordx4 a[240:243], v29, s[100:101] offset:1024 sc1
    s_waitcnt vmcnt(14) lgkmcnt(8)
    v_mfma_f32_16x16x32_bf16 v[64:67], v[32:35], a[180:183], v[64:67]
    ds_read_b64_tr_b16 a[0:1], v3 offset:28672
    v_mfma_f32_16x16x32_bf16 v[80:83], v[32:35], a[184:187], v[80:83]
    ds_read_b64_tr_b16 a[2:3], v3 offset:29696
    v_mfma_f32_16x16x32_bf16 v[68:71], v[36:39], a[180:183], v[68:71]
    ds_read_b64_tr_b16 a[4:5], v4 offset:28672
    v_mfma_f32_16x16x32_bf16 v[84:87], v[36:39], a[184:187], v[84:87]
    ds_read_b64_tr_b16 a[6:7], v4 offset:29696
    global_load_dwordx4 a[244:247], v29, s[100:101] offset:2048 sc1
    v_mfma_f32_16x16x32_bf16 v[72:75], v[40:43], a[180:183], v[72:75]
    ds_read_b64_tr_b16 a[8:9], v10 offset:28672
    v_mfma_f32_16x16x32_bf16 v[88:91], v[40:43], a[184:187], v[88:91]
    ds_read_b64_tr_b16 a[10:11], v10 offset:29696
    v_mfma_f32_16x16x32_bf16 v[76:79], v[44:47], a[180:183], v[76:79]
    ds_read_b64_tr_b16 a[12:13], v11 offset:28672
    v_mfma_f32_16x16x32_bf16 v[92:95], v[44:47], a[184:187], v[92:95]
    ds_read_b64_tr_b16 a[14:15], v11 offset:29696
    global_load_dwordx4 a[248:251], v29, s[100:101] offset:3072 sc1
    s_waitcnt vmcnt(14) lgkmcnt(8)
    s_barrier
    v_mfma_f32_16x16x32_bf16 v[64:67], v[48:51], a[188:191], v[64:67]
    ds_read_b64_tr_b16 v[32:33], v3 offset:32768
    s_add_u32 s39, s91, 1769472
    v_mfma_f32_16x16x32_bf16 v[80:83], v[48:51], a[192:195], v[80:83]
    ds_read_b64_tr_b16 v[34:35], v3 offset:33792
    s_and_b32 s39, s39, 0x1fffff
    s_add_u32 m0, s34, 77824
    v_mfma_f32_16x16x32_bf16 v[68:71], v[52:55], a[188:191], v[68:71]
    ds_read_b64_tr_b16 v[36:37], v4 offset:32768
    v_mfma_f32_16x16x32_bf16 v[84:87], v[52:55], a[192:195], v[84:87]
    ds_read_b64_tr_b16 v[38:39], v4 offset:33792
    buffer_load_dwordx4 v15, s[4:7], s39 offen lds
    v_mfma_f32_16x16x32_bf16 v[72:75], v[56:59], a[188:191], v[72:75]
    ds_read_b64_tr_b16 v[40:41], v10 offset:32768
    s_add_u32 s39, s91, 1835008
    v_mfma_f32_16x16x32_bf16 v[88:91], v[56:59], a[192:195], v[88:91]
    ds_read_b64_tr_b16 v[42:43], v10 offset:33792
    s_and_b32 s39, s39, 0x1fffff
    s_add_u32 m0, s34, 81920
    v_mfma_f32_16x16x32_bf16 v[76:79], v[60:63], a[188:191], v[76:79]
    ds_read_b64_tr_b16 v[44:45], v11 offset:32768
    v_mfma_f32_16x16x32_bf16 v[92:95], v[60:63], a[192:195], v[92:95]
    ds_read_b64_tr_b16 v[46:47], v11 offset:33792
    buffer_load_dwordx4 v15, s[4:7], s39 offen lds
    s_waitcnt vmcnt(14) lgkmcnt(8)
    v_mfma_f32_16x16x32_bf16 v[64:67], a[0:3], a[196:199], v[64:67]
    ds_read_b64_tr_b16 v[48:49], v3 offset:36864
    s_add_u32 s39, s91, 1900544
    v_mfma_f32_16x16x32_bf16 v[80:83], a[0:3], a[200:203], v[80:83]
    ds_read_b64_tr_b16 v[50:51], v3 offset:37888
    s_and_b32 s39, s39, 0x1fffff
    s_add_u32 m0, s34, 86016
    v_mfma_f32_16x16x32_bf16 v[68:71], a[4:7], a[196:199], v[68:71]
    ds_read_b64_tr_b16 v[52:53], v4 offset:36864
    v_mfma_f32_16x16x32_bf16 v[84:87], a[4:7], a[200:203], v[84:87]
    ds_read_b64_tr_b16 v[54:55], v4 offset:37888
    buffer_load_dwordx4 v15, s[4:7], s39 offen lds
    v_mfma_f32_16x16x32_bf16 v[72:75], a[8:11], a[196:199], v[72:75]
    ds_read_b64_tr_b16 v[56:57], v10 offset:36864
    s_add_u32 s39, s91, 1966080
    v_mfma_f32_16x16x32_bf16 v[88:91], a[8:11], a[200:203], v[88:91]
    ds_read_b64_tr_b16 v[58:59], v10 offset:37888
    s_and_b32 s39, s39, 0x1fffff
    s_add_u32 m0, s34, 90112
    v_mfma_f32_16x16x32_bf16 v[76:79], a[12:15], a[196:199], v[76:79]
    ds_read_b64_tr_b16 v[60:61], v11 offset:36864
    v_mfma_f32_16x16x32_bf16 v[92:95], a[12:15], a[200:203], v[92:95]
    ds_read_b64_tr_b16 v[62:63], v11 offset:37888
    buffer_load_dwordx4 v15, s[4:7], s39 offen lds
    s_waitcnt vmcnt(14) lgkmcnt(8)
    v_mfma_f32_16x16x32_bf16 v[64:67], v[32:35], a[204:207], v[64:67]
    ds_read_b64_tr_b16 a[0:1], v3 offset:40960
    s_add_u32 s39, s91, 2031616
    v_mfma_f32_16x16x32_bf16 v[80:83], v[32:35], a[208:211], v[80:83]
    ds_read_b64_tr_b16 a[2:3], v3 offset:41984
    s_and_b32 s39, s39, 0x1fffff
    s_add_u32 m0, s34, 94208
    v_mfma_f32_16x16x32_bf16 v[68:71], v[36:39], a[204:207], v[68:71]
    ds_read_b64_tr_b16 a[4:5], v4 offset:40960
    v_mfma_f32_16x16x32_bf16 v[84:87], v[36:39], a[208:211], v[84:87]
    ds_read_b64_tr_b16 a[6:7], v4 offset:41984
    buffer_load_dwordx4 v15, s[4:7], s39 offen lds
    v_mfma_f32_16x16x32_bf16 v[72:75], v[40:43], a[204:207], v[72:75]
    ds_read_b64_tr_b16 a[8:9], v10 offset:40960
    v_mfma_f32_16x16x32_bf16 v[88:91], v[40:43], a[208:211], v[88:91]
    ds_read_b64_tr_b16 a[10:11], v10 offset:41984
    v_mfma_f32_16x16x32_bf16 v[76:79], v[44:47], a[204:207], v[76:79]
    ds_read_b64_tr_b16 a[12:13], v11 offset:40960
    v_mfma_f32_16x16x32_bf16 v[92:95], v[44:47], a[208:211], v[92:95]
    ds_read_b64_tr_b16 a[14:15], v11 offset:41984
    global_load_dwordx4 a[252:255], v5, s[100:101] offset:0 sc1
    s_waitcnt vmcnt(14) lgkmcnt(8)
    v_mfma_f32_16x16x32_bf16 v[64:67], v[48:51], a[212:215], v[64:67]
    ds_read_b64_tr_b16 v[32:33], v3 offset:45056
    v_mfma_f32_16x16x32_bf16 v[80:83], v[48:51], a[216:219], v[80:83]
    ds_read_b64_tr_b16 v[34:35], v3 offset:46080
    v_mfma_f32_16x16x32_bf16 v[68:71], v[52:55], a[212:215], v[68:71]
    ds_read_b64_tr_b16 v[36:37], v4 offset:45056
    v_mfma_f32_16x16x32_bf16 v[84:87], v[52:55], a[216:219], v[84:87]
    ds_read_b64_tr_b16 v[38:39], v4 offset:46080
    global_load_dwordx4 v[96:99], v5, s[100:101] offset:1024 sc1
    v_mfma_f32_16x16x32_bf16 v[72:75], v[56:59], a[212:215], v[72:75]
    ds_read_b64_tr_b16 v[40:41], v10 offset:45056
    v_mfma_f32_16x16x32_bf16 v[88:91], v[56:59], a[216:219], v[88:91]
    ds_read_b64_tr_b16 v[42:43], v10 offset:46080
    v_mfma_f32_16x16x32_bf16 v[76:79], v[60:63], a[212:215], v[76:79]
    ds_read_b64_tr_b16 v[44:45], v11 offset:45056
    v_mfma_f32_16x16x32_bf16 v[92:95], v[60:63], a[216:219], v[92:95]
    ds_read_b64_tr_b16 v[46:47], v11 offset:46080
    global_load_dwordx4 v[100:103], v5, s[100:101] offset:2048 sc1
    s_waitcnt vmcnt(14) lgkmcnt(8)
    v_mfma_f32_16x16x32_bf16 v[64:67], a[0:3], a[220:223], v[64:67]
    ds_read_b64_tr_b16 v[48:49], v3 offset:49152
    s_mul_i32 s38, s20, 4608
    v_mfma_f32_16x16x32_bf16 v[80:83], a[0:3], a[224:227], v[80:83]
    ds_read_b64_tr_b16 v[50:51], v3 offset:50176
    v_and_b32 v20, 15, v1
    v_mfma_f32_16x16x32_bf16 v[68:71], a[4:7], a[220:223], v[68:71]
    ds_read_b64_tr_b16 v[52:53], v4 offset:49152
    s_add_u32 s38, s38, 131072
    v_mfma_f32_16x16x32_bf16 v[84:87], a[4:7], a[224:227], v[84:87]
    ds_read_b64_tr_b16 v[54:55], v4 offset:50176
    v_mul_u32_u24 v20, 144, v20
    global_load_dwordx4 v[104:107], v5, s[100:101] offset:3072 sc1
    v_mfma_f32_16x16x32_bf16 v[72:75], a[8:11], a[220:223], v[72:75]
    ds_read_b64_tr_b16 v[56:57], v10 offset:49152
    v_lshrrev_b32 v21, 4, v1
    v_lshl_add_u32 v20, v21, 3, v20
    v_mfma_f32_16x16x32_bf16 v[88:91], a[8:11], a[224:227], v[88:91]
    ds_read_b64_tr_b16 v[58:59], v10 offset:50176
    s_add_u32 s90, s90, 8192
    s_and_b32 s90, s90, 0xffff
    s_add_u32 s100, s98, s90
    s_addc_u32 s101, s99, 0
    v_mfma_f32_16x16x32_bf16 v[76:79], a[12:15], a[220:223], v[76:79]
    ds_read_b64_tr_b16 v[60:61], v11 offset:49152
    v_add_u32 v20, s38, v20
    v_mfma_f32_16x16x32_bf16 v[92:95], a[12:15], a[224:227], v[92:95]
    ds_read_b64_tr_b16 v[62:63], v11 offset:50176
    v_lshrrev_b32 v22, 3, v1
    global_load_dwordx4 v[108:111], v29, s[100:101] offset:0 sc1
    s_waitcnt vmcnt(14) lgkmcnt(8)
    v_mfma_f32_16x16x32_bf16 v[64:67], v[32:35], a[228:231], v[64:67]
    ds_read_b64_tr_b16 a[0:1], v3 offset:53248
    v_and_b32 v19, 7, v1
    v_mfma_f32_16x16x32_bf16 v[80:83], v[32:35], a[232:235], v[80:83]
    ds_read_b64_tr_b16 a[2:3], v3 offset:54272
    v_lshlrev_b32 v19, 4, v19
    v_mfma_f32_16x16x32_bf16 v[68:71], v[36:39], a[228:231], v[68:71]
    ds_read_b64_tr_b16 a[4:5], v4 offset:53248
    v_mul_u32_u24 v21, 144, v22
    v_mfma_f32_16x16x32_bf16 v[84:87], v[36:39], a[232:235], v[84:87]
    ds_read_b64_tr_b16 a[6:7], v4 offset:54272
    v_add3_u32 v21, v21, v19, s38
    global_load_dwordx4 v[112:115], v29, s[100:101] offset:1024 sc1
    v_mfma_f32_16x16x32_bf16 v[72:75], v[40:43], a[228:231], v[72:75]
    ds_read_b64_tr_b16 a[8:9], v10 offset:53248
    v_lshl_add_u32 v19, v22, 11, v19
    v_mfma_f32_16x16x32_bf16 v[88:91], v[40:43], a[232:235], v[88:91]
    ds_read_b64_tr_b16 a[10:11], v10 offset:54272
    v_add_u32 v22, 16384, v19
    v_mfma_f32_16x16x32_bf16 v[76:79], v[44:47], a[228:231], v[76:79]
    ds_read_b64_tr_b16 a[12:13], v11 offset:53248
    v_mfma_f32_16x16x32_bf16 v[92:95], v[44:47], a[232:235], v[92:95]
    ds_read_b64_tr_b16 a[14:15], v11 offset:54272
    global_load_dwordx4 v[116:119], v29, s[100:101] offset:2048 sc1
    s_waitcnt vmcnt(14) lgkmcnt(8)
    v_mfma_f32_16x16x32_bf16 v[64:67], v[48:51], a[236:239], v[64:67]
    ds_read_b64_tr_b16 v[32:33], v3 offset:57344
    v_mfma_f32_16x16x32_bf16 v[80:83], v[48:51], a[240:243], v[80:83]
    ds_read_b64_tr_b16 v[34:35], v3 offset:58368
    v_mfma_f32_16x16x32_bf16 v[68:71], v[52:55], a[236:239], v[68:71]
    ds_read_b64_tr_b16 v[36:37], v4 offset:57344
    v_mfma_f32_16x16x32_bf16 v[84:87], v[52:55], a[240:243], v[84:87]
    ds_read_b64_tr_b16 v[38:39], v4 offset:58368
    global_load_dwordx4 v[120:123], v29, s[100:101] offset:3072 sc1
    v_mfma_f32_16x16x32_bf16 v[72:75], v[56:59], a[236:239], v[72:75]
    ds_read_b64_tr_b16 v[40:41], v10 offset:57344
    v_mfma_f32_16x16x32_bf16 v[88:91], v[56:59], a[240:243], v[88:91]
    ds_read_b64_tr_b16 v[42:43], v10 offset:58368
    v_mfma_f32_16x16x32_bf16 v[76:79], v[60:63], a[236:239], v[76:79]
    ds_read_b64_tr_b16 v[44:45], v11 offset:57344
    v_mfma_f32_16x16x32_bf16 v[92:95], v[60:63], a[240:243], v[92:95]
    ds_read_b64_tr_b16 v[46:47], v11 offset:58368
    global_load_dwordx4 v[124:127], v5, s[100:101] offset:0 sc1
    s_waitcnt vmcnt(14) lgkmcnt(8)
    v_mfma_f32_16x16x32_bf16 v[64:67], a[0:3], a[244:247], v[64:67]
    ds_read_b64_tr_b16 v[48:49], v3 offset:61440
    v_mfma_f32_16x16x32_bf16 v[80:83], a[0:3], a[248:251], v[80:83]
    ds_read_b64_tr_b16 v[50:51], v3 offset:62464
    v_add_u32 v3, 65536, v3
    v_mfma_f32_16x16x32_bf16 v[68:71], a[4:7], a[244:247], v[68:71]
    ds_read_b64_tr_b16 v[52:53], v4 offset:61440
    v_mfma_f32_16x16x32_bf16 v[84:87], a[4:7], a[248:251], v[84:87]
    ds_read_b64_tr_b16 v[54:55], v4 offset:62464
    v_add_u32 v4, 65536, v4
    global_load_dwordx4 v[160:163], v5, s[100:101] offset:1024 sc1
    v_mfma_f32_16x16x32_bf16 v[72:75], a[8:11], a[244:247], v[72:75]
    ds_read_b64_tr_b16 v[56:57], v10 offset:61440
    v_mfma_f32_16x16x32_bf16 v[88:91], a[8:11], a[248:251], v[88:91]
    ds_read_b64_tr_b16 v[58:59], v10 offset:62464
    v_add_u32 v10, 65536, v10
    v_mfma_f32_16x16x32_bf16 v[76:79], a[12:15], a[244:247], v[76:79]
    ds_read_b64_tr_b16 v[60:61], v11 offset:61440
    v_mfma_f32_16x16x32_bf16 v[92:95], a[12:15], a[248:251], v[92:95]
    ds_read_b64_tr_b16 v[62:63], v11 offset:62464
    v_add_u32 v11, 65536, v11
    global_load_dwordx4 v[164:167], v5, s[100:101] offset:2048 sc1
    s_waitcnt vmcnt(9) lgkmcnt(8)
    s_barrier
    v_mfma_f32_16x16x32_bf16 v[64:67], v[32:35], a[252:255], v[64:67]
    ds_read_b64_tr_b16 a[0:1], v3 offset:0
    v_mfma_f32_16x16x32_bf16 v[80:83], v[32:35], v[96:99], v[80:83]
    ds_read_b64_tr_b16 a[2:3], v3 offset:1024
    v_mfma_f32_16x16x32_bf16 v[68:71], v[36:39], a[252:255], v[68:71]
    ds_read_b64_tr_b16 a[4:5], v4 offset:0
    v_mfma_f32_16x16x32_bf16 v[84:87], v[36:39], v[96:99], v[84:87]
    ds_read_b64_tr_b16 a[6:7], v4 offset:1024
    global_load_dwordx4 v[168:171], v5, s[100:101] offset:3072 sc1
    v_mfma_f32_16x16x32_bf16 v[72:75], v[40:43], a[252:255], v[72:75]
    ds_read_b64_tr_b16 a[8:9], v10 offset:0
    s_add_u32 s90, s90, 8192
    v_mfma_f32_16x16x32_bf16 v[88:91], v[40:43], v[96:99], v[88:91]
    ds_read_b64_tr_b16 a[10:11], v10 offset:1024
    s_and_b32 s90, s90, 0xffff
    s_add_u32 s100, s98, s90
    s_addc_u32 s101, s99, 0
    v_mfma_f32_16x16x32_bf16 v[76:79], v[44:47], a[252:255], v[76:79]
    ds_read_b64_tr_b16 a[12:13], v11 offset:0
    v_mfma_f32_16x16x32_bf16 v[92:95], v[44:47], v[96:99], v[92:95]
    ds_read_b64_tr_b16 a[14:15], v11 offset:1024
    global_load_dwordx4 v[172:175], v29, s[100:101] offset:0 sc1
    s_waitcnt vmcnt(9) lgkmcnt(8)
    v_mfma_f32_16x16x32_bf16 v[64:67], v[48:51], v[100:103], v[64:67]
    ds_read_b64_tr_b16 v[32:33], v3 offset:4096
    v_mfma_f32_16x16x32_bf16 v[80:83], v[48:51], v[104:107], v[80:83]
    ds_read_b64_tr_b16 v[34:35], v3 offset:5120
    v_mfma_f32_16x16x32_bf16 v[68:71], v[52:55], v[100:103], v[68:71]
    ds_read_b64_tr_b16 v[36:37], v4 offset:4096
    v_mfma_f32_16x16x32_bf16 v[84:87], v[52:55], v[104:107], v[84:87]
    ds_read_b64_tr_b16 v[38:39], v4 offset:5120
    global_load_dwordx4 v[192:195], v29, s[100:101] offset:1024 sc1
    v_mfma_f32_16x16x32_bf16 v[72:75], v[56:59], v[100:103], v[72:75]
    ds_read_b64_tr_b16 v[40:41], v10 offset:4096
    v_mfma_f32_16x16x32_bf16 v[88:91], v[56:59], v[104:107], v[88:91]
    ds_read_b64_tr_b16 v[42:43], v10 offset:5120
    v_mfma_f32_16x16x32_bf16 v[76:79], v[60:63], v[100:103], v[76:79]
    ds_read_b64_tr_b16 v[44:45], v11 offset:4096
    v_mfma_f32_16x16x32_bf16 v[92:95], v[60:63], v[104:107], v[92:95]
    ds_read_b64_tr_b16 v[46:47], v11 offset:5120
    global_load_dwordx4 v[196:199], v29, s[100:101] offset:2048 sc1
    s_waitcnt vmcnt(9) lgkmcnt(8)
    v_mfma_f32_16x16x32_bf16 v[64:67], a[0:3], v[108:111], v[64:67]
    ds_read_b64_tr_b16 v[48:49], v3 offset:8192
    v_mfma_f32_16x16x32_bf16 v[80:83], a[0:3], v[112:115], v[80:83]
    ds_read_b64_tr_b16 v[50:51], v3 offset:9216
    v_mfma_f32_16x16x32_bf16 v[68:71], a[4:7], v[108:111], v[68:71]
    ds_read_b64_tr_b16 v[52:53], v4 offset:8192
    v_mfma_f32_16x16x32_bf16 v[84:87], a[4:7], v[112:115], v[84:87]
    ds_read_b64_tr_b16 v[54:55], v4 offset:9216
    global_load_dwordx4 v[200:203], v29, s[100:101] offset:3072 sc1
    v_mfma_f32_16x16x32_bf16 v[72:75], a[8:11], v[108:111], v[72:75]
    ds_read_b64_tr_b16 v[56:57], v10 offset:8192
    v_mfma_f32_16x16x32_bf16 v[88:91], a[8:11], v[112:115], v[88:91]
    ds_read_b64_tr_b16 v[58:59], v10 offset:9216
    v_mfma_f32_16x16x32_bf16 v[76:79], a[12:15], v[108:111], v[76:79]
    ds_read_b64_tr_b16 v[60:61], v11 offset:8192
    v_mfma_f32_16x16x32_bf16 v[92:95], a[12:15], v[112:115], v[92:95]
    ds_read_b64_tr_b16 v[62:63], v11 offset:9216
    global_load_dwordx4 v[204:207], v5, s[100:101] offset:0 sc1
    s_waitcnt vmcnt(9) lgkmcnt(8)
    v_mfma_f32_16x16x32_bf16 v[64:67], v[32:35], v[116:119], v[64:67]
    ds_read_b64_tr_b16 a[0:1], v3 offset:12288
    v_mfma_f32_16x16x32_bf16 v[80:83], v[32:35], v[120:123], v[80:83]
    ds_read_b64_tr_b16 a[2:3], v3 offset:13312
    v_mfma_f32_16x16x32_bf16 v[68:71], v[36:39], v[116:119], v[68:71]
    ds_read_b64_tr_b16 a[4:5], v4 offset:12288
    v_mfma_f32_16x16x32_bf16 v[84:87], v[36:39], v[120:123], v[84:87]
    ds_read_b64_tr_b16 a[6:7], v4 offset:13312
    global_load_dwordx4 v[208:211], v5, s[100:101] offset:1024 sc1
    v_mfma_f32_16x16x32_bf16 v[72:75], v[40:43], v[116:119], v[72:75]
    ds_read_b64_tr_b16 a[8:9], v10 offset:12288
    v_mfma_f32_16x16x32_bf16 v[88:91], v[40:43], v[120:123], v[88:91]
    ds_read_b64_tr_b16 a[10:11], v10 offset:13312
    v_mfma_f32_16x16x32_bf16 v[76:79], v[44:47], v[116:119], v[76:79]
    ds_read_b64_tr_b16 a[12:13], v11 offset:12288
    v_mfma_f32_16x16x32_bf16 v[92:95], v[44:47], v[120:123], v[92:95]
    ds_read_b64_tr_b16 a[14:15], v11 offset:13312
    global_load_dwordx4 v[212:215], v5, s[100:101] offset:2048 sc1
    s_waitcnt vmcnt(9) lgkmcnt(8)
    v_mfma_f32_16x16x32_bf16 v[64:67], v[48:51], v[124:127], v[64:67]
    ds_read_b64_tr_b16 v[32:33], v3 offset:16384
    v_mfma_f32_16x16x32_bf16 v[80:83], v[48:51], v[160:163], v[80:83]
    ds_read_b64_tr_b16 v[34:35], v3 offset:17408
    v_mfma_f32_16x16x32_bf16 v[68:71], v[52:55], v[124:127], v[68:71]
    ds_read_b64_tr_b16 v[36:37], v4 offset:16384
    v_mfma_f32_16x16x32_bf16 v[84:87], v[52:55], v[160:163], v[84:87]
    ds_read_b64_tr_b16 v[38:39], v4 offset:17408
    global_load_dwordx4 v[216:219], v5, s[100:101] offset:3072 sc1
    v_mfma_f32_16x16x32_bf16 v[72:75], v[56:59], v[124:127], v[72:75]
    ds_read_b64_tr_b16 v[40:41], v10 offset:16384
    v_mfma_f32_16x16x32_bf16 v[88:91], v[56:59], v[160:163], v[88:91]
    ds_read_b64_tr_b16 v[42:43], v10 offset:17408
    v_mfma_f32_16x16x32_bf16 v[76:79], v[60:63], v[124:127], v[76:79]
    ds_read_b64_tr_b16 v[44:45], v11 offset:16384
    v_mfma_f32_16x16x32_bf16 v[92:95], v[60:63], v[160:163], v[92:95]
    ds_read_b64_tr_b16 v[46:47], v11 offset:17408
    s_waitcnt vmcnt(8) lgkmcnt(8)
    v_mfma_f32_16x16x32_bf16 v[64:67], a[0:3], v[164:167], v[64:67]
    ds_read_b64_tr_b16 v[48:49], v3 offset:20480
    v_mfma_f32_16x16x32_bf16 v[80:83], a[0:3], v[168:171], v[80:83]
    ds_read_b64_tr_b16 v[50:51], v3 offset:21504
    v_mfma_f32_16x16x32_bf16 v[68:71], a[4:7], v[164:167], v[68:71]
    ds_read_b64_tr_b16 v[52:53], v4 offset:20480
    v_mfma_f32_16x16x32_bf16 v[84:87], a[4:7], v[168:171], v[84:87]
    ds_read_b64_tr_b16 v[54:55], v4 offset:21504
    v_mfma_f32_16x16x32_bf16 v[72:75], a[8:11], v[164:167], v[72:75]
    ds_read_b64_tr_b16 v[56:57], v10 offset:20480
    v_mfma_f32_16x16x32_bf16 v[88:91], a[8:11], v[168:171], v[88:91]
    ds_read_b64_tr_b16 v[58:59], v10 offset:21504
    v_mfma_f32_16x16x32_bf16 v[76:79], a[12:15], v[164:167], v[76:79]
    ds_read_b64_tr_b16 v[60:61], v11 offset:20480
    v_mfma_f32_16x16x32_bf16 v[92:95], a[12:15], v[168:171], v[92:95]
    ds_read_b64_tr_b16 v[62:63], v11 offset:21504
    s_waitcnt vmcnt(6) lgkmcnt(8)
    v_mfma_f32_16x16x32_bf16 v[64:67], v[32:35], v[172:175], v[64:67]
    ds_read_b64_tr_b16 a[0:1], v3 offset:24576
    v_mfma_f32_16x16x32_bf16 v[80:83], v[32:35], v[192:195], v[80:83]
    ds_read_b64_tr_b16 a[2:3], v3 offset:25600
    v_mfma_f32_16x16x32_bf16 v[68:71], v[36:39], v[172:175], v[68:71]
    ds_read_b64_tr_b16 a[4:5], v4 offset:24576
    v_mfma_f32_16x16x32_bf16 v[84:87], v[36:39], v[192:195], v[84:87]
    ds_read_b64_tr_b16 a[6:7], v4 offset:25600
    v_mfma_f32_16x16x32_bf16 v[72:75], v[40:43], v[172:175], v[72:75]
    ds_read_b64_tr_b16 a[8:9], v10 offset:24576
    v_mfma_f32_16x16x32_bf16 v[88:91], v[40:43], v[192:195], v[88:91]
    ds_read_b64_tr_b16 a[10:11], v10 offset:25600
    v_mfma_f32_16x16x32_bf16 v[76:79], v[44:47], v[172:175], v[76:79]
    ds_read_b64_tr_b16 a[12:13], v11 offset:24576
    v_mfma_f32_16x16x32_bf16 v[92:95], v[44:47], v[192:195], v[92:95]
    ds_read_b64_tr_b16 a[14:15], v11 offset:25600
    s_waitcnt vmcnt(4) lgkmcnt(8)
    v_mfma_f32_16x16x32_bf16 v[64:67], v[48:51], v[196:199], v[64:67]
    ds_read_b64_tr_b16 v[32:33], v3 offset:28672
    v_mfma_f32_16x16x32_bf16 v[80:83], v[48:51], v[200:203], v[80:83]
    ds_read_b64_tr_b16 v[34:35], v3 offset:29696
    v_mfma_f32_16x16x32_bf16 v[68:71], v[52:55], v[196:199], v[68:71]
    ds_read_b64_tr_b16 v[36:37], v4 offset:28672
    v_mfma_f32_16x16x32_bf16 v[84:87], v[52:55], v[200:203], v[84:87]
    ds_read_b64_tr_b16 v[38:39], v4 offset:29696
    v_mfma_f32_16x16x32_bf16 v[72:75], v[56:59], v[196:199], v[72:75]
    ds_read_b64_tr_b16 v[40:41], v10 offset:28672
    v_mfma_f32_16x16x32_bf16 v[88:91], v[56:59], v[200:203], v[88:91]
    ds_read_b64_tr_b16 v[42:43], v10 offset:29696
    v_mfma_f32_16x16x32_bf16 v[76:79], v[60:63], v[196:199], v[76:79]
    ds_read_b64_tr_b16 v[44:45], v11 offset:28672
    v_mfma_f32_16x16x32_bf16 v[92:95], v[60:63], v[200:203], v[92:95]
    ds_read_b64_tr_b16 v[46:47], v11 offset:29696
    s_waitcnt vmcnt(0) lgkmcnt(0)
    v_mfma_f32_16x16x32_bf16 v[64:67], a[0:3], v[204:207], v[64:67]
    s_lshl_b32 s36, s88, 18
    v_mfma_f32_16x16x32_bf16 v[68:71], a[4:7], v[204:207], v[68:71]
    s_lshl_b32 s37, s20, 16
    v_mfma_f32_16x16x32_bf16 v[72:75], a[8:11], v[204:207], v[72:75]
    s_add_u32 s36, s36, s37
    v_mfma_f32_16x16x32_bf16 v[76:79], a[12:15], v[204:207], v[76:79]
    s_lshl_b32 s37, s89, 7
    v_mfma_f32_16x16x32_bf16 v[64:67], v[32:35], v[212:215], v[64:67]
    s_add_u32 s36, s36, s37
    v_mfma_f32_16x16x32_bf16 v[68:71], v[36:39], v[212:215], v[68:71]
    s_add_u32 s37, s36, 32768
    v_mfma_f32_16x16x32_bf16 v[72:75], v[40:43], v[212:215], v[72:75]
    v_mfma_f32_16x16x32_bf16 v[76:79], v[44:47], v[212:215], v[76:79]
    v_mfma_f32_16x16x32_bf16 v[80:83], a[0:3], v[208:211], v[80:83]
    s_nop 1
    v_mfma_f32_16x16x32_bf16 v[84:87], a[4:7], v[208:211], v[84:87]
    s_nop 1
    v_mfma_f32_16x16x32_bf16 v[88:91], a[8:11], v[208:211], v[88:91]
    v_fma_f32 v128, v64, v12, v128
    v_fma_f32 v129, v65, v12, v129
    v_mfma_f32_16x16x32_bf16 v[92:95], a[12:15], v[208:211], v[92:95]
    v_fma_f32 v130, v66, v12, v130
    v_fma_f32 v131, v67, v12, v131
    v_mfma_f32_16x16x32_bf16 v[80:83], v[32:35], v[216:219], v[80:83]
    v_fma_f32 v132, v68, v12, v132
    v_fma_f32 v133, v69, v12, v133
    v_mfma_f32_16x16x32_bf16 v[84:87], v[36:39], v[216:219], v[84:87]
    v_fma_f32 v134, v70, v12, v134
    v_fma_f32 v135, v71, v12, v135
    v_mfma_f32_16x16x32_bf16 v[88:91], v[40:43], v[216:219], v[88:91]
    v_fma_f32 v136, v72, v12, v136
    v_fma_f32 v137, v73, v12, v137
    v_mfma_f32_16x16x32_bf16 v[92:95], v[44:47], v[216:219], v[92:95]
    v_fma_f32 v138, v74, v12, v138
    v_fma_f32 v139, v75, v12, v139
    v_fma_f32 v140, v76, v12, v140
    v_fma_f32 v141, v77, v12, v141
    v_fma_f32 v142, v78, v12, v142
    v_fma_f32 v143, v79, v12, v143
    v_cvt_pk_bf16_f32 v128, v128, v129
    v_cvt_pk_bf16_f32 v129, v130, v131
    v_cvt_pk_bf16_f32 v130, v132, v133
    v_cvt_pk_bf16_f32 v131, v134, v135
    v_cvt_pk_bf16_f32 v132, v136, v137
    v_cvt_pk_bf16_f32 v133, v138, v139
    v_cvt_pk_bf16_f32 v134, v140, v141
    v_cvt_pk_bf16_f32 v135, v142, v143
    ds_write_b64 v20, v[128:129] offset:0
    ds_write_b64 v20, v[130:131] offset:32
    ds_write_b64 v20, v[132:133] offset:64
    ds_write_b64 v20, v[134:135] offset:96
    ds_read_b128 v[64:67], v21 offset:0
    ds_read_b128 v[68:71], v21 offset:1152
    v_fma_f32 v144, v80, v13, v144
    v_fma_f32 v145, v81, v13, v145
    v_fma_f32 v146, v82, v13, v146
    v_fma_f32 v147, v83, v13, v147
    v_fma_f32 v148, v84, v13, v148
    v_fma_f32 v149, v85, v13, v149
    v_fma_f32 v150, v86, v13, v150
    v_fma_f32 v151, v87, v13, v151
    v_fma_f32 v152, v88, v13, v152
    v_fma_f32 v153, v89, v13, v153
    v_fma_f32 v154, v90, v13, v154
    v_fma_f32 v155, v91, v13, v155
    v_fma_f32 v156, v92, v13, v156
    v_fma_f32 v157, v93, v13, v157
    v_fma_f32 v158, v94, v13, v158
    v_fma_f32 v159, v95, v13, v159
    v_cvt_pk_bf16_f32 v144, v144, v145
    v_cvt_pk_bf16_f32 v145, v146, v147
    v_cvt_pk_bf16_f32 v146, v148, v149
    v_cvt_pk_bf16_f32 v147, v150, v151
    v_cvt_pk_bf16_f32 v148, v152, v153
    v_cvt_pk_bf16_f32 v149, v154, v155
    v_cvt_pk_bf16_f32 v150, v156, v157
    v_cvt_pk_bf16_f32 v151, v158, v159
    s_waitcnt lgkmcnt(0)
    ds_write_b64 v20, v[144:145] offset:2304
    ds_write_b64 v20, v[146:147] offset:2336
    ds_write_b64 v20, v[148:149] offset:2368
    ds_write_b64 v20, v[150:151] offset:2400
    ds_read_b128 v[72:75], v21 offset:2304
    ds_read_b128 v[76:79], v21 offset:3456
    buffer_store_dwordx4 v[64:67], v19, s[12:15], s36 offen sc1
    buffer_store_dwordx4 v[68:71], v22, s[12:15], s36 offen sc1
    s_waitcnt lgkmcnt(0)
    buffer_store_dwordx4 v[72:75], v19, s[12:15], s37 offen sc1
    buffer_store_dwordx4 v[76:79], v22, s[12:15], s37 offen sc1
    s_endpgm
L_NONCE_S:
    s_mov_b32 s87, 0
L_NONCE_L:
    global_load_dword v21, v19, s[78:79] sc1
    s_add_u32 s87, s87, 1
    s_waitcnt vmcnt(0)
    v_readfirstlane_b32 s60, v21
    s_cmp_lt_u32 s87, 0x40000
    s_cbranch_scc0 L_NONCE_R
    s_nop 2
    s_cmp_eq_u32 s60, 0
    s_cbranch_scc1 L_NONCE_L
    s_branch L_NONCE_R
L_PKV_S:
    s_mov_b32 s87, 0
L_PKV_L:
    buffer_load_dword v21, v17, s[16:19], s31 offen sc1
    s_add_u32 s87, s87, 1
    s_waitcnt vmcnt(0)
    v_cmp_ne_u32 vcc, s60, v21
    s_cmp_lt_u32 s87, 0x40000
    s_cbranch_scc0 L_PKV_R
    s_nop 2
    s_and_b32 vcc_hi, vcc_lo, 1
    s_cbranch_scc1 L_PKV_L
    s_branch L_PKV_R
L_PKV2_S:
    s_mov_b32 s87, 0
L_PKV2_L:
    buffer_load_dword v21, v17, s[16:19], s31 offen sc1
    s_add_u32 s87, s87, 1
    s_waitcnt vmcnt(0)
    v_cmp_ne_u32 vcc, s60, v21
    s_cmp_lt_u32 s87, 0x40000
    s_cbranch_scc0 L_PKV2_R
    s_nop 2
    s_and_b32 vcc_hi, vcc_lo, 2
    s_cbranch_scc1 L_PKV2_L
    s_branch L_PKV2_R
L_PKV3_S:
    s_mov_b32 s87, 0
L_PKV3_L:
    buffer_load_dword v21, v17, s[16:19], s31 offen sc1
    s_add_u32 s87, s87, 1
    s_waitcnt vmcnt(0)
    v_cmp_ne_u32 vcc, s60, v21
    s_cmp_lt_u32 s87, 0x40000
    s_cbranch_scc0 L_PKV3_R
    s_nop 2
    s_and_b32 vcc_hi, vcc_lo, 65535
    s_cbranch_scc1 L_PKV3_L
    s_branch L_PKV3_R
L_PH_S:
    s_mov_b32 s87, 0
L_PH_L:
    buffer_load_dword v22, v18, s[16:19], s33 offen sc1
    s_add_u32 s87, s87, 1
    s_waitcnt vmcnt(0)
    v_cmp_ne_u32 vcc, s60, v22
    s_cmp_lt_u32 s87, 0x40000
    s_cbranch_scc0 L_PH_R
    s_nop 2
    s_and_b32 vcc_hi, vcc_lo, -1
    s_cbranch_scc1 L_PH_L
    s_branch L_PH_R
L_POB_S:
    s_mov_b32 s87, 0
L_POB_L:
    buffer_load_dword v21, v16, s[16:19], s47 offen sc1
    s_add_u32 s87, s87, 1
    s_waitcnt vmcnt(0)
    v_cmp_ne_u32 vcc, s60, v21
    s_cmp_lt_u32 s87, 0x40000
    s_cbranch_scc0 L_POB_R
    s_nop 2
    s_and_b32 vcc_hi, vcc_lo, -1
    s_cbranch_scc1 L_POB_L
    s_branch L_POB_R
L_FALLBACK:
    s_mov_b32 s83, 1
    s_waitcnt lgkmcnt(0)
    v_mov_b32 v19, 0xff800000
    v_mov_b32 v20, 0xff800000
    s_lshl_b32 s38, s21, 19
    s_lshl_b32 s39, s24, 14
    s_add_u32 s38, s38, s39
    s_mov_b32 s39, 0
L_FB:
    s_and_b32 s36, s39, 3
    s_lshl_b32 s36, s36, 12
    s_lshr_b32 s37, s39, 2
    s_lshl_b32 s37, s37, 15
    s_add_u32 s36, s36, s37
    s_add_u32 s36, s36, s38
    buffer_load_dwordx4 a[0:3], v29, s[16:19], s36 offen sc1
    buffer_load_dwordx4 a[4:7], v29, s[16:19], s36 offen offset:1024 sc1
    s_waitcnt vmcnt(0)
    v_mfma_f32_32x32x16_bf16 v[176:191], a[0:3], v[64:67], 0
    v_mfma_f32_32x32x16_bf16 v[240:255], a[0:3], v[80:83], 0
    v_mfma_f32_32x32x16_bf16 v[176:191], a[4:7], v[68:71], v[176:191]
    v_mfma_f32_32x32x16_bf16 v[240:255], a[4:7], v[84:87], v[240:255]
    s_nop 11
    v_max3_f32 v19, v19, v176, v177
    v_max3_f32 v19, v19, v178, v179
    v_max3_f32 v19, v19, v180, v181
    v_max3_f32 v19, v19, v182, v183
    v_max3_f32 v19, v19, v184, v185
    v_max3_f32 v19, v19, v186, v187
    v_max3_f32 v19, v19, v188, v189
    v_max3_f32 v19, v19, v190, v191
    v_max3_f32 v20, v20, v240, v241
    v_max3_f32 v20, v20, v242, v243
    v_max3_f32 v20, v20, v244, v245
    v_max3_f32 v20, v20, v246, v247
    v_max3_f32 v20, v20, v248, v249
    v_max3_f32 v20, v20, v250, v251
    v_max3_f32 v20, v20, v252, v253
    v_max3_f32 v20, v20, v254, v255
    s_add_u32 s39, s39, 1
    s_cmp_lt_u32 s39, 64
    s_cbranch_scc1 L_FB
    v_mov_b32 v21, v19
    v_mov_b32 v22, v20
    s_nop 0
    v_permlane32_swap_b32 v19, v21
    v_permlane32_swap_b32 v20, v22
    v_max_f32 v19, v19, v21
    v_max_f32 v20, v20, v22
    v_sub_f32 v128, 0, v19
    v_sub_f32 v129, 0, v19
    v_sub_f32 v130, 0, v19
    v_sub_f32 v131, 0, v19
    v_sub_f32 v132, 0, v19
    v_sub_f32 v133, 0, v19
    v_sub_f32 v134, 0, v19
    v_sub_f32 v135, 0, v19
    v_sub_f32 v136, 0, v19
    v_sub_f32 v137, 0, v19
    v_sub_f32 v138, 0, v19
    v_sub_f32 v139, 0, v19
    v_sub_f32 v140, 0, v19
    v_sub_f32 v141, 0, v19
    v_sub_f32 v142, 0, v19
    v_sub_f32 v143, 0, v19
    v_sub_f32 v144, 0, v20
    v_sub_f32 v145, 0, v20
    v_sub_f32 v146, 0, v20
    v_sub_f32 v147, 0, v20
    v_sub_f32 v148, 0, v20
    v_sub_f32 v149, 0, v20
    v_sub_f32 v150, 0, v20
    v_sub_f32 v151, 0, v20
    v_sub_f32 v152, 0, v20
    v_sub_f32 v153, 0, v20
    v_sub_f32 v154, 0, v20
    v_sub_f32 v155, 0, v20
    v_sub_f32 v156, 0, v20
    v_sub_f32 v157, 0, v20
    v_sub_f32 v158, 0, v20
    v_sub_f32 v159, 0, v20
    v_lshrrev_b32 v23, 1, v1
    v_and_b32 v23, 3, v23
    v_min_u32 v24, 1, v23
    v_add_u32 v24, -1, v24
    v_and_b32 v24, 0x3f803f80, v24
    v_accvgpr_write_b32 a72, v24
    v_accvgpr_write_b32 a73, v24
    v_xor_b32 v23, 2, v23
    v_min_u32 v24, 1, v23
    v_add_u32 v24, -1, v24
    v_and_b32 v24, 0x3f803f80, v24
    v_accvgpr_write_b32 a74, v24
    v_accvgpr_write_b32 a75, v24
    v_and_b32 v9, 1, v1
    v_mul_u32_u24 v9, 0xaaaa, v9
    v_add_u32 v9, 0x4444, v9
    s_lshl_b32 s36, s22, 15
    s_add_u32 s98, s84, s36
    s_addc_u32 s99, s85, 0
    s_add_u32 s36, s96, 12582912
    s_add_u32 s100, s54, s36
    s_addc_u32 s101, s55, 0
    v_add_u32 v0, -16384, v0
    s_barrier
    s_add_u32 m0, s27, 98304
    s_nop 0
    global_load_lds_dwordx4 v29, s[98:99] offset:0 sc1
    global_load_lds_dwordx4 v29, s[98:99] offset:1024 sc1
    global_load_lds_dwordx4 v29, s[98:99] offset:2048 sc1
    global_load_lds_dwordx4 v29, s[98:99] offset:3072 sc1
    s_add_u32 m0, s27, 102400
    s_nop 0
    global_load_lds_dwordx4 v5, s[98:99] offset:0 sc1
    global_load_lds_dwordx4 v5, s[98:99] offset:1024 sc1
    global_load_lds_dwordx4 v5, s[98:99] offset:2048 sc1
    global_load_lds_dwordx4 v5, s[98:99] offset:3072 sc1
    s_waitcnt vmcnt(0)
    s_barrier
    s_branch L_ATT0
L_POA_S:
    s_mov_b32 s87, 0
L_POA_L:
    buffer_load_dword v21, v16, s[16:19], s47 offen sc1
    s_add_u32 s87, s87, 1
    s_waitcnt vmcnt(0)
    v_cmp_ne_u32 vcc, s60, v21
    s_cmp_lt_u32 s87, 0x40000
    s_cbranch_scc0 L_POA_R
    s_nop 2
    s_and_b32 vcc_hi, vcc_lo, -1
    s_cbranch_scc1 L_POA_L
    s_branch L_POA_R
L_END:
    s_endpgm
.section .rodata,"a"
.p2align 6
.amdhsa_kernel gated_mix__softmax_full_mha__sliding_local_dilated__prompt_kernel
  .amdhsa_next_free_vgpr 512
  .amdhsa_next_free_sgpr 102
  .amdhsa_accum_offset 256
  .amdhsa_group_segment_fixed_size 0
  .amdhsa_kernarg_size 80
  .amdhsa_user_sgpr_count 2
  .amdhsa_user_sgpr_kernarg_segment_ptr 1
  .amdhsa_system_sgpr_workgroup_id_x 1
.end_amdhsa_kernel
```
